```python
import torch

def _softmax(x, axis=-1):
    return torch.softmax(x, dim=axis)
def _gelu(x):
    return torch.nn.functional.gelu(x, approximate="tanh")
def _silu(x):
    return torch.nn.functional.silu(x)
def _sigmoid(x):
    return torch.sigmoid(x)
def _layernorm(x, axis=-1, eps=1e-5):
    m = x.mean(dim=axis, keepdim=True)
    v = x.var(dim=axis, keepdim=True, unbiased=False)
    return (x - m) / torch.sqrt(v + eps)
def _scatter_add(tgt, idx, src, axis=0):
    return tgt.clone().index_add_(axis, idx, src)
def _segment_sum(src, seg, n):
    out = torch.zeros((n,) + src.shape[1:], dtype=src.dtype)
    return out.index_add_(0, seg, src)
def _pad(x, pw):
    flat = tuple(v for pair in reversed(pw) for v in pair)
    return torch.nn.functional.pad(x, flat)

kernel_name = 'parallel_sum__compressed_kv_cla__glu_gated_geglu__prompt'

def setup_inputs():

    _w = (lambda a: (lambda t: t.to(torch.bfloat16) if t.is_floating_point() else t)(torch.as_tensor(a)))
    def _A_setup():
        B, H, Sq, Sk, D, M = 1, 32, 2048, 2048, 128, 512
        Dc = 4 * D
        return {
            "x": _w((lambda *s: torch.randn(*s, dtype=torch.bfloat16) * 0.05)(B, Sq, M)),
            "c_kv": _w((lambda *s: torch.randn(*s, dtype=torch.bfloat16) * 0.4)(B, Sk, Dc)),
            "w_q": _w((lambda *s: torch.randn(*s, dtype=torch.bfloat16) * 3.2)(M, H, D) * (M ** -0.5)),
            "w_uk": _w((lambda *s: torch.randn(*s, dtype=torch.bfloat16) * 3.2)(Dc, H, D) * (Dc ** -0.5)),
            "w_uv": _w((lambda *s: torch.randn(*s, dtype=torch.bfloat16) * 0.4)(Dc, H, D) * (Dc ** -0.5)),
            "w_o": _w((lambda *s: torch.randn(*s, dtype=torch.bfloat16) * 0.4)(H, D, M) * ((H * D) ** -0.5)),
        }
    _A_in = _A_setup()

    def _B_setup():
        B, S, Dm, Df = 1, 2048, 512, 1376
        return {
            "x": _w((lambda *s: torch.randn(*s, dtype=torch.bfloat16) * 0.05)(B, S, Dm)),
            "w_gate": _w((lambda *s: torch.randn(*s, dtype=torch.bfloat16) * 0.4)(Dm, Df) * (Dm ** -0.5)),
            "w_up": _w((lambda *s: torch.randn(*s, dtype=torch.bfloat16) * 0.4)(Dm, Df) * (Dm ** -0.5)),
            "w_down": _w((lambda *s: torch.randn(*s, dtype=torch.bfloat16) * 0.4)(Df, Dm) * (Df ** -0.5)),
        }
    _B_in = _B_setup()

    return {
        "A_x": _A_in["x"],
        "A_c_kv": _A_in["c_kv"],
        "A_w_q": _A_in["w_q"],
        "A_w_uk": _A_in["w_uk"],
        "A_w_uv": _A_in["w_uv"],
        "A_w_o": _A_in["w_o"],
        "B_x": _B_in["x"],
        "B_w_gate": _B_in["w_gate"],
        "B_w_up": _B_in["w_up"],
        "B_w_down": _B_in["w_down"],
    }

def reference(A_x, A_c_kv, A_w_q, A_w_uk, A_w_uv, A_w_o, B_x, B_w_gate, B_w_up, B_w_down):
    def _A_ref(x, c_kv, w_q, w_uk, w_uv, w_o):
        B, Sq, M = x.shape[0], x.shape[1], x.shape[2]
        Sk = c_kv.shape[1]
        H, D = w_q.shape[1], w_q.shape[2]
        q = torch.einsum("bqm,mhd->bhqd", x, w_q)
        k = torch.einsum("bkc,chd->bhkd", c_kv, w_uk)
        v = torch.einsum("bkc,chd->bhkd", c_kv, w_uv)
        scores = torch.einsum("bhqd,bhkd->bhqk", q, k) * (D ** -0.5)
        off = Sk - Sq
        qi = torch.arange(Sq)[:, None]
        kj = torch.arange(Sk)[None, :]
        cmask = kj <= (qi + off)
        scores = torch.where(cmask[None, None], scores, -1e9)
        p = _softmax(scores, axis=-1)
        ctx = torch.einsum("bhqk,bhkd->bhqd", p, v)
        return torch.einsum("bhqd,hdm->bqm", ctx, w_o)

    def _B_ref(x, w_gate, w_up, w_down):
        g = torch.einsum("bsd,df->bsf", x, w_gate)
        u = torch.einsum("bsd,df->bsf", x, w_up)
        h = _gelu(g) * u
        return torch.einsum("bsf,fd->bsd", h, w_down)

    x = A_x
    xn = _layernorm(x, axis=-1)
    return x + _A_ref(xn, A_c_kv, A_w_q, A_w_uk, A_w_uv, A_w_o) + _B_ref(xn, B_w_gate, B_w_up, B_w_down)
```

```asm
; @launch grid=(256,1,1) block=(256,1,1) lds=163840
.amdgcn_target "amdgcn-amd-amdhsa--gfx950"
.text
.globl parallel_sum__compressed_kv_cla__glu_gated_geglu__prompt_kernel
.p2align 8
.type parallel_sum__compressed_kv_cla__glu_gated_geglu__prompt_kernel,@function
parallel_sum__compressed_kv_cla__glu_gated_geglu__prompt_kernel:
s_cmp_ge_u32 s2, 256
s_cbranch_scc1 END_parallel_sum__compressed_kv_cla__glu_gated_geglu__prompt_kernel
s_load_dwordx4 s[4:7], s[0:1], 0
s_load_dwordx4 s[8:11], s[0:1], 24
s_load_dwordx4 s[96:99], s[0:1], 88
s_load_dwordx2 s[12:13], s[0:1], 16
s_load_dwordx4 s[16:19], s[0:1], 56
v_lshrrev_b32 v2, 6, v0
v_and_b32 v1, 63, v0
v_readfirstlane_b32 s20, v2
s_and_b32 s21, s2, 7
s_lshl_b32 s21, s21, 2
s_lshr_b32 s22, s2, 3
s_and_b32 s23, s22, 3
s_or_b32 s21, s21, s23
s_lshr_b32 s22, s22, 2
s_getpc_b64 s[14:15]
PC0:
s_lshr_b32 s3, s2, 3
s_lshl_b32 s3, s3, 2
s_add_u32 s3, s3, s20
s_mul_i32 s3, s3, 5
v_min_u32 v2, 4, v1
v_add_u32 v2, s3, v2
v_lshlrev_b32 v2, 7, v2
s_mov_b32 s3, CODE_END-PC0-4
v_min_u32 v2, s3, v2
global_load_dword v63, v2, s[14:15]
s_waitcnt lgkmcnt(0)
s_mov_b32 s24, s4
s_mov_b32 s25, s5
s_mov_b32 s26, 2097152
s_mov_b32 s27, 0x20000
s_mov_b32 s28, s6
s_mov_b32 s29, s7
s_mov_b32 s30, 2097152
s_mov_b32 s31, 0x20000
s_mov_b32 s32, s8
s_mov_b32 s33, s9
s_mov_b32 s34, 4194304
s_mov_b32 s35, 0x20000
s_mov_b32 s36, s10
s_mov_b32 s37, s11
s_mov_b32 s38, 4194304
s_mov_b32 s39, 0x20000
s_mov_b64 s[100:101], s[96:97]
s_mov_b64 s[96:97], s[98:99]
s_mov_b64 s[98:99], s[100:101]
s_lshl_b32 s50, s2, 3
s_lshl_b32 s51, s20, 1
s_add_u32 s50, s50, s51
s_lshl_b32 s51, s50, 10
v_and_b32 v2, 1, v1
v_lshlrev_b32 v2, 10, v2
v_lshrrev_b32 v3, 1, v1
v_lshl_add_u32 v2, v3, 4, v2
v_lshrrev_b32 v3, 4, v1
v_and_b32 v8, 15, v1
v_add_u32 v9, 0, v3
v_xor_b32 v9, v9, v8
v_lshlrev_b32 v9, 4, v9
v_add_u32 v4, 0, v3
v_lshl_add_u32 v4, v4, 10, v9
v_add_u32 v9, 4, v3
v_xor_b32 v9, v9, v8
v_lshlrev_b32 v9, 4, v9
v_add_u32 v5, 4, v3
v_lshl_add_u32 v5, v5, 10, v9
v_add_u32 v9, 8, v3
v_xor_b32 v9, v9, v8
v_lshlrev_b32 v9, 4, v9
v_add_u32 v6, 16, v3
v_lshl_add_u32 v6, v6, 10, v9
v_add_u32 v9, 12, v3
v_xor_b32 v9, v9, v8
v_lshlrev_b32 v9, 4, v9
v_add_u32 v7, 20, v3
v_lshl_add_u32 v7, v7, 10, v9
s_lshl_b32 s52, s22, 18
s_lshl_b32 s53, s20, 16
s_add_u32 s52, s52, s53
s_mul_i32 s53, s20, 24576
v_lshrrev_b32 v10, 5, v1
v_lshlrev_b32 v10, 2, v10
v_bfe_u32 v9, v1, 2, 2
v_add_u32 v10, v10, v9
s_lshl_b32 s23, s20, 3
v_add_u32 v10, s23, v10
s_mov_b32 s23, 8192
v_mul_lo_u32 v10, v10, s23
v_bfe_u32 v9, v1, 4, 1
v_lshl_add_u32 v10, v9, 6, v10
s_and_b32 s23, s20, 1
s_lshl_b32 s23, s23, 1
v_and_b32 v9, 3, v1
v_xor_b32 v9, s23, v9
v_lshl_add_u32 v10, v9, 4, v10
s_lshl_b32 s55, s21, 8
s_lshl_b32 s56, s20, 10
s_add_u32 s56, s56, 98304
s_add_u32 m0, s53, 0
s_add_u32 s54, s52, 0
buffer_load_dwordx4 v4, s[28:31], s54 offen lds
s_add_u32 m0, s53, 1024
s_add_u32 s54, s52, 0
buffer_load_dwordx4 v5, s[28:31], s54 offen lds
s_add_u32 m0, s53, 2048
s_add_u32 s54, s52, 0
buffer_load_dwordx4 v6, s[28:31], s54 offen lds
s_add_u32 m0, s53, 3072
s_add_u32 s54, s52, 0
buffer_load_dwordx4 v7, s[28:31], s54 offen lds
s_add_u32 m0, s53, 4096
s_add_u32 s54, s52, 8192
buffer_load_dwordx4 v4, s[28:31], s54 offen lds
s_add_u32 m0, s53, 5120
s_add_u32 s54, s52, 8192
buffer_load_dwordx4 v5, s[28:31], s54 offen lds
s_add_u32 m0, s53, 6144
s_add_u32 s54, s52, 8192
buffer_load_dwordx4 v6, s[28:31], s54 offen lds
s_add_u32 m0, s53, 7168
s_add_u32 s54, s52, 8192
buffer_load_dwordx4 v7, s[28:31], s54 offen lds
s_add_u32 m0, s56, 0
s_add_u32 s57, s55, 0
buffer_load_dwordx4 v10, s[32:35], s57 offen lds
s_add_u32 m0, s56, 4096
s_add_u32 s57, s55, 128
buffer_load_dwordx4 v10, s[32:35], s57 offen lds
s_add_u32 m0, s56, 8192
s_add_u32 s57, s55, 262144
buffer_load_dwordx4 v10, s[32:35], s57 offen lds
s_add_u32 m0, s56, 12288
s_add_u32 s57, s55, 262272
buffer_load_dwordx4 v10, s[32:35], s57 offen lds
s_add_u32 m0, s53, 8192
s_add_u32 s54, s52, 32768
buffer_load_dwordx4 v4, s[28:31], s54 offen lds
s_add_u32 m0, s53, 9216
s_add_u32 s54, s52, 32768
buffer_load_dwordx4 v5, s[28:31], s54 offen lds
s_add_u32 m0, s53, 10240
s_add_u32 s54, s52, 32768
buffer_load_dwordx4 v6, s[28:31], s54 offen lds
s_add_u32 m0, s53, 11264
s_add_u32 s54, s52, 32768
buffer_load_dwordx4 v7, s[28:31], s54 offen lds
s_add_u32 m0, s53, 12288
s_add_u32 s54, s52, 40960
buffer_load_dwordx4 v4, s[28:31], s54 offen lds
s_add_u32 m0, s53, 13312
s_add_u32 s54, s52, 40960
buffer_load_dwordx4 v5, s[28:31], s54 offen lds
s_add_u32 m0, s53, 14336
s_add_u32 s54, s52, 40960
buffer_load_dwordx4 v6, s[28:31], s54 offen lds
s_add_u32 m0, s53, 15360
s_add_u32 s54, s52, 40960
buffer_load_dwordx4 v7, s[28:31], s54 offen lds
s_add_u32 m0, s56, 16384
s_add_u32 s57, s55, 524288
buffer_load_dwordx4 v10, s[32:35], s57 offen lds
s_add_u32 m0, s56, 20480
s_add_u32 s57, s55, 524416
buffer_load_dwordx4 v10, s[32:35], s57 offen lds
s_add_u32 m0, s56, 24576
s_add_u32 s57, s55, 786432
buffer_load_dwordx4 v10, s[32:35], s57 offen lds
s_add_u32 m0, s56, 28672
s_add_u32 s57, s55, 786560
buffer_load_dwordx4 v10, s[32:35], s57 offen lds
s_add_u32 m0, s53, 16384
s_add_u32 s54, s52, 256
buffer_load_dwordx4 v4, s[28:31], s54 offen lds
s_add_u32 m0, s53, 17408
s_add_u32 s54, s52, 256
buffer_load_dwordx4 v5, s[28:31], s54 offen lds
s_add_u32 m0, s53, 18432
s_add_u32 s54, s52, 256
buffer_load_dwordx4 v6, s[28:31], s54 offen lds
s_add_u32 m0, s53, 19456
s_add_u32 s54, s52, 256
buffer_load_dwordx4 v7, s[28:31], s54 offen lds
s_add_u32 m0, s53, 20480
s_add_u32 s54, s52, 8448
buffer_load_dwordx4 v4, s[28:31], s54 offen lds
s_add_u32 m0, s53, 21504
s_add_u32 s54, s52, 8448
buffer_load_dwordx4 v5, s[28:31], s54 offen lds
s_add_u32 m0, s53, 22528
s_add_u32 s54, s52, 8448
buffer_load_dwordx4 v6, s[28:31], s54 offen lds
s_add_u32 m0, s53, 23552
s_add_u32 s54, s52, 8448
buffer_load_dwordx4 v7, s[28:31], s54 offen lds
buffer_load_dwordx4 v[192:195], v2, s[24:27], s51 offen
buffer_load_dwordx4 v[196:199], v2, s[24:27], s51 offen offset:512
s_add_u32 m0, s56, 32768
s_add_u32 s57, s55, 1048576
buffer_load_dwordx4 v10, s[32:35], s57 offen lds
s_add_u32 m0, s56, 36864
s_add_u32 s57, s55, 1048704
buffer_load_dwordx4 v10, s[32:35], s57 offen lds
s_add_u32 m0, s56, 40960
s_add_u32 s57, s55, 1310720
buffer_load_dwordx4 v10, s[32:35], s57 offen lds
s_add_u32 m0, s56, 45056
s_add_u32 s57, s55, 1310848
buffer_load_dwordx4 v10, s[32:35], s57 offen lds
s_mov_b32 s4, s12
s_mov_b32 s5, s13
s_mov_b32 s6, 4194304
s_mov_b32 s7, 0x20000
s_mov_b32 s8, s16
s_mov_b32 s9, s17
s_mov_b32 s10, 1409024
s_mov_b32 s11, 0x20000
s_mov_b32 s12, s18
s_mov_b32 s13, s19
s_mov_b32 s14, 1409024
s_mov_b32 s15, 0x20000
s_mov_b32 s40, s96
s_mov_b32 s41, s97
s_mov_b32 s42, 2097152
s_mov_b32 s43, 0x20000
s_add_u32 s44, s96, 2097152
s_addc_u32 s45, s97, 0
s_mov_b32 s46, 33554432
s_mov_b32 s47, 0x20000
s_mul_i32 s67, s21, 96
s_lshl_b32 s54, s21, 6
s_add_u32 s54, s54, 704
s_cmp_lt_u32 s21, 22
s_cselect_b32 s67, s67, s54
s_cselect_b32 s75, 0, 0x7000000
s_lshl_b32 s3, s22, 2
s_add_u32 s3, s3, s20
s_lshl_b32 s3, s3, 4
v_lshrrev_b32 v58, 2, v1
v_add_u32 v58, s3, v58
v_mul_u32_u24 v59, 2752, v58
v_bfe_u32 v57, v1, 1, 1
v_lshlrev_b32 v58, 13, v58
v_lshl_add_u32 v58, v57, 7, v58
v_mul_u32_u24 v57, 92, v57
v_add_u32 v59, v59, v57
s_add_u32 s94, s96, 104857600
s_addc_u32 s95, s97, 0
s_lshl_b32 s66, s22, 8
s_lshl_b32 s3, s21, 2
s_add_u32 s66, s66, s3
v_mov_b32 v60, s66
v_mov_b32 v61, 0
s_lshl_b32 s3, s2, 4
s_add_u32 s3, s3, 0x1000
v_mov_b32 v53, s3
v_mov_b32 v48, 0
v_mov_b32 v49, 0
v_mov_b32 v50, 0
v_mov_b32 v51, 0
s_cmp_lg_u32 s20, 0
s_cbranch_scc1 W0_clr
s_mov_b64 exec, 1
global_store_dwordx4 v53, v[48:51], s[94:95] sc1
global_store_dword v60, v61, s[94:95] sc1
global_store_dword v60, v61, s[94:95] offset:128 sc1
s_mov_b64 exec, -1
W0_clr:
v_lshrrev_b32 v9, 4, v1
v_lshlrev_b32 v11, 10, v9
v_and_b32 v9, 1, v9
v_lshl_add_u32 v11, v9, 5, v11
v_bfe_u32 v9, v1, 2, 2
v_lshl_add_u32 v11, v9, 6, v11
v_and_b32 v9, 3, v1
v_lshl_add_u32 v11, v9, 3, v11
v_add_u32 v11, 98304, v11
v_xor_b32 v12, 32, v11
v_lshlrev_b32 v13, 8, v8
v_xor_b32 v9, v3, v8
v_lshl_add_u32 v13, v9, 4, v13
v_add_u32 v13, s53, v13
v_xor_b32 v14, 64, v13
v_xor_b32 v15, 128, v13
v_xor_b32 v9, 192, v13
v_lshrrev_b32 v72, 1, v1
v_and_b32 v73, 1, v1
v_lshlrev_b32 v73, 4, v73
v_lshl_add_u32 v54, v72, 7, v73
s_lshl_b32 s3, s20, 5
s_add_u32 s3, s3, 114688
v_add_u32 v54, s3, v54
s_lshl_b32 s3, s20, 11
s_add_u32 s3, s3, 114688
v_lshlrev_b32 v55, 4, v1
v_add_u32 v55, s3, v55
v_lshrrev_b32 v72, 3, v1
v_and_b32 v73, 7, v1
v_lshlrev_b32 v73, 4, v73
v_lshl_add_u32 v56, v72, 8, v73
s_lshr_b32 s51, s2, 1
s_lshl_b32 s51, s51, 14
s_and_b32 s50, s2, 1
s_lshl_b32 s50, s50, 7
s_add_u32 s51, s51, s50
s_lshl_b32 s50, s20, 12
s_add_u32 s51, s51, s50
v_add_u32 v56, s51, v56
v_lshrrev_b32 v72, 5, v1
v_bfe_u32 v73, v1, 4, 1
v_lshlrev_b32 v73, 9, v73
v_lshl_add_u32 v2, v72, 10, v73
v_lshl_add_u32 v3, v72, 12, v73
v_lshl_add_u32 v3, v8, 4, v3
v_lshrrev_b32 v72, 3, v8
v_lshl_add_u32 v2, v72, 8, v2
v_and_b32 v72, 7, v8
v_lshl_add_u32 v2, v72, 4, v2
s_lshl_b32 s58, s21, 20
s_lshl_b32 s59, s22, 17
s_add_u32 s58, s58, s59
s_lshl_b32 s59, s20, 15
s_add_u32 s58, s58, s59
s_add_u32 s48, s96, 44040192
s_addc_u32 s49, s97, 0
s_mov_b32 s50, 22413312
s_mov_b32 s51, 0x20000
s_waitcnt vmcnt(30)
ds_read_b128 a[0:3], v13 offset:0
ds_read_b128 a[64:67], v13 offset:4096
ds_read_b128 a[4:7], v14 offset:0
ds_read_b128 a[68:71], v14 offset:4096
ds_read_b128 a[8:11], v15 offset:0
ds_read_b128 a[72:75], v15 offset:4096
ds_read_b128 a[12:15], v9 offset:0
ds_read_b128 a[76:79], v9 offset:4096
s_waitcnt vmcnt(18)
ds_read_b128 a[128:131], v13 offset:8192
ds_read_b128 a[192:195], v13 offset:12288
ds_read_b128 a[132:135], v14 offset:8192
ds_read_b128 a[196:199], v14 offset:12288
ds_read_b128 a[136:139], v15 offset:8192
ds_read_b128 a[200:203], v15 offset:12288
ds_read_b128 a[140:143], v9 offset:8192
ds_read_b128 a[204:207], v9 offset:12288
s_barrier
ds_read_b64_tr_b16 v[16:17], v11 offset:0
ds_read_b64_tr_b16 v[18:19], v11 offset:512
ds_read_b64_tr_b16 v[20:21], v12 offset:0
ds_read_b64_tr_b16 v[22:23], v12 offset:512
ds_read_b64_tr_b16 v[24:25], v11 offset:256
ds_read_b64_tr_b16 v[26:27], v11 offset:768
ds_read_b64_tr_b16 v[28:29], v12 offset:256
ds_read_b64_tr_b16 v[30:31], v12 offset:768
s_waitcnt lgkmcnt(6)
v_mfma_f32_16x16x32_bf16 v[64:67], v[16:19], a[0:3], 0
ds_read_b64_tr_b16 v[32:33], v11 offset:4096
s_add_u32 m0, s53, 0
s_add_u32 s54, s52, 33024
buffer_load_dwordx4 v4, s[28:31], s54 offen lds
v_mfma_f32_16x16x32_bf16 v[68:71], v[16:19], a[64:67], 0
v_mfma_f32_16x16x32_bf16 v[72:75], v[16:19], a[128:131], 0
s_add_u32 m0, s53, 1024
s_add_u32 s54, s52, 33024
buffer_load_dwordx4 v5, s[28:31], s54 offen lds
ds_read_b64_tr_b16 v[34:35], v11 offset:4608
v_mfma_f32_16x16x32_bf16 v[76:79], v[16:19], a[192:195], 0
s_add_u32 m0, s53, 2048
s_add_u32 s54, s52, 33024
buffer_load_dwordx4 v6, s[28:31], s54 offen lds
s_waitcnt lgkmcnt(6)
v_mfma_f32_16x16x32_bf16 v[80:83], v[20:23], a[0:3], 0
s_waitcnt vmcnt(9)
ds_read_b64_tr_b16 v[36:37], v12 offset:4096
v_mfma_f32_16x16x32_bf16 v[84:87], v[20:23], a[64:67], 0
s_add_u32 m0, s53, 3072
s_add_u32 s54, s52, 33024
buffer_load_dwordx4 v7, s[28:31], s54 offen lds
v_mfma_f32_16x16x32_bf16 v[88:91], v[20:23], a[128:131], 0
ds_read_b64_tr_b16 v[38:39], v12 offset:4608
ds_read_b128 a[16:19], v13 offset:16384
s_add_u32 m0, s53, 4096
s_add_u32 s54, s52, 41216
buffer_load_dwordx4 v4, s[28:31], s54 offen lds
v_mfma_f32_16x16x32_bf16 v[92:95], v[20:23], a[192:195], 0
s_waitcnt lgkmcnt(7)
v_mfma_f32_16x16x32_bf16 v[96:99], v[24:27], a[0:3], 0
s_add_u32 m0, s53, 5120
s_add_u32 s54, s52, 41216
buffer_load_dwordx4 v5, s[28:31], s54 offen lds
ds_read_b64_tr_b16 v[40:41], v11 offset:4352
v_mfma_f32_16x16x32_bf16 v[100:103], v[24:27], a[64:67], 0
ds_read_b128 a[80:83], v13 offset:20480
s_add_u32 m0, s53, 6144
s_add_u32 s54, s52, 41216
buffer_load_dwordx4 v6, s[28:31], s54 offen lds
v_mfma_f32_16x16x32_bf16 v[104:107], v[24:27], a[128:131], 0
ds_read_b64_tr_b16 v[42:43], v11 offset:4864
v_mfma_f32_16x16x32_bf16 v[108:111], v[24:27], a[192:195], 0
s_add_u32 m0, s53, 7168
s_add_u32 s54, s52, 41216
buffer_load_dwordx4 v7, s[28:31], s54 offen lds
s_waitcnt lgkmcnt(8)
v_mfma_f32_16x16x32_bf16 v[112:115], v[28:31], a[0:3], 0
ds_read_b64_tr_b16 v[44:45], v12 offset:4352
ds_read_b128 a[20:23], v14 offset:16384
v_mfma_f32_16x16x32_bf16 v[116:119], v[28:31], a[64:67], 0
s_add_u32 m0, s53, 8192
s_add_u32 s54, s52, 512
buffer_load_dwordx4 v4, s[28:31], s54 offen lds
v_mfma_f32_16x16x32_bf16 v[120:123], v[28:31], a[128:131], 0
ds_read_b64_tr_b16 v[46:47], v12 offset:4864
v_mfma_f32_16x16x32_bf16 v[124:127], v[28:31], a[192:195], 0
s_add_u32 m0, s53, 9216
s_add_u32 s54, s52, 512
buffer_load_dwordx4 v5, s[28:31], s54 offen lds
ds_read_b128 a[84:87], v14 offset:20480
s_waitcnt lgkmcnt(10)
v_mfma_f32_16x16x32_bf16 v[128:131], v[32:35], a[0:3], 0
ds_read_b64_tr_b16 v[16:17], v11 offset:8192
s_waitcnt vmcnt(15)
v_lshlrev_b32 v200, 16, v192
v_mfma_f32_16x16x32_bf16 v[132:135], v[32:35], a[64:67], 0
s_add_u32 m0, s53, 10240
s_add_u32 s54, s52, 512
buffer_load_dwordx4 v6, s[28:31], s54 offen lds
v_and_b32 v201, 0xffff0000, v192
v_mfma_f32_16x16x32_bf16 v[136:139], v[32:35], a[128:131], 0
v_lshlrev_b32 v202, 16, v193
ds_read_b64_tr_b16 v[18:19], v11 offset:8704
ds_read_b128 a[24:27], v15 offset:16384
v_and_b32 v203, 0xffff0000, v193
v_mfma_f32_16x16x32_bf16 v[140:143], v[32:35], a[192:195], 0
s_add_u32 m0, s53, 11264
s_add_u32 s54, s52, 512
buffer_load_dwordx4 v7, s[28:31], s54 offen lds
v_lshlrev_b32 v204, 16, v194
s_waitcnt lgkmcnt(11)
v_mfma_f32_16x16x32_bf16 v[144:147], v[36:39], a[0:3], 0
ds_read_b64_tr_b16 v[20:21], v12 offset:8192
v_and_b32 v205, 0xffff0000, v194
v_mfma_f32_16x16x32_bf16 v[148:151], v[36:39], a[64:67], 0
s_add_u32 m0, s53, 12288
s_add_u32 s54, s52, 8704
buffer_load_dwordx4 v4, s[28:31], s54 offen lds
v_lshlrev_b32 v206, 16, v195
ds_read_b128 a[88:91], v15 offset:20480
v_mfma_f32_16x16x32_bf16 v[152:155], v[36:39], a[128:131], 0
ds_read_b64_tr_b16 v[22:23], v12 offset:8704
v_and_b32 v207, 0xffff0000, v195
s_waitcnt vmcnt(17)
v_lshlrev_b32 v208, 16, v196
v_mfma_f32_16x16x32_bf16 v[156:159], v[36:39], a[192:195], 0
s_add_u32 m0, s53, 13312
s_add_u32 s54, s52, 8704
buffer_load_dwordx4 v5, s[28:31], s54 offen lds
v_and_b32 v209, 0xffff0000, v196
s_waitcnt lgkmcnt(10)
v_mfma_f32_16x16x32_bf16 v[160:163], v[40:43], a[0:3], 0
ds_read_b64_tr_b16 v[24:25], v11 offset:8448
ds_read_b128 a[28:31], v9 offset:16384
v_lshlrev_b32 v210, 16, v197
v_mfma_f32_16x16x32_bf16 v[164:167], v[40:43], a[64:67], 0
s_add_u32 m0, s53, 14336
s_add_u32 s54, s52, 8704
buffer_load_dwordx4 v6, s[28:31], s54 offen lds
v_and_b32 v211, 0xffff0000, v197
v_mfma_f32_16x16x32_bf16 v[168:171], v[40:43], a[128:131], 0
ds_read_b64_tr_b16 v[26:27], v11 offset:8960
v_lshlrev_b32 v212, 16, v198
v_mfma_f32_16x16x32_bf16 v[172:175], v[40:43], a[192:195], 0
s_add_u32 m0, s53, 15360
s_add_u32 s54, s52, 8704
buffer_load_dwordx4 v7, s[28:31], s54 offen lds
v_and_b32 v213, 0xffff0000, v198
ds_read_b128 a[92:95], v9 offset:20480
v_lshlrev_b32 v214, 16, v199
s_waitcnt lgkmcnt(11)
v_mfma_f32_16x16x32_bf16 v[176:179], v[44:47], a[0:3], 0
ds_read_b64_tr_b16 v[28:29], v12 offset:8448
v_and_b32 v215, 0xffff0000, v199
v_mfma_f32_16x16x32_bf16 v[180:183], v[44:47], a[64:67], 0
v_add_f32 v216, v200, v201
v_mfma_f32_16x16x32_bf16 v[184:187], v[44:47], a[128:131], 0
ds_read_b64_tr_b16 v[30:31], v12 offset:8960
v_add_f32 v216, v216, v202
v_mfma_f32_16x16x32_bf16 v[188:191], v[44:47], a[192:195], 0
v_add_f32 v216, v216, v203
s_waitcnt lgkmcnt(10)
v_mfma_f32_16x16x32_bf16 v[64:67], v[16:19], a[4:7], v[64:67]
v_add_f32 v216, v216, v204
ds_read_b64_tr_b16 v[32:33], v11 offset:12288
v_add_f32 v216, v216, v205
v_mfma_f32_16x16x32_bf16 v[68:71], v[16:19], a[68:71], v[68:71]
v_add_f32 v216, v216, v206
v_mfma_f32_16x16x32_bf16 v[72:75], v[16:19], a[132:135], v[72:75]
ds_read_b64_tr_b16 v[34:35], v11 offset:12800
v_add_f32 v216, v216, v207
v_mfma_f32_16x16x32_bf16 v[76:79], v[16:19], a[196:199], v[76:79]
v_add_f32 v216, v216, v208
s_waitcnt lgkmcnt(8)
v_mfma_f32_16x16x32_bf16 v[80:83], v[20:23], a[4:7], v[80:83]
ds_read_b64_tr_b16 v[36:37], v12 offset:12288
v_add_f32 v216, v216, v209
v_add_f32 v216, v216, v210
v_mfma_f32_16x16x32_bf16 v[84:87], v[20:23], a[68:71], v[84:87]
v_add_f32 v216, v216, v211
v_mfma_f32_16x16x32_bf16 v[88:91], v[20:23], a[132:135], v[88:91]
s_waitcnt lgkmcnt(2)
ds_read_b64_tr_b16 v[38:39], v12 offset:12800
v_add_f32 v216, v216, v212
v_mfma_f32_16x16x32_bf16 v[92:95], v[20:23], a[196:199], v[92:95]
s_add_u32 m0, s53, 16384
s_add_u32 s54, s52, 33280
buffer_load_dwordx4 v4, s[28:31], s54 offen lds
v_add_f32 v216, v216, v213
v_mfma_f32_16x16x32_bf16 v[96:99], v[24:27], a[4:7], v[96:99]
ds_read_b64_tr_b16 v[40:41], v11 offset:12544
v_add_f32 v216, v216, v214
v_mfma_f32_16x16x32_bf16 v[100:103], v[24:27], a[68:71], v[100:103]
v_add_f32 v216, v216, v215
s_nop 1
v_add_f32_dpp v216, v216, v216 quad_perm:[2,3,0,1] row_mask:0xf bank_mask:0xf
v_mfma_f32_16x16x32_bf16 v[104:107], v[24:27], a[132:135], v[104:107]
s_add_u32 m0, s53, 17408
s_add_u32 s54, s52, 33280
buffer_load_dwordx4 v5, s[28:31], s54 offen lds
ds_read_b64_tr_b16 v[42:43], v11 offset:13056
v_add_f32_dpp v216, v216, v216 row_ror:4 row_mask:0xf bank_mask:0xf
v_mfma_f32_16x16x32_bf16 v[108:111], v[24:27], a[196:199], v[108:111]
s_nop 0
v_add_f32_dpp v216, v216, v216 row_ror:8 row_mask:0xf bank_mask:0xf
v_mfma_f32_16x16x32_bf16 v[112:115], v[28:31], a[4:7], v[112:115]
ds_read_b64_tr_b16 v[44:45], v12 offset:12544
v_mov_b32 v217, v216
v_mfma_f32_16x16x32_bf16 v[116:119], v[28:31], a[68:71], v[116:119]
s_add_u32 m0, s53, 18432
s_add_u32 s54, s52, 33280
buffer_load_dwordx4 v6, s[28:31], s54 offen lds
v_permlane16_swap_b32 v216, v217
v_mfma_f32_16x16x32_bf16 v[120:123], v[28:31], a[132:135], v[120:123]
v_add_f32 v216, v216, v217
ds_read_b64_tr_b16 v[46:47], v12 offset:13056
v_mov_b32 v217, v216
v_mfma_f32_16x16x32_bf16 v[124:127], v[28:31], a[196:199], v[124:127]
s_barrier
v_permlane32_swap_b32 v216, v217
s_waitcnt lgkmcnt(6)
v_mfma_f32_16x16x32_bf16 v[128:131], v[32:35], a[4:7], v[128:131]
s_add_u32 m0, s53, 19456
s_add_u32 s54, s52, 33280
buffer_load_dwordx4 v7, s[28:31], s54 offen lds
ds_read_b64_tr_b16 v[16:17], v11 offset:16384
v_add_f32 v216, v216, v217
v_mfma_f32_16x16x32_bf16 v[132:135], v[32:35], a[68:71], v[132:135]
v_mul_f32 v218, 0x3b000000, v216
s_add_u32 m0, s56, 49152
s_add_u32 s57, s55, 1572864
buffer_load_dwordx4 v10, s[32:35], s57 offen lds
v_mfma_f32_16x16x32_bf16 v[136:139], v[32:35], a[132:135], v[136:139]
ds_read_b64_tr_b16 v[18:19], v11 offset:16896
v_sub_f32 v217, v200, v218
v_mul_f32 v216, v217, v217
v_mfma_f32_16x16x32_bf16 v[140:143], v[32:35], a[196:199], v[140:143]
s_add_u32 m0, s53, 20480
s_add_u32 s54, s52, 41472
buffer_load_dwordx4 v4, s[28:31], s54 offen lds
v_sub_f32 v217, v201, v218
s_waitcnt lgkmcnt(6)
v_mfma_f32_16x16x32_bf16 v[144:147], v[36:39], a[4:7], v[144:147]
ds_read_b64_tr_b16 v[20:21], v12 offset:16384
v_fmac_f32 v216, v217, v217
v_mfma_f32_16x16x32_bf16 v[148:151], v[36:39], a[68:71], v[148:151]
v_sub_f32 v217, v202, v218
v_mfma_f32_16x16x32_bf16 v[152:155], v[36:39], a[132:135], v[152:155]
s_add_u32 m0, s53, 21504
s_add_u32 s54, s52, 41472
buffer_load_dwordx4 v5, s[28:31], s54 offen lds
ds_read_b64_tr_b16 v[22:23], v12 offset:16896
v_fmac_f32 v216, v217, v217
s_add_u32 m0, s56, 53248
s_add_u32 s57, s55, 1572992
buffer_load_dwordx4 v10, s[32:35], s57 offen lds
v_mfma_f32_16x16x32_bf16 v[156:159], v[36:39], a[196:199], v[156:159]
v_sub_f32 v217, v203, v218
v_fmac_f32 v216, v217, v217
s_waitcnt lgkmcnt(6)
v_mfma_f32_16x16x32_bf16 v[160:163], v[40:43], a[4:7], v[160:163]
ds_read_b64_tr_b16 v[24:25], v11 offset:16640
v_sub_f32 v217, v204, v218
v_mfma_f32_16x16x32_bf16 v[164:167], v[40:43], a[68:71], v[164:167]
s_add_u32 m0, s53, 22528
s_add_u32 s54, s52, 41472
buffer_load_dwordx4 v6, s[28:31], s54 offen lds
v_fmac_f32 v216, v217, v217
v_mfma_f32_16x16x32_bf16 v[168:171], v[40:43], a[132:135], v[168:171]
ds_read_b64_tr_b16 v[26:27], v11 offset:17152
v_sub_f32 v217, v205, v218
v_mfma_f32_16x16x32_bf16 v[172:175], v[40:43], a[196:199], v[172:175]
v_fmac_f32 v216, v217, v217
s_add_u32 m0, s56, 57344
s_add_u32 s57, s55, 1835008
buffer_load_dwordx4 v10, s[32:35], s57 offen lds
s_waitcnt lgkmcnt(6)
v_mfma_f32_16x16x32_bf16 v[176:179], v[44:47], a[4:7], v[176:179]
s_add_u32 m0, s53, 23552
s_add_u32 s54, s52, 41472
buffer_load_dwordx4 v7, s[28:31], s54 offen lds
v_sub_f32 v217, v206, v218
ds_read_b64_tr_b16 v[28:29], v12 offset:16640
v_fmac_f32 v216, v217, v217
v_mfma_f32_16x16x32_bf16 v[180:183], v[44:47], a[68:71], v[180:183]
v_sub_f32 v217, v207, v218
v_mfma_f32_16x16x32_bf16 v[184:187], v[44:47], a[132:135], v[184:187]
ds_read_b64_tr_b16 v[30:31], v12 offset:17152
v_fmac_f32 v216, v217, v217
v_mfma_f32_16x16x32_bf16 v[188:191], v[44:47], a[196:199], v[188:191]
v_sub_f32 v217, v208, v218
s_waitcnt lgkmcnt(6)
v_mfma_f32_16x16x32_bf16 v[64:67], v[16:19], a[8:11], v[64:67]
ds_read_b64_tr_b16 v[32:33], v11 offset:20480
v_fmac_f32 v216, v217, v217
s_add_u32 m0, s56, 61440
s_add_u32 s57, s55, 1835136
buffer_load_dwordx4 v10, s[32:35], s57 offen lds
v_sub_f32 v217, v209, v218
v_mfma_f32_16x16x32_bf16 v[68:71], v[16:19], a[72:75], v[68:71]
v_fmac_f32 v216, v217, v217
v_mfma_f32_16x16x32_bf16 v[72:75], v[16:19], a[136:139], v[72:75]
ds_read_b64_tr_b16 v[34:35], v11 offset:20992
v_sub_f32 v217, v210, v218
v_mfma_f32_16x16x32_bf16 v[76:79], v[16:19], a[200:203], v[76:79]
v_fmac_f32 v216, v217, v217
s_waitcnt lgkmcnt(6)
v_mfma_f32_16x16x32_bf16 v[80:83], v[20:23], a[8:11], v[80:83]
s_waitcnt vmcnt(20)
ds_read_b64_tr_b16 v[36:37], v12 offset:20480
v_sub_f32 v217, v211, v218
v_mfma_f32_16x16x32_bf16 v[84:87], v[20:23], a[72:75], v[84:87]
v_fmac_f32 v216, v217, v217
v_sub_f32 v217, v212, v218
v_mfma_f32_16x16x32_bf16 v[88:91], v[20:23], a[136:139], v[88:91]
ds_read_b64_tr_b16 v[38:39], v12 offset:20992
ds_read_b128 a[144:147], v13 offset:0
v_fmac_f32 v216, v217, v217
v_mfma_f32_16x16x32_bf16 v[92:95], v[20:23], a[200:203], v[92:95]
v_sub_f32 v217, v213, v218
s_waitcnt lgkmcnt(7)
v_mfma_f32_16x16x32_bf16 v[96:99], v[24:27], a[8:11], v[96:99]
ds_read_b64_tr_b16 v[40:41], v11 offset:20736
v_fmac_f32 v216, v217, v217
v_mfma_f32_16x16x32_bf16 v[100:103], v[24:27], a[72:75], v[100:103]
v_sub_f32 v217, v214, v218
ds_read_b128 a[208:211], v13 offset:4096
v_mfma_f32_16x16x32_bf16 v[104:107], v[24:27], a[136:139], v[104:107]
v_fmac_f32 v216, v217, v217
ds_read_b64_tr_b16 v[42:43], v11 offset:21248
v_sub_f32 v217, v215, v218
v_mfma_f32_16x16x32_bf16 v[108:111], v[24:27], a[200:203], v[108:111]
v_fmac_f32 v216, v217, v217
s_waitcnt lgkmcnt(8)
v_mfma_f32_16x16x32_bf16 v[112:115], v[28:31], a[8:11], v[112:115]
ds_read_b64_tr_b16 v[44:45], v12 offset:20736
v_add_f32_dpp v216, v216, v216 quad_perm:[2,3,0,1] row_mask:0xf bank_mask:0xf
ds_read_b128 a[148:151], v14 offset:0
v_mfma_f32_16x16x32_bf16 v[116:119], v[28:31], a[72:75], v[116:119]
v_add_f32_dpp v216, v216, v216 row_ror:4 row_mask:0xf bank_mask:0xf
v_mfma_f32_16x16x32_bf16 v[120:123], v[28:31], a[136:139], v[120:123]
ds_read_b64_tr_b16 v[46:47], v12 offset:21248
v_add_f32_dpp v216, v216, v216 row_ror:8 row_mask:0xf bank_mask:0xf
v_mov_b32 v217, v216
v_mfma_f32_16x16x32_bf16 v[124:127], v[28:31], a[200:203], v[124:127]
ds_read_b128 a[212:215], v14 offset:4096
v_permlane16_swap_b32 v216, v217
s_waitcnt lgkmcnt(10)
v_mfma_f32_16x16x32_bf16 v[128:131], v[32:35], a[8:11], v[128:131]
ds_read_b64_tr_b16 v[16:17], v11 offset:24576
v_add_f32 v216, v216, v217
v_mfma_f32_16x16x32_bf16 v[132:135], v[32:35], a[72:75], v[132:135]
v_mov_b32 v217, v216
v_mfma_f32_16x16x32_bf16 v[136:139], v[32:35], a[136:139], v[136:139]
ds_read_b64_tr_b16 v[18:19], v11 offset:25088
v_permlane32_swap_b32 v216, v217
ds_read_b128 a[152:155], v15 offset:0
v_mfma_f32_16x16x32_bf16 v[140:143], v[32:35], a[200:203], v[140:143]
v_add_f32 v216, v216, v217
v_mul_f32 v216, 0x3b000000, v216
s_waitcnt lgkmcnt(11)
v_mfma_f32_16x16x32_bf16 v[144:147], v[36:39], a[8:11], v[144:147]
ds_read_b64_tr_b16 v[20:21], v12 offset:24576
v_cvt_pk_bf16_f32 v216, v216, v216
v_mfma_f32_16x16x32_bf16 v[148:151], v[36:39], a[72:75], v[148:151]
ds_read_b128 a[216:219], v15 offset:4096
v_lshlrev_b32 v216, 16, v216
v_mfma_f32_16x16x32_bf16 v[152:155], v[36:39], a[136:139], v[152:155]
ds_read_b64_tr_b16 v[22:23], v12 offset:25088
v_add_f32 v216, 0x3727c5ac, v216
v_mfma_f32_16x16x32_bf16 v[156:159], v[36:39], a[200:203], v[156:159]
v_cvt_pk_bf16_f32 v216, v216, v216
v_lshlrev_b32 v216, 16, v216
s_waitcnt lgkmcnt(10)
v_mfma_f32_16x16x32_bf16 v[160:163], v[40:43], a[8:11], v[160:163]
ds_read_b64_tr_b16 v[24:25], v11 offset:24832
ds_read_b128 a[156:159], v9 offset:0
v_sqrt_f32 v216, v216
v_mfma_f32_16x16x32_bf16 v[164:167], v[40:43], a[72:75], v[164:167]
v_cvt_pk_bf16_f32 v218, v218, v218
v_mfma_f32_16x16x32_bf16 v[168:171], v[40:43], a[136:139], v[168:171]
ds_read_b64_tr_b16 v[26:27], v11 offset:25344
v_lshlrev_b32 v218, 16, v218
v_mfma_f32_16x16x32_bf16 v[172:175], v[40:43], a[200:203], v[172:175]
v_cvt_pk_bf16_f32 v216, v216, v216
ds_read_b128 a[220:223], v9 offset:4096
s_waitcnt lgkmcnt(11)
v_mfma_f32_16x16x32_bf16 v[176:179], v[44:47], a[8:11], v[176:179]
ds_read_b64_tr_b16 v[28:29], v12 offset:24832
v_lshlrev_b32 v216, 16, v216
v_rcp_f32 v216, v216
v_mfma_f32_16x16x32_bf16 v[180:183], v[44:47], a[72:75], v[180:183]
v_sub_f32 v200, v200, v218
v_mfma_f32_16x16x32_bf16 v[184:187], v[44:47], a[136:139], v[184:187]
ds_read_b64_tr_b16 v[30:31], v12 offset:25344
v_sub_f32 v201, v201, v218
v_mfma_f32_16x16x32_bf16 v[188:191], v[44:47], a[200:203], v[188:191]
v_sub_f32 v202, v202, v218
s_waitcnt lgkmcnt(10)
v_mfma_f32_16x16x32_bf16 v[64:67], v[16:19], a[12:15], v[64:67]
ds_read_b64_tr_b16 v[32:33], v11 offset:28672
v_sub_f32 v203, v203, v218
v_mfma_f32_16x16x32_bf16 v[68:71], v[16:19], a[76:79], v[68:71]
v_sub_f32 v204, v204, v218
v_sub_f32 v205, v205, v218
v_mfma_f32_16x16x32_bf16 v[72:75], v[16:19], a[140:143], v[72:75]
ds_read_b64_tr_b16 v[34:35], v11 offset:29184
v_sub_f32 v206, v206, v218
v_mfma_f32_16x16x32_bf16 v[76:79], v[16:19], a[204:207], v[76:79]
v_sub_f32 v207, v207, v218
s_waitcnt lgkmcnt(8)
v_mfma_f32_16x16x32_bf16 v[80:83], v[20:23], a[12:15], v[80:83]
buffer_load_dword v63, v58, s[36:39], s55 offen
ds_read_b64_tr_b16 v[36:37], v12 offset:28672
v_sub_f32 v208, v208, v218
v_mfma_f32_16x16x32_bf16 v[84:87], v[20:23], a[76:79], v[84:87]
v_sub_f32 v209, v209, v218
v_sub_f32 v210, v210, v218
v_mfma_f32_16x16x32_bf16 v[88:91], v[20:23], a[140:143], v[88:91]
s_waitcnt lgkmcnt(2)
ds_read_b64_tr_b16 v[38:39], v12 offset:29184
v_sub_f32 v211, v211, v218
v_mfma_f32_16x16x32_bf16 v[92:95], v[20:23], a[204:207], v[92:95]
s_add_u32 m0, s53, 0
s_add_u32 s54, s52, 768
buffer_load_dwordx4 v4, s[28:31], s54 offen lds
v_sub_f32 v212, v212, v218
v_mfma_f32_16x16x32_bf16 v[96:99], v[24:27], a[12:15], v[96:99]
ds_read_b64_tr_b16 v[40:41], v11 offset:28928
v_sub_f32 v213, v213, v218
v_mfma_f32_16x16x32_bf16 v[100:103], v[24:27], a[76:79], v[100:103]
v_sub_f32 v214, v214, v218
v_mfma_f32_16x16x32_bf16 v[104:107], v[24:27], a[140:143], v[104:107]
s_add_u32 m0, s53, 1024
s_add_u32 s54, s52, 768
buffer_load_dwordx4 v5, s[28:31], s54 offen lds
v_sub_f32 v215, v215, v218
ds_read_b64_tr_b16 v[42:43], v11 offset:29440
v_cvt_pk_bf16_f32 v192, v200, v201
v_mfma_f32_16x16x32_bf16 v[108:111], v[24:27], a[204:207], v[108:111]
v_lshlrev_b32 v200, 16, v192
v_mfma_f32_16x16x32_bf16 v[112:115], v[28:31], a[12:15], v[112:115]
ds_read_b64_tr_b16 v[44:45], v12 offset:28928
v_and_b32 v201, 0xffff0000, v192
v_mfma_f32_16x16x32_bf16 v[116:119], v[28:31], a[76:79], v[116:119]
s_add_u32 m0, s53, 2048
s_add_u32 s54, s52, 768
buffer_load_dwordx4 v6, s[28:31], s54 offen lds
v_mul_f32 v200, v200, v216
v_mfma_f32_16x16x32_bf16 v[120:123], v[28:31], a[140:143], v[120:123]
ds_read_b64_tr_b16 v[46:47], v12 offset:29440
v_mul_f32 v201, v201, v216
v_mfma_f32_16x16x32_bf16 v[124:127], v[28:31], a[204:207], v[124:127]
v_cvt_pk_bf16_f32 v192, v200, v201
s_barrier
v_cvt_pk_bf16_f32 v193, v202, v203
s_waitcnt lgkmcnt(6)
v_mfma_f32_16x16x32_bf16 v[128:131], v[32:35], a[12:15], v[128:131]
s_add_u32 m0, s53, 3072
s_add_u32 s54, s52, 768
buffer_load_dwordx4 v7, s[28:31], s54 offen lds
ds_read_b64_tr_b16 v[16:17], v11 offset:32768
v_lshlrev_b32 v202, 16, v193
v_mfma_f32_16x16x32_bf16 v[132:135], v[32:35], a[76:79], v[132:135]
v_and_b32 v203, 0xffff0000, v193
s_add_u32 m0, s56, 0
s_add_u32 s57, s55, 2097152
buffer_load_dwordx4 v10, s[32:35], s57 offen lds
v_mfma_f32_16x16x32_bf16 v[136:139], v[32:35], a[140:143], v[136:139]
ds_read_b64_tr_b16 v[18:19], v11 offset:33280
v_mul_f32 v202, v202, v216
v_mfma_f32_16x16x32_bf16 v[140:143], v[32:35], a[204:207], v[140:143]
s_add_u32 m0, s53, 4096
s_add_u32 s54, s52, 8960
buffer_load_dwordx4 v4, s[28:31], s54 offen lds
v_mul_f32 v203, v203, v216
v_cvt_pk_bf16_f32 v193, v202, v203
s_waitcnt lgkmcnt(6)
v_mfma_f32_16x16x32_bf16 v[144:147], v[36:39], a[12:15], v[144:147]
ds_read_b64_tr_b16 v[20:21], v12 offset:32768
v_cvt_pk_bf16_f32 v194, v204, v205
v_mfma_f32_16x16x32_bf16 v[148:151], v[36:39], a[76:79], v[148:151]
v_lshlrev_b32 v204, 16, v194
v_mfma_f32_16x16x32_bf16 v[152:155], v[36:39], a[140:143], v[152:155]
s_add_u32 m0, s53, 5120
s_add_u32 s54, s52, 8960
buffer_load_dwordx4 v5, s[28:31], s54 offen lds
ds_read_b64_tr_b16 v[22:23], v12 offset:33280
v_and_b32 v205, 0xffff0000, v194
s_add_u32 m0, s56, 4096
s_add_u32 s57, s55, 2097280
buffer_load_dwordx4 v10, s[32:35], s57 offen lds
v_mfma_f32_16x16x32_bf16 v[156:159], v[36:39], a[204:207], v[156:159]
v_mul_f32 v204, v204, v216
s_waitcnt lgkmcnt(6)
v_mfma_f32_16x16x32_bf16 v[160:163], v[40:43], a[12:15], v[160:163]
v_mul_f32 v205, v205, v216
ds_read_b64_tr_b16 v[24:25], v11 offset:33024
v_cvt_pk_bf16_f32 v194, v204, v205
v_mfma_f32_16x16x32_bf16 v[164:167], v[40:43], a[76:79], v[164:167]
s_add_u32 m0, s53, 6144
s_add_u32 s54, s52, 8960
buffer_load_dwordx4 v6, s[28:31], s54 offen lds
v_cvt_pk_bf16_f32 v195, v206, v207
v_mfma_f32_16x16x32_bf16 v[168:171], v[40:43], a[140:143], v[168:171]
ds_read_b64_tr_b16 v[26:27], v11 offset:33536
v_lshlrev_b32 v206, 16, v195
v_mfma_f32_16x16x32_bf16 v[172:175], v[40:43], a[204:207], v[172:175]
v_and_b32 v207, 0xffff0000, v195
s_add_u32 m0, s56, 8192
s_add_u32 s57, s55, 2359296
buffer_load_dwordx4 v10, s[32:35], s57 offen lds
s_waitcnt lgkmcnt(6)
v_mfma_f32_16x16x32_bf16 v[176:179], v[44:47], a[12:15], v[176:179]
s_add_u32 m0, s53, 7168
s_add_u32 s54, s52, 8960
buffer_load_dwordx4 v7, s[28:31], s54 offen lds
ds_read_b64_tr_b16 v[28:29], v12 offset:33024
v_mul_f32 v206, v206, v216
v_mfma_f32_16x16x32_bf16 v[180:183], v[44:47], a[76:79], v[180:183]
v_mul_f32 v207, v207, v216
v_cvt_pk_bf16_f32 v195, v206, v207
v_mfma_f32_16x16x32_bf16 v[184:187], v[44:47], a[140:143], v[184:187]
ds_read_b64_tr_b16 v[30:31], v12 offset:33536
v_cvt_pk_bf16_f32 v196, v208, v209
v_mfma_f32_16x16x32_bf16 v[188:191], v[44:47], a[204:207], v[188:191]
v_lshlrev_b32 v208, 16, v196
s_waitcnt lgkmcnt(6)
v_mfma_f32_16x16x32_bf16 v[64:67], v[16:19], a[16:19], v[64:67]
ds_read_b64_tr_b16 v[32:33], v11 offset:36864
v_and_b32 v209, 0xffff0000, v196
s_add_u32 m0, s56, 12288
s_add_u32 s57, s55, 2359424
buffer_load_dwordx4 v10, s[32:35], s57 offen lds
v_mfma_f32_16x16x32_bf16 v[68:71], v[16:19], a[80:83], v[68:71]
v_mul_f32 v208, v208, v216
v_mul_f32 v209, v209, v216
v_mfma_f32_16x16x32_bf16 v[72:75], v[16:19], a[144:147], v[72:75]
ds_read_b64_tr_b16 v[34:35], v11 offset:37376
v_cvt_pk_bf16_f32 v196, v208, v209
v_mfma_f32_16x16x32_bf16 v[76:79], v[16:19], a[208:211], v[76:79]
v_cvt_pk_bf16_f32 v197, v210, v211
s_waitcnt lgkmcnt(6)
v_mfma_f32_16x16x32_bf16 v[80:83], v[20:23], a[16:19], v[80:83]
s_waitcnt vmcnt(25)
ds_read_b64_tr_b16 v[36:37], v12 offset:36864
v_lshlrev_b32 v210, 16, v197
v_mfma_f32_16x16x32_bf16 v[84:87], v[20:23], a[80:83], v[84:87]
v_and_b32 v211, 0xffff0000, v197
v_mfma_f32_16x16x32_bf16 v[88:91], v[20:23], a[144:147], v[88:91]
v_mul_f32 v210, v210, v216
ds_read_b64_tr_b16 v[38:39], v12 offset:37376
ds_read_b128 a[32:35], v13 offset:8192
v_mul_f32 v211, v211, v216
v_mfma_f32_16x16x32_bf16 v[92:95], v[20:23], a[208:211], v[92:95]
v_cvt_pk_bf16_f32 v197, v210, v211
s_waitcnt lgkmcnt(7)
v_mfma_f32_16x16x32_bf16 v[96:99], v[24:27], a[16:19], v[96:99]
ds_read_b64_tr_b16 v[40:41], v11 offset:37120
v_cvt_pk_bf16_f32 v198, v212, v213
v_mfma_f32_16x16x32_bf16 v[100:103], v[24:27], a[80:83], v[100:103]
v_lshlrev_b32 v212, 16, v198
ds_read_b128 a[96:99], v13 offset:12288
v_mfma_f32_16x16x32_bf16 v[104:107], v[24:27], a[144:147], v[104:107]
ds_read_b64_tr_b16 v[42:43], v11 offset:37632
v_and_b32 v213, 0xffff0000, v198
v_mfma_f32_16x16x32_bf16 v[108:111], v[24:27], a[208:211], v[108:111]
v_mul_f32 v212, v212, v216
v_mul_f32 v213, v213, v216
s_waitcnt lgkmcnt(8)
v_mfma_f32_16x16x32_bf16 v[112:115], v[28:31], a[16:19], v[112:115]
ds_read_b64_tr_b16 v[44:45], v12 offset:37120
ds_read_b128 a[36:39], v14 offset:8192
v_cvt_pk_bf16_f32 v198, v212, v213
v_mfma_f32_16x16x32_bf16 v[116:119], v[28:31], a[80:83], v[116:119]
v_cvt_pk_bf16_f32 v199, v214, v215
v_mfma_f32_16x16x32_bf16 v[120:123], v[28:31], a[144:147], v[120:123]
ds_read_b64_tr_b16 v[46:47], v12 offset:37632
v_lshlrev_b32 v214, 16, v199
v_mfma_f32_16x16x32_bf16 v[124:127], v[28:31], a[208:211], v[124:127]
v_and_b32 v215, 0xffff0000, v199
ds_read_b128 a[100:103], v14 offset:12288
v_mul_f32 v214, v214, v216
s_waitcnt lgkmcnt(10)
v_mfma_f32_16x16x32_bf16 v[128:131], v[32:35], a[16:19], v[128:131]
ds_read_b64_tr_b16 v[16:17], v11 offset:40960
v_mul_f32 v215, v215, v216
v_mfma_f32_16x16x32_bf16 v[132:135], v[32:35], a[80:83], v[132:135]
v_cvt_pk_bf16_f32 v199, v214, v215
v_mfma_f32_16x16x32_bf16 v[136:139], v[32:35], a[144:147], v[136:139]
ds_read_b64_tr_b16 v[18:19], v11 offset:41472
ds_read_b128 a[40:43], v15 offset:8192
v_mfma_f32_16x16x32_bf16 v[140:143], v[32:35], a[208:211], v[140:143]
ds_write_b128 v54, v[192:195]
ds_write_b128 v54, v[196:199] offset:4096
s_waitcnt lgkmcnt(13)
v_mfma_f32_16x16x32_bf16 v[144:147], v[36:39], a[16:19], v[144:147]
ds_read_b64_tr_b16 v[20:21], v12 offset:40960
v_mfma_f32_16x16x32_bf16 v[148:151], v[36:39], a[80:83], v[148:151]
ds_read_b128 a[104:107], v15 offset:12288
v_mfma_f32_16x16x32_bf16 v[152:155], v[36:39], a[144:147], v[152:155]
ds_read_b64_tr_b16 v[22:23], v12 offset:41472
v_mfma_f32_16x16x32_bf16 v[156:159], v[36:39], a[208:211], v[156:159]
s_waitcnt lgkmcnt(12)
v_mfma_f32_16x16x32_bf16 v[160:163], v[40:43], a[16:19], v[160:163]
ds_read_b64_tr_b16 v[24:25], v11 offset:41216
ds_read_b128 a[44:47], v9 offset:8192
v_mfma_f32_16x16x32_bf16 v[164:167], v[40:43], a[80:83], v[164:167]
v_mfma_f32_16x16x32_bf16 v[168:171], v[40:43], a[144:147], v[168:171]
s_waitcnt lgkmcnt(0)
s_barrier
ds_read_b128 v[192:195], v55
ds_read_b128 v[196:199], v55 offset:1024
ds_read_b64_tr_b16 v[26:27], v11 offset:41728
v_mfma_f32_16x16x32_bf16 v[172:175], v[40:43], a[208:211], v[172:175]
ds_read_b128 a[108:111], v9 offset:12288
v_mfma_f32_16x16x32_bf16 v[176:179], v[44:47], a[16:19], v[176:179]
ds_read_b64_tr_b16 v[28:29], v12 offset:41216
v_mfma_f32_16x16x32_bf16 v[180:183], v[44:47], a[80:83], v[180:183]
v_mfma_f32_16x16x32_bf16 v[184:187], v[44:47], a[144:147], v[184:187]
ds_read_b64_tr_b16 v[30:31], v12 offset:41728
v_mfma_f32_16x16x32_bf16 v[188:191], v[44:47], a[208:211], v[188:191]
v_mfma_f32_16x16x32_bf16 v[64:67], v[16:19], a[20:23], v[64:67]
ds_read_b64_tr_b16 v[32:33], v11 offset:45056
v_mfma_f32_16x16x32_bf16 v[68:71], v[16:19], a[84:87], v[68:71]
v_mfma_f32_16x16x32_bf16 v[72:75], v[16:19], a[148:151], v[72:75]
s_waitcnt lgkmcnt(6)
buffer_store_dwordx4 v[192:195], v56, s[40:43], 0 offen sc1
s_waitcnt lgkmcnt(5)
buffer_store_dwordx4 v[196:199], v56, s[40:43], 0 offen offset:2048 sc1
ds_read_b64_tr_b16 v[34:35], v11 offset:45568
v_mfma_f32_16x16x32_bf16 v[76:79], v[16:19], a[212:215], v[76:79]
v_mfma_f32_16x16x32_bf16 v[80:83], v[20:23], a[20:23], v[80:83]
ds_read_b64_tr_b16 v[36:37], v12 offset:45056
v_mfma_f32_16x16x32_bf16 v[84:87], v[20:23], a[84:87], v[84:87]
v_mfma_f32_16x16x32_bf16 v[88:91], v[20:23], a[148:151], v[88:91]
s_waitcnt lgkmcnt(2)
ds_read_b64_tr_b16 v[38:39], v12 offset:45568
v_mfma_f32_16x16x32_bf16 v[92:95], v[20:23], a[212:215], v[92:95]
s_add_u32 m0, s53, 8192
s_add_u32 s54, s52, 33536
buffer_load_dwordx4 v4, s[28:31], s54 offen lds
v_mfma_f32_16x16x32_bf16 v[96:99], v[24:27], a[20:23], v[96:99]
ds_read_b64_tr_b16 v[40:41], v11 offset:45312
v_mfma_f32_16x16x32_bf16 v[100:103], v[24:27], a[84:87], v[100:103]
v_mfma_f32_16x16x32_bf16 v[104:107], v[24:27], a[148:151], v[104:107]
s_add_u32 m0, s53, 9216
s_add_u32 s54, s52, 33536
buffer_load_dwordx4 v5, s[28:31], s54 offen lds
ds_read_b64_tr_b16 v[42:43], v11 offset:45824
v_mfma_f32_16x16x32_bf16 v[108:111], v[24:27], a[212:215], v[108:111]
v_mfma_f32_16x16x32_bf16 v[112:115], v[28:31], a[20:23], v[112:115]
ds_read_b64_tr_b16 v[44:45], v12 offset:45312
v_mfma_f32_16x16x32_bf16 v[116:119], v[28:31], a[84:87], v[116:119]
s_add_u32 m0, s53, 10240
s_add_u32 s54, s52, 33536
buffer_load_dwordx4 v6, s[28:31], s54 offen lds
v_mfma_f32_16x16x32_bf16 v[120:123], v[28:31], a[148:151], v[120:123]
ds_read_b64_tr_b16 v[46:47], v12 offset:45824
v_mfma_f32_16x16x32_bf16 v[124:127], v[28:31], a[212:215], v[124:127]
s_waitcnt vmcnt(18)
s_barrier
s_waitcnt lgkmcnt(6)
v_mfma_f32_16x16x32_bf16 v[128:131], v[32:35], a[20:23], v[128:131]
s_add_u32 m0, s53, 11264
s_add_u32 s54, s52, 33536
buffer_load_dwordx4 v7, s[28:31], s54 offen lds
ds_read_b64_tr_b16 v[16:17], v11 offset:49152
v_mfma_f32_16x16x32_bf16 v[132:135], v[32:35], a[84:87], v[132:135]
s_add_u32 m0, s56, 16384
s_add_u32 s57, s55, 2621440
buffer_load_dwordx4 v10, s[32:35], s57 offen lds
v_mfma_f32_16x16x32_bf16 v[136:139], v[32:35], a[148:151], v[136:139]
ds_read_b64_tr_b16 v[18:19], v11 offset:49664
v_mfma_f32_16x16x32_bf16 v[140:143], v[32:35], a[212:215], v[140:143]
s_add_u32 m0, s53, 12288
s_add_u32 s54, s52, 41728
buffer_load_dwordx4 v4, s[28:31], s54 offen lds
s_waitcnt lgkmcnt(6)
v_mfma_f32_16x16x32_bf16 v[144:147], v[36:39], a[20:23], v[144:147]
ds_read_b64_tr_b16 v[20:21], v12 offset:49152
v_mfma_f32_16x16x32_bf16 v[148:151], v[36:39], a[84:87], v[148:151]
v_mfma_f32_16x16x32_bf16 v[152:155], v[36:39], a[148:151], v[152:155]
s_add_u32 m0, s53, 13312
s_add_u32 s54, s52, 41728
buffer_load_dwordx4 v5, s[28:31], s54 offen lds
ds_read_b64_tr_b16 v[22:23], v12 offset:49664
s_add_u32 m0, s56, 20480
s_add_u32 s57, s55, 2621568
buffer_load_dwordx4 v10, s[32:35], s57 offen lds
v_mfma_f32_16x16x32_bf16 v[156:159], v[36:39], a[212:215], v[156:159]
s_waitcnt lgkmcnt(6)
v_mfma_f32_16x16x32_bf16 v[160:163], v[40:43], a[20:23], v[160:163]
ds_read_b64_tr_b16 v[24:25], v11 offset:49408
v_mfma_f32_16x16x32_bf16 v[164:167], v[40:43], a[84:87], v[164:167]
s_add_u32 m0, s53, 14336
s_add_u32 s54, s52, 41728
buffer_load_dwordx4 v6, s[28:31], s54 offen lds
v_mfma_f32_16x16x32_bf16 v[168:171], v[40:43], a[148:151], v[168:171]
ds_read_b64_tr_b16 v[26:27], v11 offset:49920
v_mfma_f32_16x16x32_bf16 v[172:175], v[40:43], a[212:215], v[172:175]
s_add_u32 m0, s56, 24576
s_add_u32 s57, s55, 2883584
buffer_load_dwordx4 v10, s[32:35], s57 offen lds
s_waitcnt lgkmcnt(6)
v_mfma_f32_16x16x32_bf16 v[176:179], v[44:47], a[20:23], v[176:179]
s_add_u32 m0, s53, 15360
s_add_u32 s54, s52, 41728
buffer_load_dwordx4 v7, s[28:31], s54 offen lds
ds_read_b64_tr_b16 v[28:29], v12 offset:49408
v_mfma_f32_16x16x32_bf16 v[180:183], v[44:47], a[84:87], v[180:183]
v_mfma_f32_16x16x32_bf16 v[184:187], v[44:47], a[148:151], v[184:187]
ds_read_b64_tr_b16 v[30:31], v12 offset:49920
v_mfma_f32_16x16x32_bf16 v[188:191], v[44:47], a[212:215], v[188:191]
s_waitcnt lgkmcnt(6)
v_mfma_f32_16x16x32_bf16 v[64:67], v[16:19], a[24:27], v[64:67]
ds_read_b64_tr_b16 v[32:33], v11 offset:53248
s_add_u32 m0, s56, 28672
s_add_u32 s57, s55, 2883712
buffer_load_dwordx4 v10, s[32:35], s57 offen lds
v_mfma_f32_16x16x32_bf16 v[68:71], v[16:19], a[88:91], v[68:71]
v_mfma_f32_16x16x32_bf16 v[72:75], v[16:19], a[152:155], v[72:75]
ds_read_b64_tr_b16 v[34:35], v11 offset:53760
v_mfma_f32_16x16x32_bf16 v[76:79], v[16:19], a[216:219], v[76:79]
s_waitcnt lgkmcnt(6)
v_mfma_f32_16x16x32_bf16 v[80:83], v[20:23], a[24:27], v[80:83]
ds_read_b64_tr_b16 v[36:37], v12 offset:53248
v_mfma_f32_16x16x32_bf16 v[84:87], v[20:23], a[88:91], v[84:87]
v_mfma_f32_16x16x32_bf16 v[88:91], v[20:23], a[152:155], v[88:91]
ds_read_b64_tr_b16 v[38:39], v12 offset:53760
ds_read_b128 a[160:163], v13 offset:16384
v_mfma_f32_16x16x32_bf16 v[92:95], v[20:23], a[216:219], v[92:95]
s_waitcnt lgkmcnt(7)
v_mfma_f32_16x16x32_bf16 v[96:99], v[24:27], a[24:27], v[96:99]
ds_read_b64_tr_b16 v[40:41], v11 offset:53504
v_mfma_f32_16x16x32_bf16 v[100:103], v[24:27], a[88:91], v[100:103]
ds_read_b128 a[224:227], v13 offset:20480
v_mfma_f32_16x16x32_bf16 v[104:107], v[24:27], a[152:155], v[104:107]
ds_read_b64_tr_b16 v[42:43], v11 offset:54016
v_mfma_f32_16x16x32_bf16 v[108:111], v[24:27], a[216:219], v[108:111]
s_waitcnt lgkmcnt(8)
v_mfma_f32_16x16x32_bf16 v[112:115], v[28:31], a[24:27], v[112:115]
ds_read_b64_tr_b16 v[44:45], v12 offset:53504
ds_read_b128 a[164:167], v14 offset:16384
v_mfma_f32_16x16x32_bf16 v[116:119], v[28:31], a[88:91], v[116:119]
v_mfma_f32_16x16x32_bf16 v[120:123], v[28:31], a[152:155], v[120:123]
ds_read_b64_tr_b16 v[46:47], v12 offset:54016
v_mfma_f32_16x16x32_bf16 v[124:127], v[28:31], a[216:219], v[124:127]
ds_read_b128 a[228:231], v14 offset:20480
s_waitcnt lgkmcnt(10)
v_mfma_f32_16x16x32_bf16 v[128:131], v[32:35], a[24:27], v[128:131]
ds_read_b64_tr_b16 v[16:17], v11 offset:57344
v_mfma_f32_16x16x32_bf16 v[132:135], v[32:35], a[88:91], v[132:135]
v_mfma_f32_16x16x32_bf16 v[136:139], v[32:35], a[152:155], v[136:139]
ds_read_b64_tr_b16 v[18:19], v11 offset:57856
ds_read_b128 a[168:171], v15 offset:16384
v_mfma_f32_16x16x32_bf16 v[140:143], v[32:35], a[216:219], v[140:143]
s_waitcnt lgkmcnt(11)
v_mfma_f32_16x16x32_bf16 v[144:147], v[36:39], a[24:27], v[144:147]
ds_read_b64_tr_b16 v[20:21], v12 offset:57344
v_mfma_f32_16x16x32_bf16 v[148:151], v[36:39], a[88:91], v[148:151]
ds_read_b128 a[232:235], v15 offset:20480
v_mfma_f32_16x16x32_bf16 v[152:155], v[36:39], a[152:155], v[152:155]
ds_read_b64_tr_b16 v[22:23], v12 offset:57856
v_mfma_f32_16x16x32_bf16 v[156:159], v[36:39], a[216:219], v[156:159]
s_waitcnt lgkmcnt(10)
v_mfma_f32_16x16x32_bf16 v[160:163], v[40:43], a[24:27], v[160:163]
ds_read_b64_tr_b16 v[24:25], v11 offset:57600
ds_read_b128 a[172:175], v9 offset:16384
v_mfma_f32_16x16x32_bf16 v[164:167], v[40:43], a[88:91], v[164:167]
v_mfma_f32_16x16x32_bf16 v[168:171], v[40:43], a[152:155], v[168:171]
ds_read_b64_tr_b16 v[26:27], v11 offset:58112
v_mfma_f32_16x16x32_bf16 v[172:175], v[40:43], a[216:219], v[172:175]
ds_read_b128 a[236:239], v9 offset:20480
s_waitcnt lgkmcnt(11)
v_mfma_f32_16x16x32_bf16 v[176:179], v[44:47], a[24:27], v[176:179]
ds_read_b64_tr_b16 v[28:29], v12 offset:57600
v_mfma_f32_16x16x32_bf16 v[180:183], v[44:47], a[88:91], v[180:183]
v_mfma_f32_16x16x32_bf16 v[184:187], v[44:47], a[152:155], v[184:187]
ds_read_b64_tr_b16 v[30:31], v12 offset:58112
v_mfma_f32_16x16x32_bf16 v[188:191], v[44:47], a[216:219], v[188:191]
s_waitcnt lgkmcnt(10)
v_mfma_f32_16x16x32_bf16 v[64:67], v[16:19], a[28:31], v[64:67]
ds_read_b64_tr_b16 v[32:33], v11 offset:61440
v_mfma_f32_16x16x32_bf16 v[68:71], v[16:19], a[92:95], v[68:71]
v_mfma_f32_16x16x32_bf16 v[72:75], v[16:19], a[156:159], v[72:75]
ds_read_b64_tr_b16 v[34:35], v11 offset:61952
v_mfma_f32_16x16x32_bf16 v[76:79], v[16:19], a[220:223], v[76:79]
s_waitcnt lgkmcnt(8)
v_mfma_f32_16x16x32_bf16 v[80:83], v[20:23], a[28:31], v[80:83]
ds_read_b64_tr_b16 v[36:37], v12 offset:61440
v_mfma_f32_16x16x32_bf16 v[84:87], v[20:23], a[92:95], v[84:87]
v_mfma_f32_16x16x32_bf16 v[88:91], v[20:23], a[156:159], v[88:91]
ds_read_b64_tr_b16 v[38:39], v12 offset:61952
v_mfma_f32_16x16x32_bf16 v[92:95], v[20:23], a[220:223], v[92:95]
s_waitcnt lgkmcnt(7)
v_mfma_f32_16x16x32_bf16 v[96:99], v[24:27], a[28:31], v[96:99]
ds_read_b64_tr_b16 v[40:41], v11 offset:61696
v_mfma_f32_16x16x32_bf16 v[100:103], v[24:27], a[92:95], v[100:103]
v_mfma_f32_16x16x32_bf16 v[104:107], v[24:27], a[156:159], v[104:107]
ds_read_b64_tr_b16 v[42:43], v11 offset:62208
v_mfma_f32_16x16x32_bf16 v[108:111], v[24:27], a[220:223], v[108:111]
s_waitcnt lgkmcnt(6)
v_mfma_f32_16x16x32_bf16 v[112:115], v[28:31], a[28:31], v[112:115]
ds_read_b64_tr_b16 v[44:45], v12 offset:61696
v_mfma_f32_16x16x32_bf16 v[116:119], v[28:31], a[92:95], v[116:119]
v_mfma_f32_16x16x32_bf16 v[120:123], v[28:31], a[156:159], v[120:123]
ds_read_b64_tr_b16 v[46:47], v12 offset:62208
v_mfma_f32_16x16x32_bf16 v[124:127], v[28:31], a[220:223], v[124:127]
s_waitcnt vmcnt(14)
s_barrier
s_waitcnt lgkmcnt(6)
v_mfma_f32_16x16x32_bf16 v[128:131], v[32:35], a[28:31], v[128:131]
ds_read_b64_tr_b16 v[16:17], v11 offset:0
v_mfma_f32_16x16x32_bf16 v[132:135], v[32:35], a[92:95], v[132:135]
s_add_u32 m0, s56, 32768
s_add_u32 s57, s55, 3145728
buffer_load_dwordx4 v10, s[32:35], s57 offen lds
v_mfma_f32_16x16x32_bf16 v[136:139], v[32:35], a[156:159], v[136:139]
ds_read_b64_tr_b16 v[18:19], v11 offset:512
v_mfma_f32_16x16x32_bf16 v[140:143], v[32:35], a[220:223], v[140:143]
s_waitcnt lgkmcnt(6)
v_mfma_f32_16x16x32_bf16 v[144:147], v[36:39], a[28:31], v[144:147]
ds_read_b64_tr_b16 v[20:21], v12 offset:0
v_mfma_f32_16x16x32_bf16 v[148:151], v[36:39], a[92:95], v[148:151]
v_mfma_f32_16x16x32_bf16 v[152:155], v[36:39], a[156:159], v[152:155]
ds_read_b64_tr_b16 v[22:23], v12 offset:512
s_add_u32 m0, s56, 36864
s_add_u32 s57, s55, 3145856
buffer_load_dwordx4 v10, s[32:35], s57 offen lds
v_mfma_f32_16x16x32_bf16 v[156:159], v[36:39], a[220:223], v[156:159]
s_waitcnt lgkmcnt(6)
v_mfma_f32_16x16x32_bf16 v[160:163], v[40:43], a[28:31], v[160:163]
ds_read_b64_tr_b16 v[24:25], v11 offset:256
v_mfma_f32_16x16x32_bf16 v[164:167], v[40:43], a[92:95], v[164:167]
v_mfma_f32_16x16x32_bf16 v[168:171], v[40:43], a[156:159], v[168:171]
ds_read_b64_tr_b16 v[26:27], v11 offset:768
v_mfma_f32_16x16x32_bf16 v[172:175], v[40:43], a[220:223], v[172:175]
s_add_u32 m0, s56, 40960
s_add_u32 s57, s55, 3407872
buffer_load_dwordx4 v10, s[32:35], s57 offen lds
s_waitcnt lgkmcnt(6)
v_mfma_f32_16x16x32_bf16 v[176:179], v[44:47], a[28:31], v[176:179]
ds_read_b64_tr_b16 v[28:29], v12 offset:256
v_mfma_f32_16x16x32_bf16 v[180:183], v[44:47], a[92:95], v[180:183]
v_mfma_f32_16x16x32_bf16 v[184:187], v[44:47], a[156:159], v[184:187]
ds_read_b64_tr_b16 v[30:31], v12 offset:768
v_mfma_f32_16x16x32_bf16 v[188:191], v[44:47], a[220:223], v[188:191]
s_waitcnt lgkmcnt(6)
v_mfma_f32_16x16x32_bf16 v[64:67], v[16:19], a[32:35], v[64:67]
ds_read_b64_tr_b16 v[32:33], v11 offset:4096
s_add_u32 m0, s56, 45056
s_add_u32 s57, s55, 3408000
buffer_load_dwordx4 v10, s[32:35], s57 offen lds
v_mfma_f32_16x16x32_bf16 v[68:71], v[16:19], a[96:99], v[68:71]
v_mfma_f32_16x16x32_bf16 v[72:75], v[16:19], a[160:163], v[72:75]
ds_read_b64_tr_b16 v[34:35], v11 offset:4608
v_mfma_f32_16x16x32_bf16 v[76:79], v[16:19], a[224:227], v[76:79]
s_waitcnt lgkmcnt(6)
v_mfma_f32_16x16x32_bf16 v[80:83], v[20:23], a[32:35], v[80:83]
ds_read_b64_tr_b16 v[36:37], v12 offset:4096
v_mfma_f32_16x16x32_bf16 v[84:87], v[20:23], a[96:99], v[84:87]
v_mfma_f32_16x16x32_bf16 v[88:91], v[20:23], a[160:163], v[88:91]
ds_read_b64_tr_b16 v[38:39], v12 offset:4608
ds_read_b128 a[48:51], v13 offset:0
v_mfma_f32_16x16x32_bf16 v[92:95], v[20:23], a[224:227], v[92:95]
s_waitcnt lgkmcnt(7)
v_mfma_f32_16x16x32_bf16 v[96:99], v[24:27], a[32:35], v[96:99]
ds_read_b64_tr_b16 v[40:41], v11 offset:4352
v_mfma_f32_16x16x32_bf16 v[100:103], v[24:27], a[96:99], v[100:103]
ds_read_b128 a[112:115], v13 offset:4096
v_mfma_f32_16x16x32_bf16 v[104:107], v[24:27], a[160:163], v[104:107]
ds_read_b64_tr_b16 v[42:43], v11 offset:4864
v_mfma_f32_16x16x32_bf16 v[108:111], v[24:27], a[224:227], v[108:111]
s_waitcnt lgkmcnt(8)
v_mfma_f32_16x16x32_bf16 v[112:115], v[28:31], a[32:35], v[112:115]
ds_read_b64_tr_b16 v[44:45], v12 offset:4352
ds_read_b128 a[52:55], v14 offset:0
v_mfma_f32_16x16x32_bf16 v[116:119], v[28:31], a[96:99], v[116:119]
v_mfma_f32_16x16x32_bf16 v[120:123], v[28:31], a[160:163], v[120:123]
ds_read_b64_tr_b16 v[46:47], v12 offset:4864
v_mfma_f32_16x16x32_bf16 v[124:127], v[28:31], a[224:227], v[124:127]
ds_read_b128 a[116:119], v14 offset:4096
s_waitcnt lgkmcnt(10)
v_mfma_f32_16x16x32_bf16 v[128:131], v[32:35], a[32:35], v[128:131]
ds_read_b64_tr_b16 v[16:17], v11 offset:8192
v_mfma_f32_16x16x32_bf16 v[132:135], v[32:35], a[96:99], v[132:135]
v_mfma_f32_16x16x32_bf16 v[136:139], v[32:35], a[160:163], v[136:139]
ds_read_b64_tr_b16 v[18:19], v11 offset:8704
ds_read_b128 a[56:59], v15 offset:0
v_mfma_f32_16x16x32_bf16 v[140:143], v[32:35], a[224:227], v[140:143]
s_waitcnt lgkmcnt(11)
v_mfma_f32_16x16x32_bf16 v[144:147], v[36:39], a[32:35], v[144:147]
ds_read_b64_tr_b16 v[20:21], v12 offset:8192
v_mfma_f32_16x16x32_bf16 v[148:151], v[36:39], a[96:99], v[148:151]
ds_read_b128 a[120:123], v15 offset:4096
v_mfma_f32_16x16x32_bf16 v[152:155], v[36:39], a[160:163], v[152:155]
ds_read_b64_tr_b16 v[22:23], v12 offset:8704
v_mfma_f32_16x16x32_bf16 v[156:159], v[36:39], a[224:227], v[156:159]
s_waitcnt lgkmcnt(10)
v_mfma_f32_16x16x32_bf16 v[160:163], v[40:43], a[32:35], v[160:163]
ds_read_b64_tr_b16 v[24:25], v11 offset:8448
ds_read_b128 a[60:63], v9 offset:0
v_mfma_f32_16x16x32_bf16 v[164:167], v[40:43], a[96:99], v[164:167]
v_mfma_f32_16x16x32_bf16 v[168:171], v[40:43], a[160:163], v[168:171]
ds_read_b64_tr_b16 v[26:27], v11 offset:8960
v_mfma_f32_16x16x32_bf16 v[172:175], v[40:43], a[224:227], v[172:175]
ds_read_b128 a[124:127], v9 offset:4096
s_waitcnt lgkmcnt(11)
v_mfma_f32_16x16x32_bf16 v[176:179], v[44:47], a[32:35], v[176:179]
ds_read_b64_tr_b16 v[28:29], v12 offset:8448
v_mfma_f32_16x16x32_bf16 v[180:183], v[44:47], a[96:99], v[180:183]
v_mfma_f32_16x16x32_bf16 v[184:187], v[44:47], a[160:163], v[184:187]
ds_read_b64_tr_b16 v[30:31], v12 offset:8960
v_mfma_f32_16x16x32_bf16 v[188:191], v[44:47], a[224:227], v[188:191]
s_waitcnt lgkmcnt(10)
v_mfma_f32_16x16x32_bf16 v[64:67], v[16:19], a[36:39], v[64:67]
ds_read_b64_tr_b16 v[32:33], v11 offset:12288
v_mfma_f32_16x16x32_bf16 v[68:71], v[16:19], a[100:103], v[68:71]
v_mfma_f32_16x16x32_bf16 v[72:75], v[16:19], a[164:167], v[72:75]
ds_read_b64_tr_b16 v[34:35], v11 offset:12800
v_mfma_f32_16x16x32_bf16 v[76:79], v[16:19], a[228:231], v[76:79]
s_waitcnt lgkmcnt(8)
v_mfma_f32_16x16x32_bf16 v[80:83], v[20:23], a[36:39], v[80:83]
ds_read_b64_tr_b16 v[36:37], v12 offset:12288
v_mfma_f32_16x16x32_bf16 v[84:87], v[20:23], a[100:103], v[84:87]
v_mfma_f32_16x16x32_bf16 v[88:91], v[20:23], a[164:167], v[88:91]
ds_read_b64_tr_b16 v[38:39], v12 offset:12800
v_mfma_f32_16x16x32_bf16 v[92:95], v[20:23], a[228:231], v[92:95]
s_waitcnt lgkmcnt(7)
v_mfma_f32_16x16x32_bf16 v[96:99], v[24:27], a[36:39], v[96:99]
ds_read_b64_tr_b16 v[40:41], v11 offset:12544
v_mfma_f32_16x16x32_bf16 v[100:103], v[24:27], a[100:103], v[100:103]
v_mfma_f32_16x16x32_bf16 v[104:107], v[24:27], a[164:167], v[104:107]
ds_read_b64_tr_b16 v[42:43], v11 offset:13056
v_mfma_f32_16x16x32_bf16 v[108:111], v[24:27], a[228:231], v[108:111]
s_waitcnt lgkmcnt(6)
v_mfma_f32_16x16x32_bf16 v[112:115], v[28:31], a[36:39], v[112:115]
buffer_load_dword v63, v59, s[8:11], s67 offen
ds_read_b64_tr_b16 v[44:45], v12 offset:12544
v_mfma_f32_16x16x32_bf16 v[116:119], v[28:31], a[100:103], v[116:119]
v_mfma_f32_16x16x32_bf16 v[120:123], v[28:31], a[164:167], v[120:123]
ds_read_b64_tr_b16 v[46:47], v12 offset:13056
v_mfma_f32_16x16x32_bf16 v[124:127], v[28:31], a[228:231], v[124:127]
s_waitcnt vmcnt(5)
s_barrier
s_and_b32 s3, s2, 7
s_lshl_b32 s3, s3, 2
v_mov_b32 v60, s3
v_mov_b32 v61, 1
s_cmp_lg_u32 s20, 0
s_cbranch_scc1 W0_sx
s_mov_b64 exec, 1
global_atomic_add v60, v61, s[98:99] sc1
s_mov_b64 exec, -1
W0_sx:
s_waitcnt lgkmcnt(6)
v_mfma_f32_16x16x32_bf16 v[128:131], v[32:35], a[36:39], v[128:131]
ds_read_b64_tr_b16 v[16:17], v11 offset:16384
v_mfma_f32_16x16x32_bf16 v[132:135], v[32:35], a[100:103], v[132:135]
s_add_u32 m0, s56, 49152
s_add_u32 s57, s55, 3670016
buffer_load_dwordx4 v10, s[32:35], s57 offen lds
v_mfma_f32_16x16x32_bf16 v[136:139], v[32:35], a[164:167], v[136:139]
ds_read_b64_tr_b16 v[18:19], v11 offset:16896
v_mfma_f32_16x16x32_bf16 v[140:143], v[32:35], a[228:231], v[140:143]
s_waitcnt lgkmcnt(6)
v_mfma_f32_16x16x32_bf16 v[144:147], v[36:39], a[36:39], v[144:147]
ds_read_b64_tr_b16 v[20:21], v12 offset:16384
v_mfma_f32_16x16x32_bf16 v[148:151], v[36:39], a[100:103], v[148:151]
v_mfma_f32_16x16x32_bf16 v[152:155], v[36:39], a[164:167], v[152:155]
ds_read_b64_tr_b16 v[22:23], v12 offset:16896
s_add_u32 m0, s56, 53248
s_add_u32 s57, s55, 3670144
buffer_load_dwordx4 v10, s[32:35], s57 offen lds
v_mfma_f32_16x16x32_bf16 v[156:159], v[36:39], a[228:231], v[156:159]
s_waitcnt lgkmcnt(6)
v_mfma_f32_16x16x32_bf16 v[160:163], v[40:43], a[36:39], v[160:163]
ds_read_b64_tr_b16 v[24:25], v11 offset:16640
v_mfma_f32_16x16x32_bf16 v[164:167], v[40:43], a[100:103], v[164:167]
v_mfma_f32_16x16x32_bf16 v[168:171], v[40:43], a[164:167], v[168:171]
ds_read_b64_tr_b16 v[26:27], v11 offset:17152
v_mfma_f32_16x16x32_bf16 v[172:175], v[40:43], a[228:231], v[172:175]
s_add_u32 m0, s56, 57344
s_add_u32 s57, s55, 3932160
buffer_load_dwordx4 v10, s[32:35], s57 offen lds
s_waitcnt lgkmcnt(6)
v_mfma_f32_16x16x32_bf16 v[176:179], v[44:47], a[36:39], v[176:179]
ds_read_b64_tr_b16 v[28:29], v12 offset:16640
v_mfma_f32_16x16x32_bf16 v[180:183], v[44:47], a[100:103], v[180:183]
v_mfma_f32_16x16x32_bf16 v[184:187], v[44:47], a[164:167], v[184:187]
ds_read_b64_tr_b16 v[30:31], v12 offset:17152
v_mfma_f32_16x16x32_bf16 v[188:191], v[44:47], a[228:231], v[188:191]
s_waitcnt lgkmcnt(6)
v_mfma_f32_16x16x32_bf16 v[64:67], v[16:19], a[40:43], v[64:67]
ds_read_b64_tr_b16 v[32:33], v11 offset:20480
s_add_u32 m0, s56, 61440
s_add_u32 s57, s55, 3932288
buffer_load_dwordx4 v10, s[32:35], s57 offen lds
v_mfma_f32_16x16x32_bf16 v[68:71], v[16:19], a[104:107], v[68:71]
v_mfma_f32_16x16x32_bf16 v[72:75], v[16:19], a[168:171], v[72:75]
ds_read_b64_tr_b16 v[34:35], v11 offset:20992
v_mfma_f32_16x16x32_bf16 v[76:79], v[16:19], a[232:235], v[76:79]
s_waitcnt lgkmcnt(6)
v_mfma_f32_16x16x32_bf16 v[80:83], v[20:23], a[40:43], v[80:83]
ds_read_b64_tr_b16 v[36:37], v12 offset:20480
v_mfma_f32_16x16x32_bf16 v[84:87], v[20:23], a[104:107], v[84:87]
v_mfma_f32_16x16x32_bf16 v[88:91], v[20:23], a[168:171], v[88:91]
ds_read_b64_tr_b16 v[38:39], v12 offset:20992
ds_read_b128 a[176:179], v13 offset:8192
v_mfma_f32_16x16x32_bf16 v[92:95], v[20:23], a[232:235], v[92:95]
s_waitcnt lgkmcnt(7)
v_mfma_f32_16x16x32_bf16 v[96:99], v[24:27], a[40:43], v[96:99]
ds_read_b64_tr_b16 v[40:41], v11 offset:20736
v_mfma_f32_16x16x32_bf16 v[100:103], v[24:27], a[104:107], v[100:103]
ds_read_b128 a[240:243], v13 offset:12288
v_mfma_f32_16x16x32_bf16 v[104:107], v[24:27], a[168:171], v[104:107]
buffer_load_dword v63, v59, s[12:15], s67 offen
ds_read_b64_tr_b16 v[42:43], v11 offset:21248
v_mfma_f32_16x16x32_bf16 v[108:111], v[24:27], a[232:235], v[108:111]
s_waitcnt lgkmcnt(8)
v_mfma_f32_16x16x32_bf16 v[112:115], v[28:31], a[40:43], v[112:115]
ds_read_b64_tr_b16 v[44:45], v12 offset:20736
ds_read_b128 a[180:183], v14 offset:8192
v_mfma_f32_16x16x32_bf16 v[116:119], v[28:31], a[104:107], v[116:119]
v_mfma_f32_16x16x32_bf16 v[120:123], v[28:31], a[168:171], v[120:123]
ds_read_b64_tr_b16 v[46:47], v12 offset:21248
v_mfma_f32_16x16x32_bf16 v[124:127], v[28:31], a[232:235], v[124:127]
ds_read_b128 a[244:247], v14 offset:12288
s_waitcnt lgkmcnt(10)
v_mfma_f32_16x16x32_bf16 v[128:131], v[32:35], a[40:43], v[128:131]
ds_read_b64_tr_b16 v[16:17], v11 offset:24576
v_mfma_f32_16x16x32_bf16 v[132:135], v[32:35], a[104:107], v[132:135]
v_mfma_f32_16x16x32_bf16 v[136:139], v[32:35], a[168:171], v[136:139]
ds_read_b64_tr_b16 v[18:19], v11 offset:25088
ds_read_b128 a[184:187], v15 offset:8192
v_mfma_f32_16x16x32_bf16 v[140:143], v[32:35], a[232:235], v[140:143]
s_waitcnt lgkmcnt(11)
v_mfma_f32_16x16x32_bf16 v[144:147], v[36:39], a[40:43], v[144:147]
ds_read_b64_tr_b16 v[20:21], v12 offset:24576
v_mfma_f32_16x16x32_bf16 v[148:151], v[36:39], a[104:107], v[148:151]
ds_read_b128 a[248:251], v15 offset:12288
v_mfma_f32_16x16x32_bf16 v[152:155], v[36:39], a[168:171], v[152:155]
ds_read_b64_tr_b16 v[22:23], v12 offset:25088
v_mfma_f32_16x16x32_bf16 v[156:159], v[36:39], a[232:235], v[156:159]
s_waitcnt lgkmcnt(10)
v_mfma_f32_16x16x32_bf16 v[160:163], v[40:43], a[40:43], v[160:163]
ds_read_b64_tr_b16 v[24:25], v11 offset:24832
ds_read_b128 a[188:191], v9 offset:8192
v_mfma_f32_16x16x32_bf16 v[164:167], v[40:43], a[104:107], v[164:167]
v_mfma_f32_16x16x32_bf16 v[168:171], v[40:43], a[168:171], v[168:171]
ds_read_b64_tr_b16 v[26:27], v11 offset:25344
v_mfma_f32_16x16x32_bf16 v[172:175], v[40:43], a[232:235], v[172:175]
ds_read_b128 a[252:255], v9 offset:12288
s_waitcnt lgkmcnt(11)
v_mfma_f32_16x16x32_bf16 v[176:179], v[44:47], a[40:43], v[176:179]
ds_read_b64_tr_b16 v[28:29], v12 offset:24832
v_mfma_f32_16x16x32_bf16 v[180:183], v[44:47], a[104:107], v[180:183]
v_mfma_f32_16x16x32_bf16 v[184:187], v[44:47], a[168:171], v[184:187]
ds_read_b64_tr_b16 v[30:31], v12 offset:25344
v_mfma_f32_16x16x32_bf16 v[188:191], v[44:47], a[232:235], v[188:191]
s_waitcnt lgkmcnt(10)
v_mfma_f32_16x16x32_bf16 v[64:67], v[16:19], a[44:47], v[64:67]
ds_read_b64_tr_b16 v[32:33], v11 offset:28672
v_mfma_f32_16x16x32_bf16 v[68:71], v[16:19], a[108:111], v[68:71]
v_mfma_f32_16x16x32_bf16 v[72:75], v[16:19], a[172:175], v[72:75]
ds_read_b64_tr_b16 v[34:35], v11 offset:29184
v_mfma_f32_16x16x32_bf16 v[76:79], v[16:19], a[236:239], v[76:79]
s_waitcnt lgkmcnt(8)
v_mfma_f32_16x16x32_bf16 v[80:83], v[20:23], a[44:47], v[80:83]
ds_read_b64_tr_b16 v[36:37], v12 offset:28672
v_mfma_f32_16x16x32_bf16 v[84:87], v[20:23], a[108:111], v[84:87]
v_mfma_f32_16x16x32_bf16 v[88:91], v[20:23], a[172:175], v[88:91]
ds_read_b64_tr_b16 v[38:39], v12 offset:29184
v_mfma_f32_16x16x32_bf16 v[92:95], v[20:23], a[236:239], v[92:95]
s_waitcnt lgkmcnt(7)
v_mfma_f32_16x16x32_bf16 v[96:99], v[24:27], a[44:47], v[96:99]
ds_read_b64_tr_b16 v[40:41], v11 offset:28928
v_mfma_f32_16x16x32_bf16 v[100:103], v[24:27], a[108:111], v[100:103]
v_mfma_f32_16x16x32_bf16 v[104:107], v[24:27], a[172:175], v[104:107]
ds_read_b64_tr_b16 v[42:43], v11 offset:29440
v_mfma_f32_16x16x32_bf16 v[108:111], v[24:27], a[236:239], v[108:111]
s_waitcnt lgkmcnt(6)
v_mfma_f32_16x16x32_bf16 v[112:115], v[28:31], a[44:47], v[112:115]
ds_read_b64_tr_b16 v[44:45], v12 offset:28928
v_mfma_f32_16x16x32_bf16 v[116:119], v[28:31], a[108:111], v[116:119]
v_mfma_f32_16x16x32_bf16 v[120:123], v[28:31], a[172:175], v[120:123]
ds_read_b64_tr_b16 v[46:47], v12 offset:29440
v_mfma_f32_16x16x32_bf16 v[124:127], v[28:31], a[236:239], v[124:127]
s_waitcnt vmcnt(6)
s_barrier
s_waitcnt lgkmcnt(6)
v_mfma_f32_16x16x32_bf16 v[128:131], v[32:35], a[44:47], v[128:131]
ds_read_b64_tr_b16 v[16:17], v11 offset:32768
v_mfma_f32_16x16x32_bf16 v[132:135], v[32:35], a[108:111], v[132:135]
s_add_u32 m0, s56, 0
s_add_u32 s57, s55, 0
buffer_load_dwordx4 v10, s[36:39], s57 offen lds
v_mfma_f32_16x16x32_bf16 v[136:139], v[32:35], a[172:175], v[136:139]
ds_read_b64_tr_b16 v[18:19], v11 offset:33280
v_mfma_f32_16x16x32_bf16 v[140:143], v[32:35], a[236:239], v[140:143]
s_waitcnt lgkmcnt(6)
v_mfma_f32_16x16x32_bf16 v[144:147], v[36:39], a[44:47], v[144:147]
ds_read_b64_tr_b16 v[20:21], v12 offset:32768
v_mfma_f32_16x16x32_bf16 v[148:151], v[36:39], a[108:111], v[148:151]
v_mfma_f32_16x16x32_bf16 v[152:155], v[36:39], a[172:175], v[152:155]
ds_read_b64_tr_b16 v[22:23], v12 offset:33280
s_add_u32 m0, s56, 4096
s_add_u32 s57, s55, 262144
buffer_load_dwordx4 v10, s[36:39], s57 offen lds
v_mfma_f32_16x16x32_bf16 v[156:159], v[36:39], a[236:239], v[156:159]
s_waitcnt lgkmcnt(6)
v_mfma_f32_16x16x32_bf16 v[160:163], v[40:43], a[44:47], v[160:163]
ds_read_b64_tr_b16 v[24:25], v11 offset:33024
v_mfma_f32_16x16x32_bf16 v[164:167], v[40:43], a[108:111], v[164:167]
v_mfma_f32_16x16x32_bf16 v[168:171], v[40:43], a[172:175], v[168:171]
ds_read_b64_tr_b16 v[26:27], v11 offset:33536
v_mfma_f32_16x16x32_bf16 v[172:175], v[40:43], a[236:239], v[172:175]
s_add_u32 m0, s56, 8192
s_add_u32 s57, s55, 524288
buffer_load_dwordx4 v10, s[36:39], s57 offen lds
s_waitcnt lgkmcnt(6)
v_mfma_f32_16x16x32_bf16 v[176:179], v[44:47], a[44:47], v[176:179]
ds_read_b64_tr_b16 v[28:29], v12 offset:33024
v_mfma_f32_16x16x32_bf16 v[180:183], v[44:47], a[108:111], v[180:183]
v_mfma_f32_16x16x32_bf16 v[184:187], v[44:47], a[172:175], v[184:187]
ds_read_b64_tr_b16 v[30:31], v12 offset:33536
v_mfma_f32_16x16x32_bf16 v[188:191], v[44:47], a[236:239], v[188:191]
s_waitcnt lgkmcnt(6)
v_mfma_f32_16x16x32_bf16 v[64:67], v[16:19], a[48:51], v[64:67]
ds_read_b64_tr_b16 v[32:33], v11 offset:36864
s_add_u32 m0, s56, 12288
s_add_u32 s57, s55, 786432
buffer_load_dwordx4 v10, s[36:39], s57 offen lds
v_mfma_f32_16x16x32_bf16 v[68:71], v[16:19], a[112:115], v[68:71]
v_mfma_f32_16x16x32_bf16 v[72:75], v[16:19], a[176:179], v[72:75]
ds_read_b64_tr_b16 v[34:35], v11 offset:37376
v_mfma_f32_16x16x32_bf16 v[76:79], v[16:19], a[240:243], v[76:79]
s_waitcnt lgkmcnt(6)
v_mfma_f32_16x16x32_bf16 v[80:83], v[20:23], a[48:51], v[80:83]
ds_read_b64_tr_b16 v[36:37], v12 offset:36864
v_mfma_f32_16x16x32_bf16 v[84:87], v[20:23], a[112:115], v[84:87]
v_mfma_f32_16x16x32_bf16 v[88:91], v[20:23], a[176:179], v[88:91]
ds_read_b64_tr_b16 v[38:39], v12 offset:37376
v_mfma_f32_16x16x32_bf16 v[92:95], v[20:23], a[240:243], v[92:95]
s_waitcnt lgkmcnt(6)
v_mfma_f32_16x16x32_bf16 v[96:99], v[24:27], a[48:51], v[96:99]
ds_read_b64_tr_b16 v[40:41], v11 offset:37120
v_mfma_f32_16x16x32_bf16 v[100:103], v[24:27], a[112:115], v[100:103]
v_mfma_f32_16x16x32_bf16 v[104:107], v[24:27], a[176:179], v[104:107]
ds_read_b64_tr_b16 v[42:43], v11 offset:37632
v_mfma_f32_16x16x32_bf16 v[108:111], v[24:27], a[240:243], v[108:111]
s_waitcnt lgkmcnt(6)
v_mfma_f32_16x16x32_bf16 v[112:115], v[28:31], a[48:51], v[112:115]
ds_read_b64_tr_b16 v[44:45], v12 offset:37120
v_mfma_f32_16x16x32_bf16 v[116:119], v[28:31], a[112:115], v[116:119]
v_mfma_f32_16x16x32_bf16 v[120:123], v[28:31], a[176:179], v[120:123]
ds_read_b64_tr_b16 v[46:47], v12 offset:37632
v_mfma_f32_16x16x32_bf16 v[124:127], v[28:31], a[240:243], v[124:127]
s_waitcnt lgkmcnt(6)
v_mfma_f32_16x16x32_bf16 v[128:131], v[32:35], a[48:51], v[128:131]
ds_read_b64_tr_b16 v[16:17], v11 offset:40960
v_mfma_f32_16x16x32_bf16 v[132:135], v[32:35], a[112:115], v[132:135]
v_mfma_f32_16x16x32_bf16 v[136:139], v[32:35], a[176:179], v[136:139]
ds_read_b64_tr_b16 v[18:19], v11 offset:41472
v_mfma_f32_16x16x32_bf16 v[140:143], v[32:35], a[240:243], v[140:143]
s_waitcnt lgkmcnt(6)
v_mfma_f32_16x16x32_bf16 v[144:147], v[36:39], a[48:51], v[144:147]
ds_read_b64_tr_b16 v[20:21], v12 offset:40960
v_mfma_f32_16x16x32_bf16 v[148:151], v[36:39], a[112:115], v[148:151]
v_mfma_f32_16x16x32_bf16 v[152:155], v[36:39], a[176:179], v[152:155]
ds_read_b64_tr_b16 v[22:23], v12 offset:41472
v_mfma_f32_16x16x32_bf16 v[156:159], v[36:39], a[240:243], v[156:159]
s_waitcnt lgkmcnt(6)
v_mfma_f32_16x16x32_bf16 v[160:163], v[40:43], a[48:51], v[160:163]
ds_read_b64_tr_b16 v[24:25], v11 offset:41216
v_mfma_f32_16x16x32_bf16 v[164:167], v[40:43], a[112:115], v[164:167]
v_mfma_f32_16x16x32_bf16 v[168:171], v[40:43], a[176:179], v[168:171]
ds_read_b64_tr_b16 v[26:27], v11 offset:41728
v_mfma_f32_16x16x32_bf16 v[172:175], v[40:43], a[240:243], v[172:175]
s_waitcnt lgkmcnt(6)
v_mfma_f32_16x16x32_bf16 v[176:179], v[44:47], a[48:51], v[176:179]
ds_read_b64_tr_b16 v[28:29], v12 offset:41216
v_mfma_f32_16x16x32_bf16 v[180:183], v[44:47], a[112:115], v[180:183]
v_mfma_f32_16x16x32_bf16 v[184:187], v[44:47], a[176:179], v[184:187]
ds_read_b64_tr_b16 v[30:31], v12 offset:41728
v_mfma_f32_16x16x32_bf16 v[188:191], v[44:47], a[240:243], v[188:191]
s_waitcnt lgkmcnt(6)
v_mfma_f32_16x16x32_bf16 v[64:67], v[16:19], a[52:55], v[64:67]
ds_read_b64_tr_b16 v[32:33], v11 offset:45056
v_mfma_f32_16x16x32_bf16 v[68:71], v[16:19], a[116:119], v[68:71]
v_mfma_f32_16x16x32_bf16 v[72:75], v[16:19], a[180:183], v[72:75]
ds_read_b64_tr_b16 v[34:35], v11 offset:45568
v_mfma_f32_16x16x32_bf16 v[76:79], v[16:19], a[244:247], v[76:79]
s_waitcnt lgkmcnt(6)
v_mfma_f32_16x16x32_bf16 v[80:83], v[20:23], a[52:55], v[80:83]
ds_read_b64_tr_b16 v[36:37], v12 offset:45056
s_and_b32 s18, s20, 1
s_lshr_b32 s19, s20, 1
v_mfma_f32_16x16x32_bf16 v[84:87], v[20:23], a[116:119], v[84:87]
v_mfma_f32_16x16x32_bf16 v[88:91], v[20:23], a[180:183], v[88:91]
ds_read_b64_tr_b16 v[38:39], v12 offset:45568
s_sub_u32 s16, 15, s22
s_cmp_eq_u32 s19, 0
s_cselect_b32 s17, s22, s16
v_mfma_f32_16x16x32_bf16 v[92:95], v[20:23], a[244:247], v[92:95]
s_waitcnt lgkmcnt(6)
v_mfma_f32_16x16x32_bf16 v[96:99], v[24:27], a[52:55], v[96:99]
ds_read_b64_tr_b16 v[40:41], v11 offset:45312
s_lshl_b32 s17, s17, 3
s_lshl_b32 s23, s18, 2
v_mfma_f32_16x16x32_bf16 v[100:103], v[24:27], a[116:119], v[100:103]
v_mfma_f32_16x16x32_bf16 v[104:107], v[24:27], a[180:183], v[104:107]
ds_read_b64_tr_b16 v[42:43], v11 offset:45824
s_add_u32 s17, s17, s23
v_lshlrev_b32 v7, 4, v1
v_mfma_f32_16x16x32_bf16 v[108:111], v[24:27], a[244:247], v[108:111]
s_waitcnt lgkmcnt(6)
v_mfma_f32_16x16x32_bf16 v[112:115], v[28:31], a[52:55], v[112:115]
ds_read_b64_tr_b16 v[44:45], v12 offset:45312
s_lshl_b32 s52, s17, 14
v_lshrrev_b32 v8, 5, v1
v_mfma_f32_16x16x32_bf16 v[116:119], v[28:31], a[116:119], v[116:119]
v_mfma_f32_16x16x32_bf16 v[120:123], v[28:31], a[180:183], v[120:123]
ds_read_b64_tr_b16 v[46:47], v12 offset:45824
v_lshlrev_b32 v8, 2, v8
v_bfe_u32 v9, v1, 2, 2
v_mfma_f32_16x16x32_bf16 v[124:127], v[28:31], a[244:247], v[124:127]
s_waitcnt vmcnt(5)
s_barrier
s_waitcnt lgkmcnt(6)
v_mfma_f32_16x16x32_bf16 v[128:131], v[32:35], a[52:55], v[128:131]
ds_read_b64_tr_b16 v[16:17], v11 offset:49152
v_add_u32 v8, v8, v9
s_lshl_b32 s23, s20, 3
v_mfma_f32_16x16x32_bf16 v[132:135], v[32:35], a[116:119], v[132:135]
s_add_u32 m0, s56, 16384
s_add_u32 s57, s55, 1048576
buffer_load_dwordx4 v10, s[36:39], s57 offen lds
v_mfma_f32_16x16x32_bf16 v[136:139], v[32:35], a[180:183], v[136:139]
v_add_u32 v8, s23, v8
s_mov_b32 s23, 2752
ds_read_b64_tr_b16 v[18:19], v11 offset:49664
v_mfma_f32_16x16x32_bf16 v[140:143], v[32:35], a[244:247], v[140:143]
v_mul_lo_u32 v8, v8, s23
v_bfe_u32 v9, v1, 4, 1
s_waitcnt lgkmcnt(6)
v_mfma_f32_16x16x32_bf16 v[144:147], v[36:39], a[52:55], v[144:147]
ds_read_b64_tr_b16 v[20:21], v12 offset:49152
v_mfma_f32_16x16x32_bf16 v[148:151], v[36:39], a[116:119], v[148:151]
v_lshl_add_u32 v8, v9, 6, v8
s_and_b32 s23, s20, 1
v_mfma_f32_16x16x32_bf16 v[152:155], v[36:39], a[180:183], v[152:155]
ds_read_b64_tr_b16 v[22:23], v12 offset:49664
s_add_u32 m0, s56, 20480
s_add_u32 s57, s55, 1310720
buffer_load_dwordx4 v10, s[36:39], s57 offen lds
v_mfma_f32_16x16x32_bf16 v[156:159], v[36:39], a[244:247], v[156:159]
s_lshl_b32 s23, s23, 1
v_and_b32 v9, 3, v1
s_waitcnt lgkmcnt(6)
v_mfma_f32_16x16x32_bf16 v[160:163], v[40:43], a[52:55], v[160:163]
ds_read_b64_tr_b16 v[24:25], v11 offset:49408
v_mfma_f32_16x16x32_bf16 v[164:167], v[40:43], a[116:119], v[164:167]
v_xor_b32 v9, s23, v9
v_lshl_add_u32 v8, v9, 4, v8
v_mfma_f32_16x16x32_bf16 v[168:171], v[40:43], a[180:183], v[168:171]
ds_read_b64_tr_b16 v[26:27], v11 offset:49920
v_mfma_f32_16x16x32_bf16 v[172:175], v[40:43], a[244:247], v[172:175]
s_lshl_b32 s23, s21, 20
s_add_u32 s23, s23, 2097152
s_add_u32 m0, s56, 24576
s_add_u32 s57, s55, 1572864
buffer_load_dwordx4 v10, s[36:39], s57 offen lds
s_waitcnt lgkmcnt(6)
v_mfma_f32_16x16x32_bf16 v[176:179], v[44:47], a[52:55], v[176:179]
ds_read_b64_tr_b16 v[28:29], v12 offset:49408
v_mfma_f32_16x16x32_bf16 v[180:183], v[44:47], a[116:119], v[180:183]
s_add_u32 s28, s96, s23
s_addc_u32 s29, s97, 0
v_mfma_f32_16x16x32_bf16 v[184:187], v[44:47], a[180:183], v[184:187]
ds_read_b64_tr_b16 v[30:31], v12 offset:49920
v_mfma_f32_16x16x32_bf16 v[188:191], v[44:47], a[244:247], v[188:191]
s_add_u32 s30, s16, 1
s_lshl_b32 s30, s30, 16
s_waitcnt lgkmcnt(6)
v_mfma_f32_16x16x32_bf16 v[64:67], v[16:19], a[56:59], v[64:67]
ds_read_b64_tr_b16 v[32:33], v11 offset:53248
s_add_u32 m0, s56, 28672
s_add_u32 s57, s55, 1835008
buffer_load_dwordx4 v10, s[36:39], s57 offen lds
v_mfma_f32_16x16x32_bf16 v[68:71], v[16:19], a[120:123], v[68:71]
s_add_u32 s32, s96, 35651584
s_addc_u32 s33, s97, 0
v_mfma_f32_16x16x32_bf16 v[72:75], v[16:19], a[184:187], v[72:75]
ds_read_b64_tr_b16 v[34:35], v11 offset:53760
s_mov_b32 s34, 8388608
s_mov_b32 s35, 0x20000
v_mfma_f32_16x16x32_bf16 v[76:79], v[16:19], a[248:251], v[76:79]
s_waitcnt lgkmcnt(6)
v_mfma_f32_16x16x32_bf16 v[80:83], v[20:23], a[56:59], v[80:83]
ds_read_b64_tr_b16 v[36:37], v12 offset:53248
s_lshl_b32 s23, s19, 13
v_add_u32 v4, s23, v7
v_mfma_f32_16x16x32_bf16 v[84:87], v[20:23], a[120:123], v[84:87]
v_mfma_f32_16x16x32_bf16 v[88:91], v[20:23], a[184:187], v[88:91]
ds_read_b64_tr_b16 v[38:39], v12 offset:53760
v_add_u32 v5, 0x10000, v4
s_lshl_b32 s3, s18, 12
v_mfma_f32_16x16x32_bf16 v[92:95], v[20:23], a[248:251], v[92:95]
s_waitcnt lgkmcnt(6)
v_mfma_f32_16x16x32_bf16 v[96:99], v[24:27], a[56:59], v[96:99]
ds_read_b64_tr_b16 v[40:41], v11 offset:53504
s_add_u32 s62, s23, s3
s_add_u32 s63, s62, 0x10000
v_mfma_f32_16x16x32_bf16 v[100:103], v[24:27], a[120:123], v[100:103]
v_mfma_f32_16x16x32_bf16 v[104:107], v[24:27], a[184:187], v[104:107]
ds_read_b64_tr_b16 v[42:43], v11 offset:54016
s_lshl_b32 s23, s19, 14
s_add_u32 s23, s23, s3
v_mfma_f32_16x16x32_bf16 v[108:111], v[24:27], a[248:251], v[108:111]
s_waitcnt lgkmcnt(6)
v_mfma_f32_16x16x32_bf16 v[112:115], v[28:31], a[56:59], v[112:115]
buffer_load_dword v63, v58, s[4:7], s55 offen
ds_read_b64_tr_b16 v[44:45], v12 offset:53504
v_add_u32 v6, s23, v7
s_add_u32 s60, s22, 1
v_mfma_f32_16x16x32_bf16 v[116:119], v[28:31], a[120:123], v[116:119]
v_mfma_f32_16x16x32_bf16 v[120:123], v[28:31], a[184:187], v[120:123]
ds_read_b64_tr_b16 v[46:47], v12 offset:54016
s_lshl_b32 s60, s60, 16
s_add_u32 s61, s60, 8192
v_mfma_f32_16x16x32_bf16 v[124:127], v[28:31], a[248:251], v[124:127]
s_waitcnt lgkmcnt(6)
v_mfma_f32_16x16x32_bf16 v[128:131], v[32:35], a[56:59], v[128:131]
s_mov_b32 s64, 0x4e800000
s_mul_i32 s3, s17, 175104
ds_read_b64_tr_b16 v[16:17], v11 offset:57344
v_mfma_f32_16x16x32_bf16 v[132:135], v[32:35], a[120:123], v[132:135]
s_lshr_b32 s23, s67, 5
v_lshrrev_b32 v15, 5, v1
v_mfma_f32_16x16x32_bf16 v[136:139], v[32:35], a[184:187], v[136:139]
ds_read_b64_tr_b16 v[18:19], v11 offset:57856
v_mfma_f32_16x16x32_bf16 v[140:143], v[32:35], a[248:251], v[140:143]
v_lshlrev_b32 v15, 10, v15
v_bfe_u32 v9, v1, 4, 1
s_waitcnt lgkmcnt(6)
v_mfma_f32_16x16x32_bf16 v[144:147], v[36:39], a[56:59], v[144:147]
ds_read_b64_tr_b16 v[20:21], v12 offset:57344
v_mfma_f32_16x16x32_bf16 v[148:151], v[36:39], a[120:123], v[148:151]
v_lshl_add_u32 v15, v9, 9, v15
v_and_b32 v9, 15, v1
v_mfma_f32_16x16x32_bf16 v[152:155], v[36:39], a[184:187], v[152:155]
ds_read_b64_tr_b16 v[22:23], v12 offset:57856
v_mfma_f32_16x16x32_bf16 v[156:159], v[36:39], a[248:251], v[156:159]
v_lshl_add_u32 v15, v9, 4, v15
s_add_u32 s54, s23, 0
s_waitcnt lgkmcnt(6)
v_mfma_f32_16x16x32_bf16 v[160:163], v[40:43], a[56:59], v[160:163]
ds_read_b64_tr_b16 v[24:25], v11 offset:57600
v_mfma_f32_16x16x32_bf16 v[164:167], v[40:43], a[120:123], v[164:167]
s_lshr_b32 s70, s54, 1
s_lshl_b32 s70, s70, 10
v_mfma_f32_16x16x32_bf16 v[168:171], v[40:43], a[184:187], v[168:171]
ds_read_b64_tr_b16 v[26:27], v11 offset:58112
v_mfma_f32_16x16x32_bf16 v[172:175], v[40:43], a[248:251], v[172:175]
s_and_b32 s54, s54, 1
s_lshl_b32 s54, s54, 9
s_waitcnt lgkmcnt(6)
v_mfma_f32_16x16x32_bf16 v[176:179], v[44:47], a[56:59], v[176:179]
ds_read_b64_tr_b16 v[28:29], v12 offset:57600
v_mfma_f32_16x16x32_bf16 v[180:183], v[44:47], a[120:123], v[180:183]
s_add_u32 s70, s70, s54
s_add_u32 s70, s70, s3
v_mfma_f32_16x16x32_bf16 v[184:187], v[44:47], a[184:187], v[184:187]
ds_read_b64_tr_b16 v[30:31], v12 offset:58112
v_mfma_f32_16x16x32_bf16 v[188:191], v[44:47], a[248:251], v[188:191]
s_add_u32 s54, s23, 1
s_lshr_b32 s71, s54, 1
s_waitcnt lgkmcnt(6)
v_mfma_f32_16x16x32_bf16 v[64:67], v[16:19], a[60:63], v[64:67]
ds_read_b64_tr_b16 v[32:33], v11 offset:61440
s_lshl_b32 s71, s71, 10
s_and_b32 s54, s54, 1
v_mfma_f32_16x16x32_bf16 v[68:71], v[16:19], a[124:127], v[68:71]
v_mfma_f32_16x16x32_bf16 v[72:75], v[16:19], a[188:191], v[72:75]
ds_read_b64_tr_b16 v[34:35], v11 offset:61952
s_lshl_b32 s54, s54, 9
s_add_u32 s71, s71, s54
v_mfma_f32_16x16x32_bf16 v[76:79], v[16:19], a[252:255], v[76:79]
s_waitcnt lgkmcnt(6)
v_mfma_f32_16x16x32_bf16 v[80:83], v[20:23], a[60:63], v[80:83]
ds_read_b64_tr_b16 v[36:37], v12 offset:61440
s_add_u32 s71, s71, s3
s_add_u32 s54, s23, 2
v_mfma_f32_16x16x32_bf16 v[84:87], v[20:23], a[124:127], v[84:87]
v_mfma_f32_16x16x32_bf16 v[88:91], v[20:23], a[188:191], v[88:91]
ds_read_b64_tr_b16 v[38:39], v12 offset:61952
s_lshr_b32 s72, s54, 1
s_lshl_b32 s72, s72, 10
v_mfma_f32_16x16x32_bf16 v[92:95], v[20:23], a[252:255], v[92:95]
s_waitcnt lgkmcnt(6)
v_mfma_f32_16x16x32_bf16 v[96:99], v[24:27], a[60:63], v[96:99]
ds_read_b64_tr_b16 v[40:41], v11 offset:61696
s_and_b32 s54, s54, 1
s_lshl_b32 s54, s54, 9
v_mfma_f32_16x16x32_bf16 v[100:103], v[24:27], a[124:127], v[100:103]
v_mfma_f32_16x16x32_bf16 v[104:107], v[24:27], a[188:191], v[104:107]
ds_read_b64_tr_b16 v[42:43], v11 offset:62208
s_add_u32 s72, s72, s54
s_add_u32 s72, s72, s3
v_mfma_f32_16x16x32_bf16 v[108:111], v[24:27], a[252:255], v[108:111]
s_waitcnt lgkmcnt(6)
v_mfma_f32_16x16x32_bf16 v[112:115], v[28:31], a[60:63], v[112:115]
ds_read_b64_tr_b16 v[44:45], v12 offset:61696
s_add_u32 s72, s72, s75
s_lshl_b32 s23, s18, 14
v_mfma_f32_16x16x32_bf16 v[116:119], v[28:31], a[124:127], v[116:119]
v_mfma_f32_16x16x32_bf16 v[120:123], v[28:31], a[188:191], v[120:123]
s_add_u32 s54, s23, 32768
s_lshl_b32 s3, s2, 15
ds_read_b64_tr_b16 v[46:47], v12 offset:62208
v_mfma_f32_16x16x32_bf16 v[124:127], v[28:31], a[252:255], v[124:127]
s_waitcnt vmcnt(5)
s_barrier
s_add_u32 s3, s3, s23
s_cmp_eq_u32 s19, 0
s_cselect_b32 s54, s54, 98304
s_cselect_b32 s73, 0x7000000, s3
s_waitcnt lgkmcnt(6)
v_mfma_f32_16x16x32_bf16 v[128:131], v[32:35], a[60:63], v[128:131]
ds_read_b64_tr_b16 v[16:17], v11 offset:0
v_mfma_f32_16x16x32_bf16 v[132:135], v[32:35], a[124:127], v[132:135]
s_add_u32 m0, s56, 32768
s_add_u32 s57, s55, 2097152
buffer_load_dwordx4 v10, s[36:39], s57 offen lds
v_add_u32 v14, s54, v15
s_mov_b32 s68, 0xbdd2d3e8
v_mfma_f32_16x16x32_bf16 v[136:139], v[32:35], a[188:191], v[136:139]
ds_read_b64_tr_b16 v[18:19], v11 offset:512
v_mfma_f32_16x16x32_bf16 v[140:143], v[32:35], a[252:255], v[140:143]
s_mov_b32 s74, 0x3e0293ee
v_mov_b32 v62, 0xc0135761
s_waitcnt lgkmcnt(6)
v_mfma_f32_16x16x32_bf16 v[144:147], v[36:39], a[60:63], v[144:147]
ds_read_b64_tr_b16 v[20:21], v12 offset:0
v_mfma_f32_16x16x32_bf16 v[148:151], v[36:39], a[124:127], v[148:151]
v_and_b32 v9, 7, v1
v_lshlrev_b32 v9, 2, v9
v_mfma_f32_16x16x32_bf16 v[152:155], v[36:39], a[188:191], v[152:155]
ds_read_b64_tr_b16 v[22:23], v12 offset:512
s_add_u32 m0, s56, 36864
s_add_u32 s57, s55, 2359296
buffer_load_dwordx4 v10, s[36:39], s57 offen lds
v_mfma_f32_16x16x32_bf16 v[156:159], v[36:39], a[252:255], v[156:159]
v_add_u32 v13, s53, v7
v_bfe_u32 v56, v1, 4, 1
s_waitcnt lgkmcnt(6)
v_mfma_f32_16x16x32_bf16 v[160:163], v[40:43], a[60:63], v[160:163]
ds_read_b64_tr_b16 v[24:25], v11 offset:256
v_mfma_f32_16x16x32_bf16 v[164:167], v[40:43], a[124:127], v[164:167]
v_mul_u32_u24 v0, 175104, v56
v_lshrrev_b32 v56, 5, v1
v_mfma_f32_16x16x32_bf16 v[168:171], v[40:43], a[188:191], v[168:171]
ds_read_b64_tr_b16 v[26:27], v11 offset:768
v_mfma_f32_16x16x32_bf16 v[172:175], v[40:43], a[252:255], v[172:175]
v_lshl_add_u32 v0, v56, 8, v0
v_and_b32 v56, 15, v1
s_add_u32 m0, s56, 40960
s_add_u32 s57, s55, 2621440
buffer_load_dwordx4 v10, s[36:39], s57 offen lds
s_waitcnt lgkmcnt(6)
v_mfma_f32_16x16x32_bf16 v[176:179], v[44:47], a[60:63], v[176:179]
ds_read_b64_tr_b16 v[28:29], v12 offset:256
v_mfma_f32_16x16x32_bf16 v[180:183], v[44:47], a[124:127], v[180:183]
v_lshl_add_u32 v0, v56, 4, v0
v_mfma_f32_16x16x32_bf16 v[184:187], v[44:47], a[188:191], v[184:187]
ds_read_b64_tr_b16 v[30:31], v12 offset:768
v_mfma_f32_16x16x32_bf16 v[188:191], v[44:47], a[252:255], v[188:191]
s_waitcnt lgkmcnt(6)
v_mfma_f32_16x16x32_bf16 v[192:195], a[0:3], v[16:19], 0
global_load_dword v63, v9, s[98:99] sc1
ds_read_b64_tr_b16 v[32:33], v11 offset:4096
s_add_u32 m0, s56, 45056
s_add_u32 s57, s55, 2883584
buffer_load_dwordx4 v10, s[36:39], s57 offen lds
v_mfma_f32_16x16x32_bf16 v[196:199], a[64:67], v[16:19], 0
v_mfma_f32_16x16x32_bf16 v[200:203], a[128:131], v[16:19], 0
ds_read_b64_tr_b16 v[34:35], v11 offset:4608
v_mfma_f32_16x16x32_bf16 v[204:207], a[192:195], v[16:19], 0
s_waitcnt lgkmcnt(6)
v_mfma_f32_16x16x32_bf16 v[208:211], a[0:3], v[20:23], 0
ds_read_b64_tr_b16 v[36:37], v12 offset:4096
v_mfma_f32_16x16x32_bf16 v[212:215], a[64:67], v[20:23], 0
v_mfma_f32_16x16x32_bf16 v[216:219], a[128:131], v[20:23], 0
ds_read_b64_tr_b16 v[38:39], v12 offset:4608
v_mfma_f32_16x16x32_bf16 v[220:223], a[192:195], v[20:23], 0
s_waitcnt lgkmcnt(6)
v_mfma_f32_16x16x32_bf16 v[224:227], a[0:3], v[24:27], 0
ds_read_b64_tr_b16 v[40:41], v11 offset:4352
v_mfma_f32_16x16x32_bf16 v[228:231], a[64:67], v[24:27], 0
v_cvt_pk_bf16_f32 v48, v64, v65
v_mfma_f32_16x16x32_bf16 v[232:235], a[128:131], v[24:27], 0
ds_read_b64_tr_b16 v[42:43], v11 offset:4864
v_mfma_f32_16x16x32_bf16 v[236:239], a[192:195], v[24:27], 0
s_waitcnt lgkmcnt(6)
v_mfma_f32_16x16x32_bf16 v[240:243], a[0:3], v[28:31], 0
ds_read_b64_tr_b16 v[44:45], v12 offset:4352
v_cvt_pk_bf16_f32 v49, v66, v67
v_mfma_f32_16x16x32_bf16 v[244:247], a[64:67], v[28:31], 0
v_mfma_f32_16x16x32_bf16 v[248:251], a[128:131], v[28:31], 0
ds_read_b64_tr_b16 v[46:47], v12 offset:4864
v_mfma_f32_16x16x32_bf16 v[252:255], a[192:195], v[28:31], 0
v_cvt_pk_bf16_f32 v50, v80, v81
s_waitcnt lgkmcnt(6)
v_mfma_f32_16x16x32_bf16 v[192:195], a[4:7], v[32:35], v[192:195]
ds_read_b64_tr_b16 v[16:17], v11 offset:8192
v_mfma_f32_16x16x32_bf16 v[196:199], a[68:71], v[32:35], v[196:199]
v_mfma_f32_16x16x32_bf16 v[200:203], a[132:135], v[32:35], v[200:203]
ds_read_b64_tr_b16 v[18:19], v11 offset:8704
v_cvt_pk_bf16_f32 v51, v82, v83
v_mfma_f32_16x16x32_bf16 v[204:207], a[196:199], v[32:35], v[204:207]
s_waitcnt lgkmcnt(6)
v_mfma_f32_16x16x32_bf16 v[208:211], a[4:7], v[36:39], v[208:211]
ds_read_b64_tr_b16 v[20:21], v12 offset:8192
v_mfma_f32_16x16x32_bf16 v[212:215], a[68:71], v[36:39], v[212:215]
s_add_u32 s59, s58, 0
buffer_store_dwordx4 v[48:51], v2, s[44:47], s59 offen offset:0 sc1
v_mfma_f32_16x16x32_bf16 v[216:219], a[132:135], v[36:39], v[216:219]
ds_read_b64_tr_b16 v[22:23], v12 offset:8704
v_mfma_f32_16x16x32_bf16 v[220:223], a[196:199], v[36:39], v[220:223]
s_waitcnt lgkmcnt(6)
v_mfma_f32_16x16x32_bf16 v[224:227], a[4:7], v[40:43], v[224:227]
ds_read_b64_tr_b16 v[24:25], v11 offset:8448
v_cvt_pk_bf16_f32 v52, v96, v97
v_mfma_f32_16x16x32_bf16 v[228:231], a[68:71], v[40:43], v[228:231]
v_mfma_f32_16x16x32_bf16 v[232:235], a[132:135], v[40:43], v[232:235]
ds_read_b64_tr_b16 v[26:27], v11 offset:8960
v_mfma_f32_16x16x32_bf16 v[236:239], a[196:199], v[40:43], v[236:239]
v_cvt_pk_bf16_f32 v53, v98, v99
s_waitcnt lgkmcnt(6)
v_mfma_f32_16x16x32_bf16 v[240:243], a[4:7], v[44:47], v[240:243]
ds_read_b64_tr_b16 v[28:29], v12 offset:8448
v_mfma_f32_16x16x32_bf16 v[244:247], a[68:71], v[44:47], v[244:247]
v_mfma_f32_16x16x32_bf16 v[248:251], a[132:135], v[44:47], v[248:251]
ds_read_b64_tr_b16 v[30:31], v12 offset:8960
v_cvt_pk_bf16_f32 v54, v112, v113
v_mfma_f32_16x16x32_bf16 v[252:255], a[196:199], v[44:47], v[252:255]
s_waitcnt lgkmcnt(6)
v_mfma_f32_16x16x32_bf16 v[192:195], a[8:11], v[16:19], v[192:195]
ds_read_b64_tr_b16 v[32:33], v11 offset:12288
v_mfma_f32_16x16x32_bf16 v[196:199], a[72:75], v[16:19], v[196:199]
v_cvt_pk_bf16_f32 v55, v114, v115
v_mfma_f32_16x16x32_bf16 v[200:203], a[136:139], v[16:19], v[200:203]
ds_read_b64_tr_b16 v[34:35], v11 offset:12800
v_mfma_f32_16x16x32_bf16 v[204:207], a[200:203], v[16:19], v[204:207]
s_waitcnt lgkmcnt(6)
v_mfma_f32_16x16x32_bf16 v[208:211], a[8:11], v[20:23], v[208:211]
ds_read_b64_tr_b16 v[36:37], v12 offset:12288
s_add_u32 s59, s58, 0
buffer_store_dwordx4 v[52:55], v2, s[44:47], s59 offen offset:2048 sc1
v_mfma_f32_16x16x32_bf16 v[212:215], a[72:75], v[20:23], v[212:215]
v_mfma_f32_16x16x32_bf16 v[216:219], a[136:139], v[20:23], v[216:219]
ds_read_b64_tr_b16 v[38:39], v12 offset:12800
v_mfma_f32_16x16x32_bf16 v[220:223], a[200:203], v[20:23], v[220:223]
v_cvt_pk_bf16_f32 v56, v128, v129
s_waitcnt lgkmcnt(6)
v_mfma_f32_16x16x32_bf16 v[224:227], a[8:11], v[24:27], v[224:227]
ds_read_b64_tr_b16 v[40:41], v11 offset:12544
v_mfma_f32_16x16x32_bf16 v[228:231], a[72:75], v[24:27], v[228:231]
v_mfma_f32_16x16x32_bf16 v[232:235], a[136:139], v[24:27], v[232:235]
ds_read_b64_tr_b16 v[42:43], v11 offset:13056
v_cvt_pk_bf16_f32 v57, v130, v131
v_mfma_f32_16x16x32_bf16 v[236:239], a[200:203], v[24:27], v[236:239]
s_waitcnt lgkmcnt(6)
v_mfma_f32_16x16x32_bf16 v[240:243], a[8:11], v[28:31], v[240:243]
ds_read_b64_tr_b16 v[44:45], v12 offset:12544
v_mfma_f32_16x16x32_bf16 v[244:247], a[72:75], v[28:31], v[244:247]
v_cvt_pk_bf16_f32 v58, v144, v145
v_mfma_f32_16x16x32_bf16 v[248:251], a[136:139], v[28:31], v[248:251]
ds_read_b64_tr_b16 v[46:47], v12 offset:13056
v_mfma_f32_16x16x32_bf16 v[252:255], a[200:203], v[28:31], v[252:255]
s_waitcnt vmcnt(8)
s_barrier
s_waitcnt lgkmcnt(6)
v_mfma_f32_16x16x32_bf16 v[192:195], a[12:15], v[32:35], v[192:195]
s_waitcnt vmcnt(3)
v_cmp_ne_u32 vcc, 32, v63
s_nop 0
s_and_b64 vcc, vcc, exec
s_cbranch_scc1 SL_x
SR_x:
ds_read_b64_tr_b16 v[16:17], v11 offset:16384
v_cvt_pk_bf16_f32 v59, v146, v147
v_mfma_f32_16x16x32_bf16 v[196:199], a[76:79], v[32:35], v[196:199]
s_add_u32 m0, s56, 49152
s_add_u32 s57, s55, 3145728
buffer_load_dwordx4 v10, s[36:39], s57 offen lds
v_mfma_f32_16x16x32_bf16 v[200:203], a[140:143], v[32:35], v[200:203]
ds_read_b64_tr_b16 v[18:19], v11 offset:16896
s_add_u32 m0, s53, 0
s_add_u32 s23, s52, 0
buffer_load_dwordx4 v7, s[40:43], s23 offen offset:0 sc1 lds
v_mfma_f32_16x16x32_bf16 v[204:207], a[204:207], v[32:35], v[204:207]
s_add_u32 s59, s58, 4096
buffer_store_dwordx4 v[56:59], v2, s[44:47], s59 offen offset:0 sc1
s_waitcnt lgkmcnt(6)
v_mfma_f32_16x16x32_bf16 v[208:211], a[12:15], v[36:39], v[208:211]
ds_read_b64_tr_b16 v[20:21], v12 offset:16384
v_mfma_f32_16x16x32_bf16 v[212:215], a[76:79], v[36:39], v[212:215]
v_mfma_f32_16x16x32_bf16 v[216:219], a[140:143], v[36:39], v[216:219]
ds_read_b64_tr_b16 v[22:23], v12 offset:16896
v_cvt_pk_bf16_f32 v48, v160, v161
s_add_u32 m0, s56, 53248
s_add_u32 s57, s55, 3407872
buffer_load_dwordx4 v10, s[36:39], s57 offen lds
v_mfma_f32_16x16x32_bf16 v[220:223], a[204:207], v[36:39], v[220:223]
s_waitcnt lgkmcnt(6)
v_mfma_f32_16x16x32_bf16 v[224:227], a[12:15], v[40:43], v[224:227]
ds_read_b64_tr_b16 v[24:25], v11 offset:16640
v_mfma_f32_16x16x32_bf16 v[228:231], a[76:79], v[40:43], v[228:231]
v_cvt_pk_bf16_f32 v49, v162, v163
v_mfma_f32_16x16x32_bf16 v[232:235], a[140:143], v[40:43], v[232:235]
ds_read_b64_tr_b16 v[26:27], v11 offset:17152
s_add_u32 m0, s53, 1024
s_add_u32 s23, s52, 16384
buffer_load_dwordx4 v7, s[40:43], s23 offen offset:0 sc1 lds
v_mfma_f32_16x16x32_bf16 v[236:239], a[204:207], v[40:43], v[236:239]
s_add_u32 m0, s56, 57344
s_add_u32 s57, s55, 3670016
buffer_load_dwordx4 v10, s[36:39], s57 offen lds
s_waitcnt lgkmcnt(6)
v_mfma_f32_16x16x32_bf16 v[240:243], a[12:15], v[44:47], v[240:243]
ds_read_b64_tr_b16 v[28:29], v12 offset:16640
v_cvt_pk_bf16_f32 v50, v176, v177
v_mfma_f32_16x16x32_bf16 v[244:247], a[76:79], v[44:47], v[244:247]
v_mfma_f32_16x16x32_bf16 v[248:251], a[140:143], v[44:47], v[248:251]
ds_read_b64_tr_b16 v[30:31], v12 offset:17152
v_mfma_f32_16x16x32_bf16 v[252:255], a[204:207], v[44:47], v[252:255]
v_cvt_pk_bf16_f32 v51, v178, v179
s_waitcnt lgkmcnt(6)
v_mfma_f32_16x16x32_bf16 v[192:195], a[16:19], v[16:19], v[192:195]
ds_read_b64_tr_b16 v[32:33], v11 offset:20480
s_add_u32 m0, s56, 61440
s_add_u32 s57, s55, 3932160
buffer_load_dwordx4 v10, s[36:39], s57 offen lds
v_mfma_f32_16x16x32_bf16 v[196:199], a[80:83], v[16:19], v[196:199]
v_mfma_f32_16x16x32_bf16 v[200:203], a[144:147], v[16:19], v[200:203]
ds_read_b64_tr_b16 v[34:35], v11 offset:20992
s_add_u32 s59, s58, 4096
buffer_store_dwordx4 v[48:51], v2, s[44:47], s59 offen offset:2048 sc1
v_mfma_f32_16x16x32_bf16 v[204:207], a[208:211], v[16:19], v[204:207]
s_add_u32 m0, s53, 2048
s_add_u32 s23, s52, 32768
buffer_load_dwordx4 v7, s[40:43], s23 offen offset:0 sc1 lds
s_waitcnt lgkmcnt(6)
v_mfma_f32_16x16x32_bf16 v[208:211], a[16:19], v[20:23], v[208:211]
ds_read_b64_tr_b16 v[36:37], v12 offset:20480
v_mfma_f32_16x16x32_bf16 v[212:215], a[80:83], v[20:23], v[212:215]
v_cvt_pk_bf16_f32 v52, v68, v69
v_mfma_f32_16x16x32_bf16 v[216:219], a[144:147], v[20:23], v[216:219]
ds_read_b64_tr_b16 v[38:39], v12 offset:20992
v_mfma_f32_16x16x32_bf16 v[220:223], a[208:211], v[20:23], v[220:223]
s_waitcnt lgkmcnt(6)
v_mfma_f32_16x16x32_bf16 v[224:227], a[16:19], v[24:27], v[224:227]
ds_read_b64_tr_b16 v[40:41], v11 offset:20736
v_cvt_pk_bf16_f32 v53, v70, v71
v_mfma_f32_16x16x32_bf16 v[228:231], a[80:83], v[24:27], v[228:231]
v_mfma_f32_16x16x32_bf16 v[232:235], a[144:147], v[24:27], v[232:235]
ds_read_b64_tr_b16 v[42:43], v11 offset:21248
v_mfma_f32_16x16x32_bf16 v[236:239], a[208:211], v[24:27], v[236:239]
v_cvt_pk_bf16_f32 v54, v84, v85
s_add_u32 m0, s53, 3072
s_add_u32 s23, s52, 49152
buffer_load_dwordx4 v7, s[40:43], s23 offen offset:0 sc1 lds
s_waitcnt lgkmcnt(6)
v_mfma_f32_16x16x32_bf16 v[240:243], a[16:19], v[28:31], v[240:243]
ds_read_b64_tr_b16 v[44:45], v12 offset:20736
v_mfma_f32_16x16x32_bf16 v[244:247], a[80:83], v[28:31], v[244:247]
v_mfma_f32_16x16x32_bf16 v[248:251], a[144:147], v[28:31], v[248:251]
ds_read_b64_tr_b16 v[46:47], v12 offset:21248
v_cvt_pk_bf16_f32 v55, v86, v87
v_mfma_f32_16x16x32_bf16 v[252:255], a[208:211], v[28:31], v[252:255]
s_waitcnt lgkmcnt(6)
v_mfma_f32_16x16x32_bf16 v[192:195], a[20:23], v[32:35], v[192:195]
ds_read_b64_tr_b16 v[16:17], v11 offset:24576
v_mfma_f32_16x16x32_bf16 v[196:199], a[84:87], v[32:35], v[196:199]
s_add_u32 s59, s58, 0
buffer_store_dwordx4 v[52:55], v2, s[44:47], s59 offen offset:128 sc1
v_mfma_f32_16x16x32_bf16 v[200:203], a[148:151], v[32:35], v[200:203]
ds_read_b64_tr_b16 v[18:19], v11 offset:25088
v_mfma_f32_16x16x32_bf16 v[204:207], a[212:215], v[32:35], v[204:207]
s_add_u32 m0, s53, 3072
s_add_u32 s23, s52, 0
buffer_load_dwordx4 v7, s[40:43], s23 offen offset:1024 sc1 lds
s_waitcnt lgkmcnt(6)
v_mfma_f32_16x16x32_bf16 v[208:211], a[20:23], v[36:39], v[208:211]
ds_read_b64_tr_b16 v[20:21], v12 offset:24576
v_cvt_pk_bf16_f32 v56, v100, v101
v_mfma_f32_16x16x32_bf16 v[212:215], a[84:87], v[36:39], v[212:215]
v_mfma_f32_16x16x32_bf16 v[216:219], a[148:151], v[36:39], v[216:219]
ds_read_b64_tr_b16 v[22:23], v12 offset:25088
v_mfma_f32_16x16x32_bf16 v[220:223], a[212:215], v[36:39], v[220:223]
v_cvt_pk_bf16_f32 v57, v102, v103
s_waitcnt lgkmcnt(6)
v_mfma_f32_16x16x32_bf16 v[224:227], a[20:23], v[40:43], v[224:227]
ds_read_b64_tr_b16 v[24:25], v11 offset:24832
v_mfma_f32_16x16x32_bf16 v[228:231], a[84:87], v[40:43], v[228:231]
v_mfma_f32_16x16x32_bf16 v[232:235], a[148:151], v[40:43], v[232:235]
ds_read_b64_tr_b16 v[26:27], v11 offset:25344
v_cvt_pk_bf16_f32 v58, v116, v117
v_mfma_f32_16x16x32_bf16 v[236:239], a[212:215], v[40:43], v[236:239]
s_waitcnt lgkmcnt(6)
v_mfma_f32_16x16x32_bf16 v[240:243], a[20:23], v[44:47], v[240:243]
ds_read_b64_tr_b16 v[28:29], v12 offset:24832
s_add_u32 m0, s53, 4096
s_add_u32 s23, s52, 16384
buffer_load_dwordx4 v7, s[40:43], s23 offen offset:1024 sc1 lds
v_mfma_f32_16x16x32_bf16 v[244:247], a[84:87], v[44:47], v[244:247]
v_cvt_pk_bf16_f32 v59, v118, v119
v_mfma_f32_16x16x32_bf16 v[248:251], a[148:151], v[44:47], v[248:251]
ds_read_b64_tr_b16 v[30:31], v12 offset:25344
v_mfma_f32_16x16x32_bf16 v[252:255], a[212:215], v[44:47], v[252:255]
s_waitcnt lgkmcnt(6)
v_mfma_f32_16x16x32_bf16 v[192:195], a[24:27], v[16:19], v[192:195]
ds_read_b64_tr_b16 v[32:33], v11 offset:28672
s_add_u32 s59, s58, 0
buffer_store_dwordx4 v[56:59], v2, s[44:47], s59 offen offset:2176 sc1
v_mfma_f32_16x16x32_bf16 v[196:199], a[88:91], v[16:19], v[196:199]
v_mfma_f32_16x16x32_bf16 v[200:203], a[152:155], v[16:19], v[200:203]
ds_read_b64_tr_b16 v[34:35], v11 offset:29184
v_mfma_f32_16x16x32_bf16 v[204:207], a[216:219], v[16:19], v[204:207]
v_cvt_pk_bf16_f32 v48, v132, v133
s_waitcnt lgkmcnt(6)
v_mfma_f32_16x16x32_bf16 v[208:211], a[24:27], v[20:23], v[208:211]
ds_read_b64_tr_b16 v[36:37], v12 offset:28672
s_add_u32 m0, s53, 5120
s_add_u32 s23, s52, 32768
buffer_load_dwordx4 v7, s[40:43], s23 offen offset:1024 sc1 lds
v_mfma_f32_16x16x32_bf16 v[212:215], a[88:91], v[20:23], v[212:215]
v_mfma_f32_16x16x32_bf16 v[216:219], a[152:155], v[20:23], v[216:219]
ds_read_b64_tr_b16 v[38:39], v12 offset:29184
v_cvt_pk_bf16_f32 v49, v134, v135
v_mfma_f32_16x16x32_bf16 v[220:223], a[216:219], v[20:23], v[220:223]
s_waitcnt lgkmcnt(6)
v_mfma_f32_16x16x32_bf16 v[224:227], a[24:27], v[24:27], v[224:227]
ds_read_b64_tr_b16 v[40:41], v11 offset:28928
v_mfma_f32_16x16x32_bf16 v[228:231], a[88:91], v[24:27], v[228:231]
v_cvt_pk_bf16_f32 v50, v148, v149
v_mfma_f32_16x16x32_bf16 v[232:235], a[152:155], v[24:27], v[232:235]
ds_read_b64_tr_b16 v[42:43], v11 offset:29440
v_mfma_f32_16x16x32_bf16 v[236:239], a[216:219], v[24:27], v[236:239]
s_waitcnt lgkmcnt(6)
v_mfma_f32_16x16x32_bf16 v[240:243], a[24:27], v[28:31], v[240:243]
ds_read_b64_tr_b16 v[44:45], v12 offset:28928
v_cvt_pk_bf16_f32 v51, v150, v151
s_add_u32 m0, s53, 6144
s_add_u32 s23, s52, 49152
buffer_load_dwordx4 v7, s[40:43], s23 offen offset:1024 sc1 lds
v_mfma_f32_16x16x32_bf16 v[244:247], a[88:91], v[28:31], v[244:247]
v_mfma_f32_16x16x32_bf16 v[248:251], a[152:155], v[28:31], v[248:251]
ds_read_b64_tr_b16 v[46:47], v12 offset:29440
v_mfma_f32_16x16x32_bf16 v[252:255], a[216:219], v[28:31], v[252:255]
s_waitcnt vmcnt(18)
s_barrier
s_add_u32 s59, s58, 4096
buffer_store_dwordx4 v[48:51], v2, s[44:47], s59 offen offset:128 sc1
s_waitcnt lgkmcnt(6)
v_mfma_f32_16x16x32_bf16 v[192:195], a[28:31], v[32:35], v[192:195]
ds_read_b64_tr_b16 v[16:17], v11 offset:32768
v_mfma_f32_16x16x32_bf16 v[196:199], a[92:95], v[32:35], v[196:199]
s_add_u32 m0, s56, 0
s_add_u32 s57, s55, 128
buffer_load_dwordx4 v10, s[36:39], s57 offen lds
v_mfma_f32_16x16x32_bf16 v[200:203], a[156:159], v[32:35], v[200:203]
ds_read_b64_tr_b16 v[18:19], v11 offset:33280
v_cvt_pk_bf16_f32 v52, v164, v165
v_mfma_f32_16x16x32_bf16 v[204:207], a[220:223], v[32:35], v[204:207]
s_waitcnt lgkmcnt(6)
v_mfma_f32_16x16x32_bf16 v[208:211], a[28:31], v[36:39], v[208:211]
ds_read_b64_tr_b16 v[20:21], v12 offset:32768
v_mfma_f32_16x16x32_bf16 v[212:215], a[92:95], v[36:39], v[212:215]
s_add_u32 m0, s53, 6144
s_add_u32 s23, s52, 0
buffer_load_dwordx4 v7, s[40:43], s23 offen offset:2048 sc1 lds
v_cvt_pk_bf16_f32 v53, v166, v167
v_mfma_f32_16x16x32_bf16 v[216:219], a[156:159], v[36:39], v[216:219]
ds_read_b64_tr_b16 v[22:23], v12 offset:33280
s_add_u32 m0, s56, 4096
s_add_u32 s57, s55, 262272
buffer_load_dwordx4 v10, s[36:39], s57 offen lds
v_mfma_f32_16x16x32_bf16 v[220:223], a[220:223], v[36:39], v[220:223]
s_waitcnt lgkmcnt(6)
v_mfma_f32_16x16x32_bf16 v[224:227], a[28:31], v[40:43], v[224:227]
ds_read_b64_tr_b16 v[24:25], v11 offset:33024
v_cvt_pk_bf16_f32 v54, v180, v181
v_mfma_f32_16x16x32_bf16 v[228:231], a[92:95], v[40:43], v[228:231]
v_mfma_f32_16x16x32_bf16 v[232:235], a[156:159], v[40:43], v[232:235]
ds_read_b64_tr_b16 v[26:27], v11 offset:33536
v_mfma_f32_16x16x32_bf16 v[236:239], a[220:223], v[40:43], v[236:239]
v_cvt_pk_bf16_f32 v55, v182, v183
s_add_u32 m0, s56, 8192
s_add_u32 s57, s55, 524416
buffer_load_dwordx4 v10, s[36:39], s57 offen lds
s_waitcnt lgkmcnt(6)
v_mfma_f32_16x16x32_bf16 v[240:243], a[28:31], v[44:47], v[240:243]
ds_read_b64_tr_b16 v[28:29], v12 offset:33024
v_mfma_f32_16x16x32_bf16 v[244:247], a[92:95], v[44:47], v[244:247]
s_add_u32 m0, s53, 7168
s_add_u32 s23, s52, 16384
buffer_load_dwordx4 v7, s[40:43], s23 offen offset:2048 sc1 lds
v_mfma_f32_16x16x32_bf16 v[248:251], a[156:159], v[44:47], v[248:251]
ds_read_b64_tr_b16 v[30:31], v12 offset:33536
s_add_u32 s59, s58, 4096
buffer_store_dwordx4 v[52:55], v2, s[44:47], s59 offen offset:2176 sc1
v_mfma_f32_16x16x32_bf16 v[252:255], a[220:223], v[44:47], v[252:255]
s_waitcnt lgkmcnt(6)
v_mfma_f32_16x16x32_bf16 v[192:195], a[32:35], v[16:19], v[192:195]
ds_read_b64_tr_b16 v[32:33], v11 offset:36864
s_add_u32 m0, s56, 12288
s_add_u32 s57, s55, 786560
buffer_load_dwordx4 v10, s[36:39], s57 offen lds
v_mfma_f32_16x16x32_bf16 v[196:199], a[96:99], v[16:19], v[196:199]
v_cvt_pk_bf16_f32 v56, v72, v73
v_mfma_f32_16x16x32_bf16 v[200:203], a[160:163], v[16:19], v[200:203]
ds_read_b64_tr_b16 v[34:35], v11 offset:37376
v_mfma_f32_16x16x32_bf16 v[204:207], a[224:227], v[16:19], v[204:207]
s_waitcnt lgkmcnt(6)
v_mfma_f32_16x16x32_bf16 v[208:211], a[32:35], v[20:23], v[208:211]
ds_read_b64_tr_b16 v[36:37], v12 offset:36864
v_cvt_pk_bf16_f32 v57, v74, v75
v_mfma_f32_16x16x32_bf16 v[212:215], a[96:99], v[20:23], v[212:215]
s_add_u32 m0, s53, 8192
s_add_u32 s23, s52, 32768
buffer_load_dwordx4 v7, s[40:43], s23 offen offset:2048 sc1 lds
v_mfma_f32_16x16x32_bf16 v[216:219], a[160:163], v[20:23], v[216:219]
ds_read_b64_tr_b16 v[38:39], v12 offset:37376
v_mfma_f32_16x16x32_bf16 v[220:223], a[224:227], v[20:23], v[220:223]
v_cvt_pk_bf16_f32 v58, v88, v89
s_waitcnt lgkmcnt(6)
v_mfma_f32_16x16x32_bf16 v[224:227], a[32:35], v[24:27], v[224:227]
ds_read_b64_tr_b16 v[40:41], v11 offset:37120
v_mfma_f32_16x16x32_bf16 v[228:231], a[96:99], v[24:27], v[228:231]
v_mfma_f32_16x16x32_bf16 v[232:235], a[160:163], v[24:27], v[232:235]
ds_read_b64_tr_b16 v[42:43], v11 offset:37632
v_cvt_pk_bf16_f32 v59, v90, v91
v_mfma_f32_16x16x32_bf16 v[236:239], a[224:227], v[24:27], v[236:239]
s_waitcnt lgkmcnt(6)
v_mfma_f32_16x16x32_bf16 v[240:243], a[32:35], v[28:31], v[240:243]
ds_read_b64_tr_b16 v[44:45], v12 offset:37120
v_mfma_f32_16x16x32_bf16 v[244:247], a[96:99], v[28:31], v[244:247]
s_add_u32 s59, s58, 16384
buffer_store_dwordx4 v[56:59], v2, s[44:47], s59 offen offset:0 sc1
v_mfma_f32_16x16x32_bf16 v[248:251], a[160:163], v[28:31], v[248:251]
ds_read_b64_tr_b16 v[46:47], v12 offset:37632
s_add_u32 m0, s53, 9216
s_add_u32 s23, s52, 49152
buffer_load_dwordx4 v7, s[40:43], s23 offen offset:2048 sc1 lds
v_mfma_f32_16x16x32_bf16 v[252:255], a[224:227], v[28:31], v[252:255]
s_waitcnt lgkmcnt(6)
v_mfma_f32_16x16x32_bf16 v[192:195], a[36:39], v[32:35], v[192:195]
ds_read_b64_tr_b16 v[16:17], v11 offset:40960
v_cvt_pk_bf16_f32 v48, v104, v105
v_mfma_f32_16x16x32_bf16 v[196:199], a[100:103], v[32:35], v[196:199]
v_mfma_f32_16x16x32_bf16 v[200:203], a[164:167], v[32:35], v[200:203]
ds_read_b64_tr_b16 v[18:19], v11 offset:41472
v_mfma_f32_16x16x32_bf16 v[204:207], a[228:231], v[32:35], v[204:207]
v_cvt_pk_bf16_f32 v49, v106, v107
s_waitcnt lgkmcnt(6)
v_mfma_f32_16x16x32_bf16 v[208:211], a[36:39], v[36:39], v[208:211]
ds_read_b64_tr_b16 v[20:21], v12 offset:40960
v_mfma_f32_16x16x32_bf16 v[212:215], a[100:103], v[36:39], v[212:215]
v_mfma_f32_16x16x32_bf16 v[216:219], a[164:167], v[36:39], v[216:219]
ds_read_b64_tr_b16 v[22:23], v12 offset:41472
v_cvt_pk_bf16_f32 v50, v120, v121
s_add_u32 m0, s53, 9216
s_add_u32 s23, s52, 0
buffer_load_dwordx4 v7, s[40:43], s23 offen offset:3072 sc1 lds
v_mfma_f32_16x16x32_bf16 v[220:223], a[228:231], v[36:39], v[220:223]
s_waitcnt lgkmcnt(6)
v_mfma_f32_16x16x32_bf16 v[224:227], a[36:39], v[40:43], v[224:227]
ds_read_b64_tr_b16 v[24:25], v11 offset:41216
v_mfma_f32_16x16x32_bf16 v[228:231], a[100:103], v[40:43], v[228:231]
v_cvt_pk_bf16_f32 v51, v122, v123
v_mfma_f32_16x16x32_bf16 v[232:235], a[164:167], v[40:43], v[232:235]
ds_read_b64_tr_b16 v[26:27], v11 offset:41728
v_mfma_f32_16x16x32_bf16 v[236:239], a[228:231], v[40:43], v[236:239]
s_waitcnt lgkmcnt(6)
v_mfma_f32_16x16x32_bf16 v[240:243], a[36:39], v[44:47], v[240:243]
ds_read_b64_tr_b16 v[28:29], v12 offset:41216
s_add_u32 s59, s58, 16384
buffer_store_dwordx4 v[48:51], v2, s[44:47], s59 offen offset:2048 sc1
v_mfma_f32_16x16x32_bf16 v[244:247], a[100:103], v[44:47], v[244:247]
v_mfma_f32_16x16x32_bf16 v[248:251], a[164:167], v[44:47], v[248:251]
ds_read_b64_tr_b16 v[30:31], v12 offset:41728
s_add_u32 m0, s53, 10240
s_add_u32 s23, s52, 16384
buffer_load_dwordx4 v7, s[40:43], s23 offen offset:3072 sc1 lds
v_mfma_f32_16x16x32_bf16 v[252:255], a[228:231], v[44:47], v[252:255]
v_cvt_pk_bf16_f32 v52, v136, v137
s_waitcnt lgkmcnt(6)
v_mfma_f32_16x16x32_bf16 v[192:195], a[40:43], v[16:19], v[192:195]
ds_read_b64_tr_b16 v[32:33], v11 offset:45056
v_mfma_f32_16x16x32_bf16 v[196:199], a[104:107], v[16:19], v[196:199]
v_mfma_f32_16x16x32_bf16 v[200:203], a[168:171], v[16:19], v[200:203]
ds_read_b64_tr_b16 v[34:35], v11 offset:45568
v_cvt_pk_bf16_f32 v53, v138, v139
v_mfma_f32_16x16x32_bf16 v[204:207], a[232:235], v[16:19], v[204:207]
s_waitcnt lgkmcnt(6)
v_mfma_f32_16x16x32_bf16 v[208:211], a[40:43], v[20:23], v[208:211]
ds_read_b64_tr_b16 v[36:37], v12 offset:45056
v_mfma_f32_16x16x32_bf16 v[212:215], a[104:107], v[20:23], v[212:215]
v_cvt_pk_bf16_f32 v54, v152, v153
v_mfma_f32_16x16x32_bf16 v[216:219], a[168:171], v[20:23], v[216:219]
ds_read_b64_tr_b16 v[38:39], v12 offset:45568
v_mfma_f32_16x16x32_bf16 v[220:223], a[232:235], v[20:23], v[220:223]
s_add_u32 m0, s53, 11264
s_add_u32 s23, s52, 32768
buffer_load_dwordx4 v7, s[40:43], s23 offen offset:3072 sc1 lds
s_waitcnt lgkmcnt(6)
v_mfma_f32_16x16x32_bf16 v[224:227], a[40:43], v[24:27], v[224:227]
ds_read_b64_tr_b16 v[40:41], v11 offset:45312
v_cvt_pk_bf16_f32 v55, v154, v155
v_mfma_f32_16x16x32_bf16 v[228:231], a[104:107], v[24:27], v[228:231]
v_mfma_f32_16x16x32_bf16 v[232:235], a[168:171], v[24:27], v[232:235]
ds_read_b64_tr_b16 v[42:43], v11 offset:45824
v_mfma_f32_16x16x32_bf16 v[236:239], a[232:235], v[24:27], v[236:239]
s_add_u32 s59, s58, 20480
buffer_store_dwordx4 v[52:55], v2, s[44:47], s59 offen offset:0 sc1
s_waitcnt lgkmcnt(6)
v_mfma_f32_16x16x32_bf16 v[240:243], a[40:43], v[28:31], v[240:243]
ds_read_b64_tr_b16 v[44:45], v12 offset:45312
v_mfma_f32_16x16x32_bf16 v[244:247], a[104:107], v[28:31], v[244:247]
v_mfma_f32_16x16x32_bf16 v[248:251], a[168:171], v[28:31], v[248:251]
ds_read_b64_tr_b16 v[46:47], v12 offset:45824
v_cvt_pk_bf16_f32 v56, v168, v169
v_mfma_f32_16x16x32_bf16 v[252:255], a[232:235], v[28:31], v[252:255]
s_waitcnt vmcnt(25)
s_barrier
s_add_u32 m0, s53, 12288
s_add_u32 s23, s52, 49152
buffer_load_dwordx4 v7, s[40:43], s23 offen offset:3072 sc1 lds
s_waitcnt lgkmcnt(6)
v_mfma_f32_16x16x32_bf16 v[192:195], a[44:47], v[32:35], v[192:195]
ds_read_b64_tr_b16 v[16:17], v11 offset:49152
v_mfma_f32_16x16x32_bf16 v[196:199], a[108:111], v[32:35], v[196:199]
v_cvt_pk_bf16_f32 v57, v170, v171
s_add_u32 m0, s56, 16384
s_add_u32 s57, s55, 1048704
buffer_load_dwordx4 v10, s[36:39], s57 offen lds
v_mfma_f32_16x16x32_bf16 v[200:203], a[172:175], v[32:35], v[200:203]
ds_read_b64_tr_b16 v[18:19], v11 offset:49664
v_mfma_f32_16x16x32_bf16 v[204:207], a[236:239], v[32:35], v[204:207]
s_waitcnt lgkmcnt(6)
v_mfma_f32_16x16x32_bf16 v[208:211], a[44:47], v[36:39], v[208:211]
ds_read_b64_tr_b16 v[20:21], v12 offset:49152
v_cvt_pk_bf16_f32 v58, v184, v185
v_mfma_f32_16x16x32_bf16 v[212:215], a[108:111], v[36:39], v[212:215]
v_mfma_f32_16x16x32_bf16 v[216:219], a[172:175], v[36:39], v[216:219]
ds_read_b64_tr_b16 v[22:23], v12 offset:49664
s_add_u32 m0, s56, 20480
s_add_u32 s57, s55, 1310848
buffer_load_dwordx4 v10, s[36:39], s57 offen lds
v_mfma_f32_16x16x32_bf16 v[220:223], a[236:239], v[36:39], v[220:223]
v_cvt_pk_bf16_f32 v59, v186, v187
s_add_u32 m0, s53, 16384
s_add_u32 s23, s52, 4096
buffer_load_dwordx4 v7, s[40:43], s23 offen offset:0 sc1 lds
s_waitcnt lgkmcnt(6)
v_mfma_f32_16x16x32_bf16 v[224:227], a[44:47], v[40:43], v[224:227]
ds_read_b64_tr_b16 v[24:25], v11 offset:49408
v_mfma_f32_16x16x32_bf16 v[228:231], a[108:111], v[40:43], v[228:231]
v_mfma_f32_16x16x32_bf16 v[232:235], a[172:175], v[40:43], v[232:235]
ds_read_b64_tr_b16 v[26:27], v11 offset:49920
s_add_u32 s59, s58, 20480
buffer_store_dwordx4 v[56:59], v2, s[44:47], s59 offen offset:2048 sc1
v_mfma_f32_16x16x32_bf16 v[236:239], a[236:239], v[40:43], v[236:239]
s_add_u32 m0, s56, 24576
s_add_u32 s57, s55, 1572992
buffer_load_dwordx4 v10, s[36:39], s57 offen lds
s_waitcnt lgkmcnt(6)
v_mfma_f32_16x16x32_bf16 v[240:243], a[44:47], v[44:47], v[240:243]
ds_read_b64_tr_b16 v[28:29], v12 offset:49408
v_mfma_f32_16x16x32_bf16 v[244:247], a[108:111], v[44:47], v[244:247]
v_cvt_pk_bf16_f32 v48, v76, v77
v_mfma_f32_16x16x32_bf16 v[248:251], a[172:175], v[44:47], v[248:251]
ds_read_b64_tr_b16 v[30:31], v12 offset:49920
v_mfma_f32_16x16x32_bf16 v[252:255], a[236:239], v[44:47], v[252:255]
s_waitcnt lgkmcnt(6)
v_mfma_f32_16x16x32_bf16 v[192:195], a[48:51], v[16:19], v[192:195]
ds_read_b64_tr_b16 v[32:33], v11 offset:53248
s_add_u32 m0, s53, 17408
s_add_u32 s23, s52, 20480
buffer_load_dwordx4 v7, s[40:43], s23 offen offset:0 sc1 lds
v_cvt_pk_bf16_f32 v49, v78, v79
s_add_u32 m0, s56, 28672
s_add_u32 s57, s55, 1835136
buffer_load_dwordx4 v10, s[36:39], s57 offen lds
v_mfma_f32_16x16x32_bf16 v[196:199], a[112:115], v[16:19], v[196:199]
v_mfma_f32_16x16x32_bf16 v[200:203], a[176:179], v[16:19], v[200:203]
ds_read_b64_tr_b16 v[34:35], v11 offset:53760
v_mfma_f32_16x16x32_bf16 v[204:207], a[240:243], v[16:19], v[204:207]
v_cvt_pk_bf16_f32 v50, v92, v93
s_waitcnt lgkmcnt(6)
v_mfma_f32_16x16x32_bf16 v[208:211], a[48:51], v[20:23], v[208:211]
ds_read_b64_tr_b16 v[36:37], v12 offset:53248
v_mfma_f32_16x16x32_bf16 v[212:215], a[112:115], v[20:23], v[212:215]
v_mfma_f32_16x16x32_bf16 v[216:219], a[176:179], v[20:23], v[216:219]
ds_read_b64_tr_b16 v[38:39], v12 offset:53760
v_cvt_pk_bf16_f32 v51, v94, v95
v_mfma_f32_16x16x32_bf16 v[220:223], a[240:243], v[20:23], v[220:223]
s_waitcnt lgkmcnt(6)
v_mfma_f32_16x16x32_bf16 v[224:227], a[48:51], v[24:27], v[224:227]
ds_read_b64_tr_b16 v[40:41], v11 offset:53504
s_add_u32 m0, s53, 18432
s_add_u32 s23, s52, 36864
buffer_load_dwordx4 v7, s[40:43], s23 offen offset:0 sc1 lds
v_mfma_f32_16x16x32_bf16 v[228:231], a[112:115], v[24:27], v[228:231]
s_add_u32 s59, s58, 16384
buffer_store_dwordx4 v[48:51], v2, s[44:47], s59 offen offset:128 sc1
v_mfma_f32_16x16x32_bf16 v[232:235], a[176:179], v[24:27], v[232:235]
ds_read_b64_tr_b16 v[42:43], v11 offset:54016
v_mfma_f32_16x16x32_bf16 v[236:239], a[240:243], v[24:27], v[236:239]
s_waitcnt lgkmcnt(6)
v_mfma_f32_16x16x32_bf16 v[240:243], a[48:51], v[28:31], v[240:243]
ds_read_b64_tr_b16 v[44:45], v12 offset:53504
v_cvt_pk_bf16_f32 v52, v108, v109
v_mfma_f32_16x16x32_bf16 v[244:247], a[112:115], v[28:31], v[244:247]
v_mfma_f32_16x16x32_bf16 v[248:251], a[176:179], v[28:31], v[248:251]
ds_read_b64_tr_b16 v[46:47], v12 offset:54016
v_mfma_f32_16x16x32_bf16 v[252:255], a[240:243], v[28:31], v[252:255]
v_cvt_pk_bf16_f32 v53, v110, v111
s_waitcnt lgkmcnt(6)
v_mfma_f32_16x16x32_bf16 v[192:195], a[52:55], v[32:35], v[192:195]
ds_read_b64_tr_b16 v[16:17], v11 offset:57344
s_add_u32 m0, s53, 19456
s_add_u32 s23, s52, 53248
buffer_load_dwordx4 v7, s[40:43], s23 offen offset:0 sc1 lds
v_mfma_f32_16x16x32_bf16 v[196:199], a[116:119], v[32:35], v[196:199]
v_mfma_f32_16x16x32_bf16 v[200:203], a[180:183], v[32:35], v[200:203]
ds_read_b64_tr_b16 v[18:19], v11 offset:57856
v_cvt_pk_bf16_f32 v54, v124, v125
v_mfma_f32_16x16x32_bf16 v[204:207], a[244:247], v[32:35], v[204:207]
s_waitcnt lgkmcnt(6)
v_mfma_f32_16x16x32_bf16 v[208:211], a[52:55], v[36:39], v[208:211]
ds_read_b64_tr_b16 v[20:21], v12 offset:57344
v_mfma_f32_16x16x32_bf16 v[212:215], a[116:119], v[36:39], v[212:215]
v_cvt_pk_bf16_f32 v55, v126, v127
v_mfma_f32_16x16x32_bf16 v[216:219], a[180:183], v[36:39], v[216:219]
ds_read_b64_tr_b16 v[22:23], v12 offset:57856
v_mfma_f32_16x16x32_bf16 v[220:223], a[244:247], v[36:39], v[220:223]
s_waitcnt lgkmcnt(6)
v_mfma_f32_16x16x32_bf16 v[224:227], a[52:55], v[40:43], v[224:227]
ds_read_b64_tr_b16 v[24:25], v11 offset:57600
s_add_u32 s59, s58, 16384
buffer_store_dwordx4 v[52:55], v2, s[44:47], s59 offen offset:2176 sc1
v_mfma_f32_16x16x32_bf16 v[228:231], a[116:119], v[40:43], v[228:231]
s_add_u32 m0, s53, 19456
s_add_u32 s23, s52, 4096
buffer_load_dwordx4 v7, s[40:43], s23 offen offset:1024 sc1 lds
v_mfma_f32_16x16x32_bf16 v[232:235], a[180:183], v[40:43], v[232:235]
ds_read_b64_tr_b16 v[26:27], v11 offset:58112
v_mfma_f32_16x16x32_bf16 v[236:239], a[244:247], v[40:43], v[236:239]
v_cvt_pk_bf16_f32 v56, v140, v141
s_waitcnt lgkmcnt(6)
v_mfma_f32_16x16x32_bf16 v[240:243], a[52:55], v[44:47], v[240:243]
ds_read_b64_tr_b16 v[28:29], v12 offset:57600
v_mfma_f32_16x16x32_bf16 v[244:247], a[116:119], v[44:47], v[244:247]
v_mfma_f32_16x16x32_bf16 v[248:251], a[180:183], v[44:47], v[248:251]
ds_read_b64_tr_b16 v[30:31], v12 offset:58112
v_cvt_pk_bf16_f32 v57, v142, v143
v_mfma_f32_16x16x32_bf16 v[252:255], a[244:247], v[44:47], v[252:255]
s_waitcnt lgkmcnt(6)
v_mfma_f32_16x16x32_bf16 v[192:195], a[56:59], v[16:19], v[192:195]
ds_read_b64_tr_b16 v[32:33], v11 offset:61440
v_mfma_f32_16x16x32_bf16 v[196:199], a[120:123], v[16:19], v[196:199]
v_cvt_pk_bf16_f32 v58, v156, v157
s_add_u32 m0, s53, 20480
s_add_u32 s23, s52, 20480
buffer_load_dwordx4 v7, s[40:43], s23 offen offset:1024 sc1 lds
v_mfma_f32_16x16x32_bf16 v[200:203], a[184:187], v[16:19], v[200:203]
ds_read_b64_tr_b16 v[34:35], v11 offset:61952
v_mfma_f32_16x16x32_bf16 v[204:207], a[248:251], v[16:19], v[204:207]
s_waitcnt lgkmcnt(6)
v_mfma_f32_16x16x32_bf16 v[208:211], a[56:59], v[20:23], v[208:211]
ds_read_b64_tr_b16 v[36:37], v12 offset:61440
v_cvt_pk_bf16_f32 v59, v158, v159
v_mfma_f32_16x16x32_bf16 v[212:215], a[120:123], v[20:23], v[212:215]
v_mfma_f32_16x16x32_bf16 v[216:219], a[184:187], v[20:23], v[216:219]
ds_read_b64_tr_b16 v[38:39], v12 offset:61952
v_mfma_f32_16x16x32_bf16 v[220:223], a[248:251], v[20:23], v[220:223]
s_add_u32 s59, s58, 20480
buffer_store_dwordx4 v[56:59], v2, s[44:47], s59 offen offset:128 sc1
s_waitcnt lgkmcnt(6)
v_mfma_f32_16x16x32_bf16 v[224:227], a[56:59], v[24:27], v[224:227]
ds_read_b64_tr_b16 v[40:41], v11 offset:61696
v_mfma_f32_16x16x32_bf16 v[228:231], a[120:123], v[24:27], v[228:231]
s_add_u32 m0, s53, 21504
s_add_u32 s23, s52, 36864
buffer_load_dwordx4 v7, s[40:43], s23 offen offset:1024 sc1 lds
v_mfma_f32_16x16x32_bf16 v[232:235], a[184:187], v[24:27], v[232:235]
ds_read_b64_tr_b16 v[42:43], v11 offset:62208
v_cvt_pk_bf16_f32 v48, v172, v173
v_mfma_f32_16x16x32_bf16 v[236:239], a[248:251], v[24:27], v[236:239]
s_waitcnt lgkmcnt(6)
v_mfma_f32_16x16x32_bf16 v[240:243], a[56:59], v[28:31], v[240:243]
ds_read_b64_tr_b16 v[44:45], v12 offset:61696
v_mfma_f32_16x16x32_bf16 v[244:247], a[120:123], v[28:31], v[244:247]
v_cvt_pk_bf16_f32 v49, v174, v175
v_mfma_f32_16x16x32_bf16 v[248:251], a[184:187], v[28:31], v[248:251]
ds_read_b64_tr_b16 v[46:47], v12 offset:62208
v_mfma_f32_16x16x32_bf16 v[252:255], a[248:251], v[28:31], v[252:255]
s_waitcnt vmcnt(24)
s_barrier
s_waitcnt lgkmcnt(6)
v_mfma_f32_16x16x32_bf16 v[192:195], a[60:63], v[32:35], v[192:195]
ds_read_b64_tr_b16 v[16:17], v11 offset:0
v_cvt_pk_bf16_f32 v50, v188, v189
v_mfma_f32_16x16x32_bf16 v[196:199], a[124:127], v[32:35], v[196:199]
s_add_u32 m0, s56, 32768
s_add_u32 s57, s55, 2097280
buffer_load_dwordx4 v10, s[36:39], s57 offen lds
v_mfma_f32_16x16x32_bf16 v[200:203], a[188:191], v[32:35], v[200:203]
ds_read_b64_tr_b16 v[18:19], v11 offset:512
s_add_u32 m0, s53, 22528
s_add_u32 s23, s52, 53248
buffer_load_dwordx4 v7, s[40:43], s23 offen offset:1024 sc1 lds
v_mfma_f32_16x16x32_bf16 v[204:207], a[252:255], v[32:35], v[204:207]
v_cvt_pk_bf16_f32 v51, v190, v191
s_waitcnt lgkmcnt(6)
v_mfma_f32_16x16x32_bf16 v[208:211], a[60:63], v[36:39], v[208:211]
ds_read_b64_tr_b16 v[20:21], v12 offset:0
v_mfma_f32_16x16x32_bf16 v[212:215], a[124:127], v[36:39], v[212:215]
v_mfma_f32_16x16x32_bf16 v[216:219], a[188:191], v[36:39], v[216:219]
ds_read_b64_tr_b16 v[22:23], v12 offset:512
s_add_u32 s59, s58, 20480
buffer_store_dwordx4 v[48:51], v2, s[44:47], s59 offen offset:2176 sc1
s_add_u32 m0, s56, 36864
s_add_u32 s57, s55, 2359424
buffer_load_dwordx4 v10, s[36:39], s57 offen lds
v_mfma_f32_16x16x32_bf16 v[220:223], a[252:255], v[36:39], v[220:223]
s_waitcnt lgkmcnt(6)
v_mfma_f32_16x16x32_bf16 v[224:227], a[60:63], v[40:43], v[224:227]
ds_read_b64_tr_b16 v[24:25], v11 offset:256
v_mfma_f32_16x16x32_bf16 v[228:231], a[124:127], v[40:43], v[228:231]
v_mfma_f32_16x16x32_bf16 v[232:235], a[188:191], v[40:43], v[232:235]
ds_read_b64_tr_b16 v[26:27], v11 offset:768
v_mfma_f32_16x16x32_bf16 v[236:239], a[252:255], v[40:43], v[236:239]
s_add_u32 m0, s56, 40960
s_add_u32 s57, s55, 2621568
buffer_load_dwordx4 v10, s[36:39], s57 offen lds
s_waitcnt lgkmcnt(6)
v_mfma_f32_16x16x32_bf16 v[240:243], a[60:63], v[44:47], v[240:243]
ds_read_b64_tr_b16 v[28:29], v12 offset:256
v_mfma_f32_16x16x32_bf16 v[244:247], a[124:127], v[44:47], v[244:247]
v_mfma_f32_16x16x32_bf16 v[248:251], a[188:191], v[44:47], v[248:251]
ds_read_b64_tr_b16 v[30:31], v12 offset:768
v_mfma_f32_16x16x32_bf16 v[252:255], a[252:255], v[44:47], v[252:255]
s_waitcnt lgkmcnt(6)
v_mfma_f32_16x16x32_bf16 v[64:67], a[0:3], v[16:19], 0
ds_read_b64_tr_b16 v[32:33], v11 offset:4096
s_add_u32 m0, s56, 45056
s_add_u32 s57, s55, 2883712
buffer_load_dwordx4 v10, s[36:39], s57 offen lds
v_mfma_f32_16x16x32_bf16 v[68:71], a[64:67], v[16:19], 0
v_mfma_f32_16x16x32_bf16 v[72:75], a[128:131], v[16:19], 0
ds_read_b64_tr_b16 v[34:35], v11 offset:4608
v_mfma_f32_16x16x32_bf16 v[76:79], a[192:195], v[16:19], 0
s_waitcnt lgkmcnt(6)
v_mfma_f32_16x16x32_bf16 v[80:83], a[0:3], v[20:23], 0
ds_read_b64_tr_b16 v[36:37], v12 offset:4096
v_mfma_f32_16x16x32_bf16 v[84:87], a[64:67], v[20:23], 0
v_mfma_f32_16x16x32_bf16 v[88:91], a[128:131], v[20:23], 0
ds_read_b64_tr_b16 v[38:39], v12 offset:4608
v_mfma_f32_16x16x32_bf16 v[92:95], a[192:195], v[20:23], 0
s_waitcnt lgkmcnt(6)
v_mfma_f32_16x16x32_bf16 v[96:99], a[0:3], v[24:27], 0
ds_read_b64_tr_b16 v[40:41], v11 offset:4352
v_mfma_f32_16x16x32_bf16 v[100:103], a[64:67], v[24:27], 0
v_mfma_f32_16x16x32_bf16 v[104:107], a[128:131], v[24:27], 0
ds_read_b64_tr_b16 v[42:43], v11 offset:4864
v_cvt_pk_bf16_f32 v48, v192, v193
v_mfma_f32_16x16x32_bf16 v[108:111], a[192:195], v[24:27], 0
s_waitcnt lgkmcnt(6)
v_mfma_f32_16x16x32_bf16 v[112:115], a[0:3], v[28:31], 0
ds_read_b64_tr_b16 v[44:45], v12 offset:4352
v_mfma_f32_16x16x32_bf16 v[116:119], a[64:67], v[28:31], 0
v_mfma_f32_16x16x32_bf16 v[120:123], a[128:131], v[28:31], 0
ds_read_b64_tr_b16 v[46:47], v12 offset:4864
v_mfma_f32_16x16x32_bf16 v[124:127], a[192:195], v[28:31], 0
v_cvt_pk_bf16_f32 v49, v194, v195
s_waitcnt lgkmcnt(6)
v_mfma_f32_16x16x32_bf16 v[64:67], a[4:7], v[32:35], v[64:67]
ds_read_b64_tr_b16 v[16:17], v11 offset:8192
ds_read_b128 a[0:3], v13 offset:0
v_mfma_f32_16x16x32_bf16 v[68:71], a[68:71], v[32:35], v[68:71]
v_mfma_f32_16x16x32_bf16 v[72:75], a[132:135], v[32:35], v[72:75]
ds_read_b64_tr_b16 v[18:19], v11 offset:8704
v_mfma_f32_16x16x32_bf16 v[76:79], a[196:199], v[32:35], v[76:79]
ds_read_b128 a[64:67], v13 offset:1024
s_waitcnt lgkmcnt(8)
v_mfma_f32_16x16x32_bf16 v[80:83], a[4:7], v[36:39], v[80:83]
ds_read_b64_tr_b16 v[20:21], v12 offset:8192
v_mfma_f32_16x16x32_bf16 v[84:87], a[68:71], v[36:39], v[84:87]
v_cvt_pk_bf16_f32 v50, v196, v197
v_mfma_f32_16x16x32_bf16 v[88:91], a[132:135], v[36:39], v[88:91]
ds_read_b64_tr_b16 v[22:23], v12 offset:8704
ds_read_b128 a[128:131], v13 offset:2048
v_mfma_f32_16x16x32_bf16 v[92:95], a[196:199], v[36:39], v[92:95]
s_waitcnt lgkmcnt(9)
v_mfma_f32_16x16x32_bf16 v[96:99], a[4:7], v[40:43], v[96:99]
ds_read_b64_tr_b16 v[24:25], v11 offset:8448
v_mfma_f32_16x16x32_bf16 v[100:103], a[68:71], v[40:43], v[100:103]
ds_read_b128 a[192:195], v13 offset:3072
v_mfma_f32_16x16x32_bf16 v[104:107], a[132:135], v[40:43], v[104:107]
ds_read_b64_tr_b16 v[26:27], v11 offset:8960
v_cvt_pk_bf16_f32 v51, v198, v199
v_mfma_f32_16x16x32_bf16 v[108:111], a[196:199], v[40:43], v[108:111]
s_waitcnt lgkmcnt(10)
v_mfma_f32_16x16x32_bf16 v[112:115], a[4:7], v[44:47], v[112:115]
ds_read_b64_tr_b16 v[28:29], v12 offset:8448
v_mfma_f32_16x16x32_bf16 v[116:119], a[68:71], v[44:47], v[116:119]
v_mfma_f32_16x16x32_bf16 v[120:123], a[132:135], v[44:47], v[120:123]
ds_read_b64_tr_b16 v[30:31], v12 offset:8960
v_mfma_f32_16x16x32_bf16 v[124:127], a[196:199], v[44:47], v[124:127]
s_add_u32 s59, s58, 8192
buffer_store_dwordx4 v[48:51], v3, s[44:47], s59 offen offset:0 sc1
s_waitcnt lgkmcnt(9)
v_mfma_f32_16x16x32_bf16 v[64:67], a[8:11], v[16:19], v[64:67]
ds_read_b64_tr_b16 v[32:33], v11 offset:12288
ds_read_b128 a[4:7], v13 offset:4096
v_mfma_f32_16x16x32_bf16 v[68:71], a[72:75], v[16:19], v[68:71]
v_mfma_f32_16x16x32_bf16 v[72:75], a[136:139], v[16:19], v[72:75]
ds_read_b64_tr_b16 v[34:35], v11 offset:12800
v_mfma_f32_16x16x32_bf16 v[76:79], a[200:203], v[16:19], v[76:79]
ds_read_b128 a[68:71], v13 offset:5120
s_waitcnt lgkmcnt(10)
v_mfma_f32_16x16x32_bf16 v[80:83], a[8:11], v[20:23], v[80:83]
ds_read_b64_tr_b16 v[36:37], v12 offset:12288
v_cvt_pk_bf16_f32 v52, v208, v209
v_mfma_f32_16x16x32_bf16 v[84:87], a[72:75], v[20:23], v[84:87]
v_mfma_f32_16x16x32_bf16 v[88:91], a[136:139], v[20:23], v[88:91]
ds_read_b64_tr_b16 v[38:39], v12 offset:12800
ds_read_b128 a[132:135], v13 offset:6144
v_mfma_f32_16x16x32_bf16 v[92:95], a[200:203], v[20:23], v[92:95]
s_waitcnt lgkmcnt(9)
v_mfma_f32_16x16x32_bf16 v[96:99], a[8:11], v[24:27], v[96:99]
ds_read_b64_tr_b16 v[40:41], v11 offset:12544
v_mfma_f32_16x16x32_bf16 v[100:103], a[72:75], v[24:27], v[100:103]
ds_read_b128 a[196:199], v13 offset:7168
v_cvt_pk_bf16_f32 v53, v210, v211
v_mfma_f32_16x16x32_bf16 v[104:107], a[136:139], v[24:27], v[104:107]
ds_read_b64_tr_b16 v[42:43], v11 offset:13056
v_mfma_f32_16x16x32_bf16 v[108:111], a[200:203], v[24:27], v[108:111]
s_waitcnt lgkmcnt(10)
v_mfma_f32_16x16x32_bf16 v[112:115], a[8:11], v[28:31], v[112:115]
ds_read_b64_tr_b16 v[44:45], v12 offset:12544
v_mfma_f32_16x16x32_bf16 v[116:119], a[72:75], v[28:31], v[116:119]
v_mfma_f32_16x16x32_bf16 v[120:123], a[136:139], v[28:31], v[120:123]
ds_read_b64_tr_b16 v[46:47], v12 offset:13056
v_mfma_f32_16x16x32_bf16 v[124:127], a[200:203], v[28:31], v[124:127]
v_cvt_pk_bf16_f32 v54, v212, v213
s_waitcnt vmcnt(15)
s_barrier
s_waitcnt lgkmcnt(9)
v_mfma_f32_16x16x32_bf16 v[64:67], a[12:15], v[32:35], v[64:67]
ds_read_b64_tr_b16 v[16:17], v11 offset:16384
ds_read_b128 a[8:11], v13 offset:8192
v_mfma_f32_16x16x32_bf16 v[68:71], a[76:79], v[32:35], v[68:71]
s_add_u32 m0, s56, 49152
s_add_u32 s57, s55, 3145856
buffer_load_dwordx4 v10, s[36:39], s57 offen lds
v_mfma_f32_16x16x32_bf16 v[72:75], a[140:143], v[32:35], v[72:75]
ds_read_b64_tr_b16 v[18:19], v11 offset:16896
v_mfma_f32_16x16x32_bf16 v[76:79], a[204:207], v[32:35], v[76:79]
ds_read_b128 a[72:75], v13 offset:9216
s_waitcnt lgkmcnt(10)
v_mfma_f32_16x16x32_bf16 v[80:83], a[12:15], v[36:39], v[80:83]
ds_read_b64_tr_b16 v[20:21], v12 offset:16384
v_cvt_pk_bf16_f32 v55, v214, v215
v_mfma_f32_16x16x32_bf16 v[84:87], a[76:79], v[36:39], v[84:87]
v_mfma_f32_16x16x32_bf16 v[88:91], a[140:143], v[36:39], v[88:91]
ds_read_b64_tr_b16 v[22:23], v12 offset:16896
ds_read_b128 a[136:139], v13 offset:10240
s_add_u32 m0, s56, 53248
s_add_u32 s57, s55, 3408000
buffer_load_dwordx4 v10, s[36:39], s57 offen lds
v_mfma_f32_16x16x32_bf16 v[92:95], a[204:207], v[36:39], v[92:95]
s_waitcnt lgkmcnt(9)
v_mfma_f32_16x16x32_bf16 v[96:99], a[12:15], v[40:43], v[96:99]
ds_read_b64_tr_b16 v[24:25], v11 offset:16640
v_mfma_f32_16x16x32_bf16 v[100:103], a[76:79], v[40:43], v[100:103]
s_add_u32 s59, s58, 8192
buffer_store_dwordx4 v[52:55], v3, s[44:47], s59 offen offset:256 sc1
ds_read_b128 a[200:203], v13 offset:11264
v_mfma_f32_16x16x32_bf16 v[104:107], a[140:143], v[40:43], v[104:107]
ds_read_b64_tr_b16 v[26:27], v11 offset:17152
v_mfma_f32_16x16x32_bf16 v[108:111], a[204:207], v[40:43], v[108:111]
s_add_u32 m0, s56, 57344
s_add_u32 s57, s55, 3670144
buffer_load_dwordx4 v10, s[36:39], s57 offen lds
s_waitcnt lgkmcnt(10)
v_mfma_f32_16x16x32_bf16 v[112:115], a[12:15], v[44:47], v[112:115]
ds_read_b64_tr_b16 v[28:29], v12 offset:16640
v_mfma_f32_16x16x32_bf16 v[116:119], a[76:79], v[44:47], v[116:119]
v_mfma_f32_16x16x32_bf16 v[120:123], a[140:143], v[44:47], v[120:123]
ds_read_b64_tr_b16 v[30:31], v12 offset:17152
v_cvt_pk_bf16_f32 v56, v224, v225
v_mfma_f32_16x16x32_bf16 v[124:127], a[204:207], v[44:47], v[124:127]
s_waitcnt lgkmcnt(9)
v_mfma_f32_16x16x32_bf16 v[64:67], a[16:19], v[16:19], v[64:67]
ds_read_b64_tr_b16 v[32:33], v11 offset:20480
ds_read_b128 a[12:15], v13 offset:12288
s_add_u32 m0, s56, 61440
s_add_u32 s57, s55, 3932288
buffer_load_dwordx4 v10, s[36:39], s57 offen lds
v_mfma_f32_16x16x32_bf16 v[68:71], a[80:83], v[16:19], v[68:71]
v_mfma_f32_16x16x32_bf16 v[72:75], a[144:147], v[16:19], v[72:75]
ds_read_b64_tr_b16 v[34:35], v11 offset:20992
v_mfma_f32_16x16x32_bf16 v[76:79], a[208:211], v[16:19], v[76:79]
ds_read_b128 a[76:79], v13 offset:13312
v_cvt_pk_bf16_f32 v57, v226, v227
s_waitcnt lgkmcnt(10)
v_mfma_f32_16x16x32_bf16 v[80:83], a[16:19], v[20:23], v[80:83]
ds_read_b64_tr_b16 v[36:37], v12 offset:20480
v_mfma_f32_16x16x32_bf16 v[84:87], a[80:83], v[20:23], v[84:87]
v_mfma_f32_16x16x32_bf16 v[88:91], a[144:147], v[20:23], v[88:91]
ds_read_b64_tr_b16 v[38:39], v12 offset:20992
ds_read_b128 a[140:143], v13 offset:14336
v_mfma_f32_16x16x32_bf16 v[92:95], a[208:211], v[20:23], v[92:95]
s_waitcnt lgkmcnt(9)
v_mfma_f32_16x16x32_bf16 v[96:99], a[16:19], v[24:27], v[96:99]
ds_read_b64_tr_b16 v[40:41], v11 offset:20736
v_mfma_f32_16x16x32_bf16 v[100:103], a[80:83], v[24:27], v[100:103]
v_cvt_pk_bf16_f32 v58, v228, v229
ds_read_b128 a[204:207], v13 offset:15360
v_mfma_f32_16x16x32_bf16 v[104:107], a[144:147], v[24:27], v[104:107]
ds_read_b64_tr_b16 v[42:43], v11 offset:21248
v_mfma_f32_16x16x32_bf16 v[108:111], a[208:211], v[24:27], v[108:111]
s_waitcnt lgkmcnt(10)
v_mfma_f32_16x16x32_bf16 v[112:115], a[16:19], v[28:31], v[112:115]
ds_read_b64_tr_b16 v[44:45], v12 offset:20736
v_mfma_f32_16x16x32_bf16 v[116:119], a[80:83], v[28:31], v[116:119]
v_mfma_f32_16x16x32_bf16 v[120:123], a[144:147], v[28:31], v[120:123]
ds_read_b64_tr_b16 v[46:47], v12 offset:21248
v_cvt_pk_bf16_f32 v59, v230, v231
v_mfma_f32_16x16x32_bf16 v[124:127], a[208:211], v[28:31], v[124:127]
s_waitcnt lgkmcnt(9)
v_mfma_f32_16x16x32_bf16 v[64:67], a[20:23], v[32:35], v[64:67]
ds_read_b64_tr_b16 v[16:17], v11 offset:24576
s_waitcnt vmcnt(17)
ds_read_b128 a[16:19], v13 offset:16384
v_mfma_f32_16x16x32_bf16 v[68:71], a[84:87], v[32:35], v[68:71]
v_mfma_f32_16x16x32_bf16 v[72:75], a[148:151], v[32:35], v[72:75]
ds_read_b64_tr_b16 v[18:19], v11 offset:25088
v_mfma_f32_16x16x32_bf16 v[76:79], a[212:215], v[32:35], v[76:79]
s_add_u32 s59, s58, 8192
buffer_store_dwordx4 v[56:59], v3, s[44:47], s59 offen offset:1024 sc1
ds_read_b128 a[80:83], v13 offset:17408
s_waitcnt lgkmcnt(10)
v_mfma_f32_16x16x32_bf16 v[80:83], a[20:23], v[36:39], v[80:83]
ds_read_b64_tr_b16 v[20:21], v12 offset:24576
v_mfma_f32_16x16x32_bf16 v[84:87], a[84:87], v[36:39], v[84:87]
v_mfma_f32_16x16x32_bf16 v[88:91], a[148:151], v[36:39], v[88:91]
ds_read_b64_tr_b16 v[22:23], v12 offset:25088
ds_read_b128 a[144:147], v13 offset:18432
v_mfma_f32_16x16x32_bf16 v[92:95], a[212:215], v[36:39], v[92:95]
s_waitcnt lgkmcnt(9)
v_mfma_f32_16x16x32_bf16 v[96:99], a[20:23], v[40:43], v[96:99]
ds_read_b64_tr_b16 v[24:25], v11 offset:24832
v_cvt_pk_bf16_f32 v48, v240, v241
v_mfma_f32_16x16x32_bf16 v[100:103], a[84:87], v[40:43], v[100:103]
ds_read_b128 a[208:211], v13 offset:19456
v_mfma_f32_16x16x32_bf16 v[104:107], a[148:151], v[40:43], v[104:107]
ds_read_b64_tr_b16 v[26:27], v11 offset:25344
v_mfma_f32_16x16x32_bf16 v[108:111], a[212:215], v[40:43], v[108:111]
s_waitcnt lgkmcnt(10)
v_mfma_f32_16x16x32_bf16 v[112:115], a[20:23], v[44:47], v[112:115]
ds_read_b64_tr_b16 v[28:29], v12 offset:24832
v_mfma_f32_16x16x32_bf16 v[116:119], a[84:87], v[44:47], v[116:119]
v_cvt_pk_bf16_f32 v49, v242, v243
v_mfma_f32_16x16x32_bf16 v[120:123], a[148:151], v[44:47], v[120:123]
ds_read_b64_tr_b16 v[30:31], v12 offset:25344
v_mfma_f32_16x16x32_bf16 v[124:127], a[212:215], v[44:47], v[124:127]
s_waitcnt lgkmcnt(9)
v_mfma_f32_16x16x32_bf16 v[64:67], a[24:27], v[16:19], v[64:67]
ds_read_b64_tr_b16 v[32:33], v11 offset:28672
s_waitcnt vmcnt(11)
ds_read_b128 a[20:23], v13 offset:20480
v_mfma_f32_16x16x32_bf16 v[68:71], a[88:91], v[16:19], v[68:71]
v_mfma_f32_16x16x32_bf16 v[72:75], a[152:155], v[16:19], v[72:75]
ds_read_b64_tr_b16 v[34:35], v11 offset:29184
v_mfma_f32_16x16x32_bf16 v[76:79], a[216:219], v[16:19], v[76:79]
v_cvt_pk_bf16_f32 v50, v244, v245
ds_read_b128 a[84:87], v13 offset:21504
s_waitcnt lgkmcnt(10)
v_mfma_f32_16x16x32_bf16 v[80:83], a[24:27], v[20:23], v[80:83]
ds_read_b64_tr_b16 v[36:37], v12 offset:28672
v_mfma_f32_16x16x32_bf16 v[84:87], a[88:91], v[20:23], v[84:87]
v_mfma_f32_16x16x32_bf16 v[88:91], a[152:155], v[20:23], v[88:91]
ds_read_b64_tr_b16 v[38:39], v12 offset:29184
ds_read_b128 a[148:151], v13 offset:22528
v_mfma_f32_16x16x32_bf16 v[92:95], a[216:219], v[20:23], v[92:95]
s_waitcnt lgkmcnt(9)
v_mfma_f32_16x16x32_bf16 v[96:99], a[24:27], v[24:27], v[96:99]
ds_read_b64_tr_b16 v[40:41], v11 offset:28928
v_cvt_pk_bf16_f32 v51, v246, v247
v_mfma_f32_16x16x32_bf16 v[100:103], a[88:91], v[24:27], v[100:103]
ds_read_b128 a[212:215], v13 offset:23552
v_mfma_f32_16x16x32_bf16 v[104:107], a[152:155], v[24:27], v[104:107]
ds_read_b64_tr_b16 v[42:43], v11 offset:29440
v_mfma_f32_16x16x32_bf16 v[108:111], a[216:219], v[24:27], v[108:111]
s_waitcnt lgkmcnt(10)
v_mfma_f32_16x16x32_bf16 v[112:115], a[24:27], v[28:31], v[112:115]
ds_read_b64_tr_b16 v[44:45], v12 offset:28928
v_mfma_f32_16x16x32_bf16 v[116:119], a[88:91], v[28:31], v[116:119]
s_add_u32 s59, s58, 8192
buffer_store_dwordx4 v[48:51], v3, s[44:47], s59 offen offset:1280 sc1
v_mfma_f32_16x16x32_bf16 v[120:123], a[152:155], v[28:31], v[120:123]
ds_read_b64_tr_b16 v[46:47], v12 offset:29440
v_mfma_f32_16x16x32_bf16 v[124:127], a[216:219], v[28:31], v[124:127]
s_waitcnt vmcnt(8)
s_barrier
s_waitcnt lgkmcnt(9)
v_mfma_f32_16x16x32_bf16 v[64:67], a[28:31], v[32:35], v[64:67]
ds_read_b64_tr_b16 v[16:17], v11 offset:32768
s_add_u32 s23, s52, 4096
buffer_load_dwordx4 a[24:27], v7, s[40:43], s23 offen offset:2048 sc1
v_mfma_f32_16x16x32_bf16 v[68:71], a[92:95], v[32:35], v[68:71]
s_add_u32 m0, s56, 0
s_add_u32 s57, s67, 0
buffer_load_dwordx4 v8, s[8:11], s57 offen lds
v_mfma_f32_16x16x32_bf16 v[72:75], a[156:159], v[32:35], v[72:75]
ds_read_b64_tr_b16 v[18:19], v11 offset:33280
v_cvt_pk_bf16_f32 v52, v200, v201
v_mfma_f32_16x16x32_bf16 v[76:79], a[220:223], v[32:35], v[76:79]
s_waitcnt lgkmcnt(8)
v_mfma_f32_16x16x32_bf16 v[80:83], a[28:31], v[36:39], v[80:83]
ds_read_b64_tr_b16 v[20:21], v12 offset:32768
v_mfma_f32_16x16x32_bf16 v[84:87], a[92:95], v[36:39], v[84:87]
v_mfma_f32_16x16x32_bf16 v[88:91], a[156:159], v[36:39], v[88:91]
ds_read_b64_tr_b16 v[22:23], v12 offset:33280
s_add_u32 m0, s56, 4096
s_add_u32 s57, s67, 0
buffer_load_dwordx4 v8, s[12:15], s57 offen lds
v_mfma_f32_16x16x32_bf16 v[92:95], a[220:223], v[36:39], v[92:95]
v_cvt_pk_bf16_f32 v53, v202, v203
s_waitcnt lgkmcnt(6)
v_mfma_f32_16x16x32_bf16 v[96:99], a[28:31], v[40:43], v[96:99]
ds_read_b64_tr_b16 v[24:25], v11 offset:33024
s_add_u32 s23, s52, 20480
buffer_load_dwordx4 a[88:91], v7, s[40:43], s23 offen offset:2048 sc1
v_mfma_f32_16x16x32_bf16 v[100:103], a[92:95], v[40:43], v[100:103]
v_mfma_f32_16x16x32_bf16 v[104:107], a[156:159], v[40:43], v[104:107]
ds_read_b64_tr_b16 v[26:27], v11 offset:33536
v_mfma_f32_16x16x32_bf16 v[108:111], a[220:223], v[40:43], v[108:111]
s_add_u32 m0, s56, 8192
s_add_u32 s57, s67, 88064
buffer_load_dwordx4 v8, s[8:11], s57 offen lds
s_waitcnt lgkmcnt(6)
v_mfma_f32_16x16x32_bf16 v[112:115], a[28:31], v[44:47], v[112:115]
ds_read_b64_tr_b16 v[28:29], v12 offset:33024
v_mfma_f32_16x16x32_bf16 v[116:119], a[92:95], v[44:47], v[116:119]
v_cvt_pk_bf16_f32 v54, v204, v205
v_mfma_f32_16x16x32_bf16 v[120:123], a[156:159], v[44:47], v[120:123]
ds_read_b64_tr_b16 v[30:31], v12 offset:33536
v_mfma_f32_16x16x32_bf16 v[124:127], a[220:223], v[44:47], v[124:127]
s_waitcnt lgkmcnt(6)
v_mfma_f32_16x16x32_bf16 v[64:67], a[32:35], v[16:19], v[64:67]
ds_read_b64_tr_b16 v[32:33], v11 offset:36864
s_add_u32 s23, s52, 36864
buffer_load_dwordx4 a[152:155], v7, s[40:43], s23 offen offset:2048 sc1
s_add_u32 m0, s56, 12288
s_add_u32 s57, s67, 88064
buffer_load_dwordx4 v8, s[12:15], s57 offen lds
v_mfma_f32_16x16x32_bf16 v[68:71], a[96:99], v[16:19], v[68:71]
v_mfma_f32_16x16x32_bf16 v[72:75], a[160:163], v[16:19], v[72:75]
ds_read_b64_tr_b16 v[34:35], v11 offset:37376
v_cvt_pk_bf16_f32 v55, v206, v207
v_mfma_f32_16x16x32_bf16 v[76:79], a[224:227], v[16:19], v[76:79]
s_waitcnt lgkmcnt(6)
v_mfma_f32_16x16x32_bf16 v[80:83], a[32:35], v[20:23], v[80:83]
ds_read_b64_tr_b16 v[36:37], v12 offset:36864
v_mfma_f32_16x16x32_bf16 v[84:87], a[96:99], v[20:23], v[84:87]
v_mfma_f32_16x16x32_bf16 v[88:91], a[160:163], v[20:23], v[88:91]
ds_read_b64_tr_b16 v[38:39], v12 offset:37376
v_mfma_f32_16x16x32_bf16 v[92:95], a[224:227], v[20:23], v[92:95]
s_add_u32 s59, s58, 24576
buffer_store_dwordx4 v[52:55], v3, s[44:47], s59 offen offset:0 sc1
s_waitcnt lgkmcnt(6)
v_mfma_f32_16x16x32_bf16 v[96:99], a[32:35], v[24:27], v[96:99]
ds_read_b64_tr_b16 v[40:41], v11 offset:37120
s_add_u32 s23, s52, 53248
buffer_load_dwordx4 a[216:219], v7, s[40:43], s23 offen offset:2048 sc1
v_mfma_f32_16x16x32_bf16 v[100:103], a[96:99], v[24:27], v[100:103]
v_mfma_f32_16x16x32_bf16 v[104:107], a[160:163], v[24:27], v[104:107]
ds_read_b64_tr_b16 v[42:43], v11 offset:37632
v_mfma_f32_16x16x32_bf16 v[108:111], a[224:227], v[24:27], v[108:111]
s_waitcnt lgkmcnt(6)
v_mfma_f32_16x16x32_bf16 v[112:115], a[32:35], v[28:31], v[112:115]
ds_read_b64_tr_b16 v[44:45], v12 offset:37120
v_cvt_pk_bf16_f32 v56, v216, v217
v_mfma_f32_16x16x32_bf16 v[116:119], a[96:99], v[28:31], v[116:119]
v_mfma_f32_16x16x32_bf16 v[120:123], a[160:163], v[28:31], v[120:123]
ds_read_b64_tr_b16 v[46:47], v12 offset:37632
v_mfma_f32_16x16x32_bf16 v[124:127], a[224:227], v[28:31], v[124:127]
s_waitcnt lgkmcnt(6)
v_mfma_f32_16x16x32_bf16 v[64:67], a[36:39], v[32:35], v[64:67]
ds_read_b64_tr_b16 v[16:17], v11 offset:40960
s_add_u32 s23, s52, 4096
buffer_load_dwordx4 a[28:31], v7, s[40:43], s23 offen offset:3072 sc1
v_mfma_f32_16x16x32_bf16 v[68:71], a[100:103], v[32:35], v[68:71]
v_cvt_pk_bf16_f32 v57, v218, v219
v_mfma_f32_16x16x32_bf16 v[72:75], a[164:167], v[32:35], v[72:75]
ds_read_b64_tr_b16 v[18:19], v11 offset:41472
v_mfma_f32_16x16x32_bf16 v[76:79], a[228:231], v[32:35], v[76:79]
s_waitcnt lgkmcnt(6)
v_mfma_f32_16x16x32_bf16 v[80:83], a[36:39], v[36:39], v[80:83]
ds_read_b64_tr_b16 v[20:21], v12 offset:40960
v_mfma_f32_16x16x32_bf16 v[84:87], a[100:103], v[36:39], v[84:87]
v_mfma_f32_16x16x32_bf16 v[88:91], a[164:167], v[36:39], v[88:91]
ds_read_b64_tr_b16 v[22:23], v12 offset:41472
v_mfma_f32_16x16x32_bf16 v[92:95], a[228:231], v[36:39], v[92:95]
v_cvt_pk_bf16_f32 v58, v220, v221
s_waitcnt lgkmcnt(6)
v_mfma_f32_16x16x32_bf16 v[96:99], a[36:39], v[40:43], v[96:99]
ds_read_b64_tr_b16 v[24:25], v11 offset:41216
s_add_u32 s23, s52, 20480
buffer_load_dwordx4 a[92:95], v7, s[40:43], s23 offen offset:3072 sc1
v_mfma_f32_16x16x32_bf16 v[100:103], a[100:103], v[40:43], v[100:103]
v_mfma_f32_16x16x32_bf16 v[104:107], a[164:167], v[40:43], v[104:107]
ds_read_b64_tr_b16 v[26:27], v11 offset:41728
v_mfma_f32_16x16x32_bf16 v[108:111], a[228:231], v[40:43], v[108:111]
s_waitcnt lgkmcnt(6)
v_mfma_f32_16x16x32_bf16 v[112:115], a[36:39], v[44:47], v[112:115]
ds_read_b64_tr_b16 v[28:29], v12 offset:41216
v_cvt_pk_bf16_f32 v59, v222, v223
v_mfma_f32_16x16x32_bf16 v[116:119], a[100:103], v[44:47], v[116:119]
v_mfma_f32_16x16x32_bf16 v[120:123], a[164:167], v[44:47], v[120:123]
ds_read_b64_tr_b16 v[30:31], v12 offset:41728
v_mfma_f32_16x16x32_bf16 v[124:127], a[228:231], v[44:47], v[124:127]
s_waitcnt lgkmcnt(6)
v_mfma_f32_16x16x32_bf16 v[64:67], a[40:43], v[16:19], v[64:67]
ds_read_b64_tr_b16 v[32:33], v11 offset:45056
s_add_u32 s23, s52, 36864
buffer_load_dwordx4 a[156:159], v7, s[40:43], s23 offen offset:3072 sc1
v_mfma_f32_16x16x32_bf16 v[68:71], a[104:107], v[16:19], v[68:71]
s_add_u32 s59, s58, 24576
buffer_store_dwordx4 v[56:59], v3, s[44:47], s59 offen offset:256 sc1
v_mfma_f32_16x16x32_bf16 v[72:75], a[168:171], v[16:19], v[72:75]
ds_read_b64_tr_b16 v[34:35], v11 offset:45568
v_mfma_f32_16x16x32_bf16 v[76:79], a[232:235], v[16:19], v[76:79]
s_waitcnt lgkmcnt(6)
v_mfma_f32_16x16x32_bf16 v[80:83], a[40:43], v[20:23], v[80:83]
ds_read_b64_tr_b16 v[36:37], v12 offset:45056
v_mfma_f32_16x16x32_bf16 v[84:87], a[104:107], v[20:23], v[84:87]
v_mfma_f32_16x16x32_bf16 v[88:91], a[168:171], v[20:23], v[88:91]
ds_read_b64_tr_b16 v[38:39], v12 offset:45568
v_cvt_pk_bf16_f32 v48, v232, v233
v_mfma_f32_16x16x32_bf16 v[92:95], a[232:235], v[20:23], v[92:95]
s_waitcnt lgkmcnt(6)
v_mfma_f32_16x16x32_bf16 v[96:99], a[40:43], v[24:27], v[96:99]
ds_read_b64_tr_b16 v[40:41], v11 offset:45312
s_add_u32 s23, s52, 53248
buffer_load_dwordx4 a[220:223], v7, s[40:43], s23 offen offset:3072 sc1
v_mfma_f32_16x16x32_bf16 v[100:103], a[104:107], v[24:27], v[100:103]
v_mfma_f32_16x16x32_bf16 v[104:107], a[168:171], v[24:27], v[104:107]
ds_read_b64_tr_b16 v[42:43], v11 offset:45824
v_mfma_f32_16x16x32_bf16 v[108:111], a[232:235], v[24:27], v[108:111]
v_cvt_pk_bf16_f32 v49, v234, v235
s_waitcnt lgkmcnt(6)
v_mfma_f32_16x16x32_bf16 v[112:115], a[40:43], v[28:31], v[112:115]
ds_read_b64_tr_b16 v[44:45], v12 offset:45312
v_mfma_f32_16x16x32_bf16 v[116:119], a[104:107], v[28:31], v[116:119]
v_mfma_f32_16x16x32_bf16 v[120:123], a[168:171], v[28:31], v[120:123]
ds_read_b64_tr_b16 v[46:47], v12 offset:45824
v_mfma_f32_16x16x32_bf16 v[124:127], a[232:235], v[28:31], v[124:127]
s_waitcnt vmcnt(16)
s_barrier
s_waitcnt lgkmcnt(6)
v_mfma_f32_16x16x32_bf16 v[64:67], a[44:47], v[32:35], v[64:67]
ds_read_b64_tr_b16 v[16:17], v11 offset:49152
s_add_u32 s23, s52, 8192
buffer_load_dwordx4 a[32:35], v7, s[40:43], s23 offen offset:0 sc1
v_mfma_f32_16x16x32_bf16 v[68:71], a[108:111], v[32:35], v[68:71]
v_cvt_pk_bf16_f32 v50, v236, v237
s_add_u32 m0, s56, 16384
s_add_u32 s57, s67, 176128
buffer_load_dwordx4 v8, s[8:11], s57 offen lds
v_mfma_f32_16x16x32_bf16 v[72:75], a[172:175], v[32:35], v[72:75]
ds_read_b64_tr_b16 v[18:19], v11 offset:49664
v_mfma_f32_16x16x32_bf16 v[76:79], a[236:239], v[32:35], v[76:79]
s_waitcnt lgkmcnt(6)
v_mfma_f32_16x16x32_bf16 v[80:83], a[44:47], v[36:39], v[80:83]
ds_read_b64_tr_b16 v[20:21], v12 offset:49152
v_mfma_f32_16x16x32_bf16 v[84:87], a[108:111], v[36:39], v[84:87]
v_mfma_f32_16x16x32_bf16 v[88:91], a[172:175], v[36:39], v[88:91]
ds_read_b64_tr_b16 v[22:23], v12 offset:49664
v_cvt_pk_bf16_f32 v51, v238, v239
s_add_u32 m0, s56, 20480
s_add_u32 s57, s67, 176128
buffer_load_dwordx4 v8, s[12:15], s57 offen lds
v_mfma_f32_16x16x32_bf16 v[92:95], a[236:239], v[36:39], v[92:95]
s_waitcnt lgkmcnt(6)
v_mfma_f32_16x16x32_bf16 v[96:99], a[44:47], v[40:43], v[96:99]
ds_read_b64_tr_b16 v[24:25], v11 offset:49408
s_add_u32 s23, s52, 24576
buffer_load_dwordx4 a[96:99], v7, s[40:43], s23 offen offset:0 sc1
v_mfma_f32_16x16x32_bf16 v[100:103], a[108:111], v[40:43], v[100:103]
v_mfma_f32_16x16x32_bf16 v[104:107], a[172:175], v[40:43], v[104:107]
ds_read_b64_tr_b16 v[26:27], v11 offset:49920
v_mfma_f32_16x16x32_bf16 v[108:111], a[236:239], v[40:43], v[108:111]
s_add_u32 s59, s58, 24576
buffer_store_dwordx4 v[48:51], v3, s[44:47], s59 offen offset:1024 sc1
s_add_u32 m0, s56, 24576
s_add_u32 s57, s67, 264192
buffer_load_dwordx4 v8, s[8:11], s57 offen lds
s_waitcnt lgkmcnt(6)
v_mfma_f32_16x16x32_bf16 v[112:115], a[44:47], v[44:47], v[112:115]
ds_read_b64_tr_b16 v[28:29], v12 offset:49408
v_mfma_f32_16x16x32_bf16 v[116:119], a[108:111], v[44:47], v[116:119]
v_mfma_f32_16x16x32_bf16 v[120:123], a[172:175], v[44:47], v[120:123]
ds_read_b64_tr_b16 v[30:31], v12 offset:49920
v_mfma_f32_16x16x32_bf16 v[124:127], a[236:239], v[44:47], v[124:127]
s_waitcnt lgkmcnt(6)
v_mfma_f32_16x16x32_bf16 v[64:67], a[48:51], v[16:19], v[64:67]
ds_read_b64_tr_b16 v[32:33], v11 offset:53248
s_add_u32 s23, s52, 40960
buffer_load_dwordx4 a[160:163], v7, s[40:43], s23 offen offset:0 sc1
s_add_u32 m0, s56, 28672
s_add_u32 s57, s67, 264192
buffer_load_dwordx4 v8, s[12:15], s57 offen lds
v_cvt_pk_bf16_f32 v52, v248, v249
v_mfma_f32_16x16x32_bf16 v[68:71], a[112:115], v[16:19], v[68:71]
v_mfma_f32_16x16x32_bf16 v[72:75], a[176:179], v[16:19], v[72:75]
ds_read_b64_tr_b16 v[34:35], v11 offset:53760
v_mfma_f32_16x16x32_bf16 v[76:79], a[240:243], v[16:19], v[76:79]
s_waitcnt lgkmcnt(6)
v_mfma_f32_16x16x32_bf16 v[80:83], a[48:51], v[20:23], v[80:83]
ds_read_b64_tr_b16 v[36:37], v12 offset:53248
v_mfma_f32_16x16x32_bf16 v[84:87], a[112:115], v[20:23], v[84:87]
v_cvt_pk_bf16_f32 v53, v250, v251
v_mfma_f32_16x16x32_bf16 v[88:91], a[176:179], v[20:23], v[88:91]
ds_read_b64_tr_b16 v[38:39], v12 offset:53760
v_mfma_f32_16x16x32_bf16 v[92:95], a[240:243], v[20:23], v[92:95]
s_waitcnt lgkmcnt(6)
v_mfma_f32_16x16x32_bf16 v[96:99], a[48:51], v[24:27], v[96:99]
ds_read_b64_tr_b16 v[40:41], v11 offset:53504
s_add_u32 s23, s52, 57344
buffer_load_dwordx4 a[224:227], v7, s[40:43], s23 offen offset:0 sc1
v_mfma_f32_16x16x32_bf16 v[100:103], a[112:115], v[24:27], v[100:103]
v_mfma_f32_16x16x32_bf16 v[104:107], a[176:179], v[24:27], v[104:107]
ds_read_b64_tr_b16 v[42:43], v11 offset:54016
v_mfma_f32_16x16x32_bf16 v[108:111], a[240:243], v[24:27], v[108:111]
v_cvt_pk_bf16_f32 v54, v252, v253
s_waitcnt lgkmcnt(6)
v_mfma_f32_16x16x32_bf16 v[112:115], a[48:51], v[28:31], v[112:115]
ds_read_b64_tr_b16 v[44:45], v12 offset:53504
v_mfma_f32_16x16x32_bf16 v[116:119], a[112:115], v[28:31], v[116:119]
v_mfma_f32_16x16x32_bf16 v[120:123], a[176:179], v[28:31], v[120:123]
ds_read_b64_tr_b16 v[46:47], v12 offset:54016
v_mfma_f32_16x16x32_bf16 v[124:127], a[240:243], v[28:31], v[124:127]
s_waitcnt lgkmcnt(6)
v_mfma_f32_16x16x32_bf16 v[64:67], a[52:55], v[32:35], v[64:67]
ds_read_b64_tr_b16 v[16:17], v11 offset:57344
v_cvt_pk_bf16_f32 v55, v254, v255
s_add_u32 s23, s52, 8192
buffer_load_dwordx4 a[36:39], v7, s[40:43], s23 offen offset:1024 sc1
v_mfma_f32_16x16x32_bf16 v[68:71], a[116:119], v[32:35], v[68:71]
v_mfma_f32_16x16x32_bf16 v[72:75], a[180:183], v[32:35], v[72:75]
ds_read_b64_tr_b16 v[18:19], v11 offset:57856
v_mfma_f32_16x16x32_bf16 v[76:79], a[244:247], v[32:35], v[76:79]
s_waitcnt lgkmcnt(6)
v_mfma_f32_16x16x32_bf16 v[80:83], a[52:55], v[36:39], v[80:83]
ds_read_b64_tr_b16 v[20:21], v12 offset:57344
v_mfma_f32_16x16x32_bf16 v[84:87], a[116:119], v[36:39], v[84:87]
s_add_u32 s59, s58, 24576
buffer_store_dwordx4 v[52:55], v3, s[44:47], s59 offen offset:1280 sc1
v_mfma_f32_16x16x32_bf16 v[88:91], a[180:183], v[36:39], v[88:91]
ds_read_b64_tr_b16 v[22:23], v12 offset:57856
v_mfma_f32_16x16x32_bf16 v[92:95], a[244:247], v[36:39], v[92:95]
s_waitcnt lgkmcnt(6)
v_mfma_f32_16x16x32_bf16 v[96:99], a[52:55], v[40:43], v[96:99]
ds_read_b64_tr_b16 v[24:25], v11 offset:57600
s_add_u32 s23, s52, 24576
buffer_load_dwordx4 a[100:103], v7, s[40:43], s23 offen offset:1024 sc1
v_mfma_f32_16x16x32_bf16 v[100:103], a[116:119], v[40:43], v[100:103]
v_mfma_f32_16x16x32_bf16 v[104:107], a[180:183], v[40:43], v[104:107]
ds_read_b64_tr_b16 v[26:27], v11 offset:58112
v_mfma_f32_16x16x32_bf16 v[108:111], a[244:247], v[40:43], v[108:111]
s_waitcnt lgkmcnt(6)
v_mfma_f32_16x16x32_bf16 v[112:115], a[52:55], v[44:47], v[112:115]
ds_read_b64_tr_b16 v[28:29], v12 offset:57600
v_mfma_f32_16x16x32_bf16 v[116:119], a[116:119], v[44:47], v[116:119]
v_mfma_f32_16x16x32_bf16 v[120:123], a[180:183], v[44:47], v[120:123]
ds_read_b64_tr_b16 v[30:31], v12 offset:58112
v_mfma_f32_16x16x32_bf16 v[124:127], a[244:247], v[44:47], v[124:127]
s_waitcnt lgkmcnt(6)
v_mfma_f32_16x16x32_bf16 v[64:67], a[56:59], v[16:19], v[64:67]
ds_read_b64_tr_b16 v[32:33], v11 offset:61440
s_add_u32 s23, s52, 40960
buffer_load_dwordx4 a[164:167], v7, s[40:43], s23 offen offset:1024 sc1
v_mfma_f32_16x16x32_bf16 v[68:71], a[120:123], v[16:19], v[68:71]
v_mfma_f32_16x16x32_bf16 v[72:75], a[184:187], v[16:19], v[72:75]
ds_read_b64_tr_b16 v[34:35], v11 offset:61952
v_mfma_f32_16x16x32_bf16 v[76:79], a[248:251], v[16:19], v[76:79]
s_waitcnt lgkmcnt(6)
v_mfma_f32_16x16x32_bf16 v[80:83], a[56:59], v[20:23], v[80:83]
ds_read_b64_tr_b16 v[36:37], v12 offset:61440
v_mfma_f32_16x16x32_bf16 v[84:87], a[120:123], v[20:23], v[84:87]
v_mfma_f32_16x16x32_bf16 v[88:91], a[184:187], v[20:23], v[88:91]
ds_read_b64_tr_b16 v[38:39], v12 offset:61952
v_mfma_f32_16x16x32_bf16 v[92:95], a[248:251], v[20:23], v[92:95]
s_waitcnt lgkmcnt(6)
v_mfma_f32_16x16x32_bf16 v[96:99], a[56:59], v[24:27], v[96:99]
ds_read_b64_tr_b16 v[40:41], v11 offset:61696
s_add_u32 s23, s52, 57344
buffer_load_dwordx4 a[228:231], v7, s[40:43], s23 offen offset:1024 sc1
v_mfma_f32_16x16x32_bf16 v[100:103], a[120:123], v[24:27], v[100:103]
v_mfma_f32_16x16x32_bf16 v[104:107], a[184:187], v[24:27], v[104:107]
ds_read_b64_tr_b16 v[42:43], v11 offset:62208
v_mfma_f32_16x16x32_bf16 v[108:111], a[248:251], v[24:27], v[108:111]
s_waitcnt lgkmcnt(6)
v_mfma_f32_16x16x32_bf16 v[112:115], a[56:59], v[28:31], v[112:115]
ds_read_b64_tr_b16 v[44:45], v12 offset:61696
v_mfma_f32_16x16x32_bf16 v[116:119], a[120:123], v[28:31], v[116:119]
v_mfma_f32_16x16x32_bf16 v[120:123], a[184:187], v[28:31], v[120:123]
ds_read_b64_tr_b16 v[46:47], v12 offset:62208
v_mfma_f32_16x16x32_bf16 v[124:127], a[248:251], v[28:31], v[124:127]
s_waitcnt vmcnt(21)
s_barrier
s_waitcnt lgkmcnt(6)
v_mfma_f32_16x16x32_bf16 v[64:67], a[60:63], v[32:35], v[64:67]
ds_read_b64_tr_b16 v[16:17], v11 offset:0
s_add_u32 s23, s52, 8192
buffer_load_dwordx4 a[40:43], v7, s[40:43], s23 offen offset:2048 sc1
v_mfma_f32_16x16x32_bf16 v[68:71], a[124:127], v[32:35], v[68:71]
s_add_u32 m0, s56, 32768
s_add_u32 s57, s67, 352256
buffer_load_dwordx4 v8, s[8:11], s57 offen lds
v_mfma_f32_16x16x32_bf16 v[72:75], a[188:191], v[32:35], v[72:75]
ds_read_b64_tr_b16 v[18:19], v11 offset:512
v_mfma_f32_16x16x32_bf16 v[76:79], a[252:255], v[32:35], v[76:79]
s_waitcnt lgkmcnt(6)
v_mfma_f32_16x16x32_bf16 v[80:83], a[60:63], v[36:39], v[80:83]
ds_read_b64_tr_b16 v[20:21], v12 offset:0
v_mfma_f32_16x16x32_bf16 v[84:87], a[124:127], v[36:39], v[84:87]
v_mfma_f32_16x16x32_bf16 v[88:91], a[188:191], v[36:39], v[88:91]
ds_read_b64_tr_b16 v[22:23], v12 offset:512
s_add_u32 m0, s56, 36864
s_add_u32 s57, s67, 352256
buffer_load_dwordx4 v8, s[12:15], s57 offen lds
v_mfma_f32_16x16x32_bf16 v[92:95], a[252:255], v[36:39], v[92:95]
s_waitcnt lgkmcnt(6)
v_mfma_f32_16x16x32_bf16 v[96:99], a[60:63], v[40:43], v[96:99]
ds_read_b64_tr_b16 v[24:25], v11 offset:256
s_add_u32 s23, s52, 24576
buffer_load_dwordx4 a[104:107], v7, s[40:43], s23 offen offset:2048 sc1
v_mfma_f32_16x16x32_bf16 v[100:103], a[124:127], v[40:43], v[100:103]
v_mfma_f32_16x16x32_bf16 v[104:107], a[188:191], v[40:43], v[104:107]
ds_read_b64_tr_b16 v[26:27], v11 offset:768
v_mfma_f32_16x16x32_bf16 v[108:111], a[252:255], v[40:43], v[108:111]
s_add_u32 m0, s56, 40960
s_add_u32 s57, s67, 440320
buffer_load_dwordx4 v8, s[8:11], s57 offen lds
s_waitcnt lgkmcnt(6)
v_mfma_f32_16x16x32_bf16 v[112:115], a[60:63], v[44:47], v[112:115]
ds_read_b64_tr_b16 v[28:29], v11 offset:4096
v_mfma_f32_16x16x32_bf16 v[116:119], a[124:127], v[44:47], v[116:119]
v_mfma_f32_16x16x32_bf16 v[120:123], a[188:191], v[44:47], v[120:123]
ds_read_b64_tr_b16 v[30:31], v11 offset:4608
v_mfma_f32_16x16x32_bf16 v[124:127], a[252:255], v[44:47], v[124:127]
s_waitcnt lgkmcnt(6)
v_mfma_f32_16x16x32_bf16 v[128:131], v[16:19], a[0:3], 0
ds_read_b64_tr_b16 v[32:33], v12 offset:4096
s_add_u32 s23, s52, 40960
buffer_load_dwordx4 a[168:171], v7, s[40:43], s23 offen offset:2048 sc1
s_add_u32 m0, s56, 45056
s_add_u32 s57, s67, 440320
buffer_load_dwordx4 v8, s[12:15], s57 offen lds
v_mfma_f32_16x16x32_bf16 v[132:135], v[16:19], a[64:67], 0
v_mfma_f32_16x16x32_bf16 v[136:139], v[16:19], a[128:131], 0
ds_read_b64_tr_b16 v[34:35], v12 offset:4608
v_mfma_f32_16x16x32_bf16 v[140:143], v[16:19], a[192:195], 0
s_waitcnt lgkmcnt(6)
v_mfma_f32_16x16x32_bf16 v[160:163], v[20:23], a[0:3], 0
ds_read_b64_tr_b16 v[36:37], v11 offset:4352
v_mfma_f32_16x16x32_bf16 v[164:167], v[20:23], a[64:67], 0
v_mfma_f32_16x16x32_bf16 v[168:171], v[20:23], a[128:131], 0
ds_read_b64_tr_b16 v[38:39], v11 offset:4864
v_mfma_f32_16x16x32_bf16 v[172:175], v[20:23], a[192:195], 0
s_waitcnt lgkmcnt(6)
v_mfma_f32_16x16x32_bf16 v[192:195], v[24:27], a[0:3], 0
ds_read_b64_tr_b16 v[40:41], v11 offset:8192
s_add_u32 s23, s52, 57344
buffer_load_dwordx4 a[232:235], v7, s[40:43], s23 offen offset:2048 sc1
v_mfma_f32_16x16x32_bf16 v[196:199], v[24:27], a[64:67], 0
v_mfma_f32_16x16x32_bf16 v[200:203], v[24:27], a[128:131], 0
ds_read_b64_tr_b16 v[42:43], v11 offset:8704
v_cvt_pk_bf16_f32 v48, v64, v65
v_mfma_f32_16x16x32_bf16 v[204:207], v[24:27], a[192:195], 0
s_waitcnt lgkmcnt(6)
v_mfma_f32_16x16x32_bf16 v[144:147], v[28:31], a[0:3], 0
ds_read_b64_tr_b16 v[44:45], v12 offset:8192
v_mfma_f32_16x16x32_bf16 v[148:151], v[28:31], a[64:67], 0
v_mfma_f32_16x16x32_bf16 v[152:155], v[28:31], a[128:131], 0
ds_read_b64_tr_b16 v[46:47], v12 offset:8704
v_mfma_f32_16x16x32_bf16 v[156:159], v[28:31], a[192:195], 0
v_cvt_pk_bf16_f32 v49, v66, v67
s_waitcnt lgkmcnt(6)
v_mfma_f32_16x16x32_bf16 v[176:179], v[32:35], a[0:3], 0
ds_read_b64_tr_b16 v[16:17], v11 offset:8448
s_add_u32 s23, s52, 8192
buffer_load_dwordx4 a[44:47], v7, s[40:43], s23 offen offset:3072 sc1
v_mfma_f32_16x16x32_bf16 v[180:183], v[32:35], a[64:67], 0
v_mfma_f32_16x16x32_bf16 v[184:187], v[32:35], a[128:131], 0
ds_read_b64_tr_b16 v[18:19], v11 offset:8960
v_mfma_f32_16x16x32_bf16 v[188:191], v[32:35], a[192:195], 0
s_waitcnt lgkmcnt(6)
v_mfma_f32_16x16x32_bf16 v[208:211], v[36:39], a[0:3], 0
ds_read_b64_tr_b16 v[20:21], v11 offset:12288
v_mfma_f32_16x16x32_bf16 v[212:215], v[36:39], a[64:67], 0
v_cvt_pk_bf16_f32 v50, v68, v69
v_mfma_f32_16x16x32_bf16 v[216:219], v[36:39], a[128:131], 0
ds_read_b64_tr_b16 v[22:23], v11 offset:12800
v_mfma_f32_16x16x32_bf16 v[220:223], v[36:39], a[192:195], 0
s_waitcnt lgkmcnt(6)
v_mfma_f32_16x16x32_bf16 v[128:131], v[40:43], a[4:7], v[128:131]
ds_read_b64_tr_b16 v[24:25], v12 offset:12288
s_add_u32 s23, s52, 24576
buffer_load_dwordx4 a[108:111], v7, s[40:43], s23 offen offset:3072 sc1
v_mfma_f32_16x16x32_bf16 v[132:135], v[40:43], a[68:71], v[132:135]
v_mfma_f32_16x16x32_bf16 v[136:139], v[40:43], a[132:135], v[136:139]
ds_read_b64_tr_b16 v[26:27], v12 offset:12800
v_cvt_pk_bf16_f32 v51, v70, v71
v_mfma_f32_16x16x32_bf16 v[140:143], v[40:43], a[196:199], v[140:143]
s_waitcnt lgkmcnt(6)
v_mfma_f32_16x16x32_bf16 v[160:163], v[44:47], a[4:7], v[160:163]
ds_read_b64_tr_b16 v[28:29], v11 offset:12544
v_mfma_f32_16x16x32_bf16 v[164:167], v[44:47], a[68:71], v[164:167]
v_mfma_f32_16x16x32_bf16 v[168:171], v[44:47], a[132:135], v[168:171]
ds_read_b64_tr_b16 v[30:31], v11 offset:13056
v_mfma_f32_16x16x32_bf16 v[172:175], v[44:47], a[196:199], v[172:175]
s_add_u32 s59, s58, 8192
buffer_store_dwordx4 v[48:51], v3, s[44:47], s59 offen offset:2048 sc1
s_waitcnt vmcnt(17)
s_barrier
s_waitcnt lgkmcnt(6)
v_mfma_f32_16x16x32_bf16 v[192:195], v[16:19], a[4:7], v[192:195]
ds_read_b64_tr_b16 v[32:33], v11 offset:16384
s_add_u32 s23, s52, 40960
buffer_load_dwordx4 a[172:175], v7, s[40:43], s23 offen offset:3072 sc1
v_mfma_f32_16x16x32_bf16 v[196:199], v[16:19], a[68:71], v[196:199]
s_add_u32 m0, s56, 49152
s_add_u32 s57, s67, 528384
buffer_load_dwordx4 v8, s[8:11], s57 offen lds
v_mfma_f32_16x16x32_bf16 v[200:203], v[16:19], a[132:135], v[200:203]
ds_read_b64_tr_b16 v[34:35], v11 offset:16896
v_mfma_f32_16x16x32_bf16 v[204:207], v[16:19], a[196:199], v[204:207]
s_waitcnt lgkmcnt(6)
v_mfma_f32_16x16x32_bf16 v[144:147], v[20:23], a[4:7], v[144:147]
ds_read_b64_tr_b16 v[36:37], v12 offset:16384
v_cvt_pk_bf16_f32 v52, v80, v81
v_mfma_f32_16x16x32_bf16 v[148:151], v[20:23], a[68:71], v[148:151]
v_mfma_f32_16x16x32_bf16 v[152:155], v[20:23], a[132:135], v[152:155]
ds_read_b64_tr_b16 v[38:39], v12 offset:16896
s_add_u32 m0, s56, 53248
s_add_u32 s57, s67, 528384
buffer_load_dwordx4 v8, s[12:15], s57 offen lds
v_mfma_f32_16x16x32_bf16 v[156:159], v[20:23], a[196:199], v[156:159]
s_waitcnt lgkmcnt(6)
v_mfma_f32_16x16x32_bf16 v[176:179], v[24:27], a[4:7], v[176:179]
ds_read_b64_tr_b16 v[40:41], v11 offset:16640
s_add_u32 s23, s52, 57344
buffer_load_dwordx4 a[236:239], v7, s[40:43], s23 offen offset:3072 sc1
v_mfma_f32_16x16x32_bf16 v[180:183], v[24:27], a[68:71], v[180:183]
v_cvt_pk_bf16_f32 v53, v82, v83
v_mfma_f32_16x16x32_bf16 v[184:187], v[24:27], a[132:135], v[184:187]
ds_read_b64_tr_b16 v[42:43], v11 offset:17152
v_mfma_f32_16x16x32_bf16 v[188:191], v[24:27], a[196:199], v[188:191]
s_add_u32 m0, s56, 57344
s_add_u32 s57, s67, 616448
buffer_load_dwordx4 v8, s[8:11], s57 offen lds
s_waitcnt lgkmcnt(6)
v_mfma_f32_16x16x32_bf16 v[208:211], v[28:31], a[4:7], v[208:211]
ds_read_b64_tr_b16 v[44:45], v11 offset:20480
v_mfma_f32_16x16x32_bf16 v[212:215], v[28:31], a[68:71], v[212:215]
v_mfma_f32_16x16x32_bf16 v[216:219], v[28:31], a[132:135], v[216:219]
ds_read_b64_tr_b16 v[46:47], v11 offset:20992
v_mfma_f32_16x16x32_bf16 v[220:223], v[28:31], a[196:199], v[220:223]
v_cvt_pk_bf16_f32 v54, v84, v85
s_waitcnt lgkmcnt(6)
v_mfma_f32_16x16x32_bf16 v[128:131], v[32:35], a[8:11], v[128:131]
ds_read_b64_tr_b16 v[16:17], v12 offset:20480
s_add_u32 s23, s52, 12288
buffer_load_dwordx4 a[48:51], v7, s[40:43], s23 offen offset:0 sc1
s_add_u32 m0, s56, 61440
s_add_u32 s57, s67, 616448
buffer_load_dwordx4 v8, s[12:15], s57 offen lds
v_mfma_f32_16x16x32_bf16 v[132:135], v[32:35], a[72:75], v[132:135]
v_mfma_f32_16x16x32_bf16 v[136:139], v[32:35], a[136:139], v[136:139]
ds_read_b64_tr_b16 v[18:19], v12 offset:20992
v_mfma_f32_16x16x32_bf16 v[140:143], v[32:35], a[200:203], v[140:143]
s_waitcnt lgkmcnt(6)
v_mfma_f32_16x16x32_bf16 v[160:163], v[36:39], a[8:11], v[160:163]
ds_read_b64_tr_b16 v[20:21], v11 offset:20736
v_cvt_pk_bf16_f32 v55, v86, v87
v_mfma_f32_16x16x32_bf16 v[164:167], v[36:39], a[72:75], v[164:167]
v_mfma_f32_16x16x32_bf16 v[168:171], v[36:39], a[136:139], v[168:171]
ds_read_b64_tr_b16 v[22:23], v11 offset:21248
v_mfma_f32_16x16x32_bf16 v[172:175], v[36:39], a[200:203], v[172:175]
s_waitcnt lgkmcnt(6)
v_mfma_f32_16x16x32_bf16 v[192:195], v[40:43], a[8:11], v[192:195]
ds_read_b64_tr_b16 v[24:25], v11 offset:24576
s_add_u32 s23, s52, 28672
buffer_load_dwordx4 a[112:115], v7, s[40:43], s23 offen offset:0 sc1
v_mfma_f32_16x16x32_bf16 v[196:199], v[40:43], a[72:75], v[196:199]
s_add_u32 s59, s58, 8192
buffer_store_dwordx4 v[52:55], v3, s[44:47], s59 offen offset:2304 sc1
v_mfma_f32_16x16x32_bf16 v[200:203], v[40:43], a[136:139], v[200:203]
ds_read_b64_tr_b16 v[26:27], v11 offset:25088
v_mfma_f32_16x16x32_bf16 v[204:207], v[40:43], a[200:203], v[204:207]
s_waitcnt lgkmcnt(6)
v_mfma_f32_16x16x32_bf16 v[144:147], v[44:47], a[8:11], v[144:147]
ds_read_b64_tr_b16 v[28:29], v12 offset:24576
v_mfma_f32_16x16x32_bf16 v[148:151], v[44:47], a[72:75], v[148:151]
v_mfma_f32_16x16x32_bf16 v[152:155], v[44:47], a[136:139], v[152:155]
ds_read_b64_tr_b16 v[30:31], v12 offset:25088
v_cvt_pk_bf16_f32 v56, v96, v97
v_mfma_f32_16x16x32_bf16 v[156:159], v[44:47], a[200:203], v[156:159]
s_waitcnt lgkmcnt(6)
v_mfma_f32_16x16x32_bf16 v[176:179], v[16:19], a[8:11], v[176:179]
ds_read_b64_tr_b16 v[32:33], v11 offset:24832
s_add_u32 s23, s52, 45056
buffer_load_dwordx4 a[176:179], v7, s[40:43], s23 offen offset:0 sc1
v_mfma_f32_16x16x32_bf16 v[180:183], v[16:19], a[72:75], v[180:183]
v_mfma_f32_16x16x32_bf16 v[184:187], v[16:19], a[136:139], v[184:187]
ds_read_b64_tr_b16 v[34:35], v11 offset:25344
v_mfma_f32_16x16x32_bf16 v[188:191], v[16:19], a[200:203], v[188:191]
v_cvt_pk_bf16_f32 v57, v98, v99
s_waitcnt lgkmcnt(6)
v_mfma_f32_16x16x32_bf16 v[208:211], v[20:23], a[8:11], v[208:211]
ds_read_b64_tr_b16 v[36:37], v11 offset:28672
v_mfma_f32_16x16x32_bf16 v[212:215], v[20:23], a[72:75], v[212:215]
v_mfma_f32_16x16x32_bf16 v[216:219], v[20:23], a[136:139], v[216:219]
ds_read_b64_tr_b16 v[38:39], v11 offset:29184
v_mfma_f32_16x16x32_bf16 v[220:223], v[20:23], a[200:203], v[220:223]
s_waitcnt lgkmcnt(6)
v_mfma_f32_16x16x32_bf16 v[128:131], v[24:27], a[12:15], v[128:131]
ds_read_b64_tr_b16 v[40:41], v12 offset:28672
s_add_u32 s23, s52, 61440
buffer_load_dwordx4 a[240:243], v7, s[40:43], s23 offen offset:0 sc1
v_mfma_f32_16x16x32_bf16 v[132:135], v[24:27], a[76:79], v[132:135]
v_cvt_pk_bf16_f32 v58, v100, v101
v_mfma_f32_16x16x32_bf16 v[136:139], v[24:27], a[140:143], v[136:139]
ds_read_b64_tr_b16 v[42:43], v12 offset:29184
v_mfma_f32_16x16x32_bf16 v[140:143], v[24:27], a[204:207], v[140:143]
s_waitcnt lgkmcnt(6)
v_mfma_f32_16x16x32_bf16 v[160:163], v[28:31], a[12:15], v[160:163]
ds_read_b64_tr_b16 v[44:45], v11 offset:28928
v_mfma_f32_16x16x32_bf16 v[164:167], v[28:31], a[76:79], v[164:167]
v_mfma_f32_16x16x32_bf16 v[168:171], v[28:31], a[140:143], v[168:171]
ds_read_b64_tr_b16 v[46:47], v11 offset:29440
v_cvt_pk_bf16_f32 v59, v102, v103
v_mfma_f32_16x16x32_bf16 v[172:175], v[28:31], a[204:207], v[172:175]
s_waitcnt vmcnt(15)
s_barrier
s_waitcnt lgkmcnt(6)
v_mfma_f32_16x16x32_bf16 v[192:195], v[32:35], a[12:15], v[192:195]
ds_read_b64_tr_b16 v[16:17], v11 offset:32768
s_add_u32 s23, s52, 12288
buffer_load_dwordx4 a[52:55], v7, s[40:43], s23 offen offset:1024 sc1
v_mfma_f32_16x16x32_bf16 v[196:199], v[32:35], a[76:79], v[196:199]
s_add_u32 m0, s56, 0
s_add_u32 s57, s67, 704512
buffer_load_dwordx4 v8, s[8:11], s57 offen lds
v_mfma_f32_16x16x32_bf16 v[200:203], v[32:35], a[140:143], v[200:203]
ds_read_b64_tr_b16 v[18:19], v11 offset:33280
v_mfma_f32_16x16x32_bf16 v[204:207], v[32:35], a[204:207], v[204:207]
s_add_u32 s59, s58, 8192
buffer_store_dwordx4 v[56:59], v3, s[44:47], s59 offen offset:3072 sc1
s_waitcnt lgkmcnt(6)
v_mfma_f32_16x16x32_bf16 v[144:147], v[36:39], a[12:15], v[144:147]
ds_read_b64_tr_b16 v[20:21], v12 offset:32768
v_mfma_f32_16x16x32_bf16 v[148:151], v[36:39], a[76:79], v[148:151]
v_mfma_f32_16x16x32_bf16 v[152:155], v[36:39], a[140:143], v[152:155]
ds_read_b64_tr_b16 v[22:23], v12 offset:33280
s_add_u32 m0, s56, 4096
s_add_u32 s57, s67, 704512
buffer_load_dwordx4 v8, s[12:15], s57 offen lds
v_mfma_f32_16x16x32_bf16 v[156:159], v[36:39], a[204:207], v[156:159]
s_waitcnt lgkmcnt(6)
v_mfma_f32_16x16x32_bf16 v[176:179], v[40:43], a[12:15], v[176:179]
ds_read_b64_tr_b16 v[24:25], v11 offset:33024
s_add_u32 s23, s52, 28672
buffer_load_dwordx4 a[116:119], v7, s[40:43], s23 offen offset:1024 sc1
v_cvt_pk_bf16_f32 v48, v112, v113
v_mfma_f32_16x16x32_bf16 v[180:183], v[40:43], a[76:79], v[180:183]
v_mfma_f32_16x16x32_bf16 v[184:187], v[40:43], a[140:143], v[184:187]
ds_read_b64_tr_b16 v[26:27], v11 offset:33536
v_mfma_f32_16x16x32_bf16 v[188:191], v[40:43], a[204:207], v[188:191]
s_add_u32 m0, s56, 8192
s_add_u32 s57, s67, 792576
buffer_load_dwordx4 v8, s[8:11], s57 offen lds
s_waitcnt lgkmcnt(6)
v_mfma_f32_16x16x32_bf16 v[208:211], v[44:47], a[12:15], v[208:211]
ds_read_b64_tr_b16 v[28:29], v11 offset:36864
v_mfma_f32_16x16x32_bf16 v[212:215], v[44:47], a[76:79], v[212:215]
v_cvt_pk_bf16_f32 v49, v114, v115
v_mfma_f32_16x16x32_bf16 v[216:219], v[44:47], a[140:143], v[216:219]
ds_read_b64_tr_b16 v[30:31], v11 offset:37376
v_mfma_f32_16x16x32_bf16 v[220:223], v[44:47], a[204:207], v[220:223]
s_waitcnt lgkmcnt(6)
v_mfma_f32_16x16x32_bf16 v[128:131], v[16:19], a[16:19], v[128:131]
ds_read_b64_tr_b16 v[32:33], v12 offset:36864
s_add_u32 s23, s52, 45056
buffer_load_dwordx4 a[180:183], v7, s[40:43], s23 offen offset:1024 sc1
s_add_u32 m0, s56, 12288
s_add_u32 s57, s67, 792576
buffer_load_dwordx4 v8, s[12:15], s57 offen lds
v_mfma_f32_16x16x32_bf16 v[132:135], v[16:19], a[80:83], v[132:135]
v_mfma_f32_16x16x32_bf16 v[136:139], v[16:19], a[144:147], v[136:139]
ds_read_b64_tr_b16 v[34:35], v12 offset:37376
v_mfma_f32_16x16x32_bf16 v[140:143], v[16:19], a[208:211], v[140:143]
v_cvt_pk_bf16_f32 v50, v116, v117
s_waitcnt lgkmcnt(6)
v_mfma_f32_16x16x32_bf16 v[160:163], v[20:23], a[16:19], v[160:163]
ds_read_b64_tr_b16 v[36:37], v11 offset:37120
v_mfma_f32_16x16x32_bf16 v[164:167], v[20:23], a[80:83], v[164:167]
v_mfma_f32_16x16x32_bf16 v[168:171], v[20:23], a[144:147], v[168:171]
ds_read_b64_tr_b16 v[38:39], v11 offset:37632
v_mfma_f32_16x16x32_bf16 v[172:175], v[20:23], a[208:211], v[172:175]
s_waitcnt lgkmcnt(6)
v_mfma_f32_16x16x32_bf16 v[192:195], v[24:27], a[16:19], v[192:195]
ds_read_b64_tr_b16 v[40:41], v11 offset:40960
v_cvt_pk_bf16_f32 v51, v118, v119
s_add_u32 s23, s52, 61440
buffer_load_dwordx4 a[244:247], v7, s[40:43], s23 offen offset:1024 sc1
v_mfma_f32_16x16x32_bf16 v[196:199], v[24:27], a[80:83], v[196:199]
v_mfma_f32_16x16x32_bf16 v[200:203], v[24:27], a[144:147], v[200:203]
ds_read_b64_tr_b16 v[42:43], v11 offset:41472
v_mfma_f32_16x16x32_bf16 v[204:207], v[24:27], a[208:211], v[204:207]
s_waitcnt lgkmcnt(6)
v_mfma_f32_16x16x32_bf16 v[144:147], v[28:31], a[16:19], v[144:147]
ds_read_b64_tr_b16 v[44:45], v12 offset:40960
v_mfma_f32_16x16x32_bf16 v[148:151], v[28:31], a[80:83], v[148:151]
s_add_u32 s59, s58, 8192
buffer_store_dwordx4 v[48:51], v3, s[44:47], s59 offen offset:3328 sc1
v_mfma_f32_16x16x32_bf16 v[152:155], v[28:31], a[144:147], v[152:155]
ds_read_b64_tr_b16 v[46:47], v12 offset:41472
v_mfma_f32_16x16x32_bf16 v[156:159], v[28:31], a[208:211], v[156:159]
s_waitcnt lgkmcnt(6)
v_mfma_f32_16x16x32_bf16 v[176:179], v[32:35], a[16:19], v[176:179]
ds_read_b64_tr_b16 v[16:17], v11 offset:41216
s_add_u32 s23, s52, 12288
buffer_load_dwordx4 a[56:59], v7, s[40:43], s23 offen offset:2048 sc1
v_mfma_f32_16x16x32_bf16 v[180:183], v[32:35], a[80:83], v[180:183]
v_mfma_f32_16x16x32_bf16 v[184:187], v[32:35], a[144:147], v[184:187]
ds_read_b64_tr_b16 v[18:19], v11 offset:41728
v_cvt_pk_bf16_f32 v52, v72, v73
v_mfma_f32_16x16x32_bf16 v[188:191], v[32:35], a[208:211], v[188:191]
s_waitcnt lgkmcnt(6)
v_mfma_f32_16x16x32_bf16 v[208:211], v[36:39], a[16:19], v[208:211]
ds_read_b64_tr_b16 v[20:21], v11 offset:45056
v_mfma_f32_16x16x32_bf16 v[212:215], v[36:39], a[80:83], v[212:215]
v_mfma_f32_16x16x32_bf16 v[216:219], v[36:39], a[144:147], v[216:219]
ds_read_b64_tr_b16 v[22:23], v11 offset:45568
v_mfma_f32_16x16x32_bf16 v[220:223], v[36:39], a[208:211], v[220:223]
v_cvt_pk_bf16_f32 v53, v74, v75
s_waitcnt lgkmcnt(6)
v_mfma_f32_16x16x32_bf16 v[128:131], v[40:43], a[20:23], v[128:131]
ds_read_b64_tr_b16 v[24:25], v12 offset:45056
s_add_u32 s23, s52, 28672
buffer_load_dwordx4 a[120:123], v7, s[40:43], s23 offen offset:2048 sc1
v_mfma_f32_16x16x32_bf16 v[132:135], v[40:43], a[84:87], v[132:135]
v_mfma_f32_16x16x32_bf16 v[136:139], v[40:43], a[148:151], v[136:139]
ds_read_b64_tr_b16 v[26:27], v12 offset:45568
v_mfma_f32_16x16x32_bf16 v[140:143], v[40:43], a[212:215], v[140:143]
s_waitcnt lgkmcnt(6)
v_mfma_f32_16x16x32_bf16 v[160:163], v[44:47], a[20:23], v[160:163]
ds_read_b64_tr_b16 v[28:29], v11 offset:45312
v_mfma_f32_16x16x32_bf16 v[164:167], v[44:47], a[84:87], v[164:167]
v_cvt_pk_bf16_f32 v54, v76, v77
v_mfma_f32_16x16x32_bf16 v[168:171], v[44:47], a[148:151], v[168:171]
ds_read_b64_tr_b16 v[30:31], v11 offset:45824
v_mfma_f32_16x16x32_bf16 v[172:175], v[44:47], a[212:215], v[172:175]
s_waitcnt vmcnt(16)
s_barrier
s_waitcnt lgkmcnt(6)
v_mfma_f32_16x16x32_bf16 v[192:195], v[16:19], a[20:23], v[192:195]
ds_read_b64_tr_b16 v[32:33], v11 offset:49152
s_add_u32 s23, s52, 45056
buffer_load_dwordx4 a[184:187], v7, s[40:43], s23 offen offset:2048 sc1
v_mfma_f32_16x16x32_bf16 v[196:199], v[16:19], a[84:87], v[196:199]
s_add_u32 m0, s56, 16384
s_add_u32 s57, s67, 880640
buffer_load_dwordx4 v8, s[8:11], s57 offen lds
v_mfma_f32_16x16x32_bf16 v[200:203], v[16:19], a[148:151], v[200:203]
ds_read_b64_tr_b16 v[34:35], v11 offset:49664
v_cvt_pk_bf16_f32 v55, v78, v79
v_mfma_f32_16x16x32_bf16 v[204:207], v[16:19], a[212:215], v[204:207]
s_waitcnt lgkmcnt(6)
v_mfma_f32_16x16x32_bf16 v[144:147], v[20:23], a[20:23], v[144:147]
ds_read_b64_tr_b16 v[36:37], v12 offset:49152
v_mfma_f32_16x16x32_bf16 v[148:151], v[20:23], a[84:87], v[148:151]
v_mfma_f32_16x16x32_bf16 v[152:155], v[20:23], a[148:151], v[152:155]
ds_read_b64_tr_b16 v[38:39], v12 offset:49664
s_add_u32 m0, s56, 20480
s_add_u32 s57, s67, 880640
buffer_load_dwordx4 v8, s[12:15], s57 offen lds
v_mfma_f32_16x16x32_bf16 v[156:159], v[20:23], a[212:215], v[156:159]
s_add_u32 s59, s58, 24576
buffer_store_dwordx4 v[52:55], v3, s[44:47], s59 offen offset:2048 sc1
s_waitcnt lgkmcnt(6)
v_mfma_f32_16x16x32_bf16 v[176:179], v[24:27], a[20:23], v[176:179]
ds_read_b64_tr_b16 v[40:41], v11 offset:49408
s_add_u32 s23, s52, 61440
buffer_load_dwordx4 a[248:251], v7, s[40:43], s23 offen offset:2048 sc1
v_mfma_f32_16x16x32_bf16 v[180:183], v[24:27], a[84:87], v[180:183]
v_mfma_f32_16x16x32_bf16 v[184:187], v[24:27], a[148:151], v[184:187]
ds_read_b64_tr_b16 v[42:43], v11 offset:49920
v_mfma_f32_16x16x32_bf16 v[188:191], v[24:27], a[212:215], v[188:191]
s_add_u32 m0, s56, 24576
s_add_u32 s57, s67, 968704
buffer_load_dwordx4 v8, s[8:11], s57 offen lds
s_waitcnt lgkmcnt(6)
v_mfma_f32_16x16x32_bf16 v[208:211], v[28:31], a[20:23], v[208:211]
ds_read_b64_tr_b16 v[44:45], v11 offset:53248
v_cvt_pk_bf16_f32 v56, v88, v89
v_mfma_f32_16x16x32_bf16 v[212:215], v[28:31], a[84:87], v[212:215]
v_mfma_f32_16x16x32_bf16 v[216:219], v[28:31], a[148:151], v[216:219]
ds_read_b64_tr_b16 v[46:47], v11 offset:53760
v_mfma_f32_16x16x32_bf16 v[220:223], v[28:31], a[212:215], v[220:223]
s_waitcnt lgkmcnt(6)
v_mfma_f32_16x16x32_bf16 v[128:131], v[32:35], a[24:27], v[128:131]
ds_read_b64_tr_b16 v[16:17], v12 offset:53248
s_add_u32 s23, s52, 12288
buffer_load_dwordx4 a[60:63], v7, s[40:43], s23 offen offset:3072 sc1
s_add_u32 m0, s56, 28672
s_add_u32 s57, s67, 968704
buffer_load_dwordx4 v8, s[12:15], s57 offen lds
v_mfma_f32_16x16x32_bf16 v[132:135], v[32:35], a[88:91], v[132:135]
v_cvt_pk_bf16_f32 v57, v90, v91
v_mfma_f32_16x16x32_bf16 v[136:139], v[32:35], a[152:155], v[136:139]
ds_read_b64_tr_b16 v[18:19], v12 offset:53760
v_mfma_f32_16x16x32_bf16 v[140:143], v[32:35], a[216:219], v[140:143]
s_waitcnt lgkmcnt(6)
v_mfma_f32_16x16x32_bf16 v[160:163], v[36:39], a[24:27], v[160:163]
ds_read_b64_tr_b16 v[20:21], v11 offset:53504
v_mfma_f32_16x16x32_bf16 v[164:167], v[36:39], a[88:91], v[164:167]
v_mfma_f32_16x16x32_bf16 v[168:171], v[36:39], a[152:155], v[168:171]
ds_read_b64_tr_b16 v[22:23], v11 offset:54016
v_mfma_f32_16x16x32_bf16 v[172:175], v[36:39], a[216:219], v[172:175]
v_cvt_pk_bf16_f32 v58, v92, v93
s_waitcnt lgkmcnt(6)
v_mfma_f32_16x16x32_bf16 v[192:195], v[40:43], a[24:27], v[192:195]
ds_read_b64_tr_b16 v[24:25], v11 offset:57344
s_add_u32 s23, s52, 28672
buffer_load_dwordx4 a[124:127], v7, s[40:43], s23 offen offset:3072 sc1
v_mfma_f32_16x16x32_bf16 v[196:199], v[40:43], a[88:91], v[196:199]
v_mfma_f32_16x16x32_bf16 v[200:203], v[40:43], a[152:155], v[200:203]
ds_read_b64_tr_b16 v[26:27], v11 offset:57856
v_mfma_f32_16x16x32_bf16 v[204:207], v[40:43], a[216:219], v[204:207]
s_waitcnt lgkmcnt(6)
v_mfma_f32_16x16x32_bf16 v[144:147], v[44:47], a[24:27], v[144:147]
ds_read_b64_tr_b16 v[28:29], v12 offset:57344
v_cvt_pk_bf16_f32 v59, v94, v95
v_mfma_f32_16x16x32_bf16 v[148:151], v[44:47], a[88:91], v[148:151]
v_mfma_f32_16x16x32_bf16 v[152:155], v[44:47], a[152:155], v[152:155]
ds_read_b64_tr_b16 v[30:31], v12 offset:57856
v_mfma_f32_16x16x32_bf16 v[156:159], v[44:47], a[216:219], v[156:159]
s_waitcnt lgkmcnt(6)
v_mfma_f32_16x16x32_bf16 v[176:179], v[16:19], a[24:27], v[176:179]
ds_read_b64_tr_b16 v[32:33], v11 offset:57600
s_add_u32 s23, s52, 45056
buffer_load_dwordx4 a[188:191], v7, s[40:43], s23 offen offset:3072 sc1
v_mfma_f32_16x16x32_bf16 v[180:183], v[16:19], a[88:91], v[180:183]
s_add_u32 s59, s58, 24576
buffer_store_dwordx4 v[56:59], v3, s[44:47], s59 offen offset:2304 sc1
v_mfma_f32_16x16x32_bf16 v[184:187], v[16:19], a[152:155], v[184:187]
ds_read_b64_tr_b16 v[34:35], v11 offset:58112
v_mfma_f32_16x16x32_bf16 v[188:191], v[16:19], a[216:219], v[188:191]
s_waitcnt lgkmcnt(6)
v_mfma_f32_16x16x32_bf16 v[208:211], v[20:23], a[24:27], v[208:211]
ds_read_b64_tr_b16 v[36:37], v11 offset:61440
v_mfma_f32_16x16x32_bf16 v[212:215], v[20:23], a[88:91], v[212:215]
v_mfma_f32_16x16x32_bf16 v[216:219], v[20:23], a[152:155], v[216:219]
ds_read_b64_tr_b16 v[38:39], v11 offset:61952
v_cvt_pk_bf16_f32 v48, v104, v105
v_mfma_f32_16x16x32_bf16 v[220:223], v[20:23], a[216:219], v[220:223]
s_waitcnt lgkmcnt(6)
v_mfma_f32_16x16x32_bf16 v[128:131], v[24:27], a[28:31], v[128:131]
ds_read_b64_tr_b16 v[40:41], v12 offset:61440
s_add_u32 s23, s52, 61440
buffer_load_dwordx4 a[252:255], v7, s[40:43], s23 offen offset:3072 sc1
v_mfma_f32_16x16x32_bf16 v[132:135], v[24:27], a[92:95], v[132:135]
v_mfma_f32_16x16x32_bf16 v[136:139], v[24:27], a[156:159], v[136:139]
ds_read_b64_tr_b16 v[42:43], v12 offset:61952
v_mfma_f32_16x16x32_bf16 v[140:143], v[24:27], a[220:223], v[140:143]
v_cvt_pk_bf16_f32 v49, v106, v107
s_waitcnt lgkmcnt(6)
v_mfma_f32_16x16x32_bf16 v[160:163], v[28:31], a[28:31], v[160:163]
ds_read_b64_tr_b16 v[44:45], v11 offset:61696
v_mfma_f32_16x16x32_bf16 v[164:167], v[28:31], a[92:95], v[164:167]
v_mfma_f32_16x16x32_bf16 v[168:171], v[28:31], a[156:159], v[168:171]
ds_read_b64_tr_b16 v[46:47], v11 offset:62208
v_mfma_f32_16x16x32_bf16 v[172:175], v[28:31], a[220:223], v[172:175]
s_waitcnt vmcnt(16)
s_barrier
s_waitcnt lgkmcnt(6)
v_mfma_f32_16x16x32_bf16 v[192:195], v[32:35], a[28:31], v[192:195]
ds_read_b64_tr_b16 v[16:17], v11 offset:0
v_mfma_f32_16x16x32_bf16 v[196:199], v[32:35], a[92:95], v[196:199]
v_cvt_pk_bf16_f32 v50, v108, v109
s_add_u32 m0, s56, 32768
s_add_u32 s57, s67, 1056768
buffer_load_dwordx4 v8, s[8:11], s57 offen lds
v_mfma_f32_16x16x32_bf16 v[200:203], v[32:35], a[156:159], v[200:203]
ds_read_b64_tr_b16 v[18:19], v11 offset:512
v_mfma_f32_16x16x32_bf16 v[204:207], v[32:35], a[220:223], v[204:207]
s_waitcnt lgkmcnt(6)
v_mfma_f32_16x16x32_bf16 v[144:147], v[36:39], a[28:31], v[144:147]
ds_read_b64_tr_b16 v[20:21], v12 offset:0
v_mfma_f32_16x16x32_bf16 v[148:151], v[36:39], a[92:95], v[148:151]
v_mfma_f32_16x16x32_bf16 v[152:155], v[36:39], a[156:159], v[152:155]
ds_read_b64_tr_b16 v[22:23], v12 offset:512
v_cvt_pk_bf16_f32 v51, v110, v111
s_add_u32 m0, s56, 36864
s_add_u32 s57, s67, 1056768
buffer_load_dwordx4 v8, s[12:15], s57 offen lds
v_mfma_f32_16x16x32_bf16 v[156:159], v[36:39], a[220:223], v[156:159]
s_waitcnt lgkmcnt(6)
v_mfma_f32_16x16x32_bf16 v[176:179], v[40:43], a[28:31], v[176:179]
ds_read_b64_tr_b16 v[24:25], v11 offset:256
v_mfma_f32_16x16x32_bf16 v[180:183], v[40:43], a[92:95], v[180:183]
v_mfma_f32_16x16x32_bf16 v[184:187], v[40:43], a[156:159], v[184:187]
ds_read_b64_tr_b16 v[26:27], v11 offset:768
v_mfma_f32_16x16x32_bf16 v[188:191], v[40:43], a[220:223], v[188:191]
s_add_u32 s59, s58, 24576
buffer_store_dwordx4 v[48:51], v3, s[44:47], s59 offen offset:3072 sc1
s_add_u32 m0, s56, 40960
s_add_u32 s57, s67, 1144832
buffer_load_dwordx4 v8, s[8:11], s57 offen lds
s_waitcnt lgkmcnt(6)
v_mfma_f32_16x16x32_bf16 v[208:211], v[44:47], a[28:31], v[208:211]
ds_read_b64_tr_b16 v[28:29], v11 offset:4096
v_mfma_f32_16x16x32_bf16 v[212:215], v[44:47], a[92:95], v[212:215]
v_mfma_f32_16x16x32_bf16 v[216:219], v[44:47], a[156:159], v[216:219]
ds_read_b64_tr_b16 v[30:31], v11 offset:4608
v_mfma_f32_16x16x32_bf16 v[220:223], v[44:47], a[220:223], v[220:223]
s_waitcnt lgkmcnt(6)
v_mfma_f32_16x16x32_bf16 v[128:131], v[16:19], a[32:35], v[128:131]
ds_read_b64_tr_b16 v[32:33], v12 offset:4096
s_add_u32 m0, s56, 45056
s_add_u32 s57, s67, 1144832
buffer_load_dwordx4 v8, s[12:15], s57 offen lds
v_cvt_pk_bf16_f32 v52, v120, v121
v_mfma_f32_16x16x32_bf16 v[132:135], v[16:19], a[96:99], v[132:135]
v_mfma_f32_16x16x32_bf16 v[136:139], v[16:19], a[160:163], v[136:139]
ds_read_b64_tr_b16 v[34:35], v12 offset:4608
v_mfma_f32_16x16x32_bf16 v[140:143], v[16:19], a[224:227], v[140:143]
s_waitcnt lgkmcnt(6)
v_mfma_f32_16x16x32_bf16 v[160:163], v[20:23], a[32:35], v[160:163]
ds_read_b64_tr_b16 v[36:37], v11 offset:4352
v_mfma_f32_16x16x32_bf16 v[164:167], v[20:23], a[96:99], v[164:167]
v_cvt_pk_bf16_f32 v53, v122, v123
v_mfma_f32_16x16x32_bf16 v[168:171], v[20:23], a[160:163], v[168:171]
ds_read_b64_tr_b16 v[38:39], v11 offset:4864
v_mfma_f32_16x16x32_bf16 v[172:175], v[20:23], a[224:227], v[172:175]
s_waitcnt lgkmcnt(6)
v_mfma_f32_16x16x32_bf16 v[192:195], v[24:27], a[32:35], v[192:195]
ds_read_b64_tr_b16 v[40:41], v11 offset:8192
v_mfma_f32_16x16x32_bf16 v[196:199], v[24:27], a[96:99], v[196:199]
v_mfma_f32_16x16x32_bf16 v[200:203], v[24:27], a[160:163], v[200:203]
ds_read_b64_tr_b16 v[42:43], v11 offset:8704
v_mfma_f32_16x16x32_bf16 v[204:207], v[24:27], a[224:227], v[204:207]
v_cvt_pk_bf16_f32 v54, v124, v125
s_waitcnt lgkmcnt(6)
v_mfma_f32_16x16x32_bf16 v[144:147], v[28:31], a[32:35], v[144:147]
ds_read_b64_tr_b16 v[44:45], v12 offset:8192
v_mfma_f32_16x16x32_bf16 v[148:151], v[28:31], a[96:99], v[148:151]
v_mfma_f32_16x16x32_bf16 v[152:155], v[28:31], a[160:163], v[152:155]
ds_read_b64_tr_b16 v[46:47], v12 offset:8704
v_mfma_f32_16x16x32_bf16 v[156:159], v[28:31], a[224:227], v[156:159]
s_waitcnt lgkmcnt(6)
v_mfma_f32_16x16x32_bf16 v[176:179], v[32:35], a[32:35], v[176:179]
ds_read_b64_tr_b16 v[16:17], v11 offset:8448
v_cvt_pk_bf16_f32 v55, v126, v127
v_mfma_f32_16x16x32_bf16 v[180:183], v[32:35], a[96:99], v[180:183]
v_mfma_f32_16x16x32_bf16 v[184:187], v[32:35], a[160:163], v[184:187]
ds_read_b64_tr_b16 v[18:19], v11 offset:8960
v_mfma_f32_16x16x32_bf16 v[188:191], v[32:35], a[224:227], v[188:191]
s_waitcnt lgkmcnt(6)
v_mfma_f32_16x16x32_bf16 v[208:211], v[36:39], a[32:35], v[208:211]
ds_read_b64_tr_b16 v[20:21], v11 offset:12288
v_mfma_f32_16x16x32_bf16 v[212:215], v[36:39], a[96:99], v[212:215]
s_add_u32 s59, s58, 24576
buffer_store_dwordx4 v[52:55], v3, s[44:47], s59 offen offset:3328 sc1
v_mfma_f32_16x16x32_bf16 v[216:219], v[36:39], a[160:163], v[216:219]
ds_read_b64_tr_b16 v[22:23], v11 offset:12800
v_mfma_f32_16x16x32_bf16 v[220:223], v[36:39], a[224:227], v[220:223]
s_waitcnt lgkmcnt(6)
v_mfma_f32_16x16x32_bf16 v[128:131], v[40:43], a[36:39], v[128:131]
ds_read_b64_tr_b16 v[24:25], v12 offset:12288
v_mfma_f32_16x16x32_bf16 v[132:135], v[40:43], a[100:103], v[132:135]
v_mfma_f32_16x16x32_bf16 v[136:139], v[40:43], a[164:167], v[136:139]
ds_read_b64_tr_b16 v[26:27], v12 offset:12800
v_mfma_f32_16x16x32_bf16 v[140:143], v[40:43], a[228:231], v[140:143]
s_waitcnt lgkmcnt(6)
v_mfma_f32_16x16x32_bf16 v[160:163], v[44:47], a[36:39], v[160:163]
ds_read_b64_tr_b16 v[28:29], v11 offset:12544
v_mfma_f32_16x16x32_bf16 v[164:167], v[44:47], a[100:103], v[164:167]
v_mfma_f32_16x16x32_bf16 v[168:171], v[44:47], a[164:167], v[168:171]
ds_read_b64_tr_b16 v[30:31], v11 offset:13056
v_mfma_f32_16x16x32_bf16 v[172:175], v[44:47], a[228:231], v[172:175]
s_waitcnt vmcnt(10)
s_barrier
s_waitcnt lgkmcnt(6)
v_mfma_f32_16x16x32_bf16 v[192:195], v[16:19], a[36:39], v[192:195]
ds_read_b64_tr_b16 v[32:33], v11 offset:16384
v_mfma_f32_16x16x32_bf16 v[196:199], v[16:19], a[100:103], v[196:199]
s_add_u32 m0, s56, 49152
s_add_u32 s57, s67, 1232896
buffer_load_dwordx4 v8, s[8:11], s57 offen lds
v_mfma_f32_16x16x32_bf16 v[200:203], v[16:19], a[164:167], v[200:203]
ds_read_b64_tr_b16 v[34:35], v11 offset:16896
v_mfma_f32_16x16x32_bf16 v[204:207], v[16:19], a[228:231], v[204:207]
s_waitcnt lgkmcnt(6)
v_mfma_f32_16x16x32_bf16 v[144:147], v[20:23], a[36:39], v[144:147]
ds_read_b64_tr_b16 v[36:37], v12 offset:16384
v_mfma_f32_16x16x32_bf16 v[148:151], v[20:23], a[100:103], v[148:151]
v_mfma_f32_16x16x32_bf16 v[152:155], v[20:23], a[164:167], v[152:155]
ds_read_b64_tr_b16 v[38:39], v12 offset:16896
s_add_u32 m0, s56, 53248
s_add_u32 s57, s67, 1232896
buffer_load_dwordx4 v8, s[12:15], s57 offen lds
v_mfma_f32_16x16x32_bf16 v[156:159], v[20:23], a[228:231], v[156:159]
s_waitcnt lgkmcnt(6)
v_mfma_f32_16x16x32_bf16 v[176:179], v[24:27], a[36:39], v[176:179]
ds_read_b64_tr_b16 v[40:41], v11 offset:16640
v_mfma_f32_16x16x32_bf16 v[180:183], v[24:27], a[100:103], v[180:183]
v_mfma_f32_16x16x32_bf16 v[184:187], v[24:27], a[164:167], v[184:187]
ds_read_b64_tr_b16 v[42:43], v11 offset:17152
v_mfma_f32_16x16x32_bf16 v[188:191], v[24:27], a[228:231], v[188:191]
s_add_u32 m0, s56, 57344
s_add_u32 s57, s67, 1320960
buffer_load_dwordx4 v8, s[8:11], s57 offen lds
s_waitcnt lgkmcnt(6)
v_mfma_f32_16x16x32_bf16 v[208:211], v[28:31], a[36:39], v[208:211]
ds_read_b64_tr_b16 v[44:45], v11 offset:20480
v_mfma_f32_16x16x32_bf16 v[212:215], v[28:31], a[100:103], v[212:215]
v_mfma_f32_16x16x32_bf16 v[216:219], v[28:31], a[164:167], v[216:219]
ds_read_b64_tr_b16 v[46:47], v11 offset:20992
v_mfma_f32_16x16x32_bf16 v[220:223], v[28:31], a[228:231], v[220:223]
s_waitcnt lgkmcnt(6)
v_mfma_f32_16x16x32_bf16 v[128:131], v[32:35], a[40:43], v[128:131]
ds_read_b64_tr_b16 v[16:17], v12 offset:20480
s_add_u32 m0, s56, 61440
s_add_u32 s57, s67, 1320960
buffer_load_dwordx4 v8, s[12:15], s57 offen lds
v_mfma_f32_16x16x32_bf16 v[132:135], v[32:35], a[104:107], v[132:135]
v_mfma_f32_16x16x32_bf16 v[136:139], v[32:35], a[168:171], v[136:139]
ds_read_b64_tr_b16 v[18:19], v12 offset:20992
v_mfma_f32_16x16x32_bf16 v[140:143], v[32:35], a[232:235], v[140:143]
s_waitcnt lgkmcnt(6)
v_mfma_f32_16x16x32_bf16 v[160:163], v[36:39], a[40:43], v[160:163]
ds_read_b64_tr_b16 v[20:21], v11 offset:20736
v_mfma_f32_16x16x32_bf16 v[164:167], v[36:39], a[104:107], v[164:167]
v_mfma_f32_16x16x32_bf16 v[168:171], v[36:39], a[168:171], v[168:171]
ds_read_b64_tr_b16 v[22:23], v11 offset:21248
v_mfma_f32_16x16x32_bf16 v[172:175], v[36:39], a[232:235], v[172:175]
s_waitcnt lgkmcnt(6)
v_mfma_f32_16x16x32_bf16 v[192:195], v[40:43], a[40:43], v[192:195]
ds_read_b64_tr_b16 v[24:25], v11 offset:24576
v_mfma_f32_16x16x32_bf16 v[196:199], v[40:43], a[104:107], v[196:199]
v_mfma_f32_16x16x32_bf16 v[200:203], v[40:43], a[168:171], v[200:203]
ds_read_b64_tr_b16 v[26:27], v11 offset:25088
v_mfma_f32_16x16x32_bf16 v[204:207], v[40:43], a[232:235], v[204:207]
s_waitcnt lgkmcnt(6)
v_mfma_f32_16x16x32_bf16 v[144:147], v[44:47], a[40:43], v[144:147]
ds_read_b64_tr_b16 v[28:29], v12 offset:24576
v_mfma_f32_16x16x32_bf16 v[148:151], v[44:47], a[104:107], v[148:151]
v_mfma_f32_16x16x32_bf16 v[152:155], v[44:47], a[168:171], v[152:155]
ds_read_b64_tr_b16 v[30:31], v12 offset:25088
v_mfma_f32_16x16x32_bf16 v[156:159], v[44:47], a[232:235], v[156:159]
s_waitcnt lgkmcnt(6)
v_mfma_f32_16x16x32_bf16 v[176:179], v[16:19], a[40:43], v[176:179]
ds_read_b64_tr_b16 v[32:33], v11 offset:24832
v_mfma_f32_16x16x32_bf16 v[180:183], v[16:19], a[104:107], v[180:183]
v_mfma_f32_16x16x32_bf16 v[184:187], v[16:19], a[168:171], v[184:187]
ds_read_b64_tr_b16 v[34:35], v11 offset:25344
v_mfma_f32_16x16x32_bf16 v[188:191], v[16:19], a[232:235], v[188:191]
s_waitcnt lgkmcnt(6)
v_mfma_f32_16x16x32_bf16 v[208:211], v[20:23], a[40:43], v[208:211]
ds_read_b64_tr_b16 v[36:37], v11 offset:28672
v_mfma_f32_16x16x32_bf16 v[212:215], v[20:23], a[104:107], v[212:215]
v_mfma_f32_16x16x32_bf16 v[216:219], v[20:23], a[168:171], v[216:219]
ds_read_b64_tr_b16 v[38:39], v11 offset:29184
v_mfma_f32_16x16x32_bf16 v[220:223], v[20:23], a[232:235], v[220:223]
s_waitcnt lgkmcnt(6)
v_mfma_f32_16x16x32_bf16 v[128:131], v[24:27], a[44:47], v[128:131]
ds_read_b64_tr_b16 v[40:41], v12 offset:28672
v_mfma_f32_16x16x32_bf16 v[132:135], v[24:27], a[108:111], v[132:135]
v_mfma_f32_16x16x32_bf16 v[136:139], v[24:27], a[172:175], v[136:139]
ds_read_b64_tr_b16 v[42:43], v12 offset:29184
v_mfma_f32_16x16x32_bf16 v[140:143], v[24:27], a[236:239], v[140:143]
s_waitcnt lgkmcnt(6)
v_mfma_f32_16x16x32_bf16 v[160:163], v[28:31], a[44:47], v[160:163]
ds_read_b64_tr_b16 v[44:45], v11 offset:28928
v_mfma_f32_16x16x32_bf16 v[164:167], v[28:31], a[108:111], v[164:167]
v_mfma_f32_16x16x32_bf16 v[168:171], v[28:31], a[172:175], v[168:171]
ds_read_b64_tr_b16 v[46:47], v11 offset:29440
v_mfma_f32_16x16x32_bf16 v[172:175], v[28:31], a[236:239], v[172:175]
s_waitcnt vmcnt(5)
s_barrier
s_waitcnt lgkmcnt(6)
v_mfma_f32_16x16x32_bf16 v[192:195], v[32:35], a[44:47], v[192:195]
ds_read_b64_tr_b16 v[16:17], v11 offset:32768
v_mfma_f32_16x16x32_bf16 v[196:199], v[32:35], a[108:111], v[196:199]
s_add_u32 m0, s56, 0
s_add_u32 s57, s55, 0
buffer_load_dwordx4 v10, s[4:7], s57 offen lds
v_mfma_f32_16x16x32_bf16 v[200:203], v[32:35], a[172:175], v[200:203]
ds_read_b64_tr_b16 v[18:19], v11 offset:33280
v_mfma_f32_16x16x32_bf16 v[204:207], v[32:35], a[236:239], v[204:207]
s_waitcnt lgkmcnt(6)
v_mfma_f32_16x16x32_bf16 v[144:147], v[36:39], a[44:47], v[144:147]
ds_read_b64_tr_b16 v[20:21], v12 offset:32768
v_mfma_f32_16x16x32_bf16 v[148:151], v[36:39], a[108:111], v[148:151]
v_mfma_f32_16x16x32_bf16 v[152:155], v[36:39], a[172:175], v[152:155]
ds_read_b64_tr_b16 v[22:23], v12 offset:33280
s_add_u32 m0, s56, 4096
s_add_u32 s57, s55, 262144
buffer_load_dwordx4 v10, s[4:7], s57 offen lds
v_mfma_f32_16x16x32_bf16 v[156:159], v[36:39], a[236:239], v[156:159]
s_waitcnt lgkmcnt(6)
v_mfma_f32_16x16x32_bf16 v[176:179], v[40:43], a[44:47], v[176:179]
ds_read_b64_tr_b16 v[24:25], v11 offset:33024
v_mfma_f32_16x16x32_bf16 v[180:183], v[40:43], a[108:111], v[180:183]
v_mfma_f32_16x16x32_bf16 v[184:187], v[40:43], a[172:175], v[184:187]
ds_read_b64_tr_b16 v[26:27], v11 offset:33536
v_mfma_f32_16x16x32_bf16 v[188:191], v[40:43], a[236:239], v[188:191]
s_add_u32 m0, s56, 8192
s_add_u32 s57, s55, 524288
buffer_load_dwordx4 v10, s[4:7], s57 offen lds
s_waitcnt lgkmcnt(6)
v_mfma_f32_16x16x32_bf16 v[208:211], v[44:47], a[44:47], v[208:211]
ds_read_b64_tr_b16 v[28:29], v11 offset:36864
v_mfma_f32_16x16x32_bf16 v[212:215], v[44:47], a[108:111], v[212:215]
v_mfma_f32_16x16x32_bf16 v[216:219], v[44:47], a[172:175], v[216:219]
ds_read_b64_tr_b16 v[30:31], v11 offset:37376
v_mfma_f32_16x16x32_bf16 v[220:223], v[44:47], a[236:239], v[220:223]
s_waitcnt lgkmcnt(6)
v_mfma_f32_16x16x32_bf16 v[128:131], v[16:19], a[48:51], v[128:131]
ds_read_b64_tr_b16 v[32:33], v12 offset:36864
s_add_u32 m0, s56, 12288
s_add_u32 s57, s55, 786432
buffer_load_dwordx4 v10, s[4:7], s57 offen lds
v_mfma_f32_16x16x32_bf16 v[132:135], v[16:19], a[112:115], v[132:135]
v_mfma_f32_16x16x32_bf16 v[136:139], v[16:19], a[176:179], v[136:139]
ds_read_b64_tr_b16 v[34:35], v12 offset:37376
v_mfma_f32_16x16x32_bf16 v[140:143], v[16:19], a[240:243], v[140:143]
s_waitcnt lgkmcnt(6)
v_mfma_f32_16x16x32_bf16 v[160:163], v[20:23], a[48:51], v[160:163]
ds_read_b64_tr_b16 v[36:37], v11 offset:37120
v_mfma_f32_16x16x32_bf16 v[164:167], v[20:23], a[112:115], v[164:167]
v_mfma_f32_16x16x32_bf16 v[168:171], v[20:23], a[176:179], v[168:171]
ds_read_b64_tr_b16 v[38:39], v11 offset:37632
v_mfma_f32_16x16x32_bf16 v[172:175], v[20:23], a[240:243], v[172:175]
s_waitcnt lgkmcnt(6)
v_mfma_f32_16x16x32_bf16 v[192:195], v[24:27], a[48:51], v[192:195]
ds_read_b64_tr_b16 v[40:41], v11 offset:40960
v_mfma_f32_16x16x32_bf16 v[196:199], v[24:27], a[112:115], v[196:199]
v_mfma_f32_16x16x32_bf16 v[200:203], v[24:27], a[176:179], v[200:203]
ds_read_b64_tr_b16 v[42:43], v11 offset:41472
v_mfma_f32_16x16x32_bf16 v[204:207], v[24:27], a[240:243], v[204:207]
s_waitcnt lgkmcnt(6)
v_mfma_f32_16x16x32_bf16 v[144:147], v[28:31], a[48:51], v[144:147]
ds_read_b64_tr_b16 v[44:45], v12 offset:40960
v_mfma_f32_16x16x32_bf16 v[148:151], v[28:31], a[112:115], v[148:151]
v_mfma_f32_16x16x32_bf16 v[152:155], v[28:31], a[176:179], v[152:155]
ds_read_b64_tr_b16 v[46:47], v12 offset:41472
v_mfma_f32_16x16x32_bf16 v[156:159], v[28:31], a[240:243], v[156:159]
s_waitcnt lgkmcnt(6)
v_mfma_f32_16x16x32_bf16 v[176:179], v[32:35], a[48:51], v[176:179]
ds_read_b64_tr_b16 v[16:17], v11 offset:41216
v_mfma_f32_16x16x32_bf16 v[180:183], v[32:35], a[112:115], v[180:183]
v_mfma_f32_16x16x32_bf16 v[184:187], v[32:35], a[176:179], v[184:187]
ds_read_b64_tr_b16 v[18:19], v11 offset:41728
v_mfma_f32_16x16x32_bf16 v[188:191], v[32:35], a[240:243], v[188:191]
s_waitcnt lgkmcnt(6)
v_mfma_f32_16x16x32_bf16 v[208:211], v[36:39], a[48:51], v[208:211]
ds_read_b64_tr_b16 v[20:21], v11 offset:45056
v_mfma_f32_16x16x32_bf16 v[212:215], v[36:39], a[112:115], v[212:215]
v_mfma_f32_16x16x32_bf16 v[216:219], v[36:39], a[176:179], v[216:219]
ds_read_b64_tr_b16 v[22:23], v11 offset:45568
v_mfma_f32_16x16x32_bf16 v[220:223], v[36:39], a[240:243], v[220:223]
s_waitcnt lgkmcnt(6)
v_mfma_f32_16x16x32_bf16 v[128:131], v[40:43], a[52:55], v[128:131]
ds_read_b64_tr_b16 v[24:25], v12 offset:45056
v_mfma_f32_16x16x32_bf16 v[132:135], v[40:43], a[116:119], v[132:135]
v_mfma_f32_16x16x32_bf16 v[136:139], v[40:43], a[180:183], v[136:139]
ds_read_b64_tr_b16 v[26:27], v12 offset:45568
v_mfma_f32_16x16x32_bf16 v[140:143], v[40:43], a[244:247], v[140:143]
s_waitcnt lgkmcnt(6)
v_mfma_f32_16x16x32_bf16 v[160:163], v[44:47], a[52:55], v[160:163]
ds_read_b64_tr_b16 v[28:29], v11 offset:45312
v_mfma_f32_16x16x32_bf16 v[164:167], v[44:47], a[116:119], v[164:167]
v_mfma_f32_16x16x32_bf16 v[168:171], v[44:47], a[180:183], v[168:171]
ds_read_b64_tr_b16 v[30:31], v11 offset:45824
v_mfma_f32_16x16x32_bf16 v[172:175], v[44:47], a[244:247], v[172:175]
s_waitcnt vmcnt(4)
s_barrier
s_lshl_b32 s3, s21, 2
v_mov_b32 v60, s3
s_cmp_lg_u32 s20, 0
s_cbranch_scc1 W0_skv
s_mov_b64 exec, 1
global_atomic_add v60, v61, s[98:99] offset:32 sc1
s_mov_b64 exec, -1
W0_skv:
s_waitcnt lgkmcnt(6)
v_mfma_f32_16x16x32_bf16 v[192:195], v[16:19], a[52:55], v[192:195]
ds_read_b64_tr_b16 v[32:33], v11 offset:49152
v_mfma_f32_16x16x32_bf16 v[196:199], v[16:19], a[116:119], v[196:199]
s_add_u32 m0, s56, 16384
s_add_u32 s57, s55, 1048576
buffer_load_dwordx4 v10, s[4:7], s57 offen lds
v_mfma_f32_16x16x32_bf16 v[200:203], v[16:19], a[180:183], v[200:203]
ds_read_b64_tr_b16 v[34:35], v11 offset:49664
v_mfma_f32_16x16x32_bf16 v[204:207], v[16:19], a[244:247], v[204:207]
s_waitcnt lgkmcnt(6)
v_mfma_f32_16x16x32_bf16 v[144:147], v[20:23], a[52:55], v[144:147]
ds_read_b64_tr_b16 v[36:37], v12 offset:49152
v_mfma_f32_16x16x32_bf16 v[148:151], v[20:23], a[116:119], v[148:151]
v_mfma_f32_16x16x32_bf16 v[152:155], v[20:23], a[180:183], v[152:155]
ds_read_b64_tr_b16 v[38:39], v12 offset:49664
s_add_u32 m0, s56, 20480
s_add_u32 s57, s55, 1310720
buffer_load_dwordx4 v10, s[4:7], s57 offen lds
v_mfma_f32_16x16x32_bf16 v[156:159], v[20:23], a[244:247], v[156:159]
s_waitcnt lgkmcnt(6)
v_mfma_f32_16x16x32_bf16 v[176:179], v[24:27], a[52:55], v[176:179]
ds_read_b64_tr_b16 v[40:41], v11 offset:49408
v_mfma_f32_16x16x32_bf16 v[180:183], v[24:27], a[116:119], v[180:183]
v_mfma_f32_16x16x32_bf16 v[184:187], v[24:27], a[180:183], v[184:187]
ds_read_b64_tr_b16 v[42:43], v11 offset:49920
v_mfma_f32_16x16x32_bf16 v[188:191], v[24:27], a[244:247], v[188:191]
s_add_u32 m0, s56, 24576
s_add_u32 s57, s55, 1572864
buffer_load_dwordx4 v10, s[4:7], s57 offen lds
s_waitcnt lgkmcnt(6)
v_mfma_f32_16x16x32_bf16 v[208:211], v[28:31], a[52:55], v[208:211]
ds_read_b64_tr_b16 v[44:45], v11 offset:53248
v_mfma_f32_16x16x32_bf16 v[212:215], v[28:31], a[116:119], v[212:215]
v_mfma_f32_16x16x32_bf16 v[216:219], v[28:31], a[180:183], v[216:219]
ds_read_b64_tr_b16 v[46:47], v11 offset:53760
v_mfma_f32_16x16x32_bf16 v[220:223], v[28:31], a[244:247], v[220:223]
s_waitcnt lgkmcnt(6)
v_mfma_f32_16x16x32_bf16 v[128:131], v[32:35], a[56:59], v[128:131]
ds_read_b64_tr_b16 v[16:17], v12 offset:53248
s_add_u32 m0, s56, 28672
s_add_u32 s57, s55, 1835008
buffer_load_dwordx4 v10, s[4:7], s57 offen lds
v_mfma_f32_16x16x32_bf16 v[132:135], v[32:35], a[120:123], v[132:135]
v_mfma_f32_16x16x32_bf16 v[136:139], v[32:35], a[184:187], v[136:139]
ds_read_b64_tr_b16 v[18:19], v12 offset:53760
v_mfma_f32_16x16x32_bf16 v[140:143], v[32:35], a[248:251], v[140:143]
s_waitcnt lgkmcnt(6)
v_mfma_f32_16x16x32_bf16 v[160:163], v[36:39], a[56:59], v[160:163]
ds_read_b64_tr_b16 v[20:21], v11 offset:53504
v_mfma_f32_16x16x32_bf16 v[164:167], v[36:39], a[120:123], v[164:167]
v_mfma_f32_16x16x32_bf16 v[168:171], v[36:39], a[184:187], v[168:171]
ds_read_b64_tr_b16 v[22:23], v11 offset:54016
v_mfma_f32_16x16x32_bf16 v[172:175], v[36:39], a[248:251], v[172:175]
s_waitcnt lgkmcnt(6)
v_mfma_f32_16x16x32_bf16 v[192:195], v[40:43], a[56:59], v[192:195]
ds_read_b64_tr_b16 v[24:25], v11 offset:57344
v_mfma_f32_16x16x32_bf16 v[196:199], v[40:43], a[120:123], v[196:199]
v_mfma_f32_16x16x32_bf16 v[200:203], v[40:43], a[184:187], v[200:203]
s_load_dwordx2 s[36:37], s[0:1], 40
s_load_dwordx4 s[40:43], s[0:1], 72
ds_read_b64_tr_b16 v[26:27], v11 offset:57856
v_mfma_f32_16x16x32_bf16 v[204:207], v[40:43], a[248:251], v[204:207]
s_waitcnt lgkmcnt(0)
v_mfma_f32_16x16x32_bf16 v[144:147], v[44:47], a[56:59], v[144:147]
ds_read_b64_tr_b16 v[28:29], v12 offset:57344
v_mfma_f32_16x16x32_bf16 v[148:151], v[44:47], a[120:123], v[148:151]
v_mfma_f32_16x16x32_bf16 v[152:155], v[44:47], a[184:187], v[152:155]
ds_read_b64_tr_b16 v[30:31], v12 offset:57856
v_mfma_f32_16x16x32_bf16 v[156:159], v[44:47], a[248:251], v[156:159]
v_mfma_f32_16x16x32_bf16 v[176:179], v[16:19], a[56:59], v[176:179]
ds_read_b64_tr_b16 v[32:33], v11 offset:57600
v_mfma_f32_16x16x32_bf16 v[180:183], v[16:19], a[120:123], v[180:183]
v_mfma_f32_16x16x32_bf16 v[184:187], v[16:19], a[184:187], v[184:187]
ds_read_b64_tr_b16 v[34:35], v11 offset:58112
v_mfma_f32_16x16x32_bf16 v[188:191], v[16:19], a[248:251], v[188:191]
v_mfma_f32_16x16x32_bf16 v[208:211], v[20:23], a[56:59], v[208:211]
ds_read_b64_tr_b16 v[36:37], v11 offset:61440
v_mfma_f32_16x16x32_bf16 v[212:215], v[20:23], a[120:123], v[212:215]
v_mfma_f32_16x16x32_bf16 v[216:219], v[20:23], a[184:187], v[216:219]
ds_read_b64_tr_b16 v[38:39], v11 offset:61952
v_mfma_f32_16x16x32_bf16 v[220:223], v[20:23], a[248:251], v[220:223]
v_mfma_f32_16x16x32_bf16 v[128:131], v[24:27], a[60:63], v[128:131]
ds_read_b64_tr_b16 v[40:41], v12 offset:61440
v_mfma_f32_16x16x32_bf16 v[132:135], v[24:27], a[124:127], v[132:135]
v_mfma_f32_16x16x32_bf16 v[136:139], v[24:27], a[188:191], v[136:139]
ds_read_b64_tr_b16 v[42:43], v12 offset:61952
v_mfma_f32_16x16x32_bf16 v[140:143], v[24:27], a[252:255], v[140:143]
s_waitcnt lgkmcnt(6)
v_mfma_f32_16x16x32_bf16 v[160:163], v[28:31], a[60:63], v[160:163]
ds_read_b64_tr_b16 v[44:45], v11 offset:61696
v_mfma_f32_16x16x32_bf16 v[164:167], v[28:31], a[124:127], v[164:167]
v_mfma_f32_16x16x32_bf16 v[168:171], v[28:31], a[188:191], v[168:171]
ds_read_b64_tr_b16 v[46:47], v11 offset:62208
v_mfma_f32_16x16x32_bf16 v[172:175], v[28:31], a[252:255], v[172:175]
s_waitcnt vmcnt(4)
s_barrier
s_waitcnt lgkmcnt(6)
v_mfma_f32_16x16x32_bf16 v[192:195], v[32:35], a[60:63], v[192:195]
ds_read_b64_tr_b16 v[16:17], v11 offset:0
v_mfma_f32_16x16x32_bf16 v[196:199], v[32:35], a[124:127], v[196:199]
s_add_u32 m0, s56, 32768
s_add_u32 s57, s55, 2097152
buffer_load_dwordx4 v10, s[4:7], s57 offen lds
v_mfma_f32_16x16x32_bf16 v[200:203], v[32:35], a[188:191], v[200:203]
ds_read_b64_tr_b16 v[18:19], v11 offset:512
v_mfma_f32_16x16x32_bf16 v[204:207], v[32:35], a[252:255], v[204:207]
s_waitcnt lgkmcnt(6)
v_mfma_f32_16x16x32_bf16 v[144:147], v[36:39], a[60:63], v[144:147]
ds_read_b64_tr_b16 v[20:21], v12 offset:0
v_mfma_f32_16x16x32_bf16 v[148:151], v[36:39], a[124:127], v[148:151]
v_mfma_f32_16x16x32_bf16 v[152:155], v[36:39], a[188:191], v[152:155]
ds_read_b64_tr_b16 v[22:23], v12 offset:512
s_add_u32 m0, s56, 36864
s_add_u32 s57, s55, 2359296
buffer_load_dwordx4 v10, s[4:7], s57 offen lds
v_mfma_f32_16x16x32_bf16 v[156:159], v[36:39], a[252:255], v[156:159]
s_waitcnt lgkmcnt(6)
v_mfma_f32_16x16x32_bf16 v[176:179], v[40:43], a[60:63], v[176:179]
ds_read_b64_tr_b16 v[24:25], v11 offset:256
v_mfma_f32_16x16x32_bf16 v[180:183], v[40:43], a[124:127], v[180:183]
v_mfma_f32_16x16x32_bf16 v[184:187], v[40:43], a[188:191], v[184:187]
ds_read_b64_tr_b16 v[26:27], v11 offset:768
v_mfma_f32_16x16x32_bf16 v[188:191], v[40:43], a[252:255], v[188:191]
s_add_u32 m0, s56, 40960
s_add_u32 s57, s55, 2621440
buffer_load_dwordx4 v10, s[4:7], s57 offen lds
s_waitcnt lgkmcnt(6)
v_mfma_f32_16x16x32_bf16 v[208:211], v[44:47], a[60:63], v[208:211]
ds_read_b64_tr_b16 v[28:29], v12 offset:256
v_mfma_f32_16x16x32_bf16 v[212:215], v[44:47], a[124:127], v[212:215]
v_mfma_f32_16x16x32_bf16 v[216:219], v[44:47], a[188:191], v[216:219]
ds_read_b64_tr_b16 v[30:31], v12 offset:768
v_mfma_f32_16x16x32_bf16 v[220:223], v[44:47], a[252:255], v[220:223]
s_waitcnt lgkmcnt(6)
v_mfma_f32_16x16x32_bf16 v[64:67], v[16:19], a[0:3], 0
ds_read_b64_tr_b16 v[32:33], v11 offset:4096
s_add_u32 m0, s56, 45056
s_add_u32 s57, s55, 2883584
buffer_load_dwordx4 v10, s[4:7], s57 offen lds
v_mfma_f32_16x16x32_bf16 v[68:71], v[16:19], a[64:67], 0
v_mfma_f32_16x16x32_bf16 v[72:75], v[16:19], a[128:131], 0
s_mov_b32 s44, s42
s_mov_b32 s45, s43
s_mov_b32 s46, 2097152
s_mov_b32 s47, 0x20000
s_mov_b32 s40, s40
s_mov_b32 s41, s41
s_mov_b32 s42, 1409024
s_mov_b32 s43, 0x20000
s_mov_b32 s36, s36
s_mov_b32 s37, s37
s_mov_b32 s38, 4194304
s_mov_b32 s39, 0x20000
s_lshl_b32 s3, s2, 2
s_add_u32 s3, s3, s20
s_mul_i32 s69, s3, 1408
s_lshl_b32 s3, s3, 12
v_and_b32 v13, 31, v1
v_lshlrev_b32 v13, 7, v13
v_min_u32 v9, 1280, v13
buffer_load_dword v63, v13, s[36:39], s3 offen
buffer_load_dword v63, v9, s[40:43], s69 offen
ds_read_b64_tr_b16 v[34:35], v11 offset:4608
v_mfma_f32_16x16x32_bf16 v[76:79], v[16:19], a[192:195], 0
s_waitcnt lgkmcnt(6)
v_mfma_f32_16x16x32_bf16 v[80:83], v[20:23], a[0:3], 0
ds_read_b64_tr_b16 v[36:37], v12 offset:4096
v_mfma_f32_16x16x32_bf16 v[84:87], v[20:23], a[64:67], 0
v_mfma_f32_16x16x32_bf16 v[88:91], v[20:23], a[128:131], 0
ds_read_b64_tr_b16 v[38:39], v12 offset:4608
v_mul_f32 v48, v128, v128
v_mfma_f32_16x16x32_bf16 v[92:95], v[20:23], a[192:195], 0
v_mul_f32 v49, v129, v129
s_waitcnt lgkmcnt(6)
v_mfma_f32_16x16x32_bf16 v[96:99], v[24:27], a[0:3], 0
ds_read_b64_tr_b16 v[40:41], v11 offset:4352
v_mul_f32 v50, v130, v130
v_mfma_f32_16x16x32_bf16 v[100:103], v[24:27], a[64:67], 0
v_mul_f32 v51, v131, v131
v_fma_f32 v48, v48, s68, v62
v_mfma_f32_16x16x32_bf16 v[104:107], v[24:27], a[128:131], 0
ds_read_b64_tr_b16 v[42:43], v11 offset:4864
v_fma_f32 v49, v49, s68, v62
v_mfma_f32_16x16x32_bf16 v[108:111], v[24:27], a[192:195], 0
v_fma_f32 v50, v50, s68, v62
s_waitcnt lgkmcnt(6)
v_mfma_f32_16x16x32_bf16 v[112:115], v[28:31], a[0:3], 0
ds_read_b64_tr_b16 v[44:45], v12 offset:4352
v_fma_f32 v51, v51, s68, v62
v_mfma_f32_16x16x32_bf16 v[116:119], v[28:31], a[64:67], 0
v_mul_f32 v48, v48, v128
v_mfma_f32_16x16x32_bf16 v[120:123], v[28:31], a[128:131], 0
ds_read_b64_tr_b16 v[46:47], v12 offset:4864
v_mul_f32 v49, v49, v129
v_mfma_f32_16x16x32_bf16 v[124:127], v[28:31], a[192:195], 0
v_mul_f32 v50, v50, v130
v_mul_f32 v51, v51, v131
s_waitcnt lgkmcnt(6)
v_mfma_f32_16x16x32_bf16 v[64:67], v[32:35], a[4:7], v[64:67]
ds_read_b64_tr_b16 v[16:17], v11 offset:8192
v_exp_f32 v48, v48
v_mfma_f32_16x16x32_bf16 v[68:71], v[32:35], a[68:71], v[68:71]
v_mul_f32 v128, v128, v144
v_mfma_f32_16x16x32_bf16 v[72:75], v[32:35], a[132:135], v[72:75]
ds_read_b64_tr_b16 v[18:19], v11 offset:8704
v_exp_f32 v49, v49
v_mfma_f32_16x16x32_bf16 v[76:79], v[32:35], a[196:199], v[76:79]
v_mul_f32 v129, v129, v145
s_waitcnt lgkmcnt(6)
v_mfma_f32_16x16x32_bf16 v[80:83], v[36:39], a[4:7], v[80:83]
ds_read_b64_tr_b16 v[20:21], v12 offset:8192
v_exp_f32 v50, v50
v_mfma_f32_16x16x32_bf16 v[84:87], v[36:39], a[68:71], v[84:87]
v_mul_f32 v130, v130, v146
v_exp_f32 v51, v51
v_mfma_f32_16x16x32_bf16 v[88:91], v[36:39], a[132:135], v[88:91]
ds_read_b64_tr_b16 v[22:23], v12 offset:8704
v_mul_f32 v131, v131, v147
v_mfma_f32_16x16x32_bf16 v[92:95], v[36:39], a[196:199], v[92:95]
v_add_f32 v48, 1.0, v48
s_waitcnt lgkmcnt(6)
v_mfma_f32_16x16x32_bf16 v[96:99], v[40:43], a[4:7], v[96:99]
ds_read_b64_tr_b16 v[24:25], v11 offset:8448
v_add_f32 v49, 1.0, v49
v_mfma_f32_16x16x32_bf16 v[100:103], v[40:43], a[68:71], v[100:103]
v_add_f32 v50, 1.0, v50
v_mfma_f32_16x16x32_bf16 v[104:107], v[40:43], a[132:135], v[104:107]
ds_read_b64_tr_b16 v[26:27], v11 offset:8960
v_add_f32 v51, 1.0, v51
v_mfma_f32_16x16x32_bf16 v[108:111], v[40:43], a[196:199], v[108:111]
v_rcp_f32 v48, v48
v_rcp_f32 v49, v49
s_waitcnt lgkmcnt(6)
v_mfma_f32_16x16x32_bf16 v[112:115], v[44:47], a[4:7], v[112:115]
ds_read_b64_tr_b16 v[28:29], v12 offset:8448
v_rcp_f32 v50, v50
v_mfma_f32_16x16x32_bf16 v[116:119], v[44:47], a[68:71], v[116:119]
v_rcp_f32 v51, v51
v_mfma_f32_16x16x32_bf16 v[120:123], v[44:47], a[132:135], v[120:123]
ds_read_b64_tr_b16 v[30:31], v12 offset:8960
v_mul_f32 v128, v128, v48
v_mfma_f32_16x16x32_bf16 v[124:127], v[44:47], a[196:199], v[124:127]
v_mul_f32 v129, v129, v49
s_waitcnt lgkmcnt(6)
v_mfma_f32_16x16x32_bf16 v[64:67], v[16:19], a[8:11], v[64:67]
ds_read_b64_tr_b16 v[32:33], v11 offset:12288
v_mul_f32 v130, v130, v50
v_mfma_f32_16x16x32_bf16 v[68:71], v[16:19], a[72:75], v[68:71]
v_mul_f32 v131, v131, v51
v_cvt_pk_bf16_f32 v56, v128, v129
v_mfma_f32_16x16x32_bf16 v[72:75], v[16:19], a[136:139], v[72:75]
ds_read_b64_tr_b16 v[34:35], v11 offset:12800
v_cvt_pk_bf16_f32 v57, v130, v131
v_mfma_f32_16x16x32_bf16 v[76:79], v[16:19], a[200:203], v[76:79]
v_mul_f32 v52, v132, v132
s_waitcnt lgkmcnt(6)
v_mfma_f32_16x16x32_bf16 v[80:83], v[20:23], a[8:11], v[80:83]
ds_read_b64_tr_b16 v[36:37], v12 offset:12288
v_mul_f32 v53, v133, v133
v_mfma_f32_16x16x32_bf16 v[84:87], v[20:23], a[72:75], v[84:87]
v_mul_f32 v54, v134, v134
v_mfma_f32_16x16x32_bf16 v[88:91], v[20:23], a[136:139], v[88:91]
ds_read_b64_tr_b16 v[38:39], v12 offset:12800
v_mul_f32 v55, v135, v135
v_mfma_f32_16x16x32_bf16 v[92:95], v[20:23], a[200:203], v[92:95]
v_fma_f32 v52, v52, s68, v62
v_fma_f32 v53, v53, s68, v62
s_waitcnt lgkmcnt(6)
v_mfma_f32_16x16x32_bf16 v[96:99], v[24:27], a[8:11], v[96:99]
ds_read_b64_tr_b16 v[40:41], v11 offset:12544
v_fma_f32 v54, v54, s68, v62
v_mfma_f32_16x16x32_bf16 v[100:103], v[24:27], a[72:75], v[100:103]
v_fma_f32 v55, v55, s68, v62
v_mfma_f32_16x16x32_bf16 v[104:107], v[24:27], a[136:139], v[104:107]
ds_read_b64_tr_b16 v[42:43], v11 offset:13056
v_mul_f32 v52, v52, v132
v_mfma_f32_16x16x32_bf16 v[108:111], v[24:27], a[200:203], v[108:111]
v_mul_f32 v53, v53, v133
s_waitcnt lgkmcnt(6)
v_mfma_f32_16x16x32_bf16 v[112:115], v[28:31], a[8:11], v[112:115]
ds_read_b64_tr_b16 v[44:45], v12 offset:12544
v_mul_f32 v54, v54, v134
v_mfma_f32_16x16x32_bf16 v[116:119], v[28:31], a[72:75], v[116:119]
v_mul_f32 v55, v55, v135
v_exp_f32 v52, v52
v_mfma_f32_16x16x32_bf16 v[120:123], v[28:31], a[136:139], v[120:123]
ds_read_b64_tr_b16 v[46:47], v12 offset:13056
v_mul_f32 v132, v132, v148
v_mfma_f32_16x16x32_bf16 v[124:127], v[28:31], a[200:203], v[124:127]
s_waitcnt vmcnt(6)
s_barrier
v_exp_f32 v53, v53
s_waitcnt lgkmcnt(6)
v_mfma_f32_16x16x32_bf16 v[64:67], v[32:35], a[12:15], v[64:67]
ds_read_b64_tr_b16 v[16:17], v11 offset:16384
v_mul_f32 v133, v133, v149
v_mfma_f32_16x16x32_bf16 v[68:71], v[32:35], a[76:79], v[68:71]
v_exp_f32 v54, v54
s_add_u32 m0, s56, 49152
s_add_u32 s57, s55, 3145728
buffer_load_dwordx4 v10, s[4:7], s57 offen lds
v_mfma_f32_16x16x32_bf16 v[72:75], v[32:35], a[140:143], v[72:75]
ds_read_b64_tr_b16 v[18:19], v11 offset:16896
v_mul_f32 v134, v134, v150
v_mfma_f32_16x16x32_bf16 v[76:79], v[32:35], a[204:207], v[76:79]
v_exp_f32 v55, v55
v_mul_f32 v135, v135, v151
s_waitcnt lgkmcnt(6)
v_mfma_f32_16x16x32_bf16 v[80:83], v[36:39], a[12:15], v[80:83]
ds_read_b64_tr_b16 v[20:21], v12 offset:16384
v_add_f32 v52, 1.0, v52
v_mfma_f32_16x16x32_bf16 v[84:87], v[36:39], a[76:79], v[84:87]
v_add_f32 v53, 1.0, v53
v_mfma_f32_16x16x32_bf16 v[88:91], v[36:39], a[140:143], v[88:91]
ds_read_b64_tr_b16 v[22:23], v12 offset:16896
s_add_u32 m0, s56, 53248
s_add_u32 s57, s55, 3407872
buffer_load_dwordx4 v10, s[4:7], s57 offen lds
v_add_f32 v54, 1.0, v54
v_mfma_f32_16x16x32_bf16 v[92:95], v[36:39], a[204:207], v[92:95]
v_add_f32 v55, 1.0, v55
s_waitcnt lgkmcnt(6)
v_mfma_f32_16x16x32_bf16 v[96:99], v[40:43], a[12:15], v[96:99]
ds_read_b64_tr_b16 v[24:25], v11 offset:16640
v_rcp_f32 v52, v52
v_mfma_f32_16x16x32_bf16 v[100:103], v[40:43], a[76:79], v[100:103]
v_rcp_f32 v53, v53
v_rcp_f32 v54, v54
v_mfma_f32_16x16x32_bf16 v[104:107], v[40:43], a[140:143], v[104:107]
ds_read_b64_tr_b16 v[26:27], v11 offset:17152
v_rcp_f32 v55, v55
v_mfma_f32_16x16x32_bf16 v[108:111], v[40:43], a[204:207], v[108:111]
s_add_u32 m0, s56, 57344
s_add_u32 s57, s55, 3670016
buffer_load_dwordx4 v10, s[4:7], s57 offen lds
v_mul_f32 v132, v132, v52
s_waitcnt lgkmcnt(6)
v_mfma_f32_16x16x32_bf16 v[112:115], v[44:47], a[12:15], v[112:115]
ds_read_b64_tr_b16 v[28:29], v12 offset:16640
v_mul_f32 v133, v133, v53
v_mfma_f32_16x16x32_bf16 v[116:119], v[44:47], a[76:79], v[116:119]
v_mul_f32 v134, v134, v54
v_mfma_f32_16x16x32_bf16 v[120:123], v[44:47], a[140:143], v[120:123]
ds_read_b64_tr_b16 v[30:31], v12 offset:17152
v_mul_f32 v135, v135, v55
v_mfma_f32_16x16x32_bf16 v[124:127], v[44:47], a[204:207], v[124:127]
v_cvt_pk_bf16_f32 v58, v132, v133
v_cvt_pk_bf16_f32 v59, v134, v135
s_waitcnt lgkmcnt(6)
v_mfma_f32_16x16x32_bf16 v[64:67], v[16:19], a[16:19], v[64:67]
ds_read_b64_tr_b16 v[32:33], v11 offset:20480
s_add_u32 m0, s56, 61440
s_add_u32 s57, s55, 3932160
buffer_load_dwordx4 v10, s[4:7], s57 offen lds
s_add_u32 s23, s70, 131072
v_permlane16_swap_b32 v56, v58
v_mfma_f32_16x16x32_bf16 v[68:71], v[16:19], a[80:83], v[68:71]
v_permlane16_swap_b32 v57, v59
v_mfma_f32_16x16x32_bf16 v[72:75], v[16:19], a[144:147], v[72:75]
ds_read_b64_tr_b16 v[34:35], v11 offset:20992
buffer_store_dwordx4 v[56:59], v0, s[48:51], s23 offen sc1
v_mfma_f32_16x16x32_bf16 v[76:79], v[16:19], a[208:211], v[76:79]
v_mul_f32 v48, v136, v136
s_waitcnt lgkmcnt(6)
v_mfma_f32_16x16x32_bf16 v[80:83], v[20:23], a[16:19], v[80:83]
ds_read_b64_tr_b16 v[36:37], v12 offset:20480
v_mul_f32 v49, v137, v137
v_mfma_f32_16x16x32_bf16 v[84:87], v[20:23], a[80:83], v[84:87]
v_mul_f32 v50, v138, v138
v_mfma_f32_16x16x32_bf16 v[88:91], v[20:23], a[144:147], v[88:91]
v_mul_f32 v51, v139, v139
ds_read_b64_tr_b16 v[38:39], v12 offset:20992
v_fma_f32 v48, v48, s68, v62
v_mfma_f32_16x16x32_bf16 v[92:95], v[20:23], a[208:211], v[92:95]
v_fma_f32 v49, v49, s68, v62
s_waitcnt lgkmcnt(6)
v_mfma_f32_16x16x32_bf16 v[96:99], v[24:27], a[16:19], v[96:99]
ds_read_b64_tr_b16 v[40:41], v11 offset:20736
v_fma_f32 v50, v50, s68, v62
v_mfma_f32_16x16x32_bf16 v[100:103], v[24:27], a[80:83], v[100:103]
v_fma_f32 v51, v51, s68, v62
v_mfma_f32_16x16x32_bf16 v[104:107], v[24:27], a[144:147], v[104:107]
ds_read_b64_tr_b16 v[42:43], v11 offset:21248
v_mul_f32 v48, v48, v136
v_mfma_f32_16x16x32_bf16 v[108:111], v[24:27], a[208:211], v[108:111]
v_mul_f32 v49, v49, v137
s_waitcnt lgkmcnt(6)
v_mfma_f32_16x16x32_bf16 v[112:115], v[28:31], a[16:19], v[112:115]
v_mul_f32 v50, v50, v138
ds_read_b64_tr_b16 v[44:45], v12 offset:20736
v_mul_f32 v51, v51, v139
v_mfma_f32_16x16x32_bf16 v[116:119], v[28:31], a[80:83], v[116:119]
v_exp_f32 v48, v48
v_mfma_f32_16x16x32_bf16 v[120:123], v[28:31], a[144:147], v[120:123]
ds_read_b64_tr_b16 v[46:47], v12 offset:21248
v_mul_f32 v136, v136, v152
v_mfma_f32_16x16x32_bf16 v[124:127], v[28:31], a[208:211], v[124:127]
v_exp_f32 v49, v49
s_waitcnt lgkmcnt(6)
v_mfma_f32_16x16x32_bf16 v[64:67], v[32:35], a[20:23], v[64:67]
ds_read_b64_tr_b16 v[16:17], v11 offset:24576
v_mul_f32 v137, v137, v153
v_mfma_f32_16x16x32_bf16 v[68:71], v[32:35], a[84:87], v[68:71]
v_exp_f32 v50, v50
v_mfma_f32_16x16x32_bf16 v[72:75], v[32:35], a[148:151], v[72:75]
v_mul_f32 v138, v138, v154
ds_read_b64_tr_b16 v[18:19], v11 offset:25088
v_exp_f32 v51, v51
v_mfma_f32_16x16x32_bf16 v[76:79], v[32:35], a[212:215], v[76:79]
v_mul_f32 v139, v139, v155
s_waitcnt lgkmcnt(6)
v_mfma_f32_16x16x32_bf16 v[80:83], v[36:39], a[20:23], v[80:83]
ds_read_b64_tr_b16 v[20:21], v12 offset:24576
v_add_f32 v48, 1.0, v48
v_mfma_f32_16x16x32_bf16 v[84:87], v[36:39], a[84:87], v[84:87]
v_add_f32 v49, 1.0, v49
v_mfma_f32_16x16x32_bf16 v[88:91], v[36:39], a[148:151], v[88:91]
ds_read_b64_tr_b16 v[22:23], v12 offset:25088
v_add_f32 v50, 1.0, v50
v_mfma_f32_16x16x32_bf16 v[92:95], v[36:39], a[212:215], v[92:95]
v_add_f32 v51, 1.0, v51
s_waitcnt lgkmcnt(6)
v_mfma_f32_16x16x32_bf16 v[96:99], v[40:43], a[20:23], v[96:99]
v_rcp_f32 v48, v48
ds_read_b64_tr_b16 v[24:25], v11 offset:24832
v_rcp_f32 v49, v49
v_mfma_f32_16x16x32_bf16 v[100:103], v[40:43], a[84:87], v[100:103]
v_rcp_f32 v50, v50
v_mfma_f32_16x16x32_bf16 v[104:107], v[40:43], a[148:151], v[104:107]
ds_read_b64_tr_b16 v[26:27], v11 offset:25344
v_rcp_f32 v51, v51
v_mfma_f32_16x16x32_bf16 v[108:111], v[40:43], a[212:215], v[108:111]
v_mul_f32 v136, v136, v48
s_waitcnt lgkmcnt(6)
v_mfma_f32_16x16x32_bf16 v[112:115], v[44:47], a[20:23], v[112:115]
ds_read_b64_tr_b16 v[28:29], v12 offset:24832
v_mul_f32 v137, v137, v49
v_mfma_f32_16x16x32_bf16 v[116:119], v[44:47], a[84:87], v[116:119]
v_mul_f32 v138, v138, v50
v_mfma_f32_16x16x32_bf16 v[120:123], v[44:47], a[148:151], v[120:123]
v_mul_f32 v139, v139, v51
ds_read_b64_tr_b16 v[30:31], v12 offset:25344
v_cvt_pk_bf16_f32 v56, v136, v137
v_mfma_f32_16x16x32_bf16 v[124:127], v[44:47], a[212:215], v[124:127]
v_cvt_pk_bf16_f32 v57, v138, v139
s_waitcnt lgkmcnt(6)
v_mfma_f32_16x16x32_bf16 v[64:67], v[16:19], a[24:27], v[64:67]
ds_read_b64_tr_b16 v[32:33], v11 offset:28672
v_mul_f32 v52, v140, v140
v_mfma_f32_16x16x32_bf16 v[68:71], v[16:19], a[88:91], v[68:71]
v_mul_f32 v53, v141, v141
v_mfma_f32_16x16x32_bf16 v[72:75], v[16:19], a[152:155], v[72:75]
ds_read_b64_tr_b16 v[34:35], v11 offset:29184
v_mul_f32 v54, v142, v142
v_mfma_f32_16x16x32_bf16 v[76:79], v[16:19], a[216:219], v[76:79]
v_mul_f32 v55, v143, v143
s_waitcnt lgkmcnt(6)
v_mfma_f32_16x16x32_bf16 v[80:83], v[20:23], a[24:27], v[80:83]
v_fma_f32 v52, v52, s68, v62
ds_read_b64_tr_b16 v[36:37], v12 offset:28672
v_fma_f32 v53, v53, s68, v62
v_mfma_f32_16x16x32_bf16 v[84:87], v[20:23], a[88:91], v[84:87]
v_fma_f32 v54, v54, s68, v62
v_mfma_f32_16x16x32_bf16 v[88:91], v[20:23], a[152:155], v[88:91]
ds_read_b64_tr_b16 v[38:39], v12 offset:29184
v_fma_f32 v55, v55, s68, v62
v_mfma_f32_16x16x32_bf16 v[92:95], v[20:23], a[216:219], v[92:95]
v_mul_f32 v52, v52, v140
s_waitcnt lgkmcnt(6)
v_mfma_f32_16x16x32_bf16 v[96:99], v[24:27], a[24:27], v[96:99]
ds_read_b64_tr_b16 v[40:41], v11 offset:28928
v_mul_f32 v53, v53, v141
v_mfma_f32_16x16x32_bf16 v[100:103], v[24:27], a[88:91], v[100:103]
v_mul_f32 v54, v54, v142
v_mfma_f32_16x16x32_bf16 v[104:107], v[24:27], a[152:155], v[104:107]
v_mul_f32 v55, v55, v143
ds_read_b64_tr_b16 v[42:43], v11 offset:29440
v_exp_f32 v52, v52
v_mfma_f32_16x16x32_bf16 v[108:111], v[24:27], a[216:219], v[108:111]
v_mul_f32 v140, v140, v156
s_waitcnt lgkmcnt(6)
v_mfma_f32_16x16x32_bf16 v[112:115], v[28:31], a[24:27], v[112:115]
ds_read_b64_tr_b16 v[44:45], v12 offset:28928
v_exp_f32 v53, v53
v_mfma_f32_16x16x32_bf16 v[116:119], v[28:31], a[88:91], v[116:119]
v_mul_f32 v141, v141, v157
v_mfma_f32_16x16x32_bf16 v[120:123], v[28:31], a[152:155], v[120:123]
ds_read_b64_tr_b16 v[46:47], v12 offset:29440
v_exp_f32 v54, v54
v_mfma_f32_16x16x32_bf16 v[124:127], v[28:31], a[216:219], v[124:127]
v_mul_f32 v142, v142, v158
s_waitcnt vmcnt(7)
s_barrier
s_waitcnt lgkmcnt(6)
v_mfma_f32_16x16x32_bf16 v[64:67], v[32:35], a[28:31], v[64:67]
ds_read_b64_tr_b16 v[16:17], v11 offset:32768
v_exp_f32 v55, v55
v_mul_f32 v143, v143, v159
v_mfma_f32_16x16x32_bf16 v[68:71], v[32:35], a[92:95], v[68:71]
s_add_u32 m0, s56, 0
s_add_u32 s57, s55, 128
buffer_load_dwordx4 v10, s[4:7], s57 offen lds
v_add_f32 v52, 1.0, v52
v_mfma_f32_16x16x32_bf16 v[72:75], v[32:35], a[156:159], v[72:75]
ds_read_b64_tr_b16 v[18:19], v11 offset:33280
v_add_f32 v53, 1.0, v53
v_mfma_f32_16x16x32_bf16 v[76:79], v[32:35], a[220:223], v[76:79]
v_add_f32 v54, 1.0, v54
s_waitcnt lgkmcnt(6)
v_mfma_f32_16x16x32_bf16 v[80:83], v[36:39], a[28:31], v[80:83]
ds_read_b64_tr_b16 v[20:21], v12 offset:32768
v_add_f32 v55, 1.0, v55
v_mfma_f32_16x16x32_bf16 v[84:87], v[36:39], a[92:95], v[84:87]
v_rcp_f32 v52, v52
v_mfma_f32_16x16x32_bf16 v[88:91], v[36:39], a[156:159], v[88:91]
ds_read_b64_tr_b16 v[22:23], v12 offset:33280
v_rcp_f32 v53, v53
s_add_u32 m0, s56, 4096
s_add_u32 s57, s55, 262272
buffer_load_dwordx4 v10, s[4:7], s57 offen lds
v_rcp_f32 v54, v54
v_mfma_f32_16x16x32_bf16 v[92:95], v[36:39], a[220:223], v[92:95]
v_rcp_f32 v55, v55
s_waitcnt lgkmcnt(6)
v_mfma_f32_16x16x32_bf16 v[96:99], v[40:43], a[28:31], v[96:99]
ds_read_b64_tr_b16 v[24:25], v11 offset:33024
v_mul_f32 v140, v140, v52
v_mfma_f32_16x16x32_bf16 v[100:103], v[40:43], a[92:95], v[100:103]
v_mul_f32 v141, v141, v53
v_mfma_f32_16x16x32_bf16 v[104:107], v[40:43], a[156:159], v[104:107]
ds_read_b64_tr_b16 v[26:27], v11 offset:33536
v_mul_f32 v142, v142, v54
v_mfma_f32_16x16x32_bf16 v[108:111], v[40:43], a[220:223], v[108:111]
v_mul_f32 v143, v143, v55
s_add_u32 m0, s56, 8192
s_add_u32 s57, s55, 524416
buffer_load_dwordx4 v10, s[4:7], s57 offen lds
s_waitcnt lgkmcnt(6)
v_mfma_f32_16x16x32_bf16 v[112:115], v[44:47], a[28:31], v[112:115]
ds_read_b64_tr_b16 v[28:29], v12 offset:33024
v_cvt_pk_bf16_f32 v58, v140, v141
v_cvt_pk_bf16_f32 v59, v142, v143
v_mfma_f32_16x16x32_bf16 v[116:119], v[44:47], a[92:95], v[116:119]
s_add_u32 s23, s70, 481280
v_permlane16_swap_b32 v56, v58
v_mfma_f32_16x16x32_bf16 v[120:123], v[44:47], a[156:159], v[120:123]
ds_read_b64_tr_b16 v[30:31], v12 offset:33536
v_permlane16_swap_b32 v57, v59
v_mfma_f32_16x16x32_bf16 v[124:127], v[44:47], a[220:223], v[124:127]
buffer_store_dwordx4 v[56:59], v0, s[48:51], s23 offen sc1
s_waitcnt lgkmcnt(6)
v_mfma_f32_16x16x32_bf16 v[64:67], v[16:19], a[32:35], v[64:67]
ds_read_b64_tr_b16 v[32:33], v11 offset:36864
v_mul_f32 v48, v160, v160
s_add_u32 m0, s56, 12288
s_add_u32 s57, s55, 786560
buffer_load_dwordx4 v10, s[4:7], s57 offen lds
v_mfma_f32_16x16x32_bf16 v[68:71], v[16:19], a[96:99], v[68:71]
v_mul_f32 v49, v161, v161
v_mfma_f32_16x16x32_bf16 v[72:75], v[16:19], a[160:163], v[72:75]
ds_read_b64_tr_b16 v[34:35], v11 offset:37376
v_mul_f32 v50, v162, v162
v_mfma_f32_16x16x32_bf16 v[76:79], v[16:19], a[224:227], v[76:79]
v_mul_f32 v51, v163, v163
v_fma_f32 v48, v48, s68, v62
s_waitcnt lgkmcnt(6)
v_mfma_f32_16x16x32_bf16 v[80:83], v[20:23], a[32:35], v[80:83]
ds_read_b64_tr_b16 v[36:37], v12 offset:36864
v_fma_f32 v49, v49, s68, v62
v_mfma_f32_16x16x32_bf16 v[84:87], v[20:23], a[96:99], v[84:87]
v_fma_f32 v50, v50, s68, v62
v_mfma_f32_16x16x32_bf16 v[88:91], v[20:23], a[160:163], v[88:91]
ds_read_b64_tr_b16 v[38:39], v12 offset:37376
v_fma_f32 v51, v51, s68, v62
v_mfma_f32_16x16x32_bf16 v[92:95], v[20:23], a[224:227], v[92:95]
v_mul_f32 v48, v48, v160
s_waitcnt lgkmcnt(6)
v_mfma_f32_16x16x32_bf16 v[96:99], v[24:27], a[32:35], v[96:99]
ds_read_b64_tr_b16 v[40:41], v11 offset:37120
v_mul_f32 v49, v49, v161
v_mfma_f32_16x16x32_bf16 v[100:103], v[24:27], a[96:99], v[100:103]
v_mul_f32 v50, v50, v162
v_mul_f32 v51, v51, v163
v_mfma_f32_16x16x32_bf16 v[104:107], v[24:27], a[160:163], v[104:107]
ds_read_b64_tr_b16 v[42:43], v11 offset:37632
v_exp_f32 v48, v48
v_mfma_f32_16x16x32_bf16 v[108:111], v[24:27], a[224:227], v[108:111]
v_mul_f32 v160, v160, v176
s_waitcnt lgkmcnt(6)
v_mfma_f32_16x16x32_bf16 v[112:115], v[28:31], a[32:35], v[112:115]
ds_read_b64_tr_b16 v[44:45], v12 offset:37120
v_exp_f32 v49, v49
v_mfma_f32_16x16x32_bf16 v[116:119], v[28:31], a[96:99], v[116:119]
v_mul_f32 v161, v161, v177
v_mfma_f32_16x16x32_bf16 v[120:123], v[28:31], a[160:163], v[120:123]
ds_read_b64_tr_b16 v[46:47], v12 offset:37632
v_exp_f32 v50, v50
v_mfma_f32_16x16x32_bf16 v[124:127], v[28:31], a[224:227], v[124:127]
v_mul_f32 v162, v162, v178
v_exp_f32 v51, v51
s_waitcnt lgkmcnt(6)
v_mfma_f32_16x16x32_bf16 v[64:67], v[32:35], a[36:39], v[64:67]
ds_read_b64_tr_b16 v[16:17], v11 offset:40960
v_mul_f32 v163, v163, v179
v_mfma_f32_16x16x32_bf16 v[68:71], v[32:35], a[100:103], v[68:71]
v_add_f32 v48, 1.0, v48
v_mfma_f32_16x16x32_bf16 v[72:75], v[32:35], a[164:167], v[72:75]
ds_read_b64_tr_b16 v[18:19], v11 offset:41472
v_add_f32 v49, 1.0, v49
v_mfma_f32_16x16x32_bf16 v[76:79], v[32:35], a[228:231], v[76:79]
v_add_f32 v50, 1.0, v50
s_waitcnt lgkmcnt(6)
v_mfma_f32_16x16x32_bf16 v[80:83], v[36:39], a[36:39], v[80:83]
ds_read_b64_tr_b16 v[20:21], v12 offset:40960
v_add_f32 v51, 1.0, v51
v_mfma_f32_16x16x32_bf16 v[84:87], v[36:39], a[100:103], v[84:87]
v_rcp_f32 v48, v48
v_rcp_f32 v49, v49
v_mfma_f32_16x16x32_bf16 v[88:91], v[36:39], a[164:167], v[88:91]
ds_read_b64_tr_b16 v[22:23], v12 offset:41472
v_rcp_f32 v50, v50
v_mfma_f32_16x16x32_bf16 v[92:95], v[36:39], a[228:231], v[92:95]
v_rcp_f32 v51, v51
s_waitcnt lgkmcnt(6)
v_mfma_f32_16x16x32_bf16 v[96:99], v[40:43], a[36:39], v[96:99]
ds_read_b64_tr_b16 v[24:25], v11 offset:41216
v_mul_f32 v160, v160, v48
v_mfma_f32_16x16x32_bf16 v[100:103], v[40:43], a[100:103], v[100:103]
v_mul_f32 v161, v161, v49
v_mfma_f32_16x16x32_bf16 v[104:107], v[40:43], a[164:167], v[104:107]
ds_read_b64_tr_b16 v[26:27], v11 offset:41728
v_mul_f32 v162, v162, v50
v_mfma_f32_16x16x32_bf16 v[108:111], v[40:43], a[228:231], v[108:111]
v_mul_f32 v163, v163, v51
v_cvt_pk_bf16_f32 v56, v160, v161
s_waitcnt lgkmcnt(6)
v_mfma_f32_16x16x32_bf16 v[112:115], v[44:47], a[36:39], v[112:115]
ds_read_b64_tr_b16 v[28:29], v12 offset:41216
v_cvt_pk_bf16_f32 v57, v162, v163
v_mfma_f32_16x16x32_bf16 v[116:119], v[44:47], a[100:103], v[116:119]
v_mul_f32 v52, v164, v164
v_mfma_f32_16x16x32_bf16 v[120:123], v[44:47], a[164:167], v[120:123]
ds_read_b64_tr_b16 v[30:31], v12 offset:41728
v_mul_f32 v53, v165, v165
v_mfma_f32_16x16x32_bf16 v[124:127], v[44:47], a[228:231], v[124:127]
v_mul_f32 v54, v166, v166
s_waitcnt lgkmcnt(6)
v_mfma_f32_16x16x32_bf16 v[64:67], v[16:19], a[40:43], v[64:67]
ds_read_b64_tr_b16 v[32:33], v11 offset:45056
v_mul_f32 v55, v167, v167
v_mfma_f32_16x16x32_bf16 v[68:71], v[16:19], a[104:107], v[68:71]
v_fma_f32 v52, v52, s68, v62
v_fma_f32 v53, v53, s68, v62
v_mfma_f32_16x16x32_bf16 v[72:75], v[16:19], a[168:171], v[72:75]
ds_read_b64_tr_b16 v[34:35], v11 offset:45568
v_fma_f32 v54, v54, s68, v62
v_mfma_f32_16x16x32_bf16 v[76:79], v[16:19], a[232:235], v[76:79]
v_fma_f32 v55, v55, s68, v62
s_waitcnt lgkmcnt(6)
v_mfma_f32_16x16x32_bf16 v[80:83], v[20:23], a[40:43], v[80:83]
ds_read_b64_tr_b16 v[36:37], v12 offset:45056
v_mul_f32 v52, v52, v164
v_mfma_f32_16x16x32_bf16 v[84:87], v[20:23], a[104:107], v[84:87]
v_mul_f32 v53, v53, v165
v_mfma_f32_16x16x32_bf16 v[88:91], v[20:23], a[168:171], v[88:91]
ds_read_b64_tr_b16 v[38:39], v12 offset:45568
v_mul_f32 v54, v54, v166
v_mfma_f32_16x16x32_bf16 v[92:95], v[20:23], a[232:235], v[92:95]
v_mul_f32 v55, v55, v167
v_exp_f32 v52, v52
s_waitcnt lgkmcnt(6)
v_mfma_f32_16x16x32_bf16 v[96:99], v[24:27], a[40:43], v[96:99]
ds_read_b64_tr_b16 v[40:41], v11 offset:45312
v_mul_f32 v164, v164, v180
v_mfma_f32_16x16x32_bf16 v[100:103], v[24:27], a[104:107], v[100:103]
v_exp_f32 v53, v53
v_mfma_f32_16x16x32_bf16 v[104:107], v[24:27], a[168:171], v[104:107]
ds_read_b64_tr_b16 v[42:43], v11 offset:45824
v_mul_f32 v165, v165, v181
v_mfma_f32_16x16x32_bf16 v[108:111], v[24:27], a[232:235], v[108:111]
v_exp_f32 v54, v54
s_waitcnt lgkmcnt(6)
v_mfma_f32_16x16x32_bf16 v[112:115], v[28:31], a[40:43], v[112:115]
ds_read_b64_tr_b16 v[44:45], v12 offset:45312
v_mul_f32 v166, v166, v182
v_mfma_f32_16x16x32_bf16 v[116:119], v[28:31], a[104:107], v[116:119]
v_exp_f32 v55, v55
v_mul_f32 v167, v167, v183
v_mfma_f32_16x16x32_bf16 v[120:123], v[28:31], a[168:171], v[120:123]
ds_read_b64_tr_b16 v[46:47], v12 offset:45824
v_add_f32 v52, 1.0, v52
v_mfma_f32_16x16x32_bf16 v[124:127], v[28:31], a[232:235], v[124:127]
s_waitcnt vmcnt(6)
s_barrier
s_mov_b32 s58, 0
s_mov_b32 s59, 8192
global_load_dword v63, v60, s[98:99] offset:32 sc1
v_add_f32 v53, 1.0, v53
s_waitcnt lgkmcnt(6)
v_mfma_f32_16x16x32_bf16 v[64:67], v[32:35], a[44:47], v[64:67]
ds_read_b64_tr_b16 v[16:17], v11 offset:49152
v_add_f32 v54, 1.0, v54
v_mfma_f32_16x16x32_bf16 v[68:71], v[32:35], a[108:111], v[68:71]
v_add_f32 v55, 1.0, v55
s_add_u32 m0, s56, 16384
s_add_u32 s57, s55, 1048704
buffer_load_dwordx4 v10, s[4:7], s57 offen lds
v_mfma_f32_16x16x32_bf16 v[72:75], v[32:35], a[172:175], v[72:75]
ds_read_b64_tr_b16 v[18:19], v11 offset:49664
v_rcp_f32 v52, v52
v_mfma_f32_16x16x32_bf16 v[76:79], v[32:35], a[236:239], v[76:79]
v_rcp_f32 v53, v53
v_rcp_f32 v54, v54
s_waitcnt lgkmcnt(6)
v_mfma_f32_16x16x32_bf16 v[80:83], v[36:39], a[44:47], v[80:83]
ds_read_b64_tr_b16 v[20:21], v12 offset:49152
v_rcp_f32 v55, v55
v_mfma_f32_16x16x32_bf16 v[84:87], v[36:39], a[108:111], v[84:87]
v_mul_f32 v164, v164, v52
v_mfma_f32_16x16x32_bf16 v[88:91], v[36:39], a[172:175], v[88:91]
ds_read_b64_tr_b16 v[22:23], v12 offset:49664
s_add_u32 m0, s56, 20480
s_add_u32 s57, s55, 1310848
buffer_load_dwordx4 v10, s[4:7], s57 offen lds
v_mul_f32 v165, v165, v53
v_mfma_f32_16x16x32_bf16 v[92:95], v[36:39], a[236:239], v[92:95]
v_mul_f32 v166, v166, v54
s_waitcnt lgkmcnt(6)
v_mfma_f32_16x16x32_bf16 v[96:99], v[40:43], a[44:47], v[96:99]
ds_read_b64_tr_b16 v[24:25], v11 offset:49408
v_mul_f32 v167, v167, v55
v_mfma_f32_16x16x32_bf16 v[100:103], v[40:43], a[108:111], v[100:103]
v_cvt_pk_bf16_f32 v58, v164, v165
v_cvt_pk_bf16_f32 v59, v166, v167
v_mfma_f32_16x16x32_bf16 v[104:107], v[40:43], a[172:175], v[104:107]
ds_read_b64_tr_b16 v[26:27], v11 offset:49920
s_add_u32 s23, s71, 131072
v_permlane16_swap_b32 v56, v58
v_mfma_f32_16x16x32_bf16 v[108:111], v[40:43], a[236:239], v[108:111]
s_add_u32 m0, s56, 24576
s_add_u32 s57, s55, 1572992
buffer_load_dwordx4 v10, s[4:7], s57 offen lds
v_permlane16_swap_b32 v57, v59
s_waitcnt lgkmcnt(6)
v_mfma_f32_16x16x32_bf16 v[112:115], v[44:47], a[44:47], v[112:115]
ds_read_b64_tr_b16 v[28:29], v12 offset:49408
buffer_store_dwordx4 v[56:59], v0, s[48:51], s23 offen sc1
v_mfma_f32_16x16x32_bf16 v[116:119], v[44:47], a[108:111], v[116:119]
v_mul_f32 v48, v168, v168
v_mfma_f32_16x16x32_bf16 v[120:123], v[44:47], a[172:175], v[120:123]
ds_read_b64_tr_b16 v[30:31], v12 offset:49920
v_mul_f32 v49, v169, v169
v_mfma_f32_16x16x32_bf16 v[124:127], v[44:47], a[236:239], v[124:127]
v_mul_f32 v50, v170, v170
s_waitcnt lgkmcnt(6)
v_mfma_f32_16x16x32_bf16 v[64:67], v[16:19], a[48:51], v[64:67]
v_mul_f32 v51, v171, v171
ds_read_b64_tr_b16 v[32:33], v11 offset:53248
s_add_u32 m0, s56, 28672
s_add_u32 s57, s55, 1835136
buffer_load_dwordx4 v10, s[4:7], s57 offen lds
v_fma_f32 v48, v48, s68, v62
v_mfma_f32_16x16x32_bf16 v[68:71], v[16:19], a[112:115], v[68:71]
v_fma_f32 v49, v49, s68, v62
v_mfma_f32_16x16x32_bf16 v[72:75], v[16:19], a[176:179], v[72:75]
ds_read_b64_tr_b16 v[34:35], v11 offset:53760
v_fma_f32 v50, v50, s68, v62
v_mfma_f32_16x16x32_bf16 v[76:79], v[16:19], a[240:243], v[76:79]
v_fma_f32 v51, v51, s68, v62
s_waitcnt lgkmcnt(6)
v_mfma_f32_16x16x32_bf16 v[80:83], v[20:23], a[48:51], v[80:83]
ds_read_b64_tr_b16 v[36:37], v12 offset:53248
v_mul_f32 v48, v48, v168
v_mfma_f32_16x16x32_bf16 v[84:87], v[20:23], a[112:115], v[84:87]
v_mul_f32 v49, v49, v169
v_mfma_f32_16x16x32_bf16 v[88:91], v[20:23], a[176:179], v[88:91]
v_mul_f32 v50, v50, v170
ds_read_b64_tr_b16 v[38:39], v12 offset:53760
v_mul_f32 v51, v51, v171
v_mfma_f32_16x16x32_bf16 v[92:95], v[20:23], a[240:243], v[92:95]
v_exp_f32 v48, v48
s_waitcnt lgkmcnt(6)
v_mfma_f32_16x16x32_bf16 v[96:99], v[24:27], a[48:51], v[96:99]
ds_read_b64_tr_b16 v[40:41], v11 offset:53504
v_mul_f32 v168, v168, v184
v_mfma_f32_16x16x32_bf16 v[100:103], v[24:27], a[112:115], v[100:103]
v_exp_f32 v49, v49
v_mfma_f32_16x16x32_bf16 v[104:107], v[24:27], a[176:179], v[104:107]
ds_read_b64_tr_b16 v[42:43], v11 offset:54016
v_mul_f32 v169, v169, v185
v_mfma_f32_16x16x32_bf16 v[108:111], v[24:27], a[240:243], v[108:111]
v_exp_f32 v50, v50
s_waitcnt lgkmcnt(6)
v_mfma_f32_16x16x32_bf16 v[112:115], v[28:31], a[48:51], v[112:115]
v_mul_f32 v170, v170, v186
ds_read_b64_tr_b16 v[44:45], v12 offset:53504
v_exp_f32 v51, v51
v_mfma_f32_16x16x32_bf16 v[116:119], v[28:31], a[112:115], v[116:119]
v_mul_f32 v171, v171, v187
v_mfma_f32_16x16x32_bf16 v[120:123], v[28:31], a[176:179], v[120:123]
ds_read_b64_tr_b16 v[46:47], v12 offset:54016
v_add_f32 v48, 1.0, v48
v_mfma_f32_16x16x32_bf16 v[124:127], v[28:31], a[240:243], v[124:127]
v_add_f32 v49, 1.0, v49
s_waitcnt lgkmcnt(6)
v_mfma_f32_16x16x32_bf16 v[64:67], v[32:35], a[52:55], v[64:67]
ds_read_b64_tr_b16 v[16:17], v11 offset:57344
v_add_f32 v50, 1.0, v50
v_mfma_f32_16x16x32_bf16 v[68:71], v[32:35], a[116:119], v[68:71]
v_add_f32 v51, 1.0, v51
v_mfma_f32_16x16x32_bf16 v[72:75], v[32:35], a[180:183], v[72:75]
v_rcp_f32 v48, v48
ds_read_b64_tr_b16 v[18:19], v11 offset:57856
v_rcp_f32 v49, v49
v_mfma_f32_16x16x32_bf16 v[76:79], v[32:35], a[244:247], v[76:79]
v_rcp_f32 v50, v50
s_waitcnt lgkmcnt(6)
v_mfma_f32_16x16x32_bf16 v[80:83], v[36:39], a[52:55], v[80:83]
ds_read_b64_tr_b16 v[20:21], v12 offset:57344
v_rcp_f32 v51, v51
v_mfma_f32_16x16x32_bf16 v[84:87], v[36:39], a[116:119], v[84:87]
v_mul_f32 v168, v168, v48
v_mfma_f32_16x16x32_bf16 v[88:91], v[36:39], a[180:183], v[88:91]
ds_read_b64_tr_b16 v[22:23], v12 offset:57856
v_mul_f32 v169, v169, v49
v_mfma_f32_16x16x32_bf16 v[92:95], v[36:39], a[244:247], v[92:95]
v_mul_f32 v170, v170, v50
s_waitcnt lgkmcnt(6)
v_mfma_f32_16x16x32_bf16 v[96:99], v[40:43], a[52:55], v[96:99]
v_mul_f32 v171, v171, v51
ds_read_b64_tr_b16 v[24:25], v11 offset:57600
v_cvt_pk_bf16_f32 v56, v168, v169
v_mfma_f32_16x16x32_bf16 v[100:103], v[40:43], a[116:119], v[100:103]
v_cvt_pk_bf16_f32 v57, v170, v171
v_mfma_f32_16x16x32_bf16 v[104:107], v[40:43], a[180:183], v[104:107]
ds_read_b64_tr_b16 v[26:27], v11 offset:58112
v_mul_f32 v52, v172, v172
v_mfma_f32_16x16x32_bf16 v[108:111], v[40:43], a[244:247], v[108:111]
v_mul_f32 v53, v173, v173
s_waitcnt lgkmcnt(6)
v_mfma_f32_16x16x32_bf16 v[112:115], v[44:47], a[52:55], v[112:115]
ds_read_b64_tr_b16 v[28:29], v12 offset:57600
v_mul_f32 v54, v174, v174
v_mfma_f32_16x16x32_bf16 v[116:119], v[44:47], a[116:119], v[116:119]
v_mul_f32 v55, v175, v175
v_mfma_f32_16x16x32_bf16 v[120:123], v[44:47], a[180:183], v[120:123]
v_fma_f32 v52, v52, s68, v62
ds_read_b64_tr_b16 v[30:31], v12 offset:58112
v_fma_f32 v53, v53, s68, v62
v_mfma_f32_16x16x32_bf16 v[124:127], v[44:47], a[244:247], v[124:127]
v_fma_f32 v54, v54, s68, v62
s_waitcnt lgkmcnt(6)
v_mfma_f32_16x16x32_bf16 v[64:67], v[16:19], a[56:59], v[64:67]
ds_read_b64_tr_b16 v[32:33], v11 offset:61440
v_fma_f32 v55, v55, s68, v62
v_mfma_f32_16x16x32_bf16 v[68:71], v[16:19], a[120:123], v[68:71]
v_mul_f32 v52, v52, v172
v_mfma_f32_16x16x32_bf16 v[72:75], v[16:19], a[184:187], v[72:75]
ds_read_b64_tr_b16 v[34:35], v11 offset:61952
v_mul_f32 v53, v53, v173
v_mfma_f32_16x16x32_bf16 v[76:79], v[16:19], a[248:251], v[76:79]
v_mul_f32 v54, v54, v174
s_waitcnt lgkmcnt(6)
v_mfma_f32_16x16x32_bf16 v[80:83], v[20:23], a[56:59], v[80:83]
v_mul_f32 v55, v55, v175
ds_read_b64_tr_b16 v[36:37], v12 offset:61440
v_exp_f32 v52, v52
v_mfma_f32_16x16x32_bf16 v[84:87], v[20:23], a[120:123], v[84:87]
v_mul_f32 v172, v172, v188
v_mfma_f32_16x16x32_bf16 v[88:91], v[20:23], a[184:187], v[88:91]
ds_read_b64_tr_b16 v[38:39], v12 offset:61952
v_exp_f32 v53, v53
v_mfma_f32_16x16x32_bf16 v[92:95], v[20:23], a[248:251], v[92:95]
v_mul_f32 v173, v173, v189
s_waitcnt lgkmcnt(6)
v_mfma_f32_16x16x32_bf16 v[96:99], v[24:27], a[56:59], v[96:99]
ds_read_b64_tr_b16 v[40:41], v11 offset:61696
v_exp_f32 v54, v54
v_mfma_f32_16x16x32_bf16 v[100:103], v[24:27], a[120:123], v[100:103]
v_mul_f32 v174, v174, v190
v_mfma_f32_16x16x32_bf16 v[104:107], v[24:27], a[184:187], v[104:107]
ds_read_b64_tr_b16 v[42:43], v11 offset:62208
v_exp_f32 v55, v55
v_mul_f32 v175, v175, v191
v_mfma_f32_16x16x32_bf16 v[108:111], v[24:27], a[248:251], v[108:111]
v_add_f32 v52, 1.0, v52
s_waitcnt lgkmcnt(6)
v_mfma_f32_16x16x32_bf16 v[112:115], v[28:31], a[56:59], v[112:115]
ds_read_b64_tr_b16 v[44:45], v12 offset:61696
v_add_f32 v53, 1.0, v53
v_mfma_f32_16x16x32_bf16 v[116:119], v[28:31], a[120:123], v[116:119]
v_add_f32 v54, 1.0, v54
v_mfma_f32_16x16x32_bf16 v[120:123], v[28:31], a[184:187], v[120:123]
ds_read_b64_tr_b16 v[46:47], v12 offset:62208
v_add_f32 v55, 1.0, v55
v_mfma_f32_16x16x32_bf16 v[124:127], v[28:31], a[248:251], v[124:127]
v_rcp_f32 v52, v52
s_waitcnt vmcnt(5)
s_barrier
s_cmp_lg_u32 s20, 0
s_cbranch_scc1 SR_kv
v_cmp_ne_u32 vcc, 8, v63
s_nop 1
s_and_b64 vcc, vcc, exec
s_cbranch_scc1 SL_kv
SR2_kv:
SR_kv:
s_waitcnt lgkmcnt(6)
v_mfma_f32_16x16x32_bf16 v[64:67], v[32:35], a[60:63], v[64:67]
ds_read_b64_tr_b16 v[16:17], v11 offset:0
v_rcp_f32 v53, v53
v_rcp_f32 v54, v54
v_mfma_f32_16x16x32_bf16 v[68:71], v[32:35], a[124:127], v[68:71]
s_add_u32 m0, s56, 32768
s_add_u32 s57, s55, 2097280
buffer_load_dwordx4 v10, s[4:7], s57 offen lds
v_rcp_f32 v55, v55
v_mfma_f32_16x16x32_bf16 v[72:75], v[32:35], a[188:191], v[72:75]
ds_read_b64_tr_b16 v[18:19], v11 offset:512
v_mul_f32 v172, v172, v52
v_mfma_f32_16x16x32_bf16 v[76:79], v[32:35], a[252:255], v[76:79]
v_mul_f32 v173, v173, v53
s_waitcnt lgkmcnt(6)
v_mfma_f32_16x16x32_bf16 v[80:83], v[36:39], a[60:63], v[80:83]
ds_read_b64_tr_b16 v[20:21], v12 offset:0
v_mul_f32 v174, v174, v54
v_mfma_f32_16x16x32_bf16 v[84:87], v[36:39], a[124:127], v[84:87]
v_mul_f32 v175, v175, v55
v_mfma_f32_16x16x32_bf16 v[88:91], v[36:39], a[188:191], v[88:91]
ds_read_b64_tr_b16 v[22:23], v12 offset:512
v_cvt_pk_bf16_f32 v58, v172, v173
s_add_u32 m0, s56, 36864
s_add_u32 s57, s55, 2359424
buffer_load_dwordx4 v10, s[4:7], s57 offen lds
v_cvt_pk_bf16_f32 v59, v174, v175
v_mfma_f32_16x16x32_bf16 v[92:95], v[36:39], a[252:255], v[92:95]
s_add_u32 s23, s71, 481280
v_permlane16_swap_b32 v56, v58
s_waitcnt lgkmcnt(6)
v_mfma_f32_16x16x32_bf16 v[96:99], v[40:43], a[60:63], v[96:99]
ds_read_b64_tr_b16 v[24:25], v11 offset:256
v_permlane16_swap_b32 v57, v59
v_mfma_f32_16x16x32_bf16 v[100:103], v[40:43], a[124:127], v[100:103]
buffer_store_dwordx4 v[56:59], v0, s[48:51], s23 offen sc1
v_mfma_f32_16x16x32_bf16 v[104:107], v[40:43], a[188:191], v[104:107]
ds_read_b64_tr_b16 v[26:27], v11 offset:768
v_mul_f32 v48, v192, v192
v_mfma_f32_16x16x32_bf16 v[108:111], v[40:43], a[252:255], v[108:111]
v_mul_f32 v49, v193, v193
s_add_u32 m0, s56, 40960
s_add_u32 s57, s55, 2621568
buffer_load_dwordx4 v10, s[4:7], s57 offen lds
s_waitcnt lgkmcnt(6)
v_mfma_f32_16x16x32_bf16 v[112:115], v[44:47], a[60:63], v[112:115]
ds_read_b64_tr_b16 v[28:29], v12 offset:256
v_mul_f32 v50, v194, v194
v_mfma_f32_16x16x32_bf16 v[116:119], v[44:47], a[124:127], v[116:119]
v_mul_f32 v51, v195, v195
v_fma_f32 v48, v48, s68, v62
v_mfma_f32_16x16x32_bf16 v[120:123], v[44:47], a[188:191], v[120:123]
ds_read_b64_tr_b16 v[30:31], v12 offset:768
v_fma_f32 v49, v49, s68, v62
v_mfma_f32_16x16x32_bf16 v[124:127], v[44:47], a[252:255], v[124:127]
v_fma_f32 v50, v50, s68, v62
s_waitcnt lgkmcnt(6)
v_mfma_f32_16x16x32_bf16 v[224:227], v[16:19], a[0:3], 0
ds_read_b64_tr_b16 v[32:33], v11 offset:4096
v_fma_f32 v51, v51, s68, v62
s_add_u32 m0, s56, 45056
s_add_u32 s57, s55, 2883712
buffer_load_dwordx4 v10, s[4:7], s57 offen lds
v_mfma_f32_16x16x32_bf16 v[228:231], v[16:19], a[64:67], 0
v_mul_f32 v48, v48, v192
v_mfma_f32_16x16x32_bf16 v[232:235], v[16:19], a[128:131], 0
ds_read_b64_tr_b16 v[34:35], v11 offset:4608
v_mul_f32 v49, v49, v193
v_mfma_f32_16x16x32_bf16 v[236:239], v[16:19], a[192:195], 0
v_mul_f32 v50, v50, v194
v_mul_f32 v51, v51, v195
s_waitcnt lgkmcnt(6)
v_mfma_f32_16x16x32_bf16 v[240:243], v[20:23], a[0:3], 0
ds_read_b64_tr_b16 v[36:37], v12 offset:4096
v_exp_f32 v48, v48
v_mfma_f32_16x16x32_bf16 v[244:247], v[20:23], a[64:67], 0
v_mul_f32 v192, v192, v208
v_mfma_f32_16x16x32_bf16 v[248:251], v[20:23], a[128:131], 0
ds_read_b64_tr_b16 v[38:39], v12 offset:4608
v_exp_f32 v49, v49
v_mfma_f32_16x16x32_bf16 v[252:255], v[20:23], a[192:195], 0
v_mul_f32 v193, v193, v209
s_waitcnt lgkmcnt(6)
v_mfma_f32_16x16x32_bf16 v[128:131], v[24:27], a[0:3], 0
ds_read_b64_tr_b16 v[40:41], v11 offset:4352
v_exp_f32 v50, v50
v_mfma_f32_16x16x32_bf16 v[132:135], v[24:27], a[64:67], 0
v_mul_f32 v194, v194, v210
v_exp_f32 v51, v51
v_mfma_f32_16x16x32_bf16 v[136:139], v[24:27], a[128:131], 0
ds_read_b64_tr_b16 v[42:43], v11 offset:4864
v_mul_f32 v195, v195, v211
v_mfma_f32_16x16x32_bf16 v[140:143], v[24:27], a[192:195], 0
v_add_f32 v48, 1.0, v48
s_waitcnt lgkmcnt(6)
v_mfma_f32_16x16x32_bf16 v[144:147], v[28:31], a[0:3], 0
ds_read_b64_tr_b16 v[44:45], v12 offset:4352
v_add_f32 v49, 1.0, v49
v_mfma_f32_16x16x32_bf16 v[148:151], v[28:31], a[64:67], 0
v_add_f32 v50, 1.0, v50
v_mfma_f32_16x16x32_bf16 v[152:155], v[28:31], a[128:131], 0
ds_read_b64_tr_b16 v[46:47], v12 offset:4864
v_add_f32 v51, 1.0, v51
v_mfma_f32_16x16x32_bf16 v[156:159], v[28:31], a[192:195], 0
v_rcp_f32 v48, v48
v_rcp_f32 v49, v49
s_waitcnt lgkmcnt(6)
v_mfma_f32_16x16x32_bf16 v[224:227], v[32:35], a[4:7], v[224:227]
ds_read_b64_tr_b16 v[16:17], v11 offset:8192
v_rcp_f32 v50, v50
v_mfma_f32_16x16x32_bf16 v[228:231], v[32:35], a[68:71], v[228:231]
v_rcp_f32 v51, v51
v_mfma_f32_16x16x32_bf16 v[232:235], v[32:35], a[132:135], v[232:235]
ds_read_b64_tr_b16 v[18:19], v11 offset:8704
v_mul_f32 v192, v192, v48
v_mfma_f32_16x16x32_bf16 v[236:239], v[32:35], a[196:199], v[236:239]
v_mul_f32 v193, v193, v49
s_waitcnt lgkmcnt(6)
v_mfma_f32_16x16x32_bf16 v[240:243], v[36:39], a[4:7], v[240:243]
ds_read_b64_tr_b16 v[20:21], v12 offset:8192
v_mul_f32 v194, v194, v50
v_mfma_f32_16x16x32_bf16 v[244:247], v[36:39], a[68:71], v[244:247]
v_mul_f32 v195, v195, v51
v_cvt_pk_bf16_f32 v56, v192, v193
v_mfma_f32_16x16x32_bf16 v[248:251], v[36:39], a[132:135], v[248:251]
ds_read_b64_tr_b16 v[22:23], v12 offset:8704
v_cvt_pk_bf16_f32 v57, v194, v195
v_mfma_f32_16x16x32_bf16 v[252:255], v[36:39], a[196:199], v[252:255]
v_mul_f32 v52, v196, v196
s_waitcnt lgkmcnt(6)
v_mfma_f32_16x16x32_bf16 v[128:131], v[40:43], a[4:7], v[128:131]
ds_read_b64_tr_b16 v[24:25], v11 offset:8448
v_mul_f32 v53, v197, v197
v_mfma_f32_16x16x32_bf16 v[132:135], v[40:43], a[68:71], v[132:135]
v_mul_f32 v54, v198, v198
v_mfma_f32_16x16x32_bf16 v[136:139], v[40:43], a[132:135], v[136:139]
ds_read_b64_tr_b16 v[26:27], v11 offset:8960
v_mul_f32 v55, v199, v199
v_mfma_f32_16x16x32_bf16 v[140:143], v[40:43], a[196:199], v[140:143]
v_fma_f32 v52, v52, s68, v62
v_fma_f32 v53, v53, s68, v62
s_waitcnt lgkmcnt(6)
v_mfma_f32_16x16x32_bf16 v[144:147], v[44:47], a[4:7], v[144:147]
ds_read_b64_tr_b16 v[28:29], v12 offset:8448
v_fma_f32 v54, v54, s68, v62
v_mfma_f32_16x16x32_bf16 v[148:151], v[44:47], a[68:71], v[148:151]
v_fma_f32 v55, v55, s68, v62
v_mfma_f32_16x16x32_bf16 v[152:155], v[44:47], a[132:135], v[152:155]
ds_read_b64_tr_b16 v[30:31], v12 offset:8960
v_mul_f32 v52, v52, v196
v_mfma_f32_16x16x32_bf16 v[156:159], v[44:47], a[196:199], v[156:159]
v_mul_f32 v53, v53, v197
s_waitcnt lgkmcnt(6)
v_mfma_f32_16x16x32_bf16 v[224:227], v[16:19], a[8:11], v[224:227]
ds_read_b64_tr_b16 v[32:33], v11 offset:12288
v_mul_f32 v54, v54, v198
v_mfma_f32_16x16x32_bf16 v[228:231], v[16:19], a[72:75], v[228:231]
v_mul_f32 v55, v55, v199
v_exp_f32 v52, v52
v_mfma_f32_16x16x32_bf16 v[232:235], v[16:19], a[136:139], v[232:235]
ds_read_b64_tr_b16 v[34:35], v11 offset:12800
v_mul_f32 v196, v196, v212
v_mfma_f32_16x16x32_bf16 v[236:239], v[16:19], a[200:203], v[236:239]
v_exp_f32 v53, v53
s_waitcnt lgkmcnt(6)
v_mfma_f32_16x16x32_bf16 v[240:243], v[20:23], a[8:11], v[240:243]
ds_read_b64_tr_b16 v[36:37], v12 offset:12288
v_mul_f32 v197, v197, v213
v_mfma_f32_16x16x32_bf16 v[244:247], v[20:23], a[72:75], v[244:247]
v_exp_f32 v54, v54
v_mfma_f32_16x16x32_bf16 v[248:251], v[20:23], a[136:139], v[248:251]
ds_read_b64_tr_b16 v[38:39], v12 offset:12800
v_mul_f32 v198, v198, v214
v_mfma_f32_16x16x32_bf16 v[252:255], v[20:23], a[200:203], v[252:255]
v_exp_f32 v55, v55
v_mul_f32 v199, v199, v215
s_waitcnt lgkmcnt(6)
v_mfma_f32_16x16x32_bf16 v[128:131], v[24:27], a[8:11], v[128:131]
ds_read_b64_tr_b16 v[40:41], v11 offset:12544
v_add_f32 v52, 1.0, v52
v_mfma_f32_16x16x32_bf16 v[132:135], v[24:27], a[72:75], v[132:135]
v_add_f32 v53, 1.0, v53
v_mfma_f32_16x16x32_bf16 v[136:139], v[24:27], a[136:139], v[136:139]
ds_read_b64_tr_b16 v[42:43], v11 offset:13056
v_add_f32 v54, 1.0, v54
v_mfma_f32_16x16x32_bf16 v[140:143], v[24:27], a[200:203], v[140:143]
v_add_f32 v55, 1.0, v55
s_waitcnt lgkmcnt(6)
v_mfma_f32_16x16x32_bf16 v[144:147], v[28:31], a[8:11], v[144:147]
ds_read_b64_tr_b16 v[44:45], v12 offset:12544
v_rcp_f32 v52, v52
v_mfma_f32_16x16x32_bf16 v[148:151], v[28:31], a[72:75], v[148:151]
v_rcp_f32 v53, v53
v_rcp_f32 v54, v54
v_mfma_f32_16x16x32_bf16 v[152:155], v[28:31], a[136:139], v[152:155]
ds_read_b64_tr_b16 v[46:47], v12 offset:13056
v_rcp_f32 v55, v55
v_mfma_f32_16x16x32_bf16 v[156:159], v[28:31], a[200:203], v[156:159]
s_waitcnt vmcnt(5)
s_barrier
v_mul_f32 v196, v196, v52
s_waitcnt lgkmcnt(6)
v_mfma_f32_16x16x32_bf16 v[224:227], v[32:35], a[12:15], v[224:227]
ds_read_b64_tr_b16 v[16:17], v11 offset:16384
v_mul_f32 v197, v197, v53
v_mfma_f32_16x16x32_bf16 v[228:231], v[32:35], a[76:79], v[228:231]
v_mul_f32 v198, v198, v54
s_add_u32 m0, s56, 49152
s_add_u32 s57, s55, 3145856
buffer_load_dwordx4 v10, s[4:7], s57 offen lds
v_mfma_f32_16x16x32_bf16 v[232:235], v[32:35], a[140:143], v[232:235]
ds_read_b64_tr_b16 v[18:19], v11 offset:16896
v_mul_f32 v199, v199, v55
v_mfma_f32_16x16x32_bf16 v[236:239], v[32:35], a[204:207], v[236:239]
v_cvt_pk_bf16_f32 v58, v196, v197
v_cvt_pk_bf16_f32 v59, v198, v199
s_waitcnt lgkmcnt(6)
v_mfma_f32_16x16x32_bf16 v[240:243], v[36:39], a[12:15], v[240:243]
ds_read_b64_tr_b16 v[20:21], v12 offset:16384
s_add_u32 s23, s72, 131072
v_permlane16_swap_b32 v56, v58
v_mfma_f32_16x16x32_bf16 v[244:247], v[36:39], a[76:79], v[244:247]
v_permlane16_swap_b32 v57, v59
v_mfma_f32_16x16x32_bf16 v[248:251], v[36:39], a[140:143], v[248:251]
ds_read_b64_tr_b16 v[22:23], v12 offset:16896
s_add_u32 m0, s56, 53248
s_add_u32 s57, s55, 3408000
buffer_load_dwordx4 v10, s[4:7], s57 offen lds
buffer_store_dwordx4 v[56:59], v0, s[48:51], s23 offen sc1
v_mfma_f32_16x16x32_bf16 v[252:255], v[36:39], a[204:207], v[252:255]
v_mul_f32 v48, v200, v200
s_waitcnt lgkmcnt(6)
v_mfma_f32_16x16x32_bf16 v[128:131], v[40:43], a[12:15], v[128:131]
ds_read_b64_tr_b16 v[24:25], v11 offset:16640
v_mul_f32 v49, v201, v201
v_mfma_f32_16x16x32_bf16 v[132:135], v[40:43], a[76:79], v[132:135]
v_mul_f32 v50, v202, v202
v_mfma_f32_16x16x32_bf16 v[136:139], v[40:43], a[140:143], v[136:139]
v_mul_f32 v51, v203, v203
ds_read_b64_tr_b16 v[26:27], v11 offset:17152
v_fma_f32 v48, v48, s68, v62
v_mfma_f32_16x16x32_bf16 v[140:143], v[40:43], a[204:207], v[140:143]
s_add_u32 m0, s56, 57344
s_add_u32 s57, s55, 3670144
buffer_load_dwordx4 v10, s[4:7], s57 offen lds
v_fma_f32 v49, v49, s68, v62
s_waitcnt lgkmcnt(6)
v_mfma_f32_16x16x32_bf16 v[144:147], v[44:47], a[12:15], v[144:147]
ds_read_b64_tr_b16 v[28:29], v12 offset:16640
v_fma_f32 v50, v50, s68, v62
v_mfma_f32_16x16x32_bf16 v[148:151], v[44:47], a[76:79], v[148:151]
v_fma_f32 v51, v51, s68, v62
v_mfma_f32_16x16x32_bf16 v[152:155], v[44:47], a[140:143], v[152:155]
ds_read_b64_tr_b16 v[30:31], v12 offset:17152
v_mul_f32 v48, v48, v200
v_mfma_f32_16x16x32_bf16 v[156:159], v[44:47], a[204:207], v[156:159]
v_mul_f32 v49, v49, v201
s_waitcnt lgkmcnt(6)
v_mfma_f32_16x16x32_bf16 v[224:227], v[16:19], a[16:19], v[224:227]
v_mul_f32 v50, v50, v202
ds_read_b64_tr_b16 v[32:33], v11 offset:20480
s_add_u32 m0, s56, 61440
s_add_u32 s57, s55, 3932288
buffer_load_dwordx4 v10, s[4:7], s57 offen lds
v_mul_f32 v51, v51, v203
v_mfma_f32_16x16x32_bf16 v[228:231], v[16:19], a[80:83], v[228:231]
v_exp_f32 v48, v48
v_mfma_f32_16x16x32_bf16 v[232:235], v[16:19], a[144:147], v[232:235]
ds_read_b64_tr_b16 v[34:35], v11 offset:20992
v_mul_f32 v200, v200, v216
v_mfma_f32_16x16x32_bf16 v[236:239], v[16:19], a[208:211], v[236:239]
v_exp_f32 v49, v49
s_waitcnt lgkmcnt(6)
v_mfma_f32_16x16x32_bf16 v[240:243], v[20:23], a[16:19], v[240:243]
ds_read_b64_tr_b16 v[36:37], v12 offset:20480
v_mul_f32 v201, v201, v217
v_mfma_f32_16x16x32_bf16 v[244:247], v[20:23], a[80:83], v[244:247]
v_exp_f32 v50, v50
v_mfma_f32_16x16x32_bf16 v[248:251], v[20:23], a[144:147], v[248:251]
v_mul_f32 v202, v202, v218
ds_read_b64_tr_b16 v[38:39], v12 offset:20992
v_exp_f32 v51, v51
v_mfma_f32_16x16x32_bf16 v[252:255], v[20:23], a[208:211], v[252:255]
v_mul_f32 v203, v203, v219
s_waitcnt lgkmcnt(6)
v_mfma_f32_16x16x32_bf16 v[128:131], v[24:27], a[16:19], v[128:131]
ds_read_b64_tr_b16 v[40:41], v11 offset:20736
v_add_f32 v48, 1.0, v48
v_mfma_f32_16x16x32_bf16 v[132:135], v[24:27], a[80:83], v[132:135]
v_add_f32 v49, 1.0, v49
v_mfma_f32_16x16x32_bf16 v[136:139], v[24:27], a[144:147], v[136:139]
ds_read_b64_tr_b16 v[42:43], v11 offset:21248
v_add_f32 v50, 1.0, v50
v_mfma_f32_16x16x32_bf16 v[140:143], v[24:27], a[208:211], v[140:143]
v_add_f32 v51, 1.0, v51
s_waitcnt lgkmcnt(6)
v_mfma_f32_16x16x32_bf16 v[144:147], v[28:31], a[16:19], v[144:147]
v_rcp_f32 v48, v48
ds_read_b64_tr_b16 v[44:45], v12 offset:20736
v_rcp_f32 v49, v49
v_mfma_f32_16x16x32_bf16 v[148:151], v[28:31], a[80:83], v[148:151]
v_rcp_f32 v50, v50
v_mfma_f32_16x16x32_bf16 v[152:155], v[28:31], a[144:147], v[152:155]
ds_read_b64_tr_b16 v[46:47], v12 offset:21248
v_rcp_f32 v51, v51
v_mfma_f32_16x16x32_bf16 v[156:159], v[28:31], a[208:211], v[156:159]
v_mul_f32 v200, v200, v48
s_waitcnt lgkmcnt(6)
v_mfma_f32_16x16x32_bf16 v[224:227], v[32:35], a[20:23], v[224:227]
ds_read_b64_tr_b16 v[16:17], v11 offset:24576
v_mul_f32 v201, v201, v49
v_mfma_f32_16x16x32_bf16 v[228:231], v[32:35], a[84:87], v[228:231]
v_mul_f32 v202, v202, v50
v_mfma_f32_16x16x32_bf16 v[232:235], v[32:35], a[148:151], v[232:235]
v_mul_f32 v203, v203, v51
ds_read_b64_tr_b16 v[18:19], v11 offset:25088
v_cvt_pk_bf16_f32 v56, v200, v201
v_mfma_f32_16x16x32_bf16 v[236:239], v[32:35], a[212:215], v[236:239]
v_cvt_pk_bf16_f32 v57, v202, v203
s_waitcnt lgkmcnt(6)
v_mfma_f32_16x16x32_bf16 v[240:243], v[36:39], a[20:23], v[240:243]
ds_read_b64_tr_b16 v[20:21], v12 offset:24576
s_add_u32 m0, s62, 0
s_nop 0
buffer_load_dwordx4 v6, s[28:31], s58 offen offset:0 sc1 lds
buffer_load_dwordx4 v6, s[28:31], s58 offen offset:1024 sc1 lds
buffer_load_dwordx4 v6, s[28:31], s58 offen offset:2048 sc1 lds
buffer_load_dwordx4 v6, s[28:31], s58 offen offset:3072 sc1 lds
s_add_u32 s58, s58, 32768
s_cmp_eq_u32 s58, s60
s_cselect_b32 s58, 0, s58
s_cselect_b32 s60, -1, s60
v_mul_f32 v52, v204, v204
v_mfma_f32_16x16x32_bf16 v[244:247], v[36:39], a[84:87], v[244:247]
v_mul_f32 v53, v205, v205
v_mfma_f32_16x16x32_bf16 v[248:251], v[36:39], a[148:151], v[248:251]
ds_read_b64_tr_b16 v[22:23], v12 offset:25088
v_mul_f32 v54, v206, v206
v_mfma_f32_16x16x32_bf16 v[252:255], v[36:39], a[212:215], v[252:255]
v_mul_f32 v55, v207, v207
s_waitcnt lgkmcnt(6)
v_mfma_f32_16x16x32_bf16 v[128:131], v[40:43], a[20:23], v[128:131]
v_fma_f32 v52, v52, s68, v62
ds_read_b64_tr_b16 v[24:25], v11 offset:24832
v_fma_f32 v53, v53, s68, v62
v_mfma_f32_16x16x32_bf16 v[132:135], v[40:43], a[84:87], v[132:135]
v_fma_f32 v54, v54, s68, v62
v_mfma_f32_16x16x32_bf16 v[136:139], v[40:43], a[148:151], v[136:139]
ds_read_b64_tr_b16 v[26:27], v11 offset:25344
v_fma_f32 v55, v55, s68, v62
v_mfma_f32_16x16x32_bf16 v[140:143], v[40:43], a[212:215], v[140:143]
v_mul_f32 v52, v52, v204
s_waitcnt lgkmcnt(6)
v_mfma_f32_16x16x32_bf16 v[144:147], v[44:47], a[20:23], v[144:147]
ds_read_b64_tr_b16 v[28:29], v12 offset:24832
v_mul_f32 v53, v53, v205
v_mfma_f32_16x16x32_bf16 v[148:151], v[44:47], a[84:87], v[148:151]
v_mul_f32 v54, v54, v206
v_mfma_f32_16x16x32_bf16 v[152:155], v[44:47], a[148:151], v[152:155]
v_mul_f32 v55, v55, v207
ds_read_b64_tr_b16 v[30:31], v12 offset:25344
v_exp_f32 v52, v52
v_mfma_f32_16x16x32_bf16 v[156:159], v[44:47], a[212:215], v[156:159]
v_mul_f32 v204, v204, v220
s_waitcnt lgkmcnt(6)
v_mfma_f32_16x16x32_bf16 v[224:227], v[16:19], a[24:27], v[224:227]
ds_read_b64_tr_b16 v[32:33], v11 offset:28672
v_exp_f32 v53, v53
v_mfma_f32_16x16x32_bf16 v[228:231], v[16:19], a[88:91], v[228:231]
v_mul_f32 v205, v205, v221
v_mfma_f32_16x16x32_bf16 v[232:235], v[16:19], a[152:155], v[232:235]
ds_read_b64_tr_b16 v[34:35], v11 offset:29184
v_exp_f32 v54, v54
v_mfma_f32_16x16x32_bf16 v[236:239], v[16:19], a[216:219], v[236:239]
v_mul_f32 v206, v206, v222
s_waitcnt lgkmcnt(6)
v_mfma_f32_16x16x32_bf16 v[240:243], v[20:23], a[24:27], v[240:243]
ds_read_b64_tr_b16 v[36:37], v12 offset:28672
v_exp_f32 v55, v55
v_mul_f32 v207, v207, v223
v_mfma_f32_16x16x32_bf16 v[244:247], v[20:23], a[88:91], v[244:247]
v_add_f32 v52, 1.0, v52
v_mfma_f32_16x16x32_bf16 v[248:251], v[20:23], a[152:155], v[248:251]
ds_read_b64_tr_b16 v[38:39], v12 offset:29184
v_add_f32 v53, 1.0, v53
v_mfma_f32_16x16x32_bf16 v[252:255], v[20:23], a[216:219], v[252:255]
v_add_f32 v54, 1.0, v54
s_waitcnt lgkmcnt(6)
v_mfma_f32_16x16x32_bf16 v[128:131], v[24:27], a[24:27], v[128:131]
ds_read_b64_tr_b16 v[40:41], v11 offset:28928
v_add_f32 v55, 1.0, v55
v_mfma_f32_16x16x32_bf16 v[132:135], v[24:27], a[88:91], v[132:135]
v_rcp_f32 v52, v52
v_mfma_f32_16x16x32_bf16 v[136:139], v[24:27], a[152:155], v[136:139]
ds_read_b64_tr_b16 v[42:43], v11 offset:29440
v_rcp_f32 v53, v53
v_rcp_f32 v54, v54
v_mfma_f32_16x16x32_bf16 v[140:143], v[24:27], a[216:219], v[140:143]
v_rcp_f32 v55, v55
s_waitcnt lgkmcnt(6)
v_mfma_f32_16x16x32_bf16 v[144:147], v[28:31], a[24:27], v[144:147]
ds_read_b64_tr_b16 v[44:45], v12 offset:28928
v_mul_f32 v204, v204, v52
v_mfma_f32_16x16x32_bf16 v[148:151], v[28:31], a[88:91], v[148:151]
v_mul_f32 v205, v205, v53
v_mfma_f32_16x16x32_bf16 v[152:155], v[28:31], a[152:155], v[152:155]
ds_read_b64_tr_b16 v[46:47], v12 offset:29440
v_mul_f32 v206, v206, v54
v_mfma_f32_16x16x32_bf16 v[156:159], v[28:31], a[216:219], v[156:159]
v_mul_f32 v207, v207, v55
s_waitcnt vmcnt(9)
s_barrier
s_waitcnt lgkmcnt(6)
v_mfma_f32_16x16x32_bf16 v[224:227], v[32:35], a[28:31], v[224:227]
ds_read_b64_tr_b16 v[16:17], v11 offset:32768
v_cvt_pk_bf16_f32 v58, v204, v205
v_cvt_pk_bf16_f32 v59, v206, v207
v_mfma_f32_16x16x32_bf16 v[228:231], v[32:35], a[92:95], v[228:231]
s_add_u32 s23, s72, 481280
v_permlane16_swap_b32 v56, v58
v_mfma_f32_16x16x32_bf16 v[232:235], v[32:35], a[156:159], v[232:235]
ds_read_b64_tr_b16 v[18:19], v11 offset:33280
v_permlane16_swap_b32 v57, v59
v_mfma_f32_16x16x32_bf16 v[236:239], v[32:35], a[220:223], v[236:239]
buffer_store_dwordx4 v[56:59], v0, s[48:51], s23 offen sc1
s_waitcnt lgkmcnt(6)
v_mfma_f32_16x16x32_bf16 v[240:243], v[36:39], a[28:31], v[240:243]
ds_read_b64_tr_b16 v[20:21], v12 offset:32768
s_add_u32 m0, s62, 16384
s_nop 0
buffer_load_dwordx4 v6, s[28:31], s58 offen offset:0 sc1 lds
buffer_load_dwordx4 v6, s[28:31], s58 offen offset:1024 sc1 lds
buffer_load_dwordx4 v6, s[28:31], s58 offen offset:2048 sc1 lds
buffer_load_dwordx4 v6, s[28:31], s58 offen offset:3072 sc1 lds
s_add_u32 s58, s58, 32768
s_cmp_eq_u32 s58, s60
s_cselect_b32 s58, 0, s58
s_cselect_b32 s60, -1, s60
v_mfma_f32_16x16x32_bf16 v[244:247], v[36:39], a[92:95], v[244:247]
v_mfma_f32_16x16x32_bf16 v[248:251], v[36:39], a[156:159], v[248:251]
ds_read_b64_tr_b16 v[22:23], v12 offset:33280
v_mfma_f32_16x16x32_bf16 v[252:255], v[36:39], a[220:223], v[252:255]
s_waitcnt lgkmcnt(6)
v_mfma_f32_16x16x32_bf16 v[128:131], v[40:43], a[28:31], v[128:131]
ds_read_b64_tr_b16 v[24:25], v11 offset:33024
v_mul_f32 v64, s74, v64
v_mfma_f32_16x16x32_bf16 v[132:135], v[40:43], a[92:95], v[132:135]
v_mul_f32 v65, s74, v65
v_mfma_f32_16x16x32_bf16 v[136:139], v[40:43], a[156:159], v[136:139]
ds_read_b64_tr_b16 v[26:27], v11 offset:33536
v_mul_f32 v66, s74, v66
v_mfma_f32_16x16x32_bf16 v[140:143], v[40:43], a[220:223], v[140:143]
s_waitcnt lgkmcnt(6)
v_mfma_f32_16x16x32_bf16 v[144:147], v[44:47], a[28:31], v[144:147]
v_mul_f32 v67, s74, v67
ds_read_b64_tr_b16 v[28:29], v12 offset:33024
v_mfma_f32_16x16x32_bf16 v[148:151], v[44:47], a[92:95], v[148:151]
v_cvt_pk_bf16_f32 v48, v64, v65
v_mfma_f32_16x16x32_bf16 v[152:155], v[44:47], a[156:159], v[152:155]
ds_read_b64_tr_b16 v[30:31], v12 offset:33536
v_cvt_pk_bf16_f32 v49, v66, v67
v_mfma_f32_16x16x32_bf16 v[156:159], v[44:47], a[220:223], v[156:159]
v_mul_f32 v80, s74, v80
s_waitcnt lgkmcnt(6)
v_mfma_f32_16x16x32_bf16 v[224:227], v[16:19], a[32:35], v[224:227]
ds_read_b64_tr_b16 v[32:33], v11 offset:36864
v_mul_f32 v81, s74, v81
v_mfma_f32_16x16x32_bf16 v[228:231], v[16:19], a[96:99], v[228:231]
v_mul_f32 v82, s74, v82
v_mfma_f32_16x16x32_bf16 v[232:235], v[16:19], a[160:163], v[232:235]
ds_read_b64_tr_b16 v[34:35], v11 offset:37376
v_mul_f32 v83, s74, v83
v_mfma_f32_16x16x32_bf16 v[236:239], v[16:19], a[224:227], v[236:239]
s_waitcnt lgkmcnt(6)
v_mfma_f32_16x16x32_bf16 v[240:243], v[20:23], a[32:35], v[240:243]
v_cvt_pk_bf16_f32 v50, v80, v81
ds_read_b64_tr_b16 v[36:37], v12 offset:36864
v_mfma_f32_16x16x32_bf16 v[244:247], v[20:23], a[96:99], v[244:247]
v_cvt_pk_bf16_f32 v51, v82, v83
v_mfma_f32_16x16x32_bf16 v[248:251], v[20:23], a[160:163], v[248:251]
ds_read_b64_tr_b16 v[38:39], v12 offset:37376
ds_write_b128 v14, v[48:51] offset:0
v_mfma_f32_16x16x32_bf16 v[252:255], v[20:23], a[224:227], v[252:255]
s_add_u32 s23, s73, 0
buffer_store_dwordx4 v[48:51], v15, s[32:35], s23 offen offset:0
s_waitcnt lgkmcnt(7)
v_mfma_f32_16x16x32_bf16 v[128:131], v[24:27], a[32:35], v[128:131]
ds_read_b64_tr_b16 v[40:41], v11 offset:37120
v_mul_f32 v96, s74, v96
v_mfma_f32_16x16x32_bf16 v[132:135], v[24:27], a[96:99], v[132:135]
v_mul_f32 v97, s74, v97
v_mfma_f32_16x16x32_bf16 v[136:139], v[24:27], a[160:163], v[136:139]
ds_read_b64_tr_b16 v[42:43], v11 offset:37632
v_mul_f32 v98, s74, v98
v_mfma_f32_16x16x32_bf16 v[140:143], v[24:27], a[224:227], v[140:143]
s_waitcnt lgkmcnt(7)
v_mfma_f32_16x16x32_bf16 v[144:147], v[28:31], a[32:35], v[144:147]
v_mul_f32 v99, s74, v99
ds_read_b64_tr_b16 v[44:45], v12 offset:37120
v_mfma_f32_16x16x32_bf16 v[148:151], v[28:31], a[96:99], v[148:151]
v_cvt_pk_bf16_f32 v52, v96, v97
v_mfma_f32_16x16x32_bf16 v[152:155], v[28:31], a[160:163], v[152:155]
ds_read_b64_tr_b16 v[46:47], v12 offset:37632
v_cvt_pk_bf16_f32 v53, v98, v99
v_mfma_f32_16x16x32_bf16 v[156:159], v[28:31], a[224:227], v[156:159]
v_mul_f32 v112, s74, v112
s_waitcnt lgkmcnt(7)
v_mfma_f32_16x16x32_bf16 v[224:227], v[32:35], a[36:39], v[224:227]
ds_read_b64_tr_b16 v[16:17], v11 offset:40960
v_mul_f32 v113, s74, v113
v_mfma_f32_16x16x32_bf16 v[228:231], v[32:35], a[100:103], v[228:231]
v_mul_f32 v114, s74, v114
v_mfma_f32_16x16x32_bf16 v[232:235], v[32:35], a[164:167], v[232:235]
ds_read_b64_tr_b16 v[18:19], v11 offset:41472
v_mul_f32 v115, s74, v115
v_mfma_f32_16x16x32_bf16 v[236:239], v[32:35], a[228:231], v[236:239]
s_waitcnt lgkmcnt(7)
v_mfma_f32_16x16x32_bf16 v[240:243], v[36:39], a[36:39], v[240:243]
v_cvt_pk_bf16_f32 v54, v112, v113
ds_read_b64_tr_b16 v[20:21], v12 offset:40960
s_add_u32 m0, s63, 0
s_nop 0
buffer_load_dwordx4 v6, s[28:31], s59 offen offset:0 sc1 lds
buffer_load_dwordx4 v6, s[28:31], s59 offen offset:1024 sc1 lds
buffer_load_dwordx4 v6, s[28:31], s59 offen offset:2048 sc1 lds
buffer_load_dwordx4 v6, s[28:31], s59 offen offset:3072 sc1 lds
s_add_u32 s59, s59, 32768
s_cmp_eq_u32 s59, s61
s_cselect_b32 s59, 8192, s59
s_cselect_b32 s61, -1, s61
v_mfma_f32_16x16x32_bf16 v[244:247], v[36:39], a[100:103], v[244:247]
v_cvt_pk_bf16_f32 v55, v114, v115
v_mfma_f32_16x16x32_bf16 v[248:251], v[36:39], a[164:167], v[248:251]
ds_read_b64_tr_b16 v[22:23], v12 offset:41472
ds_write_b128 v14, v[52:55] offset:2048
v_mfma_f32_16x16x32_bf16 v[252:255], v[36:39], a[228:231], v[252:255]
s_add_u32 s23, s73, 0
buffer_store_dwordx4 v[52:55], v15, s[32:35], s23 offen offset:2048
s_waitcnt lgkmcnt(7)
v_mfma_f32_16x16x32_bf16 v[128:131], v[40:43], a[36:39], v[128:131]
ds_read_b64_tr_b16 v[24:25], v11 offset:41216
v_mul_f32 v68, s74, v68
v_mfma_f32_16x16x32_bf16 v[132:135], v[40:43], a[100:103], v[132:135]
v_mul_f32 v69, s74, v69
v_mfma_f32_16x16x32_bf16 v[136:139], v[40:43], a[164:167], v[136:139]
ds_read_b64_tr_b16 v[26:27], v11 offset:41728
v_mul_f32 v70, s74, v70
v_mfma_f32_16x16x32_bf16 v[140:143], v[40:43], a[228:231], v[140:143]
s_waitcnt lgkmcnt(7)
v_mfma_f32_16x16x32_bf16 v[144:147], v[44:47], a[36:39], v[144:147]
v_mul_f32 v71, s74, v71
ds_read_b64_tr_b16 v[28:29], v12 offset:41216
v_mfma_f32_16x16x32_bf16 v[148:151], v[44:47], a[100:103], v[148:151]
v_cvt_pk_bf16_f32 v56, v68, v69
v_mfma_f32_16x16x32_bf16 v[152:155], v[44:47], a[164:167], v[152:155]
ds_read_b64_tr_b16 v[30:31], v12 offset:41728
v_cvt_pk_bf16_f32 v57, v70, v71
v_mfma_f32_16x16x32_bf16 v[156:159], v[44:47], a[228:231], v[156:159]
v_mul_f32 v84, s74, v84
s_waitcnt lgkmcnt(7)
v_mfma_f32_16x16x32_bf16 v[224:227], v[16:19], a[40:43], v[224:227]
ds_read_b64_tr_b16 v[32:33], v11 offset:45056
v_mul_f32 v85, s74, v85
v_mfma_f32_16x16x32_bf16 v[228:231], v[16:19], a[104:107], v[228:231]
v_mul_f32 v86, s74, v86
v_mfma_f32_16x16x32_bf16 v[232:235], v[16:19], a[168:171], v[232:235]
ds_read_b64_tr_b16 v[34:35], v11 offset:45568
v_mul_f32 v87, s74, v87
v_mfma_f32_16x16x32_bf16 v[236:239], v[16:19], a[232:235], v[236:239]
s_waitcnt lgkmcnt(7)
v_mfma_f32_16x16x32_bf16 v[240:243], v[20:23], a[40:43], v[240:243]
v_cvt_pk_bf16_f32 v58, v84, v85
ds_read_b64_tr_b16 v[36:37], v12 offset:45056
v_mfma_f32_16x16x32_bf16 v[244:247], v[20:23], a[104:107], v[244:247]
v_cvt_pk_bf16_f32 v59, v86, v87
v_mfma_f32_16x16x32_bf16 v[248:251], v[20:23], a[168:171], v[248:251]
ds_read_b64_tr_b16 v[38:39], v12 offset:45568
ds_write_b128 v14, v[56:59] offset:256
v_mfma_f32_16x16x32_bf16 v[252:255], v[20:23], a[232:235], v[252:255]
s_add_u32 s23, s73, 0
buffer_store_dwordx4 v[56:59], v15, s[32:35], s23 offen offset:256
s_waitcnt lgkmcnt(7)
v_mfma_f32_16x16x32_bf16 v[128:131], v[24:27], a[40:43], v[128:131]
ds_read_b64_tr_b16 v[40:41], v11 offset:45312
v_mul_f32 v100, s74, v100
v_mfma_f32_16x16x32_bf16 v[132:135], v[24:27], a[104:107], v[132:135]
v_mul_f32 v101, s74, v101
v_mfma_f32_16x16x32_bf16 v[136:139], v[24:27], a[168:171], v[136:139]
ds_read_b64_tr_b16 v[42:43], v11 offset:45824
v_mul_f32 v102, s74, v102
v_mfma_f32_16x16x32_bf16 v[140:143], v[24:27], a[232:235], v[140:143]
s_waitcnt lgkmcnt(7)
v_mfma_f32_16x16x32_bf16 v[144:147], v[28:31], a[40:43], v[144:147]
v_mul_f32 v103, s74, v103
ds_read_b64_tr_b16 v[44:45], v12 offset:45312
v_mfma_f32_16x16x32_bf16 v[148:151], v[28:31], a[104:107], v[148:151]
v_cvt_pk_bf16_f32 v48, v100, v101
v_mfma_f32_16x16x32_bf16 v[152:155], v[28:31], a[168:171], v[152:155]
ds_read_b64_tr_b16 v[46:47], v12 offset:45824
v_cvt_pk_bf16_f32 v49, v102, v103
v_mfma_f32_16x16x32_bf16 v[156:159], v[28:31], a[232:235], v[156:159]
s_waitcnt vmcnt(16)
s_barrier
v_mul_f32 v116, s74, v116
s_waitcnt lgkmcnt(7)
v_mfma_f32_16x16x32_bf16 v[224:227], v[32:35], a[44:47], v[224:227]
ds_read_b64_tr_b16 v[16:17], v11 offset:49152
v_mul_f32 v117, s74, v117
v_mfma_f32_16x16x32_bf16 v[228:231], v[32:35], a[108:111], v[228:231]
v_mul_f32 v118, s74, v118
v_mfma_f32_16x16x32_bf16 v[232:235], v[32:35], a[172:175], v[232:235]
ds_read_b64_tr_b16 v[18:19], v11 offset:49664
v_mul_f32 v119, s74, v119
v_mfma_f32_16x16x32_bf16 v[236:239], v[32:35], a[236:239], v[236:239]
s_waitcnt lgkmcnt(7)
v_mfma_f32_16x16x32_bf16 v[240:243], v[36:39], a[44:47], v[240:243]
v_cvt_pk_bf16_f32 v50, v116, v117
ds_read_b64_tr_b16 v[20:21], v12 offset:49152
s_add_u32 m0, s63, 16384
s_nop 0
buffer_load_dwordx4 v6, s[28:31], s59 offen offset:0 sc1 lds
buffer_load_dwordx4 v6, s[28:31], s59 offen offset:1024 sc1 lds
buffer_load_dwordx4 v6, s[28:31], s59 offen offset:2048 sc1 lds
buffer_load_dwordx4 v6, s[28:31], s59 offen offset:3072 sc1 lds
s_add_u32 s59, s59, 32768
s_cmp_eq_u32 s59, s61
s_cselect_b32 s59, 8192, s59
s_cselect_b32 s61, -1, s61
v_mfma_f32_16x16x32_bf16 v[244:247], v[36:39], a[108:111], v[244:247]
v_cvt_pk_bf16_f32 v51, v118, v119
v_mfma_f32_16x16x32_bf16 v[248:251], v[36:39], a[172:175], v[248:251]
ds_read_b64_tr_b16 v[22:23], v12 offset:49664
ds_write_b128 v14, v[48:51] offset:2304
v_mfma_f32_16x16x32_bf16 v[252:255], v[36:39], a[236:239], v[252:255]
s_add_u32 s23, s73, 0
buffer_store_dwordx4 v[48:51], v15, s[32:35], s23 offen offset:2304
s_waitcnt lgkmcnt(7)
v_mfma_f32_16x16x32_bf16 v[128:131], v[40:43], a[44:47], v[128:131]
ds_read_b64_tr_b16 v[24:25], v11 offset:49408
v_mul_f32 v72, s74, v72
v_mfma_f32_16x16x32_bf16 v[132:135], v[40:43], a[108:111], v[132:135]
v_mul_f32 v73, s74, v73
v_mfma_f32_16x16x32_bf16 v[136:139], v[40:43], a[172:175], v[136:139]
ds_read_b64_tr_b16 v[26:27], v11 offset:49920
v_mul_f32 v74, s74, v74
v_mfma_f32_16x16x32_bf16 v[140:143], v[40:43], a[236:239], v[140:143]
s_waitcnt lgkmcnt(7)
v_mfma_f32_16x16x32_bf16 v[144:147], v[44:47], a[44:47], v[144:147]
v_mul_f32 v75, s74, v75
ds_read_b64_tr_b16 v[28:29], v12 offset:49408
v_mfma_f32_16x16x32_bf16 v[148:151], v[44:47], a[108:111], v[148:151]
v_cvt_pk_bf16_f32 v52, v72, v73
v_mfma_f32_16x16x32_bf16 v[152:155], v[44:47], a[172:175], v[152:155]
ds_read_b64_tr_b16 v[30:31], v12 offset:49920
v_cvt_pk_bf16_f32 v53, v74, v75
v_mfma_f32_16x16x32_bf16 v[156:159], v[44:47], a[236:239], v[156:159]
v_mul_f32 v88, s74, v88
s_waitcnt lgkmcnt(7)
v_mfma_f32_16x16x32_bf16 v[224:227], v[16:19], a[48:51], v[224:227]
ds_read_b64_tr_b16 v[32:33], v11 offset:53248
v_mul_f32 v89, s74, v89
v_mfma_f32_16x16x32_bf16 v[228:231], v[16:19], a[112:115], v[228:231]
v_mul_f32 v90, s74, v90
v_mfma_f32_16x16x32_bf16 v[232:235], v[16:19], a[176:179], v[232:235]
ds_read_b64_tr_b16 v[34:35], v11 offset:53760
v_mul_f32 v91, s74, v91
v_mfma_f32_16x16x32_bf16 v[236:239], v[16:19], a[240:243], v[236:239]
s_waitcnt lgkmcnt(7)
v_mfma_f32_16x16x32_bf16 v[240:243], v[20:23], a[48:51], v[240:243]
v_cvt_pk_bf16_f32 v54, v88, v89
ds_read_b64_tr_b16 v[36:37], v12 offset:53248
v_mfma_f32_16x16x32_bf16 v[244:247], v[20:23], a[112:115], v[244:247]
v_cvt_pk_bf16_f32 v55, v90, v91
v_mfma_f32_16x16x32_bf16 v[248:251], v[20:23], a[176:179], v[248:251]
ds_read_b64_tr_b16 v[38:39], v12 offset:53760
ds_write_b128 v14, v[52:55] offset:8192
v_mfma_f32_16x16x32_bf16 v[252:255], v[20:23], a[240:243], v[252:255]
s_add_u32 s23, s73, 8192
buffer_store_dwordx4 v[52:55], v15, s[32:35], s23 offen offset:0
s_waitcnt lgkmcnt(7)
v_mfma_f32_16x16x32_bf16 v[128:131], v[24:27], a[48:51], v[128:131]
ds_read_b64_tr_b16 v[40:41], v11 offset:53504
v_mul_f32 v104, s74, v104
v_mfma_f32_16x16x32_bf16 v[132:135], v[24:27], a[112:115], v[132:135]
v_mul_f32 v105, s74, v105
v_mfma_f32_16x16x32_bf16 v[136:139], v[24:27], a[176:179], v[136:139]
ds_read_b64_tr_b16 v[42:43], v11 offset:54016
v_mul_f32 v106, s74, v106
v_mfma_f32_16x16x32_bf16 v[140:143], v[24:27], a[240:243], v[140:143]
s_waitcnt lgkmcnt(7)
v_mfma_f32_16x16x32_bf16 v[144:147], v[28:31], a[48:51], v[144:147]
v_mul_f32 v107, s74, v107
ds_read_b64_tr_b16 v[44:45], v12 offset:53504
v_mfma_f32_16x16x32_bf16 v[148:151], v[28:31], a[112:115], v[148:151]
v_cvt_pk_bf16_f32 v56, v104, v105
v_mfma_f32_16x16x32_bf16 v[152:155], v[28:31], a[176:179], v[152:155]
ds_read_b64_tr_b16 v[46:47], v12 offset:54016
v_cvt_pk_bf16_f32 v57, v106, v107
v_mfma_f32_16x16x32_bf16 v[156:159], v[28:31], a[240:243], v[156:159]
v_mul_f32 v120, s74, v120
s_waitcnt lgkmcnt(7)
v_mfma_f32_16x16x32_bf16 v[224:227], v[32:35], a[52:55], v[224:227]
ds_read_b64_tr_b16 v[16:17], v11 offset:57344
v_mul_f32 v121, s74, v121
v_mfma_f32_16x16x32_bf16 v[228:231], v[32:35], a[116:119], v[228:231]
v_mul_f32 v122, s74, v122
v_mfma_f32_16x16x32_bf16 v[232:235], v[32:35], a[180:183], v[232:235]
ds_read_b64_tr_b16 v[18:19], v11 offset:57856
v_mul_f32 v123, s74, v123
v_mfma_f32_16x16x32_bf16 v[236:239], v[32:35], a[244:247], v[236:239]
s_waitcnt lgkmcnt(7)
v_mfma_f32_16x16x32_bf16 v[240:243], v[36:39], a[52:55], v[240:243]
v_cvt_pk_bf16_f32 v58, v120, v121
ds_read_b64_tr_b16 v[20:21], v12 offset:57344
v_mfma_f32_16x16x32_bf16 v[244:247], v[36:39], a[116:119], v[244:247]
v_cvt_pk_bf16_f32 v59, v122, v123
v_mfma_f32_16x16x32_bf16 v[248:251], v[36:39], a[180:183], v[248:251]
ds_read_b64_tr_b16 v[22:23], v12 offset:57856
ds_write_b128 v14, v[56:59] offset:10240
v_mfma_f32_16x16x32_bf16 v[252:255], v[36:39], a[244:247], v[252:255]
s_add_u32 s23, s73, 8192
buffer_store_dwordx4 v[56:59], v15, s[32:35], s23 offen offset:2048
s_waitcnt lgkmcnt(7)
v_mfma_f32_16x16x32_bf16 v[128:131], v[40:43], a[52:55], v[128:131]
ds_read_b64_tr_b16 v[24:25], v11 offset:57600
v_mul_f32 v76, s74, v76
v_mfma_f32_16x16x32_bf16 v[132:135], v[40:43], a[116:119], v[132:135]
v_mul_f32 v77, s74, v77
v_mfma_f32_16x16x32_bf16 v[136:139], v[40:43], a[180:183], v[136:139]
ds_read_b64_tr_b16 v[26:27], v11 offset:58112
v_mul_f32 v78, s74, v78
v_mfma_f32_16x16x32_bf16 v[140:143], v[40:43], a[244:247], v[140:143]
s_waitcnt lgkmcnt(7)
v_mfma_f32_16x16x32_bf16 v[144:147], v[44:47], a[52:55], v[144:147]
v_mul_f32 v79, s74, v79
ds_read_b64_tr_b16 v[28:29], v12 offset:57600
v_mfma_f32_16x16x32_bf16 v[148:151], v[44:47], a[116:119], v[148:151]
v_cvt_pk_bf16_f32 v48, v76, v77
v_mfma_f32_16x16x32_bf16 v[152:155], v[44:47], a[180:183], v[152:155]
ds_read_b64_tr_b16 v[30:31], v12 offset:58112
v_cvt_pk_bf16_f32 v49, v78, v79
v_mfma_f32_16x16x32_bf16 v[156:159], v[44:47], a[244:247], v[156:159]
v_mul_f32 v92, s74, v92
s_waitcnt lgkmcnt(7)
v_mfma_f32_16x16x32_bf16 v[224:227], v[16:19], a[56:59], v[224:227]
ds_read_b64_tr_b16 v[32:33], v11 offset:61440
v_mul_f32 v93, s74, v93
v_mfma_f32_16x16x32_bf16 v[228:231], v[16:19], a[120:123], v[228:231]
v_mul_f32 v94, s74, v94
v_mfma_f32_16x16x32_bf16 v[232:235], v[16:19], a[184:187], v[232:235]
ds_read_b64_tr_b16 v[34:35], v11 offset:61952
v_mul_f32 v95, s74, v95
v_mfma_f32_16x16x32_bf16 v[236:239], v[16:19], a[248:251], v[236:239]
s_waitcnt lgkmcnt(7)
v_mfma_f32_16x16x32_bf16 v[240:243], v[20:23], a[56:59], v[240:243]
v_cvt_pk_bf16_f32 v50, v92, v93
ds_read_b64_tr_b16 v[36:37], v12 offset:61440
v_mfma_f32_16x16x32_bf16 v[244:247], v[20:23], a[120:123], v[244:247]
v_cvt_pk_bf16_f32 v51, v94, v95
v_mfma_f32_16x16x32_bf16 v[248:251], v[20:23], a[184:187], v[248:251]
ds_read_b64_tr_b16 v[38:39], v12 offset:61952
ds_write_b128 v14, v[48:51] offset:8448
v_mfma_f32_16x16x32_bf16 v[252:255], v[20:23], a[248:251], v[252:255]
s_add_u32 s23, s73, 8192
buffer_store_dwordx4 v[48:51], v15, s[32:35], s23 offen offset:256
s_waitcnt lgkmcnt(7)
v_mfma_f32_16x16x32_bf16 v[128:131], v[24:27], a[56:59], v[128:131]
ds_read_b64_tr_b16 v[40:41], v11 offset:61696
v_mul_f32 v108, s74, v108
v_mfma_f32_16x16x32_bf16 v[132:135], v[24:27], a[120:123], v[132:135]
v_mul_f32 v109, s74, v109
v_mfma_f32_16x16x32_bf16 v[136:139], v[24:27], a[184:187], v[136:139]
ds_read_b64_tr_b16 v[42:43], v11 offset:62208
v_mul_f32 v110, s74, v110
v_mfma_f32_16x16x32_bf16 v[140:143], v[24:27], a[248:251], v[140:143]
s_waitcnt lgkmcnt(7)
v_mfma_f32_16x16x32_bf16 v[144:147], v[28:31], a[56:59], v[144:147]
v_mul_f32 v111, s74, v111
ds_read_b64_tr_b16 v[44:45], v12 offset:61696
v_mfma_f32_16x16x32_bf16 v[148:151], v[28:31], a[120:123], v[148:151]
v_cvt_pk_bf16_f32 v52, v108, v109
v_mfma_f32_16x16x32_bf16 v[152:155], v[28:31], a[184:187], v[152:155]
ds_read_b64_tr_b16 v[46:47], v12 offset:62208
v_cvt_pk_bf16_f32 v53, v110, v111
v_mfma_f32_16x16x32_bf16 v[156:159], v[28:31], a[248:251], v[156:159]
v_mul_f32 v124, s74, v124
s_waitcnt lgkmcnt(7)
v_mfma_f32_16x16x32_bf16 v[224:227], v[32:35], a[60:63], v[224:227]
v_mul_f32 v125, s74, v125
v_mfma_f32_16x16x32_bf16 v[228:231], v[32:35], a[124:127], v[228:231]
v_mul_f32 v126, s74, v126
v_mfma_f32_16x16x32_bf16 v[232:235], v[32:35], a[188:191], v[232:235]
v_mul_f32 v127, s74, v127
v_mfma_f32_16x16x32_bf16 v[236:239], v[32:35], a[252:255], v[236:239]
s_waitcnt lgkmcnt(5)
v_mfma_f32_16x16x32_bf16 v[240:243], v[36:39], a[60:63], v[240:243]
v_cvt_pk_bf16_f32 v54, v124, v125
v_mfma_f32_16x16x32_bf16 v[244:247], v[36:39], a[124:127], v[244:247]
v_cvt_pk_bf16_f32 v55, v126, v127
v_mfma_f32_16x16x32_bf16 v[248:251], v[36:39], a[188:191], v[248:251]
ds_write_b128 v14, v[52:55] offset:10496
v_mfma_f32_16x16x32_bf16 v[252:255], v[36:39], a[252:255], v[252:255]
s_add_u32 s23, s73, 8192
buffer_store_dwordx4 v[52:55], v15, s[32:35], s23 offen offset:2304
s_waitcnt lgkmcnt(3)
v_mfma_f32_16x16x32_bf16 v[128:131], v[40:43], a[60:63], v[128:131]
v_mfma_f32_16x16x32_bf16 v[132:135], v[40:43], a[124:127], v[132:135]
v_mfma_f32_16x16x32_bf16 v[136:139], v[40:43], a[188:191], v[136:139]
v_mfma_f32_16x16x32_bf16 v[140:143], v[40:43], a[252:255], v[140:143]
s_waitcnt lgkmcnt(1)
v_mfma_f32_16x16x32_bf16 v[144:147], v[44:47], a[60:63], v[144:147]
v_mfma_f32_16x16x32_bf16 v[148:151], v[44:47], a[124:127], v[148:151]
v_mfma_f32_16x16x32_bf16 v[152:155], v[44:47], a[188:191], v[152:155]
v_mfma_f32_16x16x32_bf16 v[156:159], v[44:47], a[252:255], v[156:159]
v_mul_f32 v224, s74, v224
v_mul_f32 v225, s74, v225
v_mul_f32 v226, s74, v226
v_mul_f32 v227, s74, v227
v_cvt_pk_bf16_f32 v48, v224, v225
v_cvt_pk_bf16_f32 v49, v226, v227
v_mul_f32 v240, s74, v240
v_mul_f32 v241, s74, v241
v_mul_f32 v242, s74, v242
v_mul_f32 v243, s74, v243
v_cvt_pk_bf16_f32 v50, v240, v241
v_cvt_pk_bf16_f32 v51, v242, v243
ds_write_b128 v14, v[48:51] offset:4096
s_add_u32 s23, s73, 4096
buffer_store_dwordx4 v[48:51], v15, s[32:35], s23 offen offset:0
v_mul_f32 v128, s74, v128
v_mul_f32 v129, s74, v129
v_mul_f32 v130, s74, v130
v_mul_f32 v131, s74, v131
v_cvt_pk_bf16_f32 v52, v128, v129
v_cvt_pk_bf16_f32 v53, v130, v131
v_mul_f32 v144, s74, v144
v_mul_f32 v145, s74, v145
v_mul_f32 v146, s74, v146
v_mul_f32 v147, s74, v147
v_cvt_pk_bf16_f32 v54, v144, v145
v_cvt_pk_bf16_f32 v55, v146, v147
ds_write_b128 v14, v[52:55] offset:6144
s_add_u32 s23, s73, 4096
buffer_store_dwordx4 v[52:55], v15, s[32:35], s23 offen offset:2048
v_mul_f32 v228, s74, v228
v_mul_f32 v229, s74, v229
v_mul_f32 v230, s74, v230
v_mul_f32 v231, s74, v231
v_cvt_pk_bf16_f32 v56, v228, v229
v_cvt_pk_bf16_f32 v57, v230, v231
v_mul_f32 v244, s74, v244
v_mul_f32 v245, s74, v245
v_mul_f32 v246, s74, v246
v_mul_f32 v247, s74, v247
v_cvt_pk_bf16_f32 v58, v244, v245
v_cvt_pk_bf16_f32 v59, v246, v247
ds_write_b128 v14, v[56:59] offset:4352
s_add_u32 s23, s73, 4096
buffer_store_dwordx4 v[56:59], v15, s[32:35], s23 offen offset:256
v_mul_f32 v132, s74, v132
v_mul_f32 v133, s74, v133
v_mul_f32 v134, s74, v134
v_mul_f32 v135, s74, v135
v_cvt_pk_bf16_f32 v48, v132, v133
v_cvt_pk_bf16_f32 v49, v134, v135
v_mul_f32 v148, s74, v148
v_mul_f32 v149, s74, v149
v_mul_f32 v150, s74, v150
v_mul_f32 v151, s74, v151
v_cvt_pk_bf16_f32 v50, v148, v149
v_cvt_pk_bf16_f32 v51, v150, v151
ds_write_b128 v14, v[48:51] offset:6400
s_add_u32 s23, s73, 4096
buffer_store_dwordx4 v[48:51], v15, s[32:35], s23 offen offset:2304
v_mul_f32 v232, s74, v232
v_mul_f32 v233, s74, v233
v_mul_f32 v234, s74, v234
v_mul_f32 v235, s74, v235
v_cvt_pk_bf16_f32 v52, v232, v233
v_cvt_pk_bf16_f32 v53, v234, v235
v_mul_f32 v248, s74, v248
v_mul_f32 v249, s74, v249
v_mul_f32 v250, s74, v250
v_mul_f32 v251, s74, v251
v_cvt_pk_bf16_f32 v54, v248, v249
v_cvt_pk_bf16_f32 v55, v250, v251
ds_write_b128 v14, v[52:55] offset:12288
s_add_u32 s23, s73, 12288
buffer_store_dwordx4 v[52:55], v15, s[32:35], s23 offen offset:0
v_mul_f32 v136, s74, v136
v_mul_f32 v137, s74, v137
v_mul_f32 v138, s74, v138
v_mul_f32 v139, s74, v139
v_cvt_pk_bf16_f32 v56, v136, v137
v_cvt_pk_bf16_f32 v57, v138, v139
v_mul_f32 v152, s74, v152
v_mul_f32 v153, s74, v153
v_mul_f32 v154, s74, v154
v_mul_f32 v155, s74, v155
v_cvt_pk_bf16_f32 v58, v152, v153
v_cvt_pk_bf16_f32 v59, v154, v155
ds_write_b128 v14, v[56:59] offset:14336
s_add_u32 s23, s73, 12288
buffer_store_dwordx4 v[56:59], v15, s[32:35], s23 offen offset:2048
v_mul_f32 v236, s74, v236
v_mul_f32 v237, s74, v237
v_mul_f32 v238, s74, v238
v_mul_f32 v239, s74, v239
v_cvt_pk_bf16_f32 v48, v236, v237
v_cvt_pk_bf16_f32 v49, v238, v239
v_mul_f32 v252, s74, v252
v_mul_f32 v253, s74, v253
v_mul_f32 v254, s74, v254
v_mul_f32 v255, s74, v255
v_cvt_pk_bf16_f32 v50, v252, v253
v_cvt_pk_bf16_f32 v51, v254, v255
ds_write_b128 v14, v[48:51] offset:12544
s_add_u32 s23, s73, 12288
buffer_store_dwordx4 v[48:51], v15, s[32:35], s23 offen offset:256
v_mul_f32 v140, s74, v140
v_mul_f32 v141, s74, v141
v_mul_f32 v142, s74, v142
v_mul_f32 v143, s74, v143
v_cvt_pk_bf16_f32 v52, v140, v141
v_cvt_pk_bf16_f32 v53, v142, v143
v_mul_f32 v156, s74, v156
v_mul_f32 v157, s74, v157
v_mul_f32 v158, s74, v158
v_mul_f32 v159, s74, v159
v_cvt_pk_bf16_f32 v54, v156, v157
v_cvt_pk_bf16_f32 v55, v158, v159
ds_write_b128 v14, v[52:55] offset:14592
s_add_u32 s23, s73, 12288
buffer_store_dwordx4 v[52:55], v15, s[32:35], s23 offen offset:2304
s_waitcnt vmcnt(8) lgkmcnt(0)
s_barrier
s_lshl_b32 s23, s18, 14
s_add_u32 s23, s23, 32768
s_lshl_b32 s3, s19, 13
s_add_u32 s54, s23, s3
v_add_u32 v8, s54, v7
v_xor_b32 v9, 0x2000, v8
v_mov_b32 v2, v4
ds_read_b128 a[128:131], v8 offset:0
ds_read_b128 a[132:135], v8 offset:1024
ds_read_b128 a[136:139], v8 offset:2048
ds_read_b128 a[140:143], v8 offset:3072
ds_read_b128 a[144:147], v8 offset:4096
ds_read_b128 a[148:151], v8 offset:5120
ds_read_b128 a[152:155], v8 offset:6144
ds_read_b128 a[156:159], v8 offset:7168
ds_read_b128 a[160:163], v9 offset:0
ds_read_b128 a[164:167], v9 offset:1024
ds_read_b128 a[168:171], v9 offset:2048
ds_read_b128 a[172:175], v9 offset:3072
ds_read_b128 a[176:179], v9 offset:4096
ds_read_b128 a[180:183], v9 offset:5120
ds_read_b128 a[184:187], v9 offset:6144
ds_read_b128 a[188:191], v9 offset:7168
ds_read_b128 a[192:195], v2 offset:0
ds_read_b128 a[196:199], v2 offset:1024
ds_read_b128 a[200:203], v2 offset:2048
ds_read_b128 a[204:207], v2 offset:3072
ds_read_b128 a[208:211], v2 offset:4096
ds_read_b128 a[212:215], v2 offset:5120
ds_read_b128 a[216:219], v2 offset:6144
ds_read_b128 a[220:223], v2 offset:7168
v_and_b32 v8, 31, v1
v_lshrrev_b32 v9, 5, v1
v_lshlrev_b32 v9, 2, v9
v_sub_u32 v8, v8, v9
s_lshl_b32 s23, s18, 6
v_add_u32 v238, s23, v8
s_lshl_b32 s3, s19, 6
s_sub_u32 s23, s23, s3
s_add_u32 s23, s23, 32
v_add_u32 v239, s23, v8
s_mov_b32 s74, s22
s_mov_b32 s75, 0
s_mov_b32 s56, 0
s_lshl_b32 s23, s19, 13
v_add_u32 v10, s23, v7
v_xor_b32 v11, 0x2000, v10
s_lshl_b32 s73, s2, 15
s_lshl_b32 s23, s18, 14
s_add_u32 s73, s73, s23
s_lshl_b32 s23, s20, 13
s_add_u32 s23, s23, 0x20000
v_add_u32 v12, s23, v7
v_xor_b32 v13, 0x4000, v12
v_lshlrev_b32 v14, 3, v1
s_lshl_b32 s23, s20, 9
s_add_u32 s23, s23, 0x10000
v_add_u32 v14, s23, v14
v_bfe_u32 v8, v1, 4, 1
s_mov_b32 s23, 175104
v_mul_lo_u32 v15, v8, s23
v_lshrrev_b32 v8, 5, v1
v_lshl_add_u32 v15, v8, 8, v15
v_and_b32 v8, 15, v1
v_lshl_add_u32 v15, v8, 4, v15
v_mov_b32 v233, 0xf149f2ca
v_mov_b32 v60, s66
v_mov_b32 v240, 0
v_mov_b32 v241, 0
v_mov_b32 v242, 0
v_mov_b32 v243, 0
s_add_u32 s4, s96, 104857600
s_addc_u32 s5, s97, 0
s_waitcnt lgkmcnt(0)
s_barrier
s_add_u32 m0, s62, 32768
s_nop 0
buffer_load_dwordx4 v6, s[28:31], s58 offen offset:0 sc1 lds
buffer_load_dwordx4 v6, s[28:31], s58 offen offset:1024 sc1 lds
buffer_load_dwordx4 v6, s[28:31], s58 offen offset:2048 sc1 lds
buffer_load_dwordx4 v6, s[28:31], s58 offen offset:3072 sc1 lds
s_add_u32 s58, s58, 32768
s_cmp_eq_u32 s58, s60
s_cselect_b32 s58, 0, s58
s_cselect_b32 s60, -1, s60
s_add_u32 m0, s62, 49152
s_nop 0
buffer_load_dwordx4 v6, s[28:31], s58 offen offset:0 sc1 lds
buffer_load_dwordx4 v6, s[28:31], s58 offen offset:1024 sc1 lds
buffer_load_dwordx4 v6, s[28:31], s58 offen offset:2048 sc1 lds
buffer_load_dwordx4 v6, s[28:31], s58 offen offset:3072 sc1 lds
s_add_u32 s58, s58, 32768
s_cmp_eq_u32 s58, s60
s_cselect_b32 s58, 0, s58
s_cselect_b32 s60, -1, s60
s_lshr_b32 s3, s2, 3
s_lshl_b32 s3, s3, 2
s_add_u32 s3, s3, s20
s_bfe_u32 s23, s2, 0x20001
s_mul_i32 s68, s3, 2816
s_mul_i32 s69, s23, 360448
s_add_u32 s68, s68, s69
s_lshl_b32 s69, s23, 20
s_lshl_b32 s3, s3, 13
s_add_u32 s69, s69, s3
v_lshlrev_b32 v17, 7, v1
v_min_u32 v16, 2688, v17
QBLK:
s_lshl_b32 s23, s74, 7
v_add_u32 v234, s23, v238
v_add_u32 v235, s23, v239
s_add_u32 s67, s23, 0
s_add_u32 s57, s56, 16384
s_and_b32 s57, s57, 0xffff
v_add_u32 v2, s57, v4
v_add_u32 v3, s56, v5
s_cmp_eq_u32 s74, 0
s_cbranch_scc1 HEADM
s_waitcnt vmcnt(8)
s_barrier
v_mfma_f32_32x32x16_bf16 v[64:79], a[192:195], a[128:131], 0
v_mov_b32 v230, 0
v_mov_b32 v231, 0
s_xor_b32 s23, s56, 32768
s_add_u32 m0, s23, s63
v_mfma_f32_32x32x16_bf16 v[80:95], a[192:195], a[160:163], 0
ds_read_b128 a[192:195], v2 offset:0
v_mfma_f32_32x32x16_bf16 v[64:79], a[196:199], a[132:135], v[64:79]
buffer_load_dwordx4 v6, s[28:31], s59 offen offset:0 sc1 lds
v_mfma_f32_32x32x16_bf16 v[80:95], a[196:199], a[164:167], v[80:95]
ds_read_b128 a[196:199], v2 offset:1024
buffer_load_dwordx4 v6, s[28:31], s59 offen offset:1024 sc1 lds
v_mfma_f32_32x32x16_bf16 v[64:79], a[200:203], a[136:139], v[64:79]
v_mfma_f32_32x32x16_bf16 v[80:95], a[200:203], a[168:171], v[80:95]
buffer_load_dwordx4 v6, s[28:31], s59 offen offset:2048 sc1 lds
ds_read_b128 a[200:203], v2 offset:2048
v_mfma_f32_32x32x16_bf16 v[64:79], a[204:207], a[140:143], v[64:79]
buffer_load_dwordx4 v6, s[28:31], s59 offen offset:3072 sc1 lds
s_add_u32 s59, s59, 32768
s_cmp_eq_u32 s59, s61
s_cselect_b32 s59, 8192, s59
s_cselect_b32 s61, -1, s61
v_mfma_f32_32x32x16_bf16 v[80:95], a[204:207], a[172:175], v[80:95]
ds_read_b128 a[204:207], v2 offset:3072
v_mfma_f32_32x32x16_bf16 v[64:79], a[208:211], a[144:147], v[64:79]
s_add_u32 m0, s56, s62
v_mfma_f32_32x32x16_bf16 v[80:95], a[208:211], a[176:179], v[80:95]
ds_read_b128 a[208:211], v2 offset:4096
buffer_load_dwordx4 v6, s[28:31], s58 offen offset:0 sc1 lds
v_mfma_f32_32x32x16_bf16 v[64:79], a[212:215], a[148:151], v[64:79]
v_mfma_f32_32x32x16_bf16 v[80:95], a[212:215], a[180:183], v[80:95]
buffer_load_dwordx4 v6, s[28:31], s58 offen offset:1024 sc1 lds
ds_read_b128 a[212:215], v2 offset:5120
v_mfma_f32_32x32x16_bf16 v[64:79], a[216:219], a[152:155], v[64:79]
buffer_load_dwordx4 v6, s[28:31], s58 offen offset:2048 sc1 lds
v_mfma_f32_32x32x16_bf16 v[64:79], a[220:223], a[156:159], v[64:79]
v_mfma_f32_32x32x16_bf16 v[80:95], a[216:219], a[184:187], v[80:95]
buffer_load_dwordx4 v6, s[28:31], s58 offen offset:3072 sc1 lds
s_add_u32 s58, s58, 32768
s_cmp_eq_u32 s58, s60
s_cselect_b32 s58, 0, s58
s_cselect_b32 s60, -1, s60
ds_read_b128 a[216:219], v2 offset:6144
v_mfma_f32_32x32x16_bf16 v[80:95], a[220:223], a[188:191], v[80:95]
ds_read_b128 a[220:223], v2 offset:7168
v_mfma_f32_32x32x16_bf16 a[0:15], v[240:243], v[240:243], 0
s_nop 1
v_max3_f32 v228, v64, v65, v66
v_max3_f32 v228, v228, v67, v68
v_max3_f32 v228, v228, v69, v70
v_max3_f32 v228, v228, v71, v72
v_mfma_f32_32x32x16_bf16 a[16:31], v[240:243], v[240:243], 0
v_max3_f32 v228, v228, v73, v74
v_max3_f32 v228, v228, v75, v76
v_max3_f32 v228, v228, v77, v78
v_max_f32 v228, v228, v79
v_mfma_f32_32x32x16_bf16 a[32:47], v[240:243], v[240:243], 0
v_max3_f32 v229, v80, v81, v82
v_max3_f32 v229, v229, v83, v84
v_max3_f32 v229, v229, v85, v86
v_max3_f32 v229, v229, v87, v88
v_max3_f32 v229, v229, v89, v90
v_mfma_f32_32x32x16_bf16 a[48:63], v[240:243], v[240:243], 0
v_max3_f32 v229, v229, v91, v92
v_max3_f32 v229, v229, v93, v94
v_max_f32 v229, v229, v95
v_mov_b32 v224, v228
v_mov_b32 v225, v229
v_mfma_f32_32x32x16_bf16 a[64:79], v[240:243], v[240:243], 0
v_permlane32_swap_b32 v228, v224
v_permlane32_swap_b32 v229, v225
v_max_f32 v228, v228, v224
v_max_f32 v229, v229, v225
v_mfma_f32_32x32x16_bf16 a[80:95], v[240:243], v[240:243], 0
v_sub_f32 v160, 0, v228
v_sub_f32 v161, 0, v228
v_sub_f32 v162, 0, v228
v_sub_f32 v163, 0, v228
v_sub_f32 v164, 0, v228
v_sub_f32 v165, 0, v228
v_sub_f32 v166, 0, v228
v_sub_f32 v167, 0, v228
v_sub_f32 v168, 0, v228
v_sub_f32 v169, 0, v228
v_sub_f32 v170, 0, v228
v_mfma_f32_32x32x16_bf16 a[96:111], v[240:243], v[240:243], 0
v_sub_f32 v171, 0, v228
v_sub_f32 v172, 0, v228
v_sub_f32 v173, 0, v228
v_sub_f32 v174, 0, v228
v_sub_f32 v175, 0, v228
v_sub_f32 v176, 0, v229
v_sub_f32 v177, 0, v229
v_sub_f32 v178, 0, v229
v_sub_f32 v179, 0, v229
v_sub_f32 v180, 0, v229
v_sub_f32 v181, 0, v229
v_mfma_f32_32x32x16_bf16 a[112:127], v[240:243], v[240:243], 0
v_sub_f32 v182, 0, v229
v_sub_f32 v183, 0, v229
v_sub_f32 v184, 0, v229
v_sub_f32 v185, 0, v229
v_sub_f32 v186, 0, v229
v_sub_f32 v187, 0, v229
v_sub_f32 v188, 0, v229
v_sub_f32 v189, 0, v229
v_sub_f32 v190, 0, v229
v_sub_f32 v191, 0, v229
s_waitcnt lgkmcnt(7)
v_mfma_f32_32x32x16_bf16 v[96:111], a[192:195], a[128:131], v[160:175]
v_add_f32 v64, v64, v160
v_add_f32 v65, v65, v160
v_exp_f32 v192, v64
v_add_f32 v66, v66, v160
v_mfma_f32_32x32x16_bf16 v[112:127], a[192:195], a[160:163], v[176:191]
v_add_f32 v67, v67, v160
v_exp_f32 v193, v65
v_add_f32 v68, v68, v160
v_exp_f32 v194, v66
ds_read_b128 a[224:227], v3 offset:0
v_add_f32 v228, v192, v193
s_waitcnt lgkmcnt(7)
v_mfma_f32_32x32x16_bf16 v[96:111], a[196:199], a[132:135], v[96:111]
v_add_f32 v69, v69, v160
v_exp_f32 v195, v67
v_add_f32 v228, v228, v194
v_add_f32 v70, v70, v160
v_exp_f32 v196, v68
v_add_f32 v228, v228, v195
v_add_f32 v71, v71, v160
v_mfma_f32_32x32x16_bf16 v[112:127], a[196:199], a[164:167], v[112:127]
v_exp_f32 v197, v69
v_add_f32 v80, v80, v176
v_add_f32 v228, v228, v196
v_exp_f32 v198, v70
ds_read_b128 a[228:231], v3 offset:1024
v_add_f32 v81, v81, v176
v_add_f32 v228, v228, v197
v_exp_f32 v199, v71
v_add_f32 v82, v82, v176
s_waitcnt lgkmcnt(7)
v_mfma_f32_32x32x16_bf16 v[96:111], a[200:203], a[136:139], v[96:111]
v_cvt_pk_bf16_f32 v128, v192, v193
v_add_f32 v228, v228, v198
v_exp_f32 v208, v80
v_add_f32 v83, v83, v176
v_add_f32 v228, v228, v199
v_add_f32 v84, v84, v176
v_exp_f32 v209, v81
v_cvt_pk_bf16_f32 v129, v194, v195
v_mfma_f32_32x32x16_bf16 v[112:127], a[200:203], a[168:171], v[112:127]
ds_read_b128 a[232:235], v3 offset:2048
v_add_f32 v85, v85, v176
v_exp_f32 v210, v82
v_add_f32 v229, v208, v209
v_add_f32 v86, v86, v176
v_exp_f32 v211, v83
v_cvt_pk_bf16_f32 v130, v196, v197
v_add_f32 v229, v229, v210
v_add_f32 v87, v87, v176
v_exp_f32 v212, v84
s_waitcnt lgkmcnt(7)
v_mfma_f32_32x32x16_bf16 v[96:111], a[204:207], a[140:143], v[96:111]
v_add_f32 v229, v229, v211
v_add_f32 v72, v72, v160
v_exp_f32 v213, v85
v_add_f32 v73, v73, v160
v_cvt_pk_bf16_f32 v131, v198, v199
v_add_f32 v229, v229, v212
ds_read_b128 a[236:239], v3 offset:3072
v_exp_f32 v214, v86
v_add_f32 v74, v74, v160
v_mfma_f32_32x32x16_bf16 v[112:127], a[204:207], a[172:175], v[112:127]
v_add_f32 v229, v229, v213
v_exp_f32 v215, v87
v_add_f32 v75, v75, v160
v_cvt_pk_bf16_f32 v136, v208, v209
v_add_f32 v229, v229, v214
v_exp_f32 v200, v72
v_add_f32 v76, v76, v160
v_add_f32 v229, v229, v215
s_waitcnt lgkmcnt(7)
v_mfma_f32_32x32x16_bf16 v[96:111], a[208:211], a[144:147], v[96:111]
v_add_f32 v77, v77, v160
v_exp_f32 v201, v73
v_cvt_pk_bf16_f32 v137, v210, v211
v_add_f32 v228, v228, v200
ds_read_b128 a[240:243], v3 offset:4096
v_add_f32 v78, v78, v160
v_exp_f32 v202, v74
v_add_f32 v228, v228, v201
v_add_f32 v79, v79, v160
v_exp_f32 v203, v75
v_mfma_f32_32x32x16_bf16 v[112:127], a[208:211], a[176:179], v[112:127]
v_cvt_pk_bf16_f32 v138, v212, v213
v_add_f32 v228, v228, v202
v_add_f32 v88, v88, v176
v_exp_f32 v204, v76
v_add_f32 v228, v228, v203
v_add_f32 v89, v89, v176
v_exp_f32 v205, v77
ds_read_b128 a[244:247], v3 offset:5120
v_add_f32 v90, v90, v176
v_cvt_pk_bf16_f32 v139, v214, v215
v_add_f32 v228, v228, v204
s_waitcnt lgkmcnt(8)
v_mfma_f32_32x32x16_bf16 v[96:111], a[212:215], a[148:151], v[96:111]
v_exp_f32 v206, v78
v_add_f32 v91, v91, v176
v_add_f32 v228, v228, v205
v_exp_f32 v207, v79
v_add_f32 v92, v92, v176
v_add_f32 v228, v228, v206
v_mfma_f32_32x32x16_bf16 v[112:127], a[212:215], a[180:183], v[112:127]
v_exp_f32 v216, v88
v_add_f32 v93, v93, v176
v_add_f32 v228, v228, v207
v_add_f32 v94, v94, v176
v_exp_f32 v217, v89
ds_read_b128 a[248:251], v3 offset:6144
v_add_f32 v229, v229, v216
v_add_f32 v95, v95, v176
v_exp_f32 v218, v90
s_waitcnt lgkmcnt(8)
v_mfma_f32_32x32x16_bf16 v[96:111], a[216:219], a[152:155], v[96:111]
v_add_f32 v229, v229, v217
v_exp_f32 v219, v91
v_add_f32 v229, v229, v218
v_exp_f32 v220, v92
v_add_f32 v229, v229, v219
s_waitcnt lgkmcnt(7)
v_mfma_f32_32x32x16_bf16 v[96:111], a[220:223], a[156:159], v[96:111]
v_exp_f32 v221, v93
ds_read_b128 a[252:255], v3 offset:7168
v_add_f32 v229, v229, v220
v_exp_f32 v222, v94
v_add_f32 v229, v229, v221
v_exp_f32 v223, v95
v_mfma_f32_32x32x16_bf16 v[112:127], a[216:219], a[184:187], v[112:127]
v_add_f32 v229, v229, v222
v_add_f32 v229, v229, v223
v_max_f32 v232, v228, v229
v_mfma_f32_32x32x16_bf16 v[112:127], a[220:223], a[188:191], v[112:127]
v_cmp_lt_f32 vcc, s64, v232
s_waitcnt lgkmcnt(0)
s_cbranch_vccnz RX_hn
RR_hn:
s_branch HEADX
HEADM:
v_mov_b32 v236, v234
v_mov_b32 v237, v235
v_cmp_le_i32 s[88:89], 0, v236
v_cmp_le_i32 s[90:91], 1, v236
v_cmp_le_i32 s[92:93], 2, v236
v_cmp_le_i32 s[94:95], 3, v236
v_cndmask_b32 v64, v233, 0, s[88:89]
v_cndmask_b32 v65, v233, 0, s[90:91]
v_cmp_le_i32 s[88:89], 8, v236
v_cmp_le_i32 s[90:91], 9, v236
v_cndmask_b32 v66, v233, 0, s[92:93]
v_cndmask_b32 v67, v233, 0, s[94:95]
v_cmp_le_i32 s[92:93], 10, v236
v_cmp_le_i32 s[94:95], 11, v236
v_cndmask_b32 v68, v233, 0, s[88:89]
v_cndmask_b32 v69, v233, 0, s[90:91]
v_cmp_le_i32 s[88:89], 16, v236
v_cmp_le_i32 s[90:91], 17, v236
v_cndmask_b32 v70, v233, 0, s[92:93]
v_cndmask_b32 v71, v233, 0, s[94:95]
v_cmp_le_i32 s[92:93], 18, v236
v_cmp_le_i32 s[94:95], 19, v236
v_cndmask_b32 v72, v233, 0, s[88:89]
v_cndmask_b32 v73, v233, 0, s[90:91]
v_cmp_le_i32 s[88:89], 24, v236
v_cmp_le_i32 s[90:91], 25, v236
v_cndmask_b32 v74, v233, 0, s[92:93]
v_cndmask_b32 v75, v233, 0, s[94:95]
v_cmp_le_i32 s[92:93], 26, v236
v_cmp_le_i32 s[94:95], 27, v236
v_cndmask_b32 v76, v233, 0, s[88:89]
v_cndmask_b32 v77, v233, 0, s[90:91]
v_cmp_le_i32 s[88:89], 0, v237
v_cmp_le_i32 s[90:91], 1, v237
v_cndmask_b32 v78, v233, 0, s[92:93]
v_cndmask_b32 v79, v233, 0, s[94:95]
v_cmp_le_i32 s[92:93], 2, v237
v_cmp_le_i32 s[94:95], 3, v237
v_cndmask_b32 v80, v233, 0, s[88:89]
v_cndmask_b32 v81, v233, 0, s[90:91]
v_cmp_le_i32 s[88:89], 8, v237
v_cmp_le_i32 s[90:91], 9, v237
v_cndmask_b32 v82, v233, 0, s[92:93]
v_cndmask_b32 v83, v233, 0, s[94:95]
v_cmp_le_i32 s[92:93], 10, v237
v_cmp_le_i32 s[94:95], 11, v237
v_cndmask_b32 v84, v233, 0, s[88:89]
v_cndmask_b32 v85, v233, 0, s[90:91]
v_cmp_le_i32 s[88:89], 16, v237
v_cmp_le_i32 s[90:91], 17, v237
v_cndmask_b32 v86, v233, 0, s[92:93]
v_cndmask_b32 v87, v233, 0, s[94:95]
v_cmp_le_i32 s[92:93], 18, v237
v_cmp_le_i32 s[94:95], 19, v237
v_cndmask_b32 v88, v233, 0, s[88:89]
v_cndmask_b32 v89, v233, 0, s[90:91]
v_cmp_le_i32 s[88:89], 24, v237
v_cmp_le_i32 s[90:91], 25, v237
v_cndmask_b32 v90, v233, 0, s[92:93]
v_cndmask_b32 v91, v233, 0, s[94:95]
v_cmp_le_i32 s[92:93], 26, v237
v_cmp_le_i32 s[94:95], 27, v237
v_cndmask_b32 v92, v233, 0, s[88:89]
v_cndmask_b32 v93, v233, 0, s[90:91]
v_cndmask_b32 v94, v233, 0, s[92:93]
v_cndmask_b32 v95, v233, 0, s[94:95]
v_subrev_u32 v236, 64, v234
v_subrev_u32 v237, 64, v235
s_waitcnt vmcnt(8)
s_barrier
v_mfma_f32_32x32x16_bf16 v[64:79], a[192:195], a[128:131], v[64:79]
v_accvgpr_write_b32 a0, 0
v_cmp_le_i32 s[88:89], 0, v236
v_cmp_le_i32 s[90:91], 1, v236
v_accvgpr_write_b32 a1, 0
v_accvgpr_write_b32 a2, 0
v_cmp_le_i32 s[92:93], 2, v236
v_cmp_le_i32 s[94:95], 3, v236
v_accvgpr_write_b32 a3, 0
v_mfma_f32_32x32x16_bf16 v[80:95], a[192:195], a[160:163], v[80:95]
v_accvgpr_write_b32 a4, 0
v_cndmask_b32 v96, v233, 0, s[88:89]
v_cndmask_b32 v97, v233, 0, s[90:91]
v_accvgpr_write_b32 a5, 0
ds_read_b128 a[192:195], v2 offset:0
v_accvgpr_write_b32 a6, 0
v_cmp_le_i32 s[88:89], 8, v236
v_cmp_le_i32 s[90:91], 9, v236
v_accvgpr_write_b32 a7, 0
v_mfma_f32_32x32x16_bf16 v[64:79], a[196:199], a[132:135], v[64:79]
v_accvgpr_write_b32 a8, 0
v_cndmask_b32 v98, v233, 0, s[92:93]
v_cndmask_b32 v99, v233, 0, s[94:95]
v_accvgpr_write_b32 a9, 0
s_xor_b32 s23, s56, 32768
s_add_u32 m0, s23, s63
v_accvgpr_write_b32 a10, 0
v_cmp_le_i32 s[92:93], 10, v236
v_cmp_le_i32 s[94:95], 11, v236
v_accvgpr_write_b32 a11, 0
v_mfma_f32_32x32x16_bf16 v[80:95], a[196:199], a[164:167], v[80:95]
v_accvgpr_write_b32 a12, 0
v_cndmask_b32 v100, v233, 0, s[88:89]
v_cndmask_b32 v101, v233, 0, s[90:91]
v_accvgpr_write_b32 a13, 0
ds_read_b128 a[196:199], v2 offset:1024
v_accvgpr_write_b32 a14, 0
v_cmp_le_i32 s[88:89], 16, v236
v_cmp_le_i32 s[90:91], 17, v236
v_accvgpr_write_b32 a15, 0
v_mfma_f32_32x32x16_bf16 v[64:79], a[200:203], a[136:139], v[64:79]
v_accvgpr_write_b32 a16, 0
v_cndmask_b32 v102, v233, 0, s[92:93]
v_cndmask_b32 v103, v233, 0, s[94:95]
v_accvgpr_write_b32 a17, 0
v_accvgpr_write_b32 a18, 0
v_cmp_le_i32 s[92:93], 18, v236
v_cmp_le_i32 s[94:95], 19, v236
v_accvgpr_write_b32 a19, 0
v_mfma_f32_32x32x16_bf16 v[80:95], a[200:203], a[168:171], v[80:95]
v_accvgpr_write_b32 a20, 0
v_cndmask_b32 v104, v233, 0, s[88:89]
v_cndmask_b32 v105, v233, 0, s[90:91]
buffer_load_dwordx4 v6, s[28:31], s59 offen offset:0 sc1 lds
v_accvgpr_write_b32 a21, 0
ds_read_b128 a[200:203], v2 offset:2048
v_accvgpr_write_b32 a22, 0
v_cmp_le_i32 s[88:89], 24, v236
v_cmp_le_i32 s[90:91], 25, v236
v_accvgpr_write_b32 a23, 0
v_mfma_f32_32x32x16_bf16 v[64:79], a[204:207], a[140:143], v[64:79]
v_accvgpr_write_b32 a24, 0
v_cndmask_b32 v106, v233, 0, s[92:93]
v_cndmask_b32 v107, v233, 0, s[94:95]
v_accvgpr_write_b32 a25, 0
v_accvgpr_write_b32 a26, 0
v_cmp_le_i32 s[92:93], 26, v236
v_cmp_le_i32 s[94:95], 27, v236
v_accvgpr_write_b32 a27, 0
v_mfma_f32_32x32x16_bf16 v[80:95], a[204:207], a[172:175], v[80:95]
v_accvgpr_write_b32 a28, 0
v_cndmask_b32 v108, v233, 0, s[88:89]
v_cndmask_b32 v109, v233, 0, s[90:91]
v_accvgpr_write_b32 a29, 0
ds_read_b128 a[204:207], v2 offset:3072
v_accvgpr_write_b32 a30, 0
v_cmp_le_i32 s[88:89], 0, v237
v_cmp_le_i32 s[90:91], 1, v237
v_accvgpr_write_b32 a31, 0
v_mfma_f32_32x32x16_bf16 v[64:79], a[208:211], a[144:147], v[64:79]
v_accvgpr_write_b32 a32, 0
v_cndmask_b32 v110, v233, 0, s[92:93]
v_cndmask_b32 v111, v233, 0, s[94:95]
buffer_load_dwordx4 v6, s[28:31], s59 offen offset:1024 sc1 lds
v_accvgpr_write_b32 a33, 0
v_accvgpr_write_b32 a34, 0
v_cmp_le_i32 s[92:93], 2, v237
v_cmp_le_i32 s[94:95], 3, v237
v_accvgpr_write_b32 a35, 0
v_mfma_f32_32x32x16_bf16 v[80:95], a[208:211], a[176:179], v[80:95]
v_accvgpr_write_b32 a36, 0
v_cndmask_b32 v112, v233, 0, s[88:89]
v_cndmask_b32 v113, v233, 0, s[90:91]
v_accvgpr_write_b32 a37, 0
ds_read_b128 a[208:211], v2 offset:4096
v_accvgpr_write_b32 a38, 0
v_cmp_le_i32 s[88:89], 8, v237
v_cmp_le_i32 s[90:91], 9, v237
v_accvgpr_write_b32 a39, 0
v_mfma_f32_32x32x16_bf16 v[64:79], a[212:215], a[148:151], v[64:79]
v_accvgpr_write_b32 a40, 0
v_cndmask_b32 v114, v233, 0, s[92:93]
v_cndmask_b32 v115, v233, 0, s[94:95]
v_accvgpr_write_b32 a41, 0
v_accvgpr_write_b32 a42, 0
v_cmp_le_i32 s[92:93], 10, v237
v_cmp_le_i32 s[94:95], 11, v237
v_accvgpr_write_b32 a43, 0
v_mfma_f32_32x32x16_bf16 v[80:95], a[212:215], a[180:183], v[80:95]
v_accvgpr_write_b32 a44, 0
buffer_load_dwordx4 v6, s[28:31], s59 offen offset:2048 sc1 lds
v_cndmask_b32 v116, v233, 0, s[88:89]
v_cndmask_b32 v117, v233, 0, s[90:91]
v_accvgpr_write_b32 a45, 0
ds_read_b128 a[212:215], v2 offset:5120
v_accvgpr_write_b32 a46, 0
v_cmp_le_i32 s[88:89], 16, v237
v_cmp_le_i32 s[90:91], 17, v237
v_accvgpr_write_b32 a47, 0
v_mfma_f32_32x32x16_bf16 v[64:79], a[216:219], a[152:155], v[64:79]
v_accvgpr_write_b32 a48, 0
v_cndmask_b32 v118, v233, 0, s[92:93]
v_cndmask_b32 v119, v233, 0, s[94:95]
v_accvgpr_write_b32 a49, 0
v_accvgpr_write_b32 a50, 0
v_cmp_le_i32 s[92:93], 18, v237
v_cmp_le_i32 s[94:95], 19, v237
v_accvgpr_write_b32 a51, 0
v_mfma_f32_32x32x16_bf16 v[64:79], a[220:223], a[156:159], v[64:79]
v_accvgpr_write_b32 a52, 0
v_cndmask_b32 v120, v233, 0, s[88:89]
v_cndmask_b32 v121, v233, 0, s[90:91]
v_accvgpr_write_b32 a53, 0
v_accvgpr_write_b32 a54, 0
v_cmp_le_i32 s[88:89], 24, v237
v_cmp_le_i32 s[90:91], 25, v237
v_accvgpr_write_b32 a55, 0
v_mfma_f32_32x32x16_bf16 v[80:95], a[216:219], a[184:187], v[80:95]
buffer_load_dwordx4 v6, s[28:31], s59 offen offset:3072 sc1 lds
s_add_u32 s59, s59, 32768
s_cmp_eq_u32 s59, s61
s_cselect_b32 s59, 8192, s59
s_cselect_b32 s61, -1, s61
v_accvgpr_write_b32 a56, 0
v_cndmask_b32 v122, v233, 0, s[92:93]
v_cndmask_b32 v123, v233, 0, s[94:95]
v_accvgpr_write_b32 a57, 0
ds_read_b128 a[216:219], v2 offset:6144
v_accvgpr_write_b32 a58, 0
v_cmp_le_i32 s[92:93], 26, v237
v_cmp_le_i32 s[94:95], 27, v237
v_accvgpr_write_b32 a59, 0
v_mfma_f32_32x32x16_bf16 v[80:95], a[220:223], a[188:191], v[80:95]
v_accvgpr_write_b32 a60, 0
v_cndmask_b32 v124, v233, 0, s[88:89]
v_cndmask_b32 v125, v233, 0, s[90:91]
v_accvgpr_write_b32 a61, 0
ds_read_b128 a[220:223], v2 offset:7168
v_accvgpr_write_b32 a62, 0
v_cndmask_b32 v126, v233, 0, s[92:93]
v_cndmask_b32 v127, v233, 0, s[94:95]
v_accvgpr_write_b32 a63, 0
s_waitcnt lgkmcnt(7)
v_mfma_f32_32x32x16_bf16 v[96:111], a[192:195], a[128:131], v[96:111]
v_accvgpr_write_b32 a64, 0
v_accvgpr_write_b32 a65, 0
v_mov_b32 v232, 0xe0ad78ec
v_mov_b32 v230, 0
v_mov_b32 v231, 0
v_accvgpr_write_b32 a66, 0
v_accvgpr_write_b32 a67, 0
s_add_u32 m0, s56, s62
v_mfma_f32_32x32x16_bf16 v[112:127], a[192:195], a[160:163], v[112:127]
v_max3_f32 v228, v64, v65, v66
v_accvgpr_write_b32 a68, 0
v_max3_f32 v228, v228, v67, v68
v_accvgpr_write_b32 a69, 0
v_max3_f32 v228, v228, v69, v70
v_max3_f32 v228, v228, v71, v72
v_accvgpr_write_b32 a70, 0
v_max3_f32 v228, v228, v73, v74
ds_read_b128 a[224:227], v3 offset:0
v_accvgpr_write_b32 a71, 0
v_max3_f32 v228, v228, v75, v76
s_waitcnt lgkmcnt(7)
v_mfma_f32_32x32x16_bf16 v[96:111], a[196:199], a[132:135], v[96:111]
v_max3_f32 v228, v228, v77, v78
v_accvgpr_write_b32 a72, 0
v_max_f32 v228, v228, v79
v_accvgpr_write_b32 a73, 0
v_max3_f32 v229, v80, v81, v82
v_max3_f32 v229, v229, v83, v84
v_accvgpr_write_b32 a74, 0
v_max3_f32 v229, v229, v85, v86
v_accvgpr_write_b32 a75, 0
v_max3_f32 v229, v229, v87, v88
v_mfma_f32_32x32x16_bf16 v[112:127], a[196:199], a[164:167], v[112:127]
v_max3_f32 v229, v229, v89, v90
v_accvgpr_write_b32 a76, 0
v_max3_f32 v229, v229, v91, v92
v_accvgpr_write_b32 a77, 0
v_max3_f32 v229, v229, v93, v94
v_max_f32 v229, v229, v95
ds_read_b128 a[228:231], v3 offset:1024
v_accvgpr_write_b32 a78, 0
v_mov_b32 v224, v228
buffer_load_dwordx4 v6, s[28:31], s58 offen offset:0 sc1 lds
v_accvgpr_write_b32 a79, 0
v_mov_b32 v225, v229
s_waitcnt lgkmcnt(7)
v_mfma_f32_32x32x16_bf16 v[96:111], a[200:203], a[136:139], v[96:111]
v_permlane32_swap_b32 v228, v224
v_accvgpr_write_b32 a80, 0
v_permlane32_swap_b32 v229, v225
v_accvgpr_write_b32 a81, 0
v_max_f32 v228, v228, v224
v_max_f32 v229, v229, v225
v_accvgpr_write_b32 a82, 0
v_cmp_lt_f32 vcc, v228, v232
v_accvgpr_write_b32 a83, 0
s_nop 0
v_cndmask_b32 v228, v228, 0, vcc
v_mfma_f32_32x32x16_bf16 v[112:127], a[200:203], a[168:171], v[112:127]
v_cmp_lt_f32 vcc, v229, v232
v_accvgpr_write_b32 a84, 0
s_nop 0
v_cndmask_b32 v229, v229, 0, vcc
ds_read_b128 a[232:235], v3 offset:2048
v_accvgpr_write_b32 a85, 0
v_sub_f32 v160, 0, v228
v_sub_f32 v161, 0, v228
v_accvgpr_write_b32 a86, 0
v_sub_f32 v162, 0, v228
v_accvgpr_write_b32 a87, 0
v_sub_f32 v163, 0, v228
s_waitcnt lgkmcnt(7)
v_mfma_f32_32x32x16_bf16 v[96:111], a[204:207], a[140:143], v[96:111]
v_sub_f32 v164, 0, v228
v_accvgpr_write_b32 a88, 0
v_sub_f32 v165, 0, v228
v_accvgpr_write_b32 a89, 0
v_sub_f32 v166, 0, v228
v_sub_f32 v167, 0, v228
v_accvgpr_write_b32 a90, 0
v_sub_f32 v168, 0, v228
buffer_load_dwordx4 v6, s[28:31], s58 offen offset:1024 sc1 lds
v_accvgpr_write_b32 a91, 0
v_sub_f32 v169, 0, v228
v_mfma_f32_32x32x16_bf16 v[112:127], a[204:207], a[172:175], v[112:127]
v_sub_f32 v170, 0, v228
ds_read_b128 a[236:239], v3 offset:3072
v_accvgpr_write_b32 a92, 0
v_sub_f32 v171, 0, v228
v_sub_f32 v172, 0, v228
v_accvgpr_write_b32 a93, 0
v_sub_f32 v173, 0, v228
v_accvgpr_write_b32 a94, 0
v_sub_f32 v174, 0, v228
v_sub_f32 v175, 0, v228
v_accvgpr_write_b32 a95, 0
s_waitcnt lgkmcnt(7)
v_mfma_f32_32x32x16_bf16 v[96:111], a[208:211], a[144:147], v[96:111]
v_sub_f32 v176, 0, v229
v_accvgpr_write_b32 a96, 0
v_sub_f32 v177, 0, v229
v_sub_f32 v178, 0, v229
v_accvgpr_write_b32 a97, 0
v_sub_f32 v179, 0, v229
v_accvgpr_write_b32 a98, 0
v_sub_f32 v180, 0, v229
v_sub_f32 v181, 0, v229
ds_read_b128 a[240:243], v3 offset:4096
v_accvgpr_write_b32 a99, 0
v_mfma_f32_32x32x16_bf16 v[112:127], a[208:211], a[176:179], v[112:127]
v_sub_f32 v182, 0, v229
v_accvgpr_write_b32 a100, 0
v_sub_f32 v183, 0, v229
v_sub_f32 v184, 0, v229
v_accvgpr_write_b32 a101, 0
v_sub_f32 v185, 0, v229
v_accvgpr_write_b32 a102, 0
buffer_load_dwordx4 v6, s[28:31], s58 offen offset:2048 sc1 lds
v_sub_f32 v186, 0, v229
v_sub_f32 v187, 0, v229
v_accvgpr_write_b32 a103, 0
s_waitcnt lgkmcnt(7)
v_mfma_f32_32x32x16_bf16 v[96:111], a[212:215], a[148:151], v[96:111]
v_sub_f32 v188, 0, v229
v_accvgpr_write_b32 a104, 0
v_sub_f32 v189, 0, v229
v_sub_f32 v190, 0, v229
v_accvgpr_write_b32 a105, 0
v_sub_f32 v191, 0, v229
ds_read_b128 a[244:247], v3 offset:5120
v_accvgpr_write_b32 a106, 0
v_add_f32 v64, v64, v160
v_add_f32 v65, v65, v160
v_accvgpr_write_b32 a107, 0
v_mfma_f32_32x32x16_bf16 v[112:127], a[212:215], a[180:183], v[112:127]
v_add_f32 v66, v66, v160
v_accvgpr_write_b32 a108, 0
v_add_f32 v67, v67, v160
v_add_f32 v68, v68, v160
v_accvgpr_write_b32 a109, 0
v_add_f32 v69, v69, v160
v_accvgpr_write_b32 a110, 0
v_add_f32 v70, v70, v160
v_add_f32 v71, v71, v160
v_accvgpr_write_b32 a111, 0
s_waitcnt lgkmcnt(7)
v_mfma_f32_32x32x16_bf16 v[96:111], a[216:219], a[152:155], v[96:111]
v_add_f32 v72, v72, v160
v_accvgpr_write_b32 a112, 0
v_add_f32 v73, v73, v160
v_add_f32 v74, v74, v160
ds_read_b128 a[248:251], v3 offset:6144
v_accvgpr_write_b32 a113, 0
v_add_f32 v75, v75, v160
buffer_load_dwordx4 v6, s[28:31], s58 offen offset:3072 sc1 lds
s_add_u32 s58, s58, 32768
s_cmp_eq_u32 s58, s60
s_cselect_b32 s58, 0, s58
s_cselect_b32 s60, -1, s60
v_accvgpr_write_b32 a114, 0
v_add_f32 v76, v76, v160
v_add_f32 v77, v77, v160
v_accvgpr_write_b32 a115, 0
s_waitcnt lgkmcnt(7)
v_mfma_f32_32x32x16_bf16 v[96:111], a[220:223], a[156:159], v[96:111]
v_add_f32 v78, v78, v160
v_accvgpr_write_b32 a116, 0
v_add_f32 v79, v79, v160
v_add_f32 v80, v80, v176
v_accvgpr_write_b32 a117, 0
v_add_f32 v81, v81, v176
v_accvgpr_write_b32 a118, 0
v_add_f32 v82, v82, v176
v_add_f32 v83, v83, v176
v_accvgpr_write_b32 a119, 0
v_add_f32 v84, v84, v176
v_mfma_f32_32x32x16_bf16 v[112:127], a[216:219], a[184:187], v[112:127]
ds_read_b128 a[252:255], v3 offset:7168
v_accvgpr_write_b32 a120, 0
v_add_f32 v85, v85, v176
v_add_f32 v86, v86, v176
v_accvgpr_write_b32 a121, 0
v_add_f32 v87, v87, v176
v_accvgpr_write_b32 a122, 0
v_add_f32 v88, v88, v176
v_add_f32 v89, v89, v176
v_accvgpr_write_b32 a123, 0
v_add_f32 v90, v90, v176
v_mfma_f32_32x32x16_bf16 v[112:127], a[220:223], a[188:191], v[112:127]
v_accvgpr_write_b32 a124, 0
v_add_f32 v91, v91, v176
v_add_f32 v92, v92, v176
v_accvgpr_write_b32 a125, 0
v_add_f32 v93, v93, v176
v_accvgpr_write_b32 a126, 0
v_add_f32 v94, v94, v176
v_add_f32 v95, v95, v176
v_accvgpr_write_b32 a127, 0
v_exp_f32 v192, v64
v_exp_f32 v193, v65
v_exp_f32 v194, v66
v_add_f32 v228, v192, v193
v_exp_f32 v195, v67
v_add_f32 v228, v228, v194
v_exp_f32 v196, v68
v_add_f32 v228, v228, v195
v_exp_f32 v197, v69
v_add_f32 v228, v228, v196
v_exp_f32 v198, v70
v_add_f32 v228, v228, v197
v_exp_f32 v199, v71
v_cvt_pk_bf16_f32 v128, v192, v193
v_add_f32 v228, v228, v198
v_exp_f32 v208, v80
v_add_f32 v96, v96, v160
v_add_f32 v228, v228, v199
v_exp_f32 v209, v81
v_add_f32 v97, v97, v160
v_cvt_pk_bf16_f32 v129, v194, v195
v_add_f32 v98, v98, v160
v_exp_f32 v210, v82
v_add_f32 v99, v99, v160
v_add_f32 v229, v208, v209
v_exp_f32 v211, v83
v_add_f32 v100, v100, v160
v_cvt_pk_bf16_f32 v130, v196, v197
v_add_f32 v229, v229, v210
v_add_f32 v101, v101, v160
v_exp_f32 v212, v84
v_add_f32 v102, v102, v160
v_add_f32 v229, v229, v211
v_exp_f32 v213, v85
v_add_f32 v103, v103, v160
v_cvt_pk_bf16_f32 v131, v198, v199
v_add_f32 v229, v229, v212
v_add_f32 v104, v104, v160
v_exp_f32 v214, v86
v_add_f32 v229, v229, v213
v_add_f32 v105, v105, v160
v_exp_f32 v215, v87
v_add_f32 v106, v106, v160
v_cvt_pk_bf16_f32 v136, v208, v209
v_add_f32 v229, v229, v214
v_add_f32 v107, v107, v160
v_exp_f32 v200, v72
v_add_f32 v229, v229, v215
v_add_f32 v108, v108, v160
v_exp_f32 v201, v73
v_add_f32 v109, v109, v160
v_cvt_pk_bf16_f32 v137, v210, v211
v_add_f32 v228, v228, v200
v_add_f32 v110, v110, v160
v_exp_f32 v202, v74
v_add_f32 v228, v228, v201
v_add_f32 v111, v111, v160
v_exp_f32 v203, v75
v_add_f32 v112, v112, v176
v_cvt_pk_bf16_f32 v138, v212, v213
v_add_f32 v228, v228, v202
v_exp_f32 v204, v76
v_add_f32 v113, v113, v176
v_add_f32 v228, v228, v203
v_add_f32 v114, v114, v176
v_exp_f32 v205, v77
v_add_f32 v115, v115, v176
v_cvt_pk_bf16_f32 v139, v214, v215
v_add_f32 v228, v228, v204
v_exp_f32 v206, v78
v_add_f32 v116, v116, v176
v_add_f32 v228, v228, v205
v_add_f32 v117, v117, v176
v_exp_f32 v207, v79
v_add_f32 v118, v118, v176
v_add_f32 v228, v228, v206
v_exp_f32 v216, v88
v_add_f32 v119, v119, v176
v_add_f32 v228, v228, v207
v_add_f32 v120, v120, v176
v_exp_f32 v217, v89
v_add_f32 v229, v229, v216
v_add_f32 v121, v121, v176
v_exp_f32 v218, v90
v_add_f32 v122, v122, v176
v_add_f32 v229, v229, v217
v_add_f32 v123, v123, v176
v_exp_f32 v219, v91
v_add_f32 v229, v229, v218
v_add_f32 v124, v124, v176
v_exp_f32 v220, v92
v_add_f32 v125, v125, v176
v_add_f32 v229, v229, v219
v_add_f32 v126, v126, v176
v_exp_f32 v221, v93
v_add_f32 v229, v229, v220
v_add_f32 v127, v127, v176
v_exp_f32 v222, v94
v_add_f32 v229, v229, v221
v_exp_f32 v223, v95
v_add_f32 v229, v229, v222
v_add_f32 v229, v229, v223
v_max_f32 v232, v228, v229
v_cmp_lt_f32 vcc, s64, v232
s_waitcnt lgkmcnt(0)
s_cbranch_vccnz RX_h
RR_h:
s_cmp_eq_u32 s74, 0
s_cbranch_scc1 LAST
HEADX:
s_sub_u32 s54, s74, 1
s_cmp_eq_u32 s54, 0
s_cbranch_scc1 MASKED
LOOP:
s_add_u32 s56, s57, 16384
s_and_b32 s56, s56, 0xffff
v_add_u32 v2, s56, v4
v_add_u32 v3, s57, v5
s_waitcnt lgkmcnt(0)
v_mfma_f32_32x32x16_bf16 a[0:15], a[224:227], v[128:131], a[0:15]
v_add_f32 v230, v230, v228
v_add_f32 v231, v231, v229
v_exp_f32 v192, v96
v_mfma_f32_32x32x16_bf16 a[16:31], a[224:227], v[136:139], a[16:31]
v_cvt_pk_bf16_f32 v132, v200, v201
v_exp_f32 v193, v97
s_waitcnt vmcnt(12)
s_barrier
v_cvt_pk_bf16_f32 v133, v202, v203
v_mfma_f32_32x32x16_bf16 a[32:47], a[228:231], v[128:131], a[32:47]
v_cvt_pk_bf16_f32 v134, v204, v205
v_exp_f32 v194, v98
ds_read_b128 a[192:195], v2 offset:0
v_add_f32 v228, v192, v193
v_mfma_f32_32x32x16_bf16 a[48:63], a[228:231], v[136:139], a[48:63]
v_cvt_pk_bf16_f32 v135, v206, v207
v_exp_f32 v195, v99
s_xor_b32 s23, s57, 32768
s_add_u32 m0, s23, s63
v_add_f32 v228, v228, v194
v_mfma_f32_32x32x16_bf16 a[64:79], a[232:235], v[128:131], a[64:79]
v_cvt_pk_bf16_f32 v140, v216, v217
ds_read_b128 a[196:199], v2 offset:1024
v_exp_f32 v196, v100
v_cvt_pk_bf16_f32 v141, v218, v219
v_add_f32 v228, v228, v195
v_mfma_f32_32x32x16_bf16 a[80:95], a[232:235], v[136:139], a[80:95]
v_exp_f32 v197, v101
v_cvt_pk_bf16_f32 v142, v220, v221
v_add_f32 v228, v228, v196
ds_read_b128 a[200:203], v2 offset:2048
v_cvt_pk_bf16_f32 v143, v222, v223
v_mfma_f32_32x32x16_bf16 a[96:111], a[236:239], v[128:131], a[96:111]
v_exp_f32 v198, v102
v_add_f32 v228, v228, v197
buffer_load_dwordx4 v6, s[28:31], s59 offen offset:0 sc1 lds
v_mfma_f32_32x32x16_bf16 a[112:127], a[236:239], v[136:139], a[112:127]
v_exp_f32 v199, v103
ds_read_b128 a[204:207], v2 offset:3072
v_add_f32 v228, v228, v198
v_cvt_pk_bf16_f32 v144, v192, v193
v_mfma_f32_32x32x16_bf16 a[0:15], a[240:243], v[132:135], a[0:15]
v_exp_f32 v208, v112
v_add_f32 v228, v228, v199
ds_read_b128 a[208:211], v2 offset:4096
v_exp_f32 v209, v113
v_mfma_f32_32x32x16_bf16 a[16:31], a[240:243], v[140:143], a[16:31]
v_cvt_pk_bf16_f32 v145, v194, v195
buffer_load_dwordx4 v6, s[28:31], s59 offen offset:1024 sc1 lds
v_exp_f32 v210, v114
ds_read_b128 a[212:215], v2 offset:5120
v_mfma_f32_32x32x16_bf16 a[32:47], a[244:247], v[132:135], a[32:47]
v_add_f32 v229, v208, v209
v_exp_f32 v211, v115
v_cvt_pk_bf16_f32 v146, v196, v197
v_add_f32 v229, v229, v210
ds_read_b128 a[216:219], v2 offset:6144
v_mfma_f32_32x32x16_bf16 a[48:63], a[244:247], v[140:143], a[48:63]
v_exp_f32 v212, v116
v_add_f32 v229, v229, v211
v_exp_f32 v213, v117
v_mfma_f32_32x32x16_bf16 a[64:79], a[248:251], v[132:135], a[64:79]
buffer_load_dwordx4 v6, s[28:31], s59 offen offset:2048 sc1 lds
ds_read_b128 a[220:223], v2 offset:7168
v_add_f32 v229, v229, v212
v_cvt_pk_bf16_f32 v147, v198, v199
v_mfma_f32_32x32x16_bf16 a[80:95], a[248:251], v[140:143], a[80:95]
v_exp_f32 v214, v118
v_add_f32 v229, v229, v213
v_exp_f32 v215, v119
v_mfma_f32_32x32x16_bf16 a[96:111], a[252:255], v[132:135], a[96:111]
v_cvt_pk_bf16_f32 v152, v208, v209
v_add_f32 v229, v229, v214
v_exp_f32 v200, v104
v_add_f32 v229, v229, v215
v_mfma_f32_32x32x16_bf16 a[112:127], a[252:255], v[140:143], a[112:127]
buffer_load_dwordx4 v6, s[28:31], s59 offen offset:3072 sc1 lds
s_add_u32 s59, s59, 32768
v_exp_f32 v201, v105
v_cvt_pk_bf16_f32 v153, v210, v211
s_waitcnt lgkmcnt(0)
v_mfma_f32_32x32x16_bf16 v[64:79], a[192:195], a[128:131], v[160:175]
v_add_f32 v228, v228, v200
v_exp_f32 v202, v106
v_add_f32 v228, v228, v201
ds_read_b128 a[224:227], v3 offset:0
v_mfma_f32_32x32x16_bf16 v[80:95], a[192:195], a[160:163], v[176:191]
v_exp_f32 v203, v107
v_cvt_pk_bf16_f32 v154, v212, v213
v_add_f32 v228, v228, v202
s_add_u32 m0, s57, s62
v_mfma_f32_32x32x16_bf16 v[64:79], a[196:199], a[132:135], v[64:79]
v_exp_f32 v204, v108
ds_read_b128 a[228:231], v3 offset:1024
v_add_f32 v228, v228, v203
v_exp_f32 v205, v109
v_mfma_f32_32x32x16_bf16 v[80:95], a[196:199], a[164:167], v[80:95]
v_cvt_pk_bf16_f32 v155, v214, v215
v_add_f32 v228, v228, v204
v_exp_f32 v206, v110
v_mfma_f32_32x32x16_bf16 v[64:79], a[200:203], a[136:139], v[64:79]
ds_read_b128 a[232:235], v3 offset:2048
v_add_f32 v228, v228, v205
v_exp_f32 v207, v111
buffer_load_dwordx4 v6, s[28:31], s58 offen offset:0 sc1 lds
v_mfma_f32_32x32x16_bf16 v[80:95], a[200:203], a[168:171], v[80:95]
v_add_f32 v228, v228, v206
v_exp_f32 v216, v120
ds_read_b128 a[236:239], v3 offset:3072
v_add_f32 v228, v228, v207
v_mfma_f32_32x32x16_bf16 v[64:79], a[204:207], a[140:143], v[64:79]
v_exp_f32 v217, v121
v_add_f32 v229, v229, v216
v_mfma_f32_32x32x16_bf16 v[80:95], a[204:207], a[172:175], v[80:95]
v_exp_f32 v218, v122
ds_read_b128 a[240:243], v3 offset:4096
v_add_f32 v229, v229, v217
buffer_load_dwordx4 v6, s[28:31], s58 offen offset:1024 sc1 lds
v_mfma_f32_32x32x16_bf16 v[64:79], a[208:211], a[144:147], v[64:79]
v_exp_f32 v219, v123
v_add_f32 v229, v229, v218
ds_read_b128 a[244:247], v3 offset:5120
v_mfma_f32_32x32x16_bf16 v[80:95], a[208:211], a[176:179], v[80:95]
v_exp_f32 v220, v124
v_add_f32 v229, v229, v219
v_exp_f32 v221, v125
v_mfma_f32_32x32x16_bf16 v[64:79], a[212:215], a[148:151], v[64:79]
v_add_f32 v229, v229, v220
ds_read_b128 a[248:251], v3 offset:6144
buffer_load_dwordx4 v6, s[28:31], s58 offen offset:2048 sc1 lds
v_exp_f32 v222, v126
v_mfma_f32_32x32x16_bf16 v[80:95], a[212:215], a[180:183], v[80:95]
v_add_f32 v229, v229, v221
v_exp_f32 v223, v127
v_mfma_f32_32x32x16_bf16 v[64:79], a[216:219], a[152:155], v[64:79]
v_add_f32 v229, v229, v222
ds_read_b128 a[252:255], v3 offset:7168
v_add_f32 v229, v229, v223
v_mfma_f32_32x32x16_bf16 v[64:79], a[220:223], a[156:159], v[64:79]
v_max_f32 v232, v228, v229
buffer_load_dwordx4 v6, s[28:31], s58 offen offset:3072 sc1 lds
s_add_u32 s58, s58, 32768
s_cmp_eq_u32 s58, s60
s_cselect_b32 s58, 0, s58
v_mfma_f32_32x32x16_bf16 v[80:95], a[216:219], a[184:187], v[80:95]
v_cmp_lt_f32 vcc, s64, v232
v_mfma_f32_32x32x16_bf16 v[80:95], a[220:223], a[188:191], v[80:95]
s_cbranch_vccnz RX_l1
RR_l1:
s_add_u32 s57, s56, 16384
s_and_b32 s57, s57, 0xffff
v_add_u32 v2, s57, v4
v_add_u32 v3, s56, v5
s_waitcnt lgkmcnt(0)
v_mfma_f32_32x32x16_bf16 a[0:15], a[224:227], v[144:147], a[0:15]
v_add_f32 v230, v230, v228
v_add_f32 v231, v231, v229
v_exp_f32 v192, v64
v_mfma_f32_32x32x16_bf16 a[16:31], a[224:227], v[152:155], a[16:31]
v_cvt_pk_bf16_f32 v148, v200, v201
v_exp_f32 v193, v65
s_waitcnt vmcnt(12)
s_barrier
v_cvt_pk_bf16_f32 v149, v202, v203
v_mfma_f32_32x32x16_bf16 a[32:47], a[228:231], v[144:147], a[32:47]
v_cvt_pk_bf16_f32 v150, v204, v205
v_exp_f32 v194, v66
ds_read_b128 a[192:195], v2 offset:0
v_add_f32 v228, v192, v193
v_mfma_f32_32x32x16_bf16 a[48:63], a[228:231], v[152:155], a[48:63]
v_cvt_pk_bf16_f32 v151, v206, v207
v_exp_f32 v195, v67
s_xor_b32 s23, s56, 32768
s_add_u32 m0, s23, s63
v_add_f32 v228, v228, v194
v_mfma_f32_32x32x16_bf16 a[64:79], a[232:235], v[144:147], a[64:79]
v_cvt_pk_bf16_f32 v156, v216, v217
ds_read_b128 a[196:199], v2 offset:1024
v_exp_f32 v196, v68
v_cvt_pk_bf16_f32 v157, v218, v219
v_add_f32 v228, v228, v195
v_mfma_f32_32x32x16_bf16 a[80:95], a[232:235], v[152:155], a[80:95]
v_exp_f32 v197, v69
v_cvt_pk_bf16_f32 v158, v220, v221
v_add_f32 v228, v228, v196
ds_read_b128 a[200:203], v2 offset:2048
v_cvt_pk_bf16_f32 v159, v222, v223
v_mfma_f32_32x32x16_bf16 a[96:111], a[236:239], v[144:147], a[96:111]
v_exp_f32 v198, v70
v_add_f32 v228, v228, v197
buffer_load_dwordx4 v6, s[28:31], s59 offen offset:0 sc1 lds
v_mfma_f32_32x32x16_bf16 a[112:127], a[236:239], v[152:155], a[112:127]
v_exp_f32 v199, v71
ds_read_b128 a[204:207], v2 offset:3072
v_add_f32 v228, v228, v198
v_cvt_pk_bf16_f32 v128, v192, v193
v_mfma_f32_32x32x16_bf16 a[0:15], a[240:243], v[148:151], a[0:15]
v_exp_f32 v208, v80
v_add_f32 v228, v228, v199
ds_read_b128 a[208:211], v2 offset:4096
v_exp_f32 v209, v81
v_mfma_f32_32x32x16_bf16 a[16:31], a[240:243], v[156:159], a[16:31]
v_cvt_pk_bf16_f32 v129, v194, v195
buffer_load_dwordx4 v6, s[28:31], s59 offen offset:1024 sc1 lds
v_exp_f32 v210, v82
ds_read_b128 a[212:215], v2 offset:5120
v_mfma_f32_32x32x16_bf16 a[32:47], a[244:247], v[148:151], a[32:47]
v_add_f32 v229, v208, v209
v_exp_f32 v211, v83
v_cvt_pk_bf16_f32 v130, v196, v197
v_add_f32 v229, v229, v210
ds_read_b128 a[216:219], v2 offset:6144
v_mfma_f32_32x32x16_bf16 a[48:63], a[244:247], v[156:159], a[48:63]
v_exp_f32 v212, v84
v_add_f32 v229, v229, v211
v_exp_f32 v213, v85
v_mfma_f32_32x32x16_bf16 a[64:79], a[248:251], v[148:151], a[64:79]
buffer_load_dwordx4 v6, s[28:31], s59 offen offset:2048 sc1 lds
ds_read_b128 a[220:223], v2 offset:7168
v_add_f32 v229, v229, v212
v_cvt_pk_bf16_f32 v131, v198, v199
v_mfma_f32_32x32x16_bf16 a[80:95], a[248:251], v[156:159], a[80:95]
v_exp_f32 v214, v86
v_add_f32 v229, v229, v213
v_exp_f32 v215, v87
v_mfma_f32_32x32x16_bf16 a[96:111], a[252:255], v[148:151], a[96:111]
v_cvt_pk_bf16_f32 v136, v208, v209
v_add_f32 v229, v229, v214
v_exp_f32 v200, v72
v_add_f32 v229, v229, v215
v_mfma_f32_32x32x16_bf16 a[112:127], a[252:255], v[156:159], a[112:127]
buffer_load_dwordx4 v6, s[28:31], s59 offen offset:3072 sc1 lds
s_add_u32 s59, s59, 32768
v_exp_f32 v201, v73
v_cvt_pk_bf16_f32 v137, v210, v211
s_waitcnt lgkmcnt(0)
v_mfma_f32_32x32x16_bf16 v[96:111], a[192:195], a[128:131], v[160:175]
v_add_f32 v228, v228, v200
v_exp_f32 v202, v74
v_add_f32 v228, v228, v201
ds_read_b128 a[224:227], v3 offset:0
v_mfma_f32_32x32x16_bf16 v[112:127], a[192:195], a[160:163], v[176:191]
v_exp_f32 v203, v75
v_cvt_pk_bf16_f32 v138, v212, v213
v_add_f32 v228, v228, v202
s_add_u32 m0, s56, s62
v_mfma_f32_32x32x16_bf16 v[96:111], a[196:199], a[132:135], v[96:111]
v_exp_f32 v204, v76
ds_read_b128 a[228:231], v3 offset:1024
v_add_f32 v228, v228, v203
v_exp_f32 v205, v77
v_mfma_f32_32x32x16_bf16 v[112:127], a[196:199], a[164:167], v[112:127]
v_cvt_pk_bf16_f32 v139, v214, v215
v_add_f32 v228, v228, v204
v_exp_f32 v206, v78
v_mfma_f32_32x32x16_bf16 v[96:111], a[200:203], a[136:139], v[96:111]
ds_read_b128 a[232:235], v3 offset:2048
v_add_f32 v228, v228, v205
v_exp_f32 v207, v79
buffer_load_dwordx4 v6, s[28:31], s58 offen offset:0 sc1 lds
v_mfma_f32_32x32x16_bf16 v[112:127], a[200:203], a[168:171], v[112:127]
v_add_f32 v228, v228, v206
v_exp_f32 v216, v88
ds_read_b128 a[236:239], v3 offset:3072
v_add_f32 v228, v228, v207
v_mfma_f32_32x32x16_bf16 v[96:111], a[204:207], a[140:143], v[96:111]
v_exp_f32 v217, v89
v_add_f32 v229, v229, v216
v_mfma_f32_32x32x16_bf16 v[112:127], a[204:207], a[172:175], v[112:127]
v_exp_f32 v218, v90
ds_read_b128 a[240:243], v3 offset:4096
v_add_f32 v229, v229, v217
buffer_load_dwordx4 v6, s[28:31], s58 offen offset:1024 sc1 lds
v_mfma_f32_32x32x16_bf16 v[96:111], a[208:211], a[144:147], v[96:111]
v_exp_f32 v219, v91
v_add_f32 v229, v229, v218
ds_read_b128 a[244:247], v3 offset:5120
v_mfma_f32_32x32x16_bf16 v[112:127], a[208:211], a[176:179], v[112:127]
v_exp_f32 v220, v92
v_add_f32 v229, v229, v219
v_exp_f32 v221, v93
v_mfma_f32_32x32x16_bf16 v[96:111], a[212:215], a[148:151], v[96:111]
v_add_f32 v229, v229, v220
ds_read_b128 a[248:251], v3 offset:6144
buffer_load_dwordx4 v6, s[28:31], s58 offen offset:2048 sc1 lds
v_exp_f32 v222, v94
v_mfma_f32_32x32x16_bf16 v[112:127], a[212:215], a[180:183], v[112:127]
v_add_f32 v229, v229, v221
v_exp_f32 v223, v95
v_mfma_f32_32x32x16_bf16 v[96:111], a[216:219], a[152:155], v[96:111]
v_add_f32 v229, v229, v222
ds_read_b128 a[252:255], v3 offset:7168
v_add_f32 v229, v229, v223
v_mfma_f32_32x32x16_bf16 v[96:111], a[220:223], a[156:159], v[96:111]
v_max_f32 v232, v228, v229
buffer_load_dwordx4 v6, s[28:31], s58 offen offset:3072 sc1 lds
s_add_u32 s58, s58, 32768
v_mfma_f32_32x32x16_bf16 v[112:127], a[216:219], a[184:187], v[112:127]
v_cmp_lt_f32 vcc, s64, v232
v_mfma_f32_32x32x16_bf16 v[112:127], a[220:223], a[188:191], v[112:127]
s_cbranch_vccnz RX_l0
RR_l0:
s_sub_u32 s54, s54, 1
s_cmp_lg_u32 s54, 0
s_cbranch_scc1 LOOP
MASKED:
s_cmp_eq_u32 s75, 0
s_cbranch_scc1 NOPF
buffer_load_dword v19, v16, s[40:43], s68 offen
NOPF:
s_xor_b32 s3, s75, 1
s_or_b32 s3, s3, s20
s_cmp_lg_u32 s3, 0
s_cbranch_scc1 W0_sa
s_mov_b64 exec, 1
global_store_dword v60, v61, s[4:5] sc1
s_mov_b64 exec, -1
W0_sa:
s_add_u32 s56, s57, 16384
s_and_b32 s56, s56, 0xffff
v_add_u32 v2, s56, v4
v_add_u32 v3, s57, v5
s_waitcnt lgkmcnt(0)
v_subrev_u32 v236, s67, v234
v_subrev_u32 v237, s67, v235
s_add_u32 s67, s67, 64
v_mfma_f32_32x32x16_bf16 a[0:15], a[224:227], v[128:131], a[0:15]
v_cmp_le_i32 s[88:89], 0, v236
v_cmp_le_i32 s[90:91], 1, v236
v_add_f32 v230, v230, v228
v_add_f32 v231, v231, v229
v_exp_f32 v192, v96
v_cmp_le_i32 s[92:93], 2, v236
v_cmp_le_i32 s[94:95], 3, v236
v_mfma_f32_32x32x16_bf16 a[16:31], a[224:227], v[136:139], a[16:31]
v_cvt_pk_bf16_f32 v132, v200, v201
v_cndmask_b32 v64, v233, v160, s[88:89]
v_cndmask_b32 v65, v233, v160, s[90:91]
v_exp_f32 v193, v97
s_waitcnt vmcnt(12)
s_barrier
v_cvt_pk_bf16_f32 v133, v202, v203
v_cmp_le_i32 s[88:89], 8, v236
v_cmp_le_i32 s[90:91], 9, v236
v_mfma_f32_32x32x16_bf16 a[32:47], a[228:231], v[128:131], a[32:47]
v_cndmask_b32 v66, v233, v160, s[92:93]
v_cndmask_b32 v67, v233, v160, s[94:95]
v_cvt_pk_bf16_f32 v134, v204, v205
v_exp_f32 v194, v98
ds_read_b128 a[192:195], v2 offset:0
v_cmp_le_i32 s[92:93], 10, v236
v_cmp_le_i32 s[94:95], 11, v236
v_add_f32 v228, v192, v193
v_mfma_f32_32x32x16_bf16 a[48:63], a[228:231], v[136:139], a[48:63]
v_cvt_pk_bf16_f32 v135, v206, v207
v_exp_f32 v195, v99
v_cndmask_b32 v68, v233, v160, s[88:89]
v_cndmask_b32 v69, v233, v160, s[90:91]
s_xor_b32 s23, s57, 32768
s_add_u32 m0, s23, s63
v_add_f32 v228, v228, v194
v_cvt_pk_bf16_f32 v140, v216, v217
v_cmp_le_i32 s[88:89], 16, v236
v_cmp_le_i32 s[90:91], 17, v236
v_mfma_f32_32x32x16_bf16 a[64:79], a[232:235], v[128:131], a[64:79]
ds_read_b128 a[196:199], v2 offset:1024
v_exp_f32 v196, v100
v_cndmask_b32 v70, v233, v160, s[92:93]
v_cndmask_b32 v71, v233, v160, s[94:95]
v_cvt_pk_bf16_f32 v141, v218, v219
v_add_f32 v228, v228, v195
v_cmp_le_i32 s[92:93], 18, v236
v_cmp_le_i32 s[94:95], 19, v236
v_exp_f32 v197, v101
v_mfma_f32_32x32x16_bf16 a[80:95], a[232:235], v[136:139], a[80:95]
v_cvt_pk_bf16_f32 v142, v220, v221
v_cndmask_b32 v72, v233, v160, s[88:89]
v_cndmask_b32 v73, v233, v160, s[90:91]
v_add_f32 v228, v228, v196
ds_read_b128 a[200:203], v2 offset:2048
v_cvt_pk_bf16_f32 v143, v222, v223
v_cmp_le_i32 s[88:89], 24, v236
v_cmp_le_i32 s[90:91], 25, v236
v_exp_f32 v198, v102
v_mfma_f32_32x32x16_bf16 a[96:111], a[236:239], v[128:131], a[96:111]
v_cndmask_b32 v74, v233, v160, s[92:93]
v_cndmask_b32 v75, v233, v160, s[94:95]
v_add_f32 v228, v228, v197
buffer_load_dwordx4 v6, s[28:31], s59 offen offset:0 sc1 lds
v_exp_f32 v199, v103
v_cmp_le_i32 s[92:93], 26, v236
v_cmp_le_i32 s[94:95], 27, v236
ds_read_b128 a[204:207], v2 offset:3072
v_mfma_f32_32x32x16_bf16 a[112:127], a[236:239], v[136:139], a[112:127]
v_add_f32 v228, v228, v198
v_cvt_pk_bf16_f32 v144, v192, v193
v_cndmask_b32 v76, v233, v160, s[88:89]
v_cndmask_b32 v77, v233, v160, s[90:91]
v_exp_f32 v208, v112
v_cmp_le_i32 s[88:89], 0, v237
v_cmp_le_i32 s[90:91], 1, v237
v_mfma_f32_32x32x16_bf16 a[0:15], a[240:243], v[132:135], a[0:15]
v_add_f32 v228, v228, v199
ds_read_b128 a[208:211], v2 offset:4096
v_cndmask_b32 v78, v233, v160, s[92:93]
v_cndmask_b32 v79, v233, v160, s[94:95]
v_exp_f32 v209, v113
v_cmp_le_i32 s[92:93], 2, v237
v_cmp_le_i32 s[94:95], 3, v237
v_cvt_pk_bf16_f32 v145, v194, v195
v_mfma_f32_32x32x16_bf16 a[16:31], a[240:243], v[140:143], a[16:31]
v_cndmask_b32 v80, v233, v176, s[88:89]
v_cndmask_b32 v81, v233, v176, s[90:91]
buffer_load_dwordx4 v6, s[28:31], s59 offen offset:1024 sc1 lds
v_exp_f32 v210, v114
ds_read_b128 a[212:215], v2 offset:5120
v_cmp_le_i32 s[88:89], 8, v237
v_cmp_le_i32 s[90:91], 9, v237
v_add_f32 v229, v208, v209
v_mfma_f32_32x32x16_bf16 a[32:47], a[244:247], v[132:135], a[32:47]
v_cndmask_b32 v82, v233, v176, s[92:93]
v_cndmask_b32 v83, v233, v176, s[94:95]
v_exp_f32 v211, v115
v_cvt_pk_bf16_f32 v146, v196, v197
v_add_f32 v229, v229, v210
v_cmp_le_i32 s[92:93], 10, v237
v_cmp_le_i32 s[94:95], 11, v237
ds_read_b128 a[216:219], v2 offset:6144
v_mfma_f32_32x32x16_bf16 a[48:63], a[244:247], v[140:143], a[48:63]
v_exp_f32 v212, v116
v_cndmask_b32 v84, v233, v176, s[88:89]
v_cndmask_b32 v85, v233, v176, s[90:91]
v_add_f32 v229, v229, v211
v_cmp_le_i32 s[88:89], 16, v237
v_cmp_le_i32 s[90:91], 17, v237
v_exp_f32 v213, v117
v_mfma_f32_32x32x16_bf16 a[64:79], a[248:251], v[132:135], a[64:79]
buffer_load_dwordx4 v6, s[28:31], s59 offen offset:2048 sc1 lds
v_cndmask_b32 v86, v233, v176, s[92:93]
v_cndmask_b32 v87, v233, v176, s[94:95]
ds_read_b128 a[220:223], v2 offset:7168
v_add_f32 v229, v229, v212
v_cvt_pk_bf16_f32 v147, v198, v199
v_cmp_le_i32 s[92:93], 18, v237
v_cmp_le_i32 s[94:95], 19, v237
v_exp_f32 v214, v118
v_mfma_f32_32x32x16_bf16 a[80:95], a[248:251], v[140:143], a[80:95]
v_cndmask_b32 v88, v233, v176, s[88:89]
v_cndmask_b32 v89, v233, v176, s[90:91]
v_add_f32 v229, v229, v213
v_cmp_le_i32 s[88:89], 24, v237
v_cmp_le_i32 s[90:91], 25, v237
v_exp_f32 v215, v119
v_mfma_f32_32x32x16_bf16 a[96:111], a[252:255], v[132:135], a[96:111]
v_cvt_pk_bf16_f32 v152, v208, v209
v_add_f32 v229, v229, v214
v_cndmask_b32 v90, v233, v176, s[92:93]
v_cndmask_b32 v91, v233, v176, s[94:95]
v_exp_f32 v200, v104
v_cmp_le_i32 s[92:93], 26, v237
v_cmp_le_i32 s[94:95], 27, v237
v_add_f32 v229, v229, v215
v_mfma_f32_32x32x16_bf16 a[112:127], a[252:255], v[140:143], a[112:127]
buffer_load_dwordx4 v6, s[28:31], s59 offen offset:3072 sc1 lds
s_add_u32 s59, s59, 32768
s_cmp_eq_u32 s59, s61
s_cselect_b32 s59, 8192, s59
s_cselect_b32 s61, -1, s61
v_cndmask_b32 v92, v233, v176, s[88:89]
v_cndmask_b32 v93, v233, v176, s[90:91]
v_exp_f32 v201, v105
v_cndmask_b32 v94, v233, v176, s[92:93]
v_cndmask_b32 v95, v233, v176, s[94:95]
v_cvt_pk_bf16_f32 v153, v210, v211
v_add_f32 v228, v228, v200
s_waitcnt lgkmcnt(0)
v_mfma_f32_32x32x16_bf16 v[64:79], a[192:195], a[128:131], v[64:79]
v_exp_f32 v202, v106
v_add_f32 v228, v228, v201
ds_read_b128 a[224:227], v3 offset:0
v_mfma_f32_32x32x16_bf16 v[80:95], a[192:195], a[160:163], v[80:95]
v_exp_f32 v203, v107
v_cvt_pk_bf16_f32 v154, v212, v213
v_add_f32 v228, v228, v202
s_add_u32 m0, s57, s62
v_mfma_f32_32x32x16_bf16 v[64:79], a[196:199], a[132:135], v[64:79]
v_exp_f32 v204, v108
ds_read_b128 a[228:231], v3 offset:1024
v_add_f32 v228, v228, v203
v_exp_f32 v205, v109
v_mfma_f32_32x32x16_bf16 v[80:95], a[196:199], a[164:167], v[80:95]
v_cvt_pk_bf16_f32 v155, v214, v215
v_add_f32 v228, v228, v204
v_exp_f32 v206, v110
v_mfma_f32_32x32x16_bf16 v[64:79], a[200:203], a[136:139], v[64:79]
ds_read_b128 a[232:235], v3 offset:2048
v_add_f32 v228, v228, v205
v_exp_f32 v207, v111
buffer_load_dwordx4 v6, s[28:31], s58 offen offset:0 sc1 lds
v_mfma_f32_32x32x16_bf16 v[80:95], a[200:203], a[168:171], v[80:95]
v_add_f32 v228, v228, v206
v_exp_f32 v216, v120
ds_read_b128 a[236:239], v3 offset:3072
v_add_f32 v228, v228, v207
v_mfma_f32_32x32x16_bf16 v[64:79], a[204:207], a[140:143], v[64:79]
v_exp_f32 v217, v121
v_add_f32 v229, v229, v216
v_mfma_f32_32x32x16_bf16 v[80:95], a[204:207], a[172:175], v[80:95]
v_exp_f32 v218, v122
ds_read_b128 a[240:243], v3 offset:4096
v_add_f32 v229, v229, v217
buffer_load_dwordx4 v6, s[28:31], s58 offen offset:1024 sc1 lds
v_mfma_f32_32x32x16_bf16 v[64:79], a[208:211], a[144:147], v[64:79]
v_exp_f32 v219, v123
v_add_f32 v229, v229, v218
ds_read_b128 a[244:247], v3 offset:5120
v_mfma_f32_32x32x16_bf16 v[80:95], a[208:211], a[176:179], v[80:95]
v_exp_f32 v220, v124
v_add_f32 v229, v229, v219
v_exp_f32 v221, v125
v_mfma_f32_32x32x16_bf16 v[64:79], a[212:215], a[148:151], v[64:79]
v_add_f32 v229, v229, v220
ds_read_b128 a[248:251], v3 offset:6144
buffer_load_dwordx4 v6, s[28:31], s58 offen offset:2048 sc1 lds
v_exp_f32 v222, v126
v_mfma_f32_32x32x16_bf16 v[80:95], a[212:215], a[180:183], v[80:95]
v_add_f32 v229, v229, v221
v_exp_f32 v223, v127
v_mfma_f32_32x32x16_bf16 v[64:79], a[216:219], a[152:155], v[64:79]
v_add_f32 v229, v229, v222
ds_read_b128 a[252:255], v3 offset:7168
v_add_f32 v229, v229, v223
v_mfma_f32_32x32x16_bf16 v[64:79], a[220:223], a[156:159], v[64:79]
v_max_f32 v232, v228, v229
buffer_load_dwordx4 v6, s[28:31], s58 offen offset:3072 sc1 lds
s_add_u32 s58, s58, 32768
s_cmp_eq_u32 s58, s60
s_cselect_b32 s58, 0, s58
s_cselect_b32 s60, -1, s60
v_mfma_f32_32x32x16_bf16 v[80:95], a[216:219], a[184:187], v[80:95]
v_cmp_lt_f32 vcc, s64, v232
v_mfma_f32_32x32x16_bf16 v[80:95], a[220:223], a[188:191], v[80:95]
s_cbranch_vccnz RX_m1
RR_m1:
s_add_u32 s57, s56, 16384
s_and_b32 s57, s57, 0xffff
v_add_u32 v2, s57, v4
v_add_u32 v3, s56, v5
s_waitcnt lgkmcnt(0)
v_subrev_u32 v236, s67, v234
v_subrev_u32 v237, s67, v235
s_add_u32 s67, s67, 64
v_mfma_f32_32x32x16_bf16 a[0:15], a[224:227], v[144:147], a[0:15]
v_cmp_le_i32 s[88:89], 0, v236
v_cmp_le_i32 s[90:91], 1, v236
v_add_f32 v230, v230, v228
v_add_f32 v231, v231, v229
v_exp_f32 v192, v64
v_cmp_le_i32 s[92:93], 2, v236
v_cmp_le_i32 s[94:95], 3, v236
v_mfma_f32_32x32x16_bf16 a[16:31], a[224:227], v[152:155], a[16:31]
v_cvt_pk_bf16_f32 v148, v200, v201
v_cndmask_b32 v96, v233, v160, s[88:89]
v_cndmask_b32 v97, v233, v160, s[90:91]
v_exp_f32 v193, v65
s_waitcnt vmcnt(12)
s_barrier
v_cvt_pk_bf16_f32 v149, v202, v203
v_cmp_le_i32 s[88:89], 8, v236
v_cmp_le_i32 s[90:91], 9, v236
v_mfma_f32_32x32x16_bf16 a[32:47], a[228:231], v[144:147], a[32:47]
v_cndmask_b32 v98, v233, v160, s[92:93]
v_cndmask_b32 v99, v233, v160, s[94:95]
v_cvt_pk_bf16_f32 v150, v204, v205
v_exp_f32 v194, v66
ds_read_b128 a[192:195], v2 offset:0
v_cmp_le_i32 s[92:93], 10, v236
v_cmp_le_i32 s[94:95], 11, v236
v_add_f32 v228, v192, v193
v_mfma_f32_32x32x16_bf16 a[48:63], a[228:231], v[152:155], a[48:63]
v_cvt_pk_bf16_f32 v151, v206, v207
v_exp_f32 v195, v67
v_cndmask_b32 v100, v233, v160, s[88:89]
v_cndmask_b32 v101, v233, v160, s[90:91]
s_xor_b32 s23, s56, 32768
s_add_u32 m0, s23, s63
v_add_f32 v228, v228, v194
v_cvt_pk_bf16_f32 v156, v216, v217
v_cmp_le_i32 s[88:89], 16, v236
v_cmp_le_i32 s[90:91], 17, v236
v_mfma_f32_32x32x16_bf16 a[64:79], a[232:235], v[144:147], a[64:79]
ds_read_b128 a[196:199], v2 offset:1024
v_exp_f32 v196, v68
v_cndmask_b32 v102, v233, v160, s[92:93]
v_cndmask_b32 v103, v233, v160, s[94:95]
v_cvt_pk_bf16_f32 v157, v218, v219
v_add_f32 v228, v228, v195
v_cmp_le_i32 s[92:93], 18, v236
v_cmp_le_i32 s[94:95], 19, v236
v_exp_f32 v197, v69
v_mfma_f32_32x32x16_bf16 a[80:95], a[232:235], v[152:155], a[80:95]
v_cvt_pk_bf16_f32 v158, v220, v221
v_cndmask_b32 v104, v233, v160, s[88:89]
v_cndmask_b32 v105, v233, v160, s[90:91]
v_add_f32 v228, v228, v196
ds_read_b128 a[200:203], v2 offset:2048
v_cvt_pk_bf16_f32 v159, v222, v223
v_cmp_le_i32 s[88:89], 24, v236
v_cmp_le_i32 s[90:91], 25, v236
v_exp_f32 v198, v70
v_mfma_f32_32x32x16_bf16 a[96:111], a[236:239], v[144:147], a[96:111]
v_cndmask_b32 v106, v233, v160, s[92:93]
v_cndmask_b32 v107, v233, v160, s[94:95]
v_add_f32 v228, v228, v197
buffer_load_dwordx4 v6, s[28:31], s59 offen offset:0 sc1 lds
v_exp_f32 v199, v71
v_cmp_le_i32 s[92:93], 26, v236
v_cmp_le_i32 s[94:95], 27, v236
ds_read_b128 a[204:207], v2 offset:3072
v_mfma_f32_32x32x16_bf16 a[112:127], a[236:239], v[152:155], a[112:127]
v_add_f32 v228, v228, v198
v_cvt_pk_bf16_f32 v128, v192, v193
v_cndmask_b32 v108, v233, v160, s[88:89]
v_cndmask_b32 v109, v233, v160, s[90:91]
v_exp_f32 v208, v80
v_cmp_le_i32 s[88:89], 0, v237
v_cmp_le_i32 s[90:91], 1, v237
v_mfma_f32_32x32x16_bf16 a[0:15], a[240:243], v[148:151], a[0:15]
v_add_f32 v228, v228, v199
ds_read_b128 a[208:211], v2 offset:4096
v_cndmask_b32 v110, v233, v160, s[92:93]
v_cndmask_b32 v111, v233, v160, s[94:95]
v_exp_f32 v209, v81
v_cmp_le_i32 s[92:93], 2, v237
v_cmp_le_i32 s[94:95], 3, v237
v_cvt_pk_bf16_f32 v129, v194, v195
v_mfma_f32_32x32x16_bf16 a[16:31], a[240:243], v[156:159], a[16:31]
v_cndmask_b32 v112, v233, v176, s[88:89]
v_cndmask_b32 v113, v233, v176, s[90:91]
buffer_load_dwordx4 v6, s[28:31], s59 offen offset:1024 sc1 lds
v_exp_f32 v210, v82
ds_read_b128 a[212:215], v2 offset:5120
v_cmp_le_i32 s[88:89], 8, v237
v_cmp_le_i32 s[90:91], 9, v237
v_add_f32 v229, v208, v209
v_mfma_f32_32x32x16_bf16 a[32:47], a[244:247], v[148:151], a[32:47]
v_cndmask_b32 v114, v233, v176, s[92:93]
v_cndmask_b32 v115, v233, v176, s[94:95]
v_exp_f32 v211, v83
v_cvt_pk_bf16_f32 v130, v196, v197
v_add_f32 v229, v229, v210
v_cmp_le_i32 s[92:93], 10, v237
v_cmp_le_i32 s[94:95], 11, v237
ds_read_b128 a[216:219], v2 offset:6144
v_mfma_f32_32x32x16_bf16 a[48:63], a[244:247], v[156:159], a[48:63]
v_exp_f32 v212, v84
v_cndmask_b32 v116, v233, v176, s[88:89]
v_cndmask_b32 v117, v233, v176, s[90:91]
v_add_f32 v229, v229, v211
v_cmp_le_i32 s[88:89], 16, v237
v_cmp_le_i32 s[90:91], 17, v237
v_exp_f32 v213, v85
v_mfma_f32_32x32x16_bf16 a[64:79], a[248:251], v[148:151], a[64:79]
buffer_load_dwordx4 v6, s[28:31], s59 offen offset:2048 sc1 lds
v_cndmask_b32 v118, v233, v176, s[92:93]
v_cndmask_b32 v119, v233, v176, s[94:95]
ds_read_b128 a[220:223], v2 offset:7168
v_add_f32 v229, v229, v212
v_cvt_pk_bf16_f32 v131, v198, v199
v_cmp_le_i32 s[92:93], 18, v237
v_cmp_le_i32 s[94:95], 19, v237
v_exp_f32 v214, v86
v_mfma_f32_32x32x16_bf16 a[80:95], a[248:251], v[156:159], a[80:95]
v_cndmask_b32 v120, v233, v176, s[88:89]
v_cndmask_b32 v121, v233, v176, s[90:91]
v_add_f32 v229, v229, v213
v_cmp_le_i32 s[88:89], 24, v237
v_cmp_le_i32 s[90:91], 25, v237
v_exp_f32 v215, v87
v_mfma_f32_32x32x16_bf16 a[96:111], a[252:255], v[148:151], a[96:111]
v_cvt_pk_bf16_f32 v136, v208, v209
v_add_f32 v229, v229, v214
v_cndmask_b32 v122, v233, v176, s[92:93]
v_cndmask_b32 v123, v233, v176, s[94:95]
v_exp_f32 v200, v72
v_cmp_le_i32 s[92:93], 26, v237
v_cmp_le_i32 s[94:95], 27, v237
v_add_f32 v229, v229, v215
v_mfma_f32_32x32x16_bf16 a[112:127], a[252:255], v[156:159], a[112:127]
buffer_load_dwordx4 v6, s[28:31], s59 offen offset:3072 sc1 lds
s_add_u32 s59, s59, 32768
s_cmp_eq_u32 s59, s61
s_cselect_b32 s59, 8192, s59
s_cselect_b32 s61, -1, s61
v_cndmask_b32 v124, v233, v176, s[88:89]
v_cndmask_b32 v125, v233, v176, s[90:91]
v_exp_f32 v201, v73
v_cndmask_b32 v126, v233, v176, s[92:93]
v_cndmask_b32 v127, v233, v176, s[94:95]
v_cvt_pk_bf16_f32 v137, v210, v211
v_add_f32 v228, v228, v200
s_waitcnt lgkmcnt(0)
v_mfma_f32_32x32x16_bf16 v[96:111], a[192:195], a[128:131], v[96:111]
v_exp_f32 v202, v74
v_add_f32 v228, v228, v201
ds_read_b128 a[224:227], v3 offset:0
v_mfma_f32_32x32x16_bf16 v[112:127], a[192:195], a[160:163], v[112:127]
v_exp_f32 v203, v75
v_cvt_pk_bf16_f32 v138, v212, v213
v_add_f32 v228, v228, v202
s_add_u32 m0, s56, s62
v_mfma_f32_32x32x16_bf16 v[96:111], a[196:199], a[132:135], v[96:111]
v_exp_f32 v204, v76
ds_read_b128 a[228:231], v3 offset:1024
v_add_f32 v228, v228, v203
v_exp_f32 v205, v77
v_mfma_f32_32x32x16_bf16 v[112:127], a[196:199], a[164:167], v[112:127]
v_cvt_pk_bf16_f32 v139, v214, v215
v_add_f32 v228, v228, v204
v_exp_f32 v206, v78
v_mfma_f32_32x32x16_bf16 v[96:111], a[200:203], a[136:139], v[96:111]
ds_read_b128 a[232:235], v3 offset:2048
v_add_f32 v228, v228, v205
v_exp_f32 v207, v79
buffer_load_dwordx4 v6, s[28:31], s58 offen offset:0 sc1 lds
v_mfma_f32_32x32x16_bf16 v[112:127], a[200:203], a[168:171], v[112:127]
v_add_f32 v228, v228, v206
v_exp_f32 v216, v88
ds_read_b128 a[236:239], v3 offset:3072
v_add_f32 v228, v228, v207
v_mfma_f32_32x32x16_bf16 v[96:111], a[204:207], a[140:143], v[96:111]
v_exp_f32 v217, v89
v_add_f32 v229, v229, v216
v_mfma_f32_32x32x16_bf16 v[112:127], a[204:207], a[172:175], v[112:127]
v_exp_f32 v218, v90
ds_read_b128 a[240:243], v3 offset:4096
v_add_f32 v229, v229, v217
buffer_load_dwordx4 v6, s[28:31], s58 offen offset:1024 sc1 lds
v_mfma_f32_32x32x16_bf16 v[96:111], a[208:211], a[144:147], v[96:111]
v_exp_f32 v219, v91
v_add_f32 v229, v229, v218
ds_read_b128 a[244:247], v3 offset:5120
v_mfma_f32_32x32x16_bf16 v[112:127], a[208:211], a[176:179], v[112:127]
v_exp_f32 v220, v92
v_add_f32 v229, v229, v219
v_exp_f32 v221, v93
v_mfma_f32_32x32x16_bf16 v[96:111], a[212:215], a[148:151], v[96:111]
v_add_f32 v229, v229, v220
ds_read_b128 a[248:251], v3 offset:6144
buffer_load_dwordx4 v6, s[28:31], s58 offen offset:2048 sc1 lds
v_exp_f32 v222, v94
v_mfma_f32_32x32x16_bf16 v[112:127], a[212:215], a[180:183], v[112:127]
v_add_f32 v229, v229, v221
v_exp_f32 v223, v95
v_mfma_f32_32x32x16_bf16 v[96:111], a[216:219], a[152:155], v[96:111]
v_add_f32 v229, v229, v222
ds_read_b128 a[252:255], v3 offset:7168
v_add_f32 v229, v229, v223
v_mfma_f32_32x32x16_bf16 v[96:111], a[220:223], a[156:159], v[96:111]
v_max_f32 v232, v228, v229
buffer_load_dwordx4 v6, s[28:31], s58 offen offset:3072 sc1 lds
s_add_u32 s58, s58, 32768
s_cmp_eq_u32 s58, s60
s_cselect_b32 s58, 0, s58
s_cselect_b32 s60, -1, s60
v_mfma_f32_32x32x16_bf16 v[112:127], a[216:219], a[184:187], v[112:127]
v_cmp_lt_f32 vcc, s64, v232
v_mfma_f32_32x32x16_bf16 v[112:127], a[220:223], a[188:191], v[112:127]
s_cbranch_vccnz RX_m0
RR_m0:
LAST:
s_cmp_lg_u32 s75, 0
s_cbranch_scc1 LASTB
s_add_u32 s56, s57, 16384
s_and_b32 s56, s56, 0xffff
v_add_u32 v2, s56, v4
v_add_u32 v3, s57, v5
s_waitcnt lgkmcnt(7)
v_mfma_f32_32x32x16_bf16 a[0:15], a[224:227], v[128:131], a[0:15]
v_add_f32 v230, v230, v228
v_add_f32 v231, v231, v229
v_mfma_f32_32x32x16_bf16 a[16:31], a[224:227], v[136:139], a[16:31]
v_cvt_pk_bf16_f32 v132, v200, v201
v_exp_f32 v192, v96
s_waitcnt vmcnt(12) lgkmcnt(0)
s_barrier
ds_read_b128 a[224:227], v3 offset:0
v_exp_f32 v193, v97
v_cvt_pk_bf16_f32 v133, v202, v203
v_mfma_f32_32x32x16_bf16 a[32:47], a[228:231], v[128:131], a[32:47]
v_exp_f32 v194, v98
v_add_f32 v228, v192, v193
v_cvt_pk_bf16_f32 v134, v204, v205
ds_read_b128 a[192:195], v2 offset:0
v_exp_f32 v195, v99
v_add_f32 v228, v228, v194
v_exp_f32 v196, v100
v_mfma_f32_32x32x16_bf16 a[48:63], a[228:231], v[136:139], a[48:63]
v_cvt_pk_bf16_f32 v135, v206, v207
v_add_f32 v228, v228, v195
ds_read_b128 a[196:199], v2 offset:1024
v_exp_f32 v197, v101
v_add_f32 v228, v228, v196
ds_read_b128 a[228:231], v3 offset:1024
s_xor_b32 s23, s57, 32768
s_add_u32 m0, s23, s63
v_cvt_pk_bf16_f32 v140, v216, v217
v_exp_f32 v198, v102
ds_read_b128 a[200:203], v2 offset:2048
v_add_f32 v228, v228, v197
v_mfma_f32_32x32x16_bf16 a[64:79], a[232:235], v[128:131], a[64:79]
v_exp_f32 v199, v103
v_cvt_pk_bf16_f32 v144, v192, v193
v_add_f32 v228, v228, v198
v_cvt_pk_bf16_f32 v141, v218, v219
v_exp_f32 v208, v112
ds_read_b128 a[204:207], v2 offset:3072
v_add_f32 v228, v228, v199
buffer_load_dwordx4 v6, s[28:31], s59 offen offset:0 sc1 lds
v_exp_f32 v209, v113
v_mfma_f32_32x32x16_bf16 a[80:95], a[232:235], v[136:139], a[80:95]
v_cvt_pk_bf16_f32 v142, v220, v221
v_cvt_pk_bf16_f32 v145, v194, v195
v_exp_f32 v210, v114
ds_read_b128 a[208:211], v2 offset:4096
v_add_f32 v229, v208, v209
ds_read_b128 a[232:235], v3 offset:2048
v_cvt_pk_bf16_f32 v143, v222, v223
v_exp_f32 v211, v115
v_cvt_pk_bf16_f32 v146, v196, v197
v_add_f32 v229, v229, v210
v_mfma_f32_32x32x16_bf16 a[96:111], a[236:239], v[128:131], a[96:111]
ds_read_b128 a[212:215], v2 offset:5120
v_exp_f32 v212, v116
buffer_load_dwordx4 v6, s[28:31], s59 offen offset:1024 sc1 lds
v_add_f32 v229, v229, v211
v_exp_f32 v213, v117
v_cvt_pk_bf16_f32 v147, v198, v199
v_add_f32 v229, v229, v212
ds_read_b128 a[216:219], v2 offset:6144
v_mfma_f32_32x32x16_bf16 a[112:127], a[236:239], v[136:139], a[112:127]
v_exp_f32 v214, v118
v_add_f32 v229, v229, v213
v_exp_f32 v215, v119
buffer_load_dwordx4 v6, s[28:31], s59 offen offset:2048 sc1 lds
ds_read_b128 a[236:239], v3 offset:3072
ds_read_b128 a[220:223], v2 offset:7168
v_cvt_pk_bf16_f32 v152, v208, v209
v_add_f32 v229, v229, v214
v_exp_f32 v200, v104
v_mfma_f32_32x32x16_bf16 a[0:15], a[240:243], v[132:135], a[0:15]
v_add_f32 v229, v229, v215
v_exp_f32 v201, v105
v_cvt_pk_bf16_f32 v153, v210, v211
v_add_f32 v228, v228, v200
v_exp_f32 v202, v106
buffer_load_dwordx4 v6, s[28:31], s59 offen offset:3072 sc1 lds
s_add_u32 s59, s59, 32768
s_cmp_eq_u32 s59, s61
s_cselect_b32 s59, 8192, s59
s_cselect_b32 s61, -1, s61
v_add_f32 v228, v228, v201
v_mfma_f32_32x32x16_bf16 a[16:31], a[240:243], v[140:143], a[16:31]
v_exp_f32 v203, v107
v_cvt_pk_bf16_f32 v154, v212, v213
v_add_f32 v228, v228, v202
v_exp_f32 v204, v108
ds_read_b128 a[240:243], v3 offset:4096
v_add_f32 v228, v228, v203
v_exp_f32 v205, v109
v_mfma_f32_32x32x16_bf16 a[32:47], a[244:247], v[132:135], a[32:47]
s_add_u32 m0, s57, s62
v_add_f32 v228, v228, v204
v_cvt_pk_bf16_f32 v155, v214, v215
v_exp_f32 v206, v110
v_add_f32 v228, v228, v205
v_exp_f32 v207, v111
v_add_f32 v228, v228, v206
v_mfma_f32_32x32x16_bf16 a[48:63], a[244:247], v[140:143], a[48:63]
v_exp_f32 v216, v120
v_add_f32 v228, v228, v207
buffer_load_dwordx4 v6, s[28:31], s58 offen offset:0 sc1 lds
v_exp_f32 v217, v121
ds_read_b128 a[244:247], v3 offset:5120
v_add_f32 v229, v229, v216
v_mfma_f32_32x32x16_bf16 a[64:79], a[248:251], v[132:135], a[64:79]
v_exp_f32 v218, v122
v_add_f32 v229, v229, v217
v_exp_f32 v219, v123
v_add_f32 v229, v229, v218
buffer_load_dwordx4 v6, s[28:31], s58 offen offset:1024 sc1 lds
v_exp_f32 v220, v124
v_mfma_f32_32x32x16_bf16 a[80:95], a[248:251], v[140:143], a[80:95]
v_add_f32 v229, v229, v219
v_exp_f32 v221, v125
v_add_f32 v229, v229, v220
ds_read_b128 a[248:251], v3 offset:6144
v_exp_f32 v222, v126
v_add_f32 v229, v229, v221
buffer_load_dwordx4 v6, s[28:31], s58 offen offset:2048 sc1 lds
v_mfma_f32_32x32x16_bf16 a[96:111], a[252:255], v[132:135], a[96:111]
v_exp_f32 v223, v127
v_add_f32 v229, v229, v222
v_add_f32 v229, v229, v223
v_max_f32 v232, v228, v229
v_mfma_f32_32x32x16_bf16 a[112:127], a[252:255], v[140:143], a[112:127]
buffer_load_dwordx4 v6, s[28:31], s58 offen offset:3072 sc1 lds
s_add_u32 s58, s58, 32768
s_cmp_eq_u32 s58, s60
s_cselect_b32 s58, 0, s58
s_cselect_b32 s60, -1, s60
v_cmp_lt_f32 vcc, s64, v232
ds_read_b128 a[252:255], v3 offset:7168
s_cbranch_vccnz RX_t
RR_t:
v_add_f32 v230, v230, v228
v_add_f32 v231, v231, v229
v_cvt_pk_bf16_f32 v156, v216, v217
v_cvt_pk_bf16_f32 v157, v218, v219
v_cvt_pk_bf16_f32 v158, v220, v221
v_cvt_pk_bf16_f32 v159, v222, v223
s_waitcnt lgkmcnt(15)
v_mfma_f32_32x32x16_bf16 a[16:31], a[224:227], v[152:155], a[16:31]
v_cvt_pk_bf16_f32 v148, v200, v201
buffer_load_dwordx4 a[128:131], v10, s[32:35], s73 offen offset:0
s_waitcnt lgkmcnt(3)
v_mfma_f32_32x32x16_bf16 a[16:31], a[240:243], v[156:159], a[16:31]
buffer_load_dwordx4 a[132:135], v10, s[32:35], s73 offen offset:1024
v_cvt_pk_bf16_f32 v149, v202, v203
v_mov_b32 v224, v230
buffer_load_dwordx4 a[136:139], v10, s[32:35], s73 offen offset:2048
v_mov_b32 v225, v231
v_cvt_pk_bf16_f32 v150, v204, v205
v_mfma_f32_32x32x16_bf16 a[48:63], a[228:231], v[152:155], a[48:63]
buffer_load_dwordx4 a[140:143], v10, s[32:35], s73 offen offset:3072
v_permlane32_swap_b32 v230, v224
s_add_u32 s23, s73, 4096
buffer_load_dwordx4 a[144:147], v10, s[32:35], s23 offen offset:0
v_permlane32_swap_b32 v231, v225
v_cvt_pk_bf16_f32 v151, v206, v207
s_waitcnt lgkmcnt(2)
v_mfma_f32_32x32x16_bf16 a[48:63], a[244:247], v[156:159], a[48:63]
s_add_u32 s23, s73, 4096
buffer_load_dwordx4 a[148:151], v10, s[32:35], s23 offen offset:1024
v_add_f32 v230, v230, v224
s_add_u32 s23, s73, 4096
buffer_load_dwordx4 a[152:155], v10, s[32:35], s23 offen offset:2048
v_add_f32 v227, v231, v225
v_sub_f32 v228, 0, v160
v_mfma_f32_32x32x16_bf16 a[80:95], a[232:235], v[152:155], a[80:95]
s_add_u32 s23, s73, 4096
buffer_load_dwordx4 a[156:159], v10, s[32:35], s23 offen offset:3072
v_sub_f32 v226, 0, v176
buffer_load_dwordx4 a[160:163], v11, s[32:35], s73 offen offset:0
v_cmp_lt_f32 vcc, 0, v230
s_waitcnt lgkmcnt(1)
v_mfma_f32_32x32x16_bf16 a[80:95], a[248:251], v[156:159], a[80:95]
buffer_load_dwordx4 a[164:167], v11, s[32:35], s73 offen offset:1024
v_cndmask_b32 v228, v233, v228, vcc
buffer_load_dwordx4 a[168:171], v11, s[32:35], s73 offen offset:2048
v_cmp_lt_f32 vcc, 0, v227
v_mfma_f32_32x32x16_bf16 a[112:127], a[236:239], v[152:155], a[112:127]
buffer_load_dwordx4 a[172:175], v11, s[32:35], s73 offen offset:3072
v_cndmask_b32 v226, v233, v226, vcc
s_add_u32 s23, s73, 4096
buffer_load_dwordx4 a[176:179], v11, s[32:35], s23 offen offset:0
s_xor_b32 s23, s56, 32768
v_add_u32 v8, s23, v14
s_waitcnt lgkmcnt(0)
v_mfma_f32_32x32x16_bf16 a[112:127], a[252:255], v[156:159], a[112:127]
s_add_u32 s23, s73, 4096
buffer_load_dwordx4 a[180:183], v11, s[32:35], s23 offen offset:1024
ds_write_b64 v8, v[226:227]
s_add_u32 s23, s73, 4096
buffer_load_dwordx4 a[184:187], v11, s[32:35], s23 offen offset:2048
v_xor_b32 v8, 0x400, v8
v_mfma_f32_32x32x16_bf16 a[0:15], a[224:227], v[144:147], a[0:15]
s_add_u32 s23, s73, 4096
buffer_load_dwordx4 a[188:191], v11, s[32:35], s23 offen offset:3072
v_accvgpr_read_b32 v192, a16
v_accvgpr_read_b32 v193, a17
v_accvgpr_read_b32 v194, a18
v_accvgpr_read_b32 v195, a19
v_accvgpr_read_b32 v196, a20
v_accvgpr_read_b32 v197, a21
v_mfma_f32_32x32x16_bf16 a[0:15], a[240:243], v[148:151], a[0:15]
v_accvgpr_read_b32 v198, a22
v_accvgpr_read_b32 v199, a23
v_cvt_pk_bf16_f32 v64, v192, v193
v_cvt_pk_bf16_f32 v65, v194, v195
v_cvt_pk_bf16_f32 v66, v196, v197
v_cvt_pk_bf16_f32 v67, v198, v199
ds_write_b128 v12, v[64:67] offset:0
v_accvgpr_read_b32 v200, a24
v_accvgpr_read_b32 v201, a25
v_accvgpr_read_b32 v202, a26
v_accvgpr_read_b32 v203, a27
v_accvgpr_read_b32 v204, a28
v_mfma_f32_32x32x16_bf16 a[32:47], a[228:231], v[144:147], a[32:47]
v_accvgpr_read_b32 v205, a29
v_accvgpr_read_b32 v206, a30
v_accvgpr_read_b32 v207, a31
v_cvt_pk_bf16_f32 v68, v200, v201
v_cvt_pk_bf16_f32 v69, v202, v203
v_cvt_pk_bf16_f32 v70, v204, v205
v_cvt_pk_bf16_f32 v71, v206, v207
ds_write_b128 v12, v[68:71] offset:1024
v_accvgpr_read_b32 v208, a48
v_accvgpr_read_b32 v209, a49
v_accvgpr_read_b32 v210, a50
v_accvgpr_read_b32 v211, a51
v_accvgpr_read_b32 v212, a52
v_mfma_f32_32x32x16_bf16 a[32:47], a[244:247], v[148:151], a[32:47]
v_accvgpr_read_b32 v213, a53
v_accvgpr_read_b32 v214, a54
v_accvgpr_read_b32 v215, a55
v_cvt_pk_bf16_f32 v72, v208, v209
v_cvt_pk_bf16_f32 v73, v210, v211
v_cvt_pk_bf16_f32 v74, v212, v213
v_cvt_pk_bf16_f32 v75, v214, v215
ds_write_b128 v12, v[72:75] offset:2048
v_accvgpr_read_b32 v216, a56
v_accvgpr_read_b32 v217, a57
v_accvgpr_read_b32 v218, a58
v_accvgpr_read_b32 v219, a59
v_mfma_f32_32x32x16_bf16 a[64:79], a[232:235], v[144:147], a[64:79]
v_accvgpr_read_b32 v220, a60
v_accvgpr_read_b32 v221, a61
v_accvgpr_read_b32 v222, a62
v_accvgpr_read_b32 v223, a63
v_cvt_pk_bf16_f32 v76, v216, v217
v_cvt_pk_bf16_f32 v77, v218, v219
v_cvt_pk_bf16_f32 v78, v220, v221
v_cvt_pk_bf16_f32 v79, v222, v223
ds_write_b128 v12, v[76:79] offset:3072
v_accvgpr_read_b32 v192, a80
v_accvgpr_read_b32 v193, a81
v_accvgpr_read_b32 v194, a82
v_mfma_f32_32x32x16_bf16 a[64:79], a[248:251], v[148:151], a[64:79]
v_accvgpr_read_b32 v195, a83
v_accvgpr_read_b32 v196, a84
v_accvgpr_read_b32 v197, a85
v_accvgpr_read_b32 v198, a86
v_accvgpr_read_b32 v199, a87
v_cvt_pk_bf16_f32 v80, v192, v193
v_cvt_pk_bf16_f32 v81, v194, v195
v_cvt_pk_bf16_f32 v82, v196, v197
v_cvt_pk_bf16_f32 v83, v198, v199
ds_write_b128 v12, v[80:83] offset:4096
v_accvgpr_read_b32 v200, a88
v_accvgpr_read_b32 v201, a89
v_mfma_f32_32x32x16_bf16 a[96:111], a[236:239], v[144:147], a[96:111]
v_accvgpr_read_b32 v202, a90
v_accvgpr_read_b32 v203, a91
v_accvgpr_read_b32 v204, a92
v_accvgpr_read_b32 v205, a93
v_accvgpr_read_b32 v206, a94
v_accvgpr_read_b32 v207, a95
v_cvt_pk_bf16_f32 v84, v200, v201
v_cvt_pk_bf16_f32 v85, v202, v203
v_cvt_pk_bf16_f32 v86, v204, v205
v_cvt_pk_bf16_f32 v87, v206, v207
ds_write_b128 v12, v[84:87] offset:5120
v_accvgpr_read_b32 v208, a112
v_accvgpr_read_b32 v209, a113
v_mfma_f32_32x32x16_bf16 a[96:111], a[252:255], v[148:151], a[96:111]
v_accvgpr_read_b32 v210, a114
v_accvgpr_read_b32 v211, a115
v_accvgpr_read_b32 v212, a116
v_accvgpr_read_b32 v213, a117
v_accvgpr_read_b32 v214, a118
v_accvgpr_read_b32 v215, a119
v_cvt_pk_bf16_f32 v88, v208, v209
v_cvt_pk_bf16_f32 v89, v210, v211
v_cvt_pk_bf16_f32 v90, v212, v213
v_cvt_pk_bf16_f32 v91, v214, v215
ds_write_b128 v12, v[88:91] offset:6144
v_accvgpr_read_b32 v216, a120
v_accvgpr_read_b32 v217, a121
v_accvgpr_read_b32 v218, a122
v_accvgpr_read_b32 v219, a123
v_accvgpr_read_b32 v220, a124
v_accvgpr_read_b32 v221, a125
v_accvgpr_read_b32 v222, a126
v_accvgpr_read_b32 v223, a127
v_cvt_pk_bf16_f32 v92, v216, v217
v_cvt_pk_bf16_f32 v93, v218, v219
v_cvt_pk_bf16_f32 v94, v220, v221
v_cvt_pk_bf16_f32 v95, v222, v223
ds_write_b128 v12, v[92:95] offset:7168
s_waitcnt vmcnt(0) lgkmcnt(0)
s_barrier
ds_read_b64 v[224:225], v8
ds_read_b128 v[96:99], v13 offset:0
ds_read_b128 v[100:103], v13 offset:1024
ds_read_b128 v[104:107], v13 offset:2048
ds_read_b128 v[108:111], v13 offset:3072
ds_read_b128 v[112:115], v13 offset:4096
ds_read_b128 v[116:119], v13 offset:5120
ds_read_b128 v[120:123], v13 offset:6144
ds_read_b128 v[124:127], v13 offset:7168
s_waitcnt lgkmcnt(8)
v_max_f32 v232, v228, v224
v_sub_f32 v228, v228, v232
v_sub_f32 v224, v224, v232
v_exp_f32 v228, v228
v_exp_f32 v224, v224
v_mul_f32 v230, v230, v228
v_fmac_f32 v230, v224, v225
v_rcp_f32 v230, v230
s_nop 0
v_mul_f32 v228, v228, v230
v_mul_f32 v224, v224, v230
v_mov_b32 v229, v228
v_mov_b32 v225, v224
s_lshl_b32 s23, s74, 3
s_lshl_b32 s3, s20, 1
s_and_b32 s3, s3, 2
s_or_b32 s3, s3, s19
s_lshl_b32 s3, s3, 1
s_add_u32 s23, s23, s3
s_mul_i32 s23, s23, 175104
s_lshl_b32 s3, s21, 12
s_add_u32 s3, s3, s23
v_accvgpr_read_b32 v192, a0
v_accvgpr_read_b32 v193, a1
v_accvgpr_read_b32 v194, a2
v_accvgpr_read_b32 v195, a3
v_accvgpr_read_b32 v196, a4
v_accvgpr_read_b32 v197, a5
v_accvgpr_read_b32 v198, a6
v_accvgpr_read_b32 v199, a7
s_waitcnt lgkmcnt(7)
v_lshlrev_b32 v200, 16, v96
v_and_b32 v201, 0xffff0000, v96
v_lshlrev_b32 v202, 16, v97
v_and_b32 v203, 0xffff0000, v97
v_lshlrev_b32 v204, 16, v98
v_and_b32 v205, 0xffff0000, v98
v_lshlrev_b32 v206, 16, v99
v_and_b32 v207, 0xffff0000, v99
v_pk_mul_f32 v[192:193], v[192:193], v[228:229]
v_pk_mul_f32 v[194:195], v[194:195], v[228:229]
v_pk_mul_f32 v[196:197], v[196:197], v[228:229]
v_pk_mul_f32 v[198:199], v[198:199], v[228:229]
v_pk_fma_f32 v[192:193], v[200:201], v[224:225], v[192:193]
v_pk_fma_f32 v[194:195], v[202:203], v[224:225], v[194:195]
v_pk_fma_f32 v[196:197], v[204:205], v[224:225], v[196:197]
v_pk_fma_f32 v[198:199], v[206:207], v[224:225], v[198:199]
v_cvt_pk_bf16_f32 v64, v192, v193
v_cvt_pk_bf16_f32 v65, v194, v195
v_cvt_pk_bf16_f32 v66, v196, v197
v_cvt_pk_bf16_f32 v67, v198, v199
buffer_store_dwordx4 v[64:67], v15, s[48:51], s3 offen offset:0 sc1
v_accvgpr_read_b32 v208, a8
v_accvgpr_read_b32 v209, a9
v_accvgpr_read_b32 v210, a10
v_accvgpr_read_b32 v211, a11
v_accvgpr_read_b32 v212, a12
v_accvgpr_read_b32 v213, a13
v_accvgpr_read_b32 v214, a14
v_accvgpr_read_b32 v215, a15
s_waitcnt lgkmcnt(6)
v_lshlrev_b32 v216, 16, v100
v_and_b32 v217, 0xffff0000, v100
v_lshlrev_b32 v218, 16, v101
v_and_b32 v219, 0xffff0000, v101
v_lshlrev_b32 v220, 16, v102
v_and_b32 v221, 0xffff0000, v102
v_lshlrev_b32 v222, 16, v103
v_and_b32 v223, 0xffff0000, v103
v_pk_mul_f32 v[208:209], v[208:209], v[228:229]
v_pk_mul_f32 v[210:211], v[210:211], v[228:229]
v_pk_mul_f32 v[212:213], v[212:213], v[228:229]
v_pk_mul_f32 v[214:215], v[214:215], v[228:229]
v_pk_fma_f32 v[208:209], v[216:217], v[224:225], v[208:209]
v_pk_fma_f32 v[210:211], v[218:219], v[224:225], v[210:211]
v_pk_fma_f32 v[212:213], v[220:221], v[224:225], v[212:213]
v_pk_fma_f32 v[214:215], v[222:223], v[224:225], v[214:215]
v_cvt_pk_bf16_f32 v68, v208, v209
v_cvt_pk_bf16_f32 v69, v210, v211
v_cvt_pk_bf16_f32 v70, v212, v213
v_cvt_pk_bf16_f32 v71, v214, v215
buffer_store_dwordx4 v[68:71], v15, s[48:51], s3 offen offset:512 sc1
v_accvgpr_read_b32 v192, a32
v_accvgpr_read_b32 v193, a33
v_accvgpr_read_b32 v194, a34
v_accvgpr_read_b32 v195, a35
v_accvgpr_read_b32 v196, a36
v_accvgpr_read_b32 v197, a37
v_accvgpr_read_b32 v198, a38
v_accvgpr_read_b32 v199, a39
s_waitcnt lgkmcnt(5)
v_lshlrev_b32 v200, 16, v104
v_and_b32 v201, 0xffff0000, v104
v_lshlrev_b32 v202, 16, v105
v_and_b32 v203, 0xffff0000, v105
v_lshlrev_b32 v204, 16, v106
v_and_b32 v205, 0xffff0000, v106
v_lshlrev_b32 v206, 16, v107
v_and_b32 v207, 0xffff0000, v107
v_pk_mul_f32 v[192:193], v[192:193], v[228:229]
v_pk_mul_f32 v[194:195], v[194:195], v[228:229]
v_pk_mul_f32 v[196:197], v[196:197], v[228:229]
v_pk_mul_f32 v[198:199], v[198:199], v[228:229]
v_pk_fma_f32 v[192:193], v[200:201], v[224:225], v[192:193]
v_pk_fma_f32 v[194:195], v[202:203], v[224:225], v[194:195]
v_pk_fma_f32 v[196:197], v[204:205], v[224:225], v[196:197]
v_pk_fma_f32 v[198:199], v[206:207], v[224:225], v[198:199]
v_cvt_pk_bf16_f32 v72, v192, v193
v_cvt_pk_bf16_f32 v73, v194, v195
v_cvt_pk_bf16_f32 v74, v196, v197
v_cvt_pk_bf16_f32 v75, v198, v199
buffer_store_dwordx4 v[72:75], v15, s[48:51], s3 offen offset:1024 sc1
v_accvgpr_read_b32 v208, a40
v_accvgpr_read_b32 v209, a41
v_accvgpr_read_b32 v210, a42
v_accvgpr_read_b32 v211, a43
v_accvgpr_read_b32 v212, a44
v_accvgpr_read_b32 v213, a45
v_accvgpr_read_b32 v214, a46
v_accvgpr_read_b32 v215, a47
s_waitcnt lgkmcnt(4)
v_lshlrev_b32 v216, 16, v108
v_and_b32 v217, 0xffff0000, v108
v_lshlrev_b32 v218, 16, v109
v_and_b32 v219, 0xffff0000, v109
v_lshlrev_b32 v220, 16, v110
v_and_b32 v221, 0xffff0000, v110
v_lshlrev_b32 v222, 16, v111
v_and_b32 v223, 0xffff0000, v111
v_pk_mul_f32 v[208:209], v[208:209], v[228:229]
v_pk_mul_f32 v[210:211], v[210:211], v[228:229]
v_pk_mul_f32 v[212:213], v[212:213], v[228:229]
v_pk_mul_f32 v[214:215], v[214:215], v[228:229]
v_pk_fma_f32 v[208:209], v[216:217], v[224:225], v[208:209]
v_pk_fma_f32 v[210:211], v[218:219], v[224:225], v[210:211]
v_pk_fma_f32 v[212:213], v[220:221], v[224:225], v[212:213]
v_pk_fma_f32 v[214:215], v[222:223], v[224:225], v[214:215]
v_cvt_pk_bf16_f32 v76, v208, v209
v_cvt_pk_bf16_f32 v77, v210, v211
v_cvt_pk_bf16_f32 v78, v212, v213
v_cvt_pk_bf16_f32 v79, v214, v215
buffer_store_dwordx4 v[76:79], v15, s[48:51], s3 offen offset:1536 sc1
v_accvgpr_read_b32 v192, a64
v_accvgpr_read_b32 v193, a65
v_accvgpr_read_b32 v194, a66
v_accvgpr_read_b32 v195, a67
v_accvgpr_read_b32 v196, a68
v_accvgpr_read_b32 v197, a69
v_accvgpr_read_b32 v198, a70
v_accvgpr_read_b32 v199, a71
s_waitcnt lgkmcnt(3)
v_lshlrev_b32 v200, 16, v112
v_and_b32 v201, 0xffff0000, v112
v_lshlrev_b32 v202, 16, v113
v_and_b32 v203, 0xffff0000, v113
v_lshlrev_b32 v204, 16, v114
v_and_b32 v205, 0xffff0000, v114
v_lshlrev_b32 v206, 16, v115
v_and_b32 v207, 0xffff0000, v115
v_pk_mul_f32 v[192:193], v[192:193], v[228:229]
v_pk_mul_f32 v[194:195], v[194:195], v[228:229]
v_pk_mul_f32 v[196:197], v[196:197], v[228:229]
v_pk_mul_f32 v[198:199], v[198:199], v[228:229]
v_pk_fma_f32 v[192:193], v[200:201], v[224:225], v[192:193]
v_pk_fma_f32 v[194:195], v[202:203], v[224:225], v[194:195]
v_pk_fma_f32 v[196:197], v[204:205], v[224:225], v[196:197]
v_pk_fma_f32 v[198:199], v[206:207], v[224:225], v[198:199]
v_cvt_pk_bf16_f32 v80, v192, v193
v_cvt_pk_bf16_f32 v81, v194, v195
v_cvt_pk_bf16_f32 v82, v196, v197
v_cvt_pk_bf16_f32 v83, v198, v199
buffer_store_dwordx4 v[80:83], v15, s[48:51], s3 offen offset:2048 sc1
v_accvgpr_read_b32 v208, a72
v_accvgpr_read_b32 v209, a73
v_accvgpr_read_b32 v210, a74
v_accvgpr_read_b32 v211, a75
v_accvgpr_read_b32 v212, a76
v_accvgpr_read_b32 v213, a77
v_accvgpr_read_b32 v214, a78
v_accvgpr_read_b32 v215, a79
s_waitcnt lgkmcnt(2)
v_lshlrev_b32 v216, 16, v116
v_and_b32 v217, 0xffff0000, v116
v_lshlrev_b32 v218, 16, v117
v_and_b32 v219, 0xffff0000, v117
v_lshlrev_b32 v220, 16, v118
v_and_b32 v221, 0xffff0000, v118
v_lshlrev_b32 v222, 16, v119
v_and_b32 v223, 0xffff0000, v119
v_pk_mul_f32 v[208:209], v[208:209], v[228:229]
v_pk_mul_f32 v[210:211], v[210:211], v[228:229]
v_pk_mul_f32 v[212:213], v[212:213], v[228:229]
v_pk_mul_f32 v[214:215], v[214:215], v[228:229]
v_pk_fma_f32 v[208:209], v[216:217], v[224:225], v[208:209]
v_pk_fma_f32 v[210:211], v[218:219], v[224:225], v[210:211]
v_pk_fma_f32 v[212:213], v[220:221], v[224:225], v[212:213]
v_pk_fma_f32 v[214:215], v[222:223], v[224:225], v[214:215]
v_cvt_pk_bf16_f32 v84, v208, v209
v_cvt_pk_bf16_f32 v85, v210, v211
v_cvt_pk_bf16_f32 v86, v212, v213
v_cvt_pk_bf16_f32 v87, v214, v215
buffer_store_dwordx4 v[84:87], v15, s[48:51], s3 offen offset:2560 sc1
v_accvgpr_read_b32 v192, a96
v_accvgpr_read_b32 v193, a97
v_accvgpr_read_b32 v194, a98
v_accvgpr_read_b32 v195, a99
v_accvgpr_read_b32 v196, a100
v_accvgpr_read_b32 v197, a101
v_accvgpr_read_b32 v198, a102
v_accvgpr_read_b32 v199, a103
s_waitcnt lgkmcnt(1)
v_lshlrev_b32 v200, 16, v120
v_and_b32 v201, 0xffff0000, v120
v_lshlrev_b32 v202, 16, v121
v_and_b32 v203, 0xffff0000, v121
v_lshlrev_b32 v204, 16, v122
v_and_b32 v205, 0xffff0000, v122
v_lshlrev_b32 v206, 16, v123
v_and_b32 v207, 0xffff0000, v123
v_pk_mul_f32 v[192:193], v[192:193], v[228:229]
v_pk_mul_f32 v[194:195], v[194:195], v[228:229]
v_pk_mul_f32 v[196:197], v[196:197], v[228:229]
v_pk_mul_f32 v[198:199], v[198:199], v[228:229]
v_pk_fma_f32 v[192:193], v[200:201], v[224:225], v[192:193]
v_pk_fma_f32 v[194:195], v[202:203], v[224:225], v[194:195]
v_pk_fma_f32 v[196:197], v[204:205], v[224:225], v[196:197]
v_pk_fma_f32 v[198:199], v[206:207], v[224:225], v[198:199]
v_cvt_pk_bf16_f32 v88, v192, v193
v_cvt_pk_bf16_f32 v89, v194, v195
v_cvt_pk_bf16_f32 v90, v196, v197
v_cvt_pk_bf16_f32 v91, v198, v199
buffer_store_dwordx4 v[88:91], v15, s[48:51], s3 offen offset:3072 sc1
v_accvgpr_read_b32 v208, a104
v_accvgpr_read_b32 v209, a105
v_accvgpr_read_b32 v210, a106
v_accvgpr_read_b32 v211, a107
v_accvgpr_read_b32 v212, a108
v_accvgpr_read_b32 v213, a109
v_accvgpr_read_b32 v214, a110
v_accvgpr_read_b32 v215, a111
s_waitcnt lgkmcnt(0)
v_lshlrev_b32 v216, 16, v124
v_and_b32 v217, 0xffff0000, v124
v_lshlrev_b32 v218, 16, v125
v_and_b32 v219, 0xffff0000, v125
v_lshlrev_b32 v220, 16, v126
v_and_b32 v221, 0xffff0000, v126
v_lshlrev_b32 v222, 16, v127
v_and_b32 v223, 0xffff0000, v127
v_pk_mul_f32 v[208:209], v[208:209], v[228:229]
v_pk_mul_f32 v[210:211], v[210:211], v[228:229]
v_pk_mul_f32 v[212:213], v[212:213], v[228:229]
v_pk_mul_f32 v[214:215], v[214:215], v[228:229]
v_pk_fma_f32 v[208:209], v[216:217], v[224:225], v[208:209]
v_pk_fma_f32 v[210:211], v[218:219], v[224:225], v[210:211]
v_pk_fma_f32 v[212:213], v[220:221], v[224:225], v[212:213]
v_pk_fma_f32 v[214:215], v[222:223], v[224:225], v[214:215]
v_cvt_pk_bf16_f32 v92, v208, v209
v_cvt_pk_bf16_f32 v93, v210, v211
v_cvt_pk_bf16_f32 v94, v212, v213
v_cvt_pk_bf16_f32 v95, v214, v215
buffer_store_dwordx4 v[92:95], v15, s[48:51], s3 offen offset:3584 sc1
s_nop 1
s_mov_b32 s74, s16
s_mov_b32 s75, 1
s_mov_b32 s60, -1
s_branch QBLK
LASTB:
s_add_u32 s56, s57, 16384
s_and_b32 s56, s56, 0xffff
v_add_u32 v2, s56, v4
v_add_u32 v3, s57, v5
s_waitcnt lgkmcnt(7)
v_mfma_f32_32x32x16_bf16 a[0:15], a[224:227], v[128:131], a[0:15]
v_add_f32 v230, v230, v228
v_add_f32 v231, v231, v229
v_mfma_f32_32x32x16_bf16 a[16:31], a[224:227], v[136:139], a[16:31]
v_cvt_pk_bf16_f32 v132, v200, v201
v_exp_f32 v192, v96
s_waitcnt vmcnt(12) lgkmcnt(0)
s_barrier
ds_read_b128 a[224:227], v3 offset:0
v_exp_f32 v193, v97
v_cvt_pk_bf16_f32 v133, v202, v203
v_mfma_f32_32x32x16_bf16 a[32:47], a[228:231], v[128:131], a[32:47]
v_exp_f32 v194, v98
v_add_f32 v228, v192, v193
v_cvt_pk_bf16_f32 v134, v204, v205
v_exp_f32 v195, v99
v_add_f32 v228, v228, v194
v_exp_f32 v196, v100
v_mfma_f32_32x32x16_bf16 a[48:63], a[228:231], v[136:139], a[48:63]
v_cvt_pk_bf16_f32 v135, v206, v207
v_add_f32 v228, v228, v195
v_exp_f32 v197, v101
s_bfe_u32 s9, s2, 0x30003
s_lshl_b32 s9, s9, 1
s_and_b32 s3, s2, 1
s_or_b32 s9, s9, s3
s_sub_u32 s3, 15, s9
s_min_u32 s3, s3, s9
s_lshl_b32 s3, s3, 8
v_lshl_add_u32 v59, v1, 2, s3
global_load_dword v63, v59, s[4:5] sc1
v_add_f32 v228, v228, v196
ds_read_b128 a[228:231], v3 offset:1024
v_cvt_pk_bf16_f32 v140, v216, v217
v_exp_f32 v198, v102
v_add_f32 v228, v228, v197
v_mfma_f32_32x32x16_bf16 a[64:79], a[232:235], v[128:131], a[64:79]
s_bfe_u32 s8, s2, 0x20001
s_lshr_b32 s10, s2, 6
v_lshrrev_b32 v24, 5, v1
v_exp_f32 v199, v103
v_cvt_pk_bf16_f32 v144, v192, v193
v_add_f32 v228, v228, v198
v_cvt_pk_bf16_f32 v141, v218, v219
v_exp_f32 v208, v112
v_add_f32 v228, v228, v199
v_bfe_u32 v25, v1, 2, 2
v_bfe_u32 v26, v1, 4, 1
v_and_b32 v27, 3, v1
v_exp_f32 v209, v113
v_mfma_f32_32x32x16_bf16 a[80:95], a[232:235], v[136:139], a[80:95]
v_cvt_pk_bf16_f32 v142, v220, v221
v_cvt_pk_bf16_f32 v145, v194, v195
v_exp_f32 v210, v114
v_lshlrev_b32 v26, 6, v26
v_lshl_add_u32 v28, v24, 3, v25
v_lshl_add_u32 v29, v24, 2, v25
v_add_f32 v229, v208, v209
ds_read_b128 a[232:235], v3 offset:2048
v_cvt_pk_bf16_f32 v143, v222, v223
v_exp_f32 v211, v115
v_cvt_pk_bf16_f32 v146, v196, v197
v_add_f32 v229, v229, v210
v_mfma_f32_32x32x16_bf16 a[96:111], a[236:239], v[128:131], a[96:111]
s_lshl_b32 s11, s18, 4
v_add_u32 v28, s11, v28
v_add_u32 v29, s11, v29
v_exp_f32 v212, v116
v_add_f32 v229, v229, v211
v_exp_f32 v213, v117
v_cvt_pk_bf16_f32 v147, v198, v199
v_add_f32 v229, v229, v212
v_xor_b32 v30, 0, v27
v_lshl_add_u32 v30, v30, 4, v26
v_add_u32 v16, 0, v28
v_mfma_f32_32x32x16_bf16 a[112:127], a[236:239], v[136:139], a[112:127]
v_exp_f32 v214, v118
v_add_f32 v229, v229, v213
v_exp_f32 v215, v119
v_lshl_add_u32 v16, v16, 10, v30
v_add_u32 v18, 0, v29
v_lshl_add_u32 v18, v18, 10, v30
ds_read_b128 a[236:239], v3 offset:3072
v_cvt_pk_bf16_f32 v152, v208, v209
v_add_f32 v229, v229, v214
v_exp_f32 v200, v104
v_mfma_f32_32x32x16_bf16 a[0:15], a[240:243], v[132:135], a[0:15]
v_add_f32 v229, v229, v215
v_exp_f32 v201, v105
v_xor_b32 v30, 2, v27
v_lshl_add_u32 v30, v30, 4, v26
v_add_u32 v17, 3, v28
v_cvt_pk_bf16_f32 v153, v210, v211
v_add_f32 v228, v228, v200
v_exp_f32 v202, v106
v_add_f32 v228, v228, v201
v_mfma_f32_32x32x16_bf16 a[16:31], a[240:243], v[140:143], a[16:31]
v_lshl_add_u32 v17, v17, 10, v30
v_add_u32 v19, 7, v29
v_lshl_add_u32 v19, v19, 10, v30
v_exp_f32 v203, v107
v_cvt_pk_bf16_f32 v154, v212, v213
v_add_f32 v228, v228, v202
v_exp_f32 v204, v108
ds_read_b128 a[240:243], v3 offset:4096
v_add_u32 v20, 174080, v7
s_lshl_b32 s66, s20, 12
s_lshl_b32 s53, s10, 8
v_add_f32 v228, v228, v203
v_exp_f32 v205, v109
v_mfma_f32_32x32x16_bf16 a[32:47], a[244:247], v[132:135], a[32:47]
v_add_f32 v228, v228, v204
v_cvt_pk_bf16_f32 v155, v214, v215
v_exp_f32 v206, v110
s_lshl_b32 s11, s19, 7
s_add_u32 s53, s53, s11
s_lshl_b32 s67, s8, 20
v_add_f32 v228, v228, v205
v_exp_f32 v207, v111
v_add_f32 v228, v228, v206
v_mfma_f32_32x32x16_bf16 a[48:63], a[244:247], v[140:143], a[48:63]
s_add_u32 s67, s67, s53
s_mul_i32 s52, s8, 360448
s_add_u32 s52, s52, s53
v_exp_f32 v216, v120
v_add_f32 v228, v228, v207
v_exp_f32 v217, v121
ds_read_b128 a[244:247], v3 offset:5120
v_add_f32 v229, v229, v216
s_lshl_b32 s53, s9, 3
s_lshl_b32 s11, s20, 1
s_add_u32 s53, s53, s11
v_mfma_f32_32x32x16_bf16 a[64:79], a[248:251], v[132:135], a[64:79]
v_exp_f32 v218, v122
v_add_f32 v229, v229, v217
v_exp_f32 v219, v123
s_mul_i32 s53, s53, 175104
s_lshl_b32 s12, s8, 15
s_add_u32 s12, s12, s53
v_add_f32 v229, v229, v218
v_exp_f32 v220, v124
v_mfma_f32_32x32x16_bf16 a[80:95], a[248:251], v[140:143], a[80:95]
v_add_f32 v229, v229, v219
s_mul_i32 s13, s8, 11264
s_add_u32 s13, s13, s53
s_add_u32 s13, s13, 131072
v_exp_f32 v221, v125
v_add_f32 v229, v229, v220
ds_read_b128 a[248:251], v3 offset:6144
v_exp_f32 v222, v126
v_add_f32 v229, v229, v221
s_add_u32 s14, s8, 1
s_lshr_b32 s14, s14, 2
s_mul_i32 s14, s14, 0x7000000
v_mfma_f32_32x32x16_bf16 a[96:111], a[252:255], v[132:135], a[96:111]
v_exp_f32 v223, v127
v_add_f32 v229, v229, v222
s_add_u32 s14, s14, 1024
s_add_u32 s15, s66, 2048
v_add_f32 v229, v229, v223
v_max_f32 v232, v228, v229
v_mfma_f32_32x32x16_bf16 a[112:127], a[252:255], v[140:143], a[112:127]
v_cmp_lt_f32 vcc, s64, v232
ds_read_b128 a[252:255], v3 offset:7168
s_cbranch_vccnz RX_tb
RR_tb:
v_add_f32 v230, v230, v228
v_add_f32 v231, v231, v229
v_cvt_pk_bf16_f32 v156, v216, v217
v_cvt_pk_bf16_f32 v157, v218, v219
v_cvt_pk_bf16_f32 v158, v220, v221
v_cvt_pk_bf16_f32 v159, v222, v223
s_waitcnt lgkmcnt(7)
v_mfma_f32_32x32x16_bf16 a[16:31], a[224:227], v[152:155], a[16:31]
v_cvt_pk_bf16_f32 v148, v200, v201
s_waitcnt lgkmcnt(3)
v_mfma_f32_32x32x16_bf16 a[16:31], a[240:243], v[156:159], a[16:31]
v_cvt_pk_bf16_f32 v149, v202, v203
v_mov_b32 v224, v230
v_mov_b32 v225, v231
v_cvt_pk_bf16_f32 v150, v204, v205
v_mfma_f32_32x32x16_bf16 a[48:63], a[228:231], v[152:155], a[48:63]
v_permlane32_swap_b32 v230, v224
v_permlane32_swap_b32 v231, v225
v_cvt_pk_bf16_f32 v151, v206, v207
s_waitcnt lgkmcnt(2)
v_mfma_f32_32x32x16_bf16 a[48:63], a[244:247], v[156:159], a[48:63]
v_add_f32 v230, v230, v224
v_add_f32 v227, v231, v225
v_sub_f32 v228, 0, v160
v_mfma_f32_32x32x16_bf16 a[80:95], a[232:235], v[152:155], a[80:95]
v_sub_f32 v226, 0, v176
v_cmp_lt_f32 vcc, 0, v230
s_waitcnt lgkmcnt(1)
v_mfma_f32_32x32x16_bf16 a[80:95], a[248:251], v[156:159], a[80:95]
v_cndmask_b32 v228, v233, v228, vcc
v_cmp_lt_f32 vcc, 0, v227
v_mfma_f32_32x32x16_bf16 a[112:127], a[236:239], v[152:155], a[112:127]
s_nop 0
v_cndmask_b32 v226, v233, v226, vcc
s_xor_b32 s23, s56, 32768
v_add_u32 v8, s23, v14
s_waitcnt lgkmcnt(0)
v_mfma_f32_32x32x16_bf16 a[112:127], a[252:255], v[156:159], a[112:127]
ds_write_b64 v8, v[226:227]
v_xor_b32 v8, 0x400, v8
v_mfma_f32_32x32x16_bf16 a[0:15], a[224:227], v[144:147], a[0:15]
v_accvgpr_read_b32 v192, a16
v_accvgpr_read_b32 v193, a17
v_accvgpr_read_b32 v194, a18
v_accvgpr_read_b32 v195, a19
v_accvgpr_read_b32 v196, a20
v_accvgpr_read_b32 v197, a21
v_mfma_f32_32x32x16_bf16 a[0:15], a[240:243], v[148:151], a[0:15]
v_accvgpr_read_b32 v198, a22
v_accvgpr_read_b32 v199, a23
v_cvt_pk_bf16_f32 v64, v192, v193
v_cvt_pk_bf16_f32 v65, v194, v195
v_cvt_pk_bf16_f32 v66, v196, v197
v_cvt_pk_bf16_f32 v67, v198, v199
ds_write_b128 v12, v[64:67] offset:0
v_accvgpr_read_b32 v200, a24
v_accvgpr_read_b32 v201, a25
v_accvgpr_read_b32 v202, a26
v_accvgpr_read_b32 v203, a27
v_accvgpr_read_b32 v204, a28
v_mfma_f32_32x32x16_bf16 a[32:47], a[228:231], v[144:147], a[32:47]
v_accvgpr_read_b32 v205, a29
v_accvgpr_read_b32 v206, a30
v_accvgpr_read_b32 v207, a31
v_cvt_pk_bf16_f32 v68, v200, v201
v_cvt_pk_bf16_f32 v69, v202, v203
v_cvt_pk_bf16_f32 v70, v204, v205
v_cvt_pk_bf16_f32 v71, v206, v207
ds_write_b128 v12, v[68:71] offset:1024
v_accvgpr_read_b32 v208, a48
v_accvgpr_read_b32 v209, a49
v_accvgpr_read_b32 v210, a50
v_accvgpr_read_b32 v211, a51
v_accvgpr_read_b32 v212, a52
v_mfma_f32_32x32x16_bf16 a[32:47], a[244:247], v[148:151], a[32:47]
v_accvgpr_read_b32 v213, a53
v_accvgpr_read_b32 v214, a54
v_accvgpr_read_b32 v215, a55
v_cvt_pk_bf16_f32 v72, v208, v209
v_cvt_pk_bf16_f32 v73, v210, v211
v_cvt_pk_bf16_f32 v74, v212, v213
v_cvt_pk_bf16_f32 v75, v214, v215
ds_write_b128 v12, v[72:75] offset:2048
v_accvgpr_read_b32 v216, a56
v_accvgpr_read_b32 v217, a57
v_accvgpr_read_b32 v218, a58
v_accvgpr_read_b32 v219, a59
v_mfma_f32_32x32x16_bf16 a[64:79], a[232:235], v[144:147], a[64:79]
v_accvgpr_read_b32 v220, a60
v_accvgpr_read_b32 v221, a61
v_accvgpr_read_b32 v222, a62
v_accvgpr_read_b32 v223, a63
v_cvt_pk_bf16_f32 v76, v216, v217
v_cvt_pk_bf16_f32 v77, v218, v219
v_cvt_pk_bf16_f32 v78, v220, v221
v_cvt_pk_bf16_f32 v79, v222, v223
ds_write_b128 v12, v[76:79] offset:3072
v_accvgpr_read_b32 v192, a80
v_accvgpr_read_b32 v193, a81
v_accvgpr_read_b32 v194, a82
v_mfma_f32_32x32x16_bf16 a[64:79], a[248:251], v[148:151], a[64:79]
v_accvgpr_read_b32 v195, a83
v_accvgpr_read_b32 v196, a84
v_accvgpr_read_b32 v197, a85
v_accvgpr_read_b32 v198, a86
v_accvgpr_read_b32 v199, a87
v_cvt_pk_bf16_f32 v80, v192, v193
v_cvt_pk_bf16_f32 v81, v194, v195
v_cvt_pk_bf16_f32 v82, v196, v197
v_cvt_pk_bf16_f32 v83, v198, v199
ds_write_b128 v12, v[80:83] offset:4096
v_accvgpr_read_b32 v200, a88
v_accvgpr_read_b32 v201, a89
v_mfma_f32_32x32x16_bf16 a[96:111], a[236:239], v[144:147], a[96:111]
v_accvgpr_read_b32 v202, a90
v_accvgpr_read_b32 v203, a91
v_accvgpr_read_b32 v204, a92
v_accvgpr_read_b32 v205, a93
v_accvgpr_read_b32 v206, a94
v_accvgpr_read_b32 v207, a95
v_cvt_pk_bf16_f32 v84, v200, v201
v_cvt_pk_bf16_f32 v85, v202, v203
v_cvt_pk_bf16_f32 v86, v204, v205
v_cvt_pk_bf16_f32 v87, v206, v207
ds_write_b128 v12, v[84:87] offset:5120
v_accvgpr_read_b32 v208, a112
v_accvgpr_read_b32 v209, a113
v_mfma_f32_32x32x16_bf16 a[96:111], a[252:255], v[148:151], a[96:111]
v_accvgpr_read_b32 v210, a114
v_accvgpr_read_b32 v211, a115
v_accvgpr_read_b32 v212, a116
v_accvgpr_read_b32 v213, a117
v_accvgpr_read_b32 v214, a118
v_accvgpr_read_b32 v215, a119
v_cvt_pk_bf16_f32 v88, v208, v209
v_cvt_pk_bf16_f32 v89, v210, v211
v_cvt_pk_bf16_f32 v90, v212, v213
v_cvt_pk_bf16_f32 v91, v214, v215
ds_write_b128 v12, v[88:91] offset:6144
v_accvgpr_read_b32 v216, a120
v_accvgpr_read_b32 v217, a121
v_accvgpr_read_b32 v218, a122
v_accvgpr_read_b32 v219, a123
v_accvgpr_read_b32 v220, a124
v_accvgpr_read_b32 v221, a125
v_accvgpr_read_b32 v222, a126
v_accvgpr_read_b32 v223, a127
v_cvt_pk_bf16_f32 v92, v216, v217
v_cvt_pk_bf16_f32 v93, v218, v219
v_cvt_pk_bf16_f32 v94, v220, v221
v_cvt_pk_bf16_f32 v95, v222, v223
ds_write_b128 v12, v[92:95] offset:7168
s_waitcnt vmcnt(0) lgkmcnt(0)
s_barrier
ds_read_b64 v[224:225], v8
ds_read_b128 v[96:99], v13 offset:0
ds_read_b128 v[100:103], v13 offset:1024
ds_read_b128 v[104:107], v13 offset:2048
ds_read_b128 v[108:111], v13 offset:3072
ds_read_b128 v[112:115], v13 offset:4096
ds_read_b128 v[116:119], v13 offset:5120
ds_read_b128 v[120:123], v13 offset:6144
ds_read_b128 v[124:127], v13 offset:7168
s_waitcnt lgkmcnt(8)
v_max_f32 v232, v228, v224
v_sub_f32 v228, v228, v232
v_sub_f32 v224, v224, v232
v_exp_f32 v228, v228
v_exp_f32 v224, v224
v_mul_f32 v230, v230, v228
v_fmac_f32 v230, v224, v225
v_rcp_f32 v230, v230
s_nop 0
v_mul_f32 v228, v228, v230
v_mul_f32 v224, v224, v230
v_mov_b32 v229, v228
v_mov_b32 v225, v224
s_lshl_b32 s23, s74, 3
s_lshl_b32 s3, s20, 1
s_and_b32 s3, s3, 2
s_or_b32 s3, s3, s19
s_lshl_b32 s3, s3, 1
s_add_u32 s23, s23, s3
s_mul_i32 s23, s23, 175104
s_lshl_b32 s3, s21, 12
s_add_u32 s3, s3, s23
s_lshl_b32 s90, s8, 3
s_lshl_b32 s90, 0xff, s90
s_cmp_ge_u32 s9, 8
s_cselect_b32 s91, s90, 0
s_cselect_b32 s90, 0, s90
s_mov_b32 s88, -1
s_mov_b32 s89, 0
v_cmp_ne_u32 vcc, 1, v63
s_nop 0
s_and_b64 vcc, vcc, s[88:89]
s_cbranch_scc1 SL_fa
SR_fa:
s_add_u32 m0, s66, 0
s_nop 0
buffer_load_dwordx4 v7, s[48:51], s13 offen sc1 lds
buffer_load_dwordx4 v20, s[48:51], s13 offen offset:1024 sc1 lds
s_add_u32 s13, s13, 1024
s_add_u32 m0, s15, 0
s_nop 0
buffer_load_dwordx4 v18, s[40:43], s52 offen lds
buffer_load_dwordx4 v19, s[40:43], s52 offen offset:1024 lds
s_add_u32 s52, s52, 32768
v_accvgpr_read_b32 v192, a0
v_accvgpr_read_b32 v193, a1
v_accvgpr_read_b32 v194, a2
v_accvgpr_read_b32 v195, a3
v_accvgpr_read_b32 v196, a4
v_accvgpr_read_b32 v197, a5
v_accvgpr_read_b32 v198, a6
v_accvgpr_read_b32 v199, a7
s_waitcnt lgkmcnt(7)
v_lshlrev_b32 v200, 16, v96
v_and_b32 v201, 0xffff0000, v96
v_lshlrev_b32 v202, 16, v97
v_and_b32 v203, 0xffff0000, v97
v_lshlrev_b32 v204, 16, v98
v_and_b32 v205, 0xffff0000, v98
v_lshlrev_b32 v206, 16, v99
v_and_b32 v207, 0xffff0000, v99
v_pk_mul_f32 v[192:193], v[192:193], v[228:229]
v_pk_mul_f32 v[194:195], v[194:195], v[228:229]
v_pk_mul_f32 v[196:197], v[196:197], v[228:229]
v_pk_mul_f32 v[198:199], v[198:199], v[228:229]
v_pk_fma_f32 v[192:193], v[200:201], v[224:225], v[192:193]
v_pk_fma_f32 v[194:195], v[202:203], v[224:225], v[194:195]
v_pk_fma_f32 v[196:197], v[204:205], v[224:225], v[196:197]
v_pk_fma_f32 v[198:199], v[206:207], v[224:225], v[198:199]
v_cvt_pk_bf16_f32 v64, v192, v193
v_cvt_pk_bf16_f32 v65, v194, v195
v_cvt_pk_bf16_f32 v66, v196, v197
v_cvt_pk_bf16_f32 v67, v198, v199
buffer_store_dwordx4 v[64:67], v15, s[48:51], s3 offen offset:0 sc1
s_add_u32 m0, s66, 16384
s_nop 0
buffer_load_dwordx4 v7, s[48:51], s13 offen sc1 lds
buffer_load_dwordx4 v20, s[48:51], s13 offen offset:1024 sc1 lds
s_add_u32 s13, s13, 1024
s_add_u32 m0, s15, 16384
s_nop 0
buffer_load_dwordx4 v18, s[40:43], s52 offen lds
buffer_load_dwordx4 v19, s[40:43], s52 offen offset:1024 lds
s_add_u32 s52, s52, 32768
v_accvgpr_read_b32 v208, a8
v_accvgpr_read_b32 v209, a9
v_accvgpr_read_b32 v210, a10
v_accvgpr_read_b32 v211, a11
v_accvgpr_read_b32 v212, a12
v_accvgpr_read_b32 v213, a13
v_accvgpr_read_b32 v214, a14
v_accvgpr_read_b32 v215, a15
s_waitcnt lgkmcnt(6)
v_lshlrev_b32 v216, 16, v100
v_and_b32 v217, 0xffff0000, v100
v_lshlrev_b32 v218, 16, v101
v_and_b32 v219, 0xffff0000, v101
v_lshlrev_b32 v220, 16, v102
v_and_b32 v221, 0xffff0000, v102
v_lshlrev_b32 v222, 16, v103
v_and_b32 v223, 0xffff0000, v103
v_pk_mul_f32 v[208:209], v[208:209], v[228:229]
v_pk_mul_f32 v[210:211], v[210:211], v[228:229]
v_pk_mul_f32 v[212:213], v[212:213], v[228:229]
v_pk_mul_f32 v[214:215], v[214:215], v[228:229]
v_pk_fma_f32 v[208:209], v[216:217], v[224:225], v[208:209]
v_pk_fma_f32 v[210:211], v[218:219], v[224:225], v[210:211]
v_pk_fma_f32 v[212:213], v[220:221], v[224:225], v[212:213]
v_pk_fma_f32 v[214:215], v[222:223], v[224:225], v[214:215]
v_cvt_pk_bf16_f32 v68, v208, v209
v_cvt_pk_bf16_f32 v69, v210, v211
v_cvt_pk_bf16_f32 v70, v212, v213
v_cvt_pk_bf16_f32 v71, v214, v215
buffer_store_dwordx4 v[68:71], v15, s[48:51], s3 offen offset:512 sc1
s_add_u32 m0, s66, 32768
s_nop 0
buffer_load_dwordx4 v7, s[48:51], s13 offen sc1 lds
buffer_load_dwordx4 v20, s[48:51], s13 offen offset:1024 sc1 lds
s_add_u32 s13, s13, 1024
s_add_u32 m0, s15, 32768
s_nop 0
buffer_load_dwordx4 v18, s[40:43], s52 offen lds
buffer_load_dwordx4 v19, s[40:43], s52 offen offset:1024 lds
s_add_u32 s52, s52, 32768
v_accvgpr_read_b32 v192, a32
v_accvgpr_read_b32 v193, a33
v_accvgpr_read_b32 v194, a34
v_accvgpr_read_b32 v195, a35
v_accvgpr_read_b32 v196, a36
v_accvgpr_read_b32 v197, a37
v_accvgpr_read_b32 v198, a38
v_accvgpr_read_b32 v199, a39
s_waitcnt lgkmcnt(5)
v_lshlrev_b32 v200, 16, v104
v_and_b32 v201, 0xffff0000, v104
v_lshlrev_b32 v202, 16, v105
v_and_b32 v203, 0xffff0000, v105
v_lshlrev_b32 v204, 16, v106
v_and_b32 v205, 0xffff0000, v106
v_lshlrev_b32 v206, 16, v107
v_and_b32 v207, 0xffff0000, v107
v_pk_mul_f32 v[192:193], v[192:193], v[228:229]
v_pk_mul_f32 v[194:195], v[194:195], v[228:229]
v_pk_mul_f32 v[196:197], v[196:197], v[228:229]
v_pk_mul_f32 v[198:199], v[198:199], v[228:229]
v_pk_fma_f32 v[192:193], v[200:201], v[224:225], v[192:193]
v_pk_fma_f32 v[194:195], v[202:203], v[224:225], v[194:195]
v_pk_fma_f32 v[196:197], v[204:205], v[224:225], v[196:197]
v_pk_fma_f32 v[198:199], v[206:207], v[224:225], v[198:199]
v_cvt_pk_bf16_f32 v72, v192, v193
v_cvt_pk_bf16_f32 v73, v194, v195
v_cvt_pk_bf16_f32 v74, v196, v197
v_cvt_pk_bf16_f32 v75, v198, v199
buffer_store_dwordx4 v[72:75], v15, s[48:51], s3 offen offset:1024 sc1
s_add_u32 m0, s66, 49152
s_nop 0
buffer_load_dwordx4 v7, s[48:51], s13 offen sc1 lds
buffer_load_dwordx4 v20, s[48:51], s13 offen offset:1024 sc1 lds
s_add_u32 s13, s13, 1024
s_add_u32 m0, s15, 49152
s_nop 0
buffer_load_dwordx4 v18, s[40:43], s52 offen lds
buffer_load_dwordx4 v19, s[40:43], s52 offen offset:1024 lds
s_add_u32 s52, s52, 32768
v_accvgpr_read_b32 v208, a40
v_accvgpr_read_b32 v209, a41
v_accvgpr_read_b32 v210, a42
v_accvgpr_read_b32 v211, a43
v_accvgpr_read_b32 v212, a44
v_accvgpr_read_b32 v213, a45
v_accvgpr_read_b32 v214, a46
v_accvgpr_read_b32 v215, a47
s_waitcnt lgkmcnt(4)
v_lshlrev_b32 v216, 16, v108
v_and_b32 v217, 0xffff0000, v108
v_lshlrev_b32 v218, 16, v109
v_and_b32 v219, 0xffff0000, v109
v_lshlrev_b32 v220, 16, v110
v_and_b32 v221, 0xffff0000, v110
v_lshlrev_b32 v222, 16, v111
v_and_b32 v223, 0xffff0000, v111
v_pk_mul_f32 v[208:209], v[208:209], v[228:229]
v_pk_mul_f32 v[210:211], v[210:211], v[228:229]
v_pk_mul_f32 v[212:213], v[212:213], v[228:229]
v_pk_mul_f32 v[214:215], v[214:215], v[228:229]
v_pk_fma_f32 v[208:209], v[216:217], v[224:225], v[208:209]
v_pk_fma_f32 v[210:211], v[218:219], v[224:225], v[210:211]
v_pk_fma_f32 v[212:213], v[220:221], v[224:225], v[212:213]
v_pk_fma_f32 v[214:215], v[222:223], v[224:225], v[214:215]
v_cvt_pk_bf16_f32 v76, v208, v209
v_cvt_pk_bf16_f32 v77, v210, v211
v_cvt_pk_bf16_f32 v78, v212, v213
v_cvt_pk_bf16_f32 v79, v214, v215
buffer_store_dwordx4 v[76:79], v15, s[48:51], s3 offen offset:1536 sc1
v_accvgpr_read_b32 v192, a64
v_accvgpr_read_b32 v193, a65
v_accvgpr_read_b32 v194, a66
v_accvgpr_read_b32 v195, a67
v_accvgpr_read_b32 v196, a68
v_accvgpr_read_b32 v197, a69
v_accvgpr_read_b32 v198, a70
v_accvgpr_read_b32 v199, a71
s_waitcnt lgkmcnt(3)
v_lshlrev_b32 v200, 16, v112
v_and_b32 v201, 0xffff0000, v112
v_lshlrev_b32 v202, 16, v113
v_and_b32 v203, 0xffff0000, v113
v_lshlrev_b32 v204, 16, v114
v_and_b32 v205, 0xffff0000, v114
v_lshlrev_b32 v206, 16, v115
v_and_b32 v207, 0xffff0000, v115
v_pk_mul_f32 v[192:193], v[192:193], v[228:229]
v_pk_mul_f32 v[194:195], v[194:195], v[228:229]
v_pk_mul_f32 v[196:197], v[196:197], v[228:229]
v_pk_mul_f32 v[198:199], v[198:199], v[228:229]
v_pk_fma_f32 v[192:193], v[200:201], v[224:225], v[192:193]
v_pk_fma_f32 v[194:195], v[202:203], v[224:225], v[194:195]
v_pk_fma_f32 v[196:197], v[204:205], v[224:225], v[196:197]
v_pk_fma_f32 v[198:199], v[206:207], v[224:225], v[198:199]
v_cvt_pk_bf16_f32 v80, v192, v193
v_cvt_pk_bf16_f32 v81, v194, v195
v_cvt_pk_bf16_f32 v82, v196, v197
v_cvt_pk_bf16_f32 v83, v198, v199
buffer_store_dwordx4 v[80:83], v15, s[48:51], s3 offen offset:2048 sc1
v_accvgpr_read_b32 v208, a72
v_accvgpr_read_b32 v209, a73
v_accvgpr_read_b32 v210, a74
v_accvgpr_read_b32 v211, a75
v_accvgpr_read_b32 v212, a76
v_accvgpr_read_b32 v213, a77
v_accvgpr_read_b32 v214, a78
v_accvgpr_read_b32 v215, a79
s_waitcnt lgkmcnt(2)
v_lshlrev_b32 v216, 16, v116
v_and_b32 v217, 0xffff0000, v116
v_lshlrev_b32 v218, 16, v117
v_and_b32 v219, 0xffff0000, v117
v_lshlrev_b32 v220, 16, v118
v_and_b32 v221, 0xffff0000, v118
v_lshlrev_b32 v222, 16, v119
v_and_b32 v223, 0xffff0000, v119
v_pk_mul_f32 v[208:209], v[208:209], v[228:229]
v_pk_mul_f32 v[210:211], v[210:211], v[228:229]
v_pk_mul_f32 v[212:213], v[212:213], v[228:229]
v_pk_mul_f32 v[214:215], v[214:215], v[228:229]
v_pk_fma_f32 v[208:209], v[216:217], v[224:225], v[208:209]
v_pk_fma_f32 v[210:211], v[218:219], v[224:225], v[210:211]
v_pk_fma_f32 v[212:213], v[220:221], v[224:225], v[212:213]
v_pk_fma_f32 v[214:215], v[222:223], v[224:225], v[214:215]
v_cvt_pk_bf16_f32 v84, v208, v209
v_cvt_pk_bf16_f32 v85, v210, v211
v_cvt_pk_bf16_f32 v86, v212, v213
v_cvt_pk_bf16_f32 v87, v214, v215
buffer_store_dwordx4 v[84:87], v15, s[48:51], s3 offen offset:2560 sc1
v_accvgpr_read_b32 v192, a96
v_accvgpr_read_b32 v193, a97
v_accvgpr_read_b32 v194, a98
v_accvgpr_read_b32 v195, a99
v_accvgpr_read_b32 v196, a100
v_accvgpr_read_b32 v197, a101
v_accvgpr_read_b32 v198, a102
v_accvgpr_read_b32 v199, a103
s_waitcnt lgkmcnt(1)
v_lshlrev_b32 v200, 16, v120
v_and_b32 v201, 0xffff0000, v120
v_lshlrev_b32 v202, 16, v121
v_and_b32 v203, 0xffff0000, v121
v_lshlrev_b32 v204, 16, v122
v_and_b32 v205, 0xffff0000, v122
v_lshlrev_b32 v206, 16, v123
v_and_b32 v207, 0xffff0000, v123
v_pk_mul_f32 v[192:193], v[192:193], v[228:229]
v_pk_mul_f32 v[194:195], v[194:195], v[228:229]
v_pk_mul_f32 v[196:197], v[196:197], v[228:229]
v_pk_mul_f32 v[198:199], v[198:199], v[228:229]
v_pk_fma_f32 v[192:193], v[200:201], v[224:225], v[192:193]
v_pk_fma_f32 v[194:195], v[202:203], v[224:225], v[194:195]
v_pk_fma_f32 v[196:197], v[204:205], v[224:225], v[196:197]
v_pk_fma_f32 v[198:199], v[206:207], v[224:225], v[198:199]
v_cvt_pk_bf16_f32 v88, v192, v193
v_cvt_pk_bf16_f32 v89, v194, v195
v_cvt_pk_bf16_f32 v90, v196, v197
v_cvt_pk_bf16_f32 v91, v198, v199
buffer_store_dwordx4 v[88:91], v15, s[48:51], s3 offen offset:3072 sc1
v_accvgpr_read_b32 v208, a104
v_accvgpr_read_b32 v209, a105
v_accvgpr_read_b32 v210, a106
v_accvgpr_read_b32 v211, a107
v_accvgpr_read_b32 v212, a108
v_accvgpr_read_b32 v213, a109
v_accvgpr_read_b32 v214, a110
v_accvgpr_read_b32 v215, a111
s_waitcnt lgkmcnt(0)
v_lshlrev_b32 v216, 16, v124
v_and_b32 v217, 0xffff0000, v124
v_lshlrev_b32 v218, 16, v125
v_and_b32 v219, 0xffff0000, v125
v_lshlrev_b32 v220, 16, v126
v_and_b32 v221, 0xffff0000, v126
v_lshlrev_b32 v222, 16, v127
v_and_b32 v223, 0xffff0000, v127
v_pk_mul_f32 v[208:209], v[208:209], v[228:229]
v_pk_mul_f32 v[210:211], v[210:211], v[228:229]
v_pk_mul_f32 v[212:213], v[212:213], v[228:229]
v_pk_mul_f32 v[214:215], v[214:215], v[228:229]
v_pk_fma_f32 v[208:209], v[216:217], v[224:225], v[208:209]
v_pk_fma_f32 v[210:211], v[218:219], v[224:225], v[210:211]
v_pk_fma_f32 v[212:213], v[220:221], v[224:225], v[212:213]
v_pk_fma_f32 v[214:215], v[222:223], v[224:225], v[214:215]
v_cvt_pk_bf16_f32 v92, v208, v209
v_cvt_pk_bf16_f32 v93, v210, v211
v_cvt_pk_bf16_f32 v94, v212, v213
v_cvt_pk_bf16_f32 v95, v214, v215
buffer_store_dwordx4 v[92:95], v15, s[48:51], s3 offen offset:3584 sc1
s_barrier
s_add_u32 m0, s66, 65536
s_nop 0
buffer_load_dwordx4 v7, s[48:51], s13 offen sc1 lds
buffer_load_dwordx4 v20, s[48:51], s13 offen offset:1024 sc1 lds
s_add_u32 s13, s13, 1024
s_add_u32 m0, s15, 65536
s_nop 0
buffer_load_dwordx4 v18, s[40:43], s52 offen lds
buffer_load_dwordx4 v19, s[40:43], s52 offen offset:1024 lds
s_add_u32 s52, s52, 32768
s_add_u32 m0, s66, 81920
s_nop 0
buffer_load_dwordx4 v7, s[48:51], s13 offen sc1 lds
buffer_load_dwordx4 v20, s[48:51], s13 offen offset:1024 sc1 lds
s_add_u32 s13, s13, 1024
s_add_u32 m0, s15, 81920
s_nop 0
buffer_load_dwordx4 v18, s[40:43], s52 offen lds
buffer_load_dwordx4 v19, s[40:43], s52 offen offset:1024 lds
s_add_u32 s52, s52, 32768
s_add_u32 m0, s66, 98304
s_nop 0
buffer_load_dwordx4 v7, s[48:51], s13 offen sc1 lds
buffer_load_dwordx4 v20, s[48:51], s13 offen offset:1024 sc1 lds
s_add_u32 s13, s13, 1024
s_add_u32 m0, s15, 98304
s_nop 0
buffer_load_dwordx4 v18, s[40:43], s52 offen lds
buffer_load_dwordx4 v19, s[40:43], s52 offen offset:1024 lds
s_add_u32 s52, s52, 32768
v_lshrrev_b32 v14, 4, v1
v_lshlrev_b32 v12, 10, v14
v_and_b32 v14, 1, v14
v_lshl_add_u32 v12, v14, 5, v12
v_bfe_u32 v14, v1, 2, 2
v_lshl_add_u32 v12, v14, 6, v12
v_and_b32 v14, 3, v1
v_lshl_add_u32 v12, v14, 3, v12
v_add_u32 v12, 2048, v12
v_xor_b32 v13, 32, v12
v_lshrrev_b32 v14, 5, v1
v_mul_u32_u24 v14, 2048, v14
s_lshl_b32 s3, s19, 13
v_add3_u32 v12, v12, v14, s3
v_xor_b32 v13, 32, v12
v_add_u32 v14, 0x10000, v12
v_add_u32 v15, 0x10000, v13
s_lshl_b32 s3, s18, 13
s_and_b32 s23, s8, 1
s_lshl_b32 s23, s23, 10
s_add_u32 s3, s3, s23
s_lshr_b32 s23, s8, 1
s_lshl_b32 s23, s23, 12
s_add_u32 s3, s3, s23
v_add_u32 v4, s3, v7
v_xor_b32 v5, 0x400, v4
v_xor_b32 v6, 0x1000, v4
v_xor_b32 v8, 0x1400, v4
v_add_u32 v9, 0x10000, v4
v_add_u32 v10, 0x10000, v5
v_add_u32 v11, 0x10000, v6
v_add_u32 v21, 0x10000, v8
v_and_b32 v3, 15, v1
v_lshlrev_b32 v3, 10, v3
v_bfe_u32 v2, v1, 4, 1
v_lshl_add_u32 v3, v2, 5, v3
v_lshrrev_b32 v2, 5, v1
v_lshl_add_u32 v3, v2, 4, v3
s_lshl_b32 s62, s9, 3
s_lshl_b32 s3, s18, 2
s_add_u32 s62, s62, s3
s_add_u32 s62, s62, s8
s_lshl_b32 s62, s62, 14
s_lshl_b32 s3, s10, 8
s_add_u32 s62, s62, s3
s_lshl_b32 s3, s19, 7
s_add_u32 s62, s62, s3
s_lshl_b32 s3, s2, 4
s_lshl_b32 s23, s20, 2
s_add_u32 s3, s3, s23
s_add_u32 s3, s3, 0x1000
v_mov_b32 v22, s3
v_and_b32 v23, 3, v1
v_lshlrev_b32 v23, 5, v23
v_xor_b32 v23, v23, v22
s_add_u32 s32, s96, 67108864
s_addc_u32 s33, s97, 0
s_mov_b32 s34, 16777216
s_mov_b32 s35, 0x20000
s_waitcnt vmcnt(12)
s_barrier
s_cmp_lg_u32 s20, 0
s_cbranch_scc1 W0_sb
s_mov_b64 exec, 1
global_store_dword v60, v61, s[4:5] offset:128 sc1
s_mov_b64 exec, -1
W0_sb:
ds_read_b64_tr_b16 v[24:25], v12 offset:0
ds_read_b64_tr_b16 v[26:27], v12 offset:512
ds_read_b128 a[128:131], v4 offset:0
ds_read_b128 a[132:135], v5 offset:0
ds_read_b128 a[136:139], v6 offset:0
ds_read_b128 a[140:143], v8 offset:0
ds_read_b64_tr_b16 v[28:29], v13 offset:0
ds_read_b64_tr_b16 v[30:31], v13 offset:512
ds_read_b64_tr_b16 v[32:33], v12 offset:256
ds_read_b64_tr_b16 v[34:35], v12 offset:768
ds_read_b64_tr_b16 v[36:37], v13 offset:256
ds_read_b64_tr_b16 v[38:39], v13 offset:768
s_waitcnt lgkmcnt(9)
v_mfma_f32_16x16x32_bf16 v[64:67], v[24:27], a[128:131], 0
s_waitcnt vmcnt(20)
s_barrier
s_waitcnt lgkmcnt(8)
v_mfma_f32_16x16x32_bf16 v[68:71], v[24:27], a[132:135], 0
ds_read_b64_tr_b16 v[40:41], v12 offset:16384
s_waitcnt lgkmcnt(8)
v_mfma_f32_16x16x32_bf16 v[72:75], v[24:27], a[136:139], 0
ds_read_b64_tr_b16 v[42:43], v12 offset:16896
s_add_u32 m0, s66, 114688
s_waitcnt lgkmcnt(8)
v_mfma_f32_16x16x32_bf16 v[76:79], v[24:27], a[140:143], 0
ds_read_b128 a[144:147], v4 offset:16384
s_waitcnt lgkmcnt(7)
v_mfma_f32_16x16x32_bf16 v[80:83], v[28:31], a[128:131], 0
ds_read_b128 a[148:151], v5 offset:16384
v_mfma_f32_16x16x32_bf16 v[84:87], v[28:31], a[132:135], 0
ds_read_b128 a[152:155], v6 offset:16384
buffer_load_dwordx4 v7, s[48:51], s13 offen sc1 lds
v_mfma_f32_16x16x32_bf16 v[88:91], v[28:31], a[136:139], 0
ds_read_b128 a[156:159], v8 offset:16384
v_mfma_f32_16x16x32_bf16 v[92:95], v[28:31], a[140:143], 0
ds_read_b64_tr_b16 v[44:45], v13 offset:16384
s_waitcnt lgkmcnt(9)
v_mfma_f32_16x16x32_bf16 v[96:99], v[32:35], a[128:131], 0
ds_read_b64_tr_b16 v[46:47], v13 offset:16896
buffer_load_dwordx4 v20, s[48:51], s13 offen offset:1024 sc1 lds
s_add_u32 s13, s13, 1024
s_add_u32 m0, s15, 114688
v_mfma_f32_16x16x32_bf16 v[100:103], v[32:35], a[132:135], 0
ds_read_b64_tr_b16 v[48:49], v12 offset:16640
v_mfma_f32_16x16x32_bf16 v[104:107], v[32:35], a[136:139], 0
ds_read_b64_tr_b16 v[50:51], v12 offset:17152
v_mfma_f32_16x16x32_bf16 v[108:111], v[32:35], a[140:143], 0
ds_read_b64_tr_b16 v[52:53], v13 offset:16640
buffer_load_dwordx4 v18, s[40:43], s52 offen lds
s_waitcnt lgkmcnt(11)
v_mfma_f32_16x16x32_bf16 v[112:115], v[36:39], a[128:131], 0
ds_read_b64_tr_b16 v[54:55], v13 offset:17152
v_mfma_f32_16x16x32_bf16 v[116:119], v[36:39], a[132:135], 0
v_mfma_f32_16x16x32_bf16 v[120:123], v[36:39], a[136:139], 0
buffer_load_dwordx4 v19, s[40:43], s52 offen offset:1024 lds
s_add_u32 s52, s52, 32768
v_mfma_f32_16x16x32_bf16 v[124:127], v[36:39], a[140:143], 0
s_waitcnt lgkmcnt(9)
v_mfma_f32_16x16x32_bf16 v[64:67], v[40:43], a[144:147], v[64:67]
s_waitcnt vmcnt(20)
s_barrier
s_waitcnt lgkmcnt(8)
v_mfma_f32_16x16x32_bf16 v[68:71], v[40:43], a[148:151], v[68:71]
ds_read_b64_tr_b16 v[24:25], v12 offset:32768
s_waitcnt lgkmcnt(8)
v_mfma_f32_16x16x32_bf16 v[72:75], v[40:43], a[152:155], v[72:75]
ds_read_b64_tr_b16 v[26:27], v12 offset:33280
s_add_u32 m0, s66, 0
s_waitcnt lgkmcnt(8)
v_mfma_f32_16x16x32_bf16 v[76:79], v[40:43], a[156:159], v[76:79]
ds_read_b128 a[128:131], v4 offset:32768
s_waitcnt lgkmcnt(7)
v_mfma_f32_16x16x32_bf16 v[80:83], v[44:47], a[144:147], v[80:83]
ds_read_b128 a[132:135], v5 offset:32768
v_mfma_f32_16x16x32_bf16 v[84:87], v[44:47], a[148:151], v[84:87]
ds_read_b128 a[136:139], v6 offset:32768
buffer_load_dwordx4 v7, s[48:51], s13 offen sc1 lds
v_mfma_f32_16x16x32_bf16 v[88:91], v[44:47], a[152:155], v[88:91]
ds_read_b128 a[140:143], v8 offset:32768
v_mfma_f32_16x16x32_bf16 v[92:95], v[44:47], a[156:159], v[92:95]
ds_read_b64_tr_b16 v[28:29], v13 offset:32768
s_waitcnt lgkmcnt(9)
v_mfma_f32_16x16x32_bf16 v[96:99], v[48:51], a[144:147], v[96:99]
ds_read_b64_tr_b16 v[30:31], v13 offset:33280
buffer_load_dwordx4 v20, s[48:51], s13 offen offset:1024 sc1 lds
s_add_u32 s13, s13, 1024
s_add_u32 m0, s15, 0
v_mfma_f32_16x16x32_bf16 v[100:103], v[48:51], a[148:151], v[100:103]
ds_read_b64_tr_b16 v[32:33], v12 offset:33024
v_mfma_f32_16x16x32_bf16 v[104:107], v[48:51], a[152:155], v[104:107]
ds_read_b64_tr_b16 v[34:35], v12 offset:33536
v_mfma_f32_16x16x32_bf16 v[108:111], v[48:51], a[156:159], v[108:111]
ds_read_b64_tr_b16 v[36:37], v13 offset:33024
buffer_load_dwordx4 v18, s[40:43], s52 offen lds
s_waitcnt lgkmcnt(11)
v_mfma_f32_16x16x32_bf16 v[112:115], v[52:55], a[144:147], v[112:115]
ds_read_b64_tr_b16 v[38:39], v13 offset:33536
v_mfma_f32_16x16x32_bf16 v[116:119], v[52:55], a[148:151], v[116:119]
v_mfma_f32_16x16x32_bf16 v[120:123], v[52:55], a[152:155], v[120:123]
buffer_load_dwordx4 v19, s[40:43], s52 offen offset:1024 lds
s_add_u32 s52, s52, 32768
v_mfma_f32_16x16x32_bf16 v[124:127], v[52:55], a[156:159], v[124:127]
s_waitcnt lgkmcnt(9)
v_mfma_f32_16x16x32_bf16 v[64:67], v[24:27], a[128:131], v[64:67]
s_waitcnt vmcnt(20)
s_barrier
global_load_dword v63, v59, s[4:5] sc1
s_waitcnt lgkmcnt(8)
v_mfma_f32_16x16x32_bf16 v[68:71], v[24:27], a[132:135], v[68:71]
ds_read_b64_tr_b16 v[40:41], v12 offset:49152
s_waitcnt lgkmcnt(8)
v_mfma_f32_16x16x32_bf16 v[72:75], v[24:27], a[136:139], v[72:75]
ds_read_b64_tr_b16 v[42:43], v12 offset:49664
s_add_u32 m0, s66, 16384
s_waitcnt lgkmcnt(8)
v_mfma_f32_16x16x32_bf16 v[76:79], v[24:27], a[140:143], v[76:79]
ds_read_b128 a[144:147], v4 offset:49152
s_waitcnt lgkmcnt(7)
v_mfma_f32_16x16x32_bf16 v[80:83], v[28:31], a[128:131], v[80:83]
ds_read_b128 a[148:151], v5 offset:49152
v_mfma_f32_16x16x32_bf16 v[84:87], v[28:31], a[132:135], v[84:87]
ds_read_b128 a[152:155], v6 offset:49152
buffer_load_dwordx4 v7, s[48:51], s13 offen sc1 lds
v_mfma_f32_16x16x32_bf16 v[88:91], v[28:31], a[136:139], v[88:91]
ds_read_b128 a[156:159], v8 offset:49152
v_mfma_f32_16x16x32_bf16 v[92:95], v[28:31], a[140:143], v[92:95]
ds_read_b64_tr_b16 v[44:45], v13 offset:49152
s_waitcnt lgkmcnt(9)
v_mfma_f32_16x16x32_bf16 v[96:99], v[32:35], a[128:131], v[96:99]
ds_read_b64_tr_b16 v[46:47], v13 offset:49664
buffer_load_dwordx4 v20, s[48:51], s13 offen offset:1024 sc1 lds
s_add_u32 s13, s13, s14
s_add_u32 m0, s15, 16384
v_mfma_f32_16x16x32_bf16 v[100:103], v[32:35], a[132:135], v[100:103]
ds_read_b64_tr_b16 v[48:49], v12 offset:49408
v_mfma_f32_16x16x32_bf16 v[104:107], v[32:35], a[136:139], v[104:107]
ds_read_b64_tr_b16 v[50:51], v12 offset:49920
v_mfma_f32_16x16x32_bf16 v[108:111], v[32:35], a[140:143], v[108:111]
ds_read_b64_tr_b16 v[52:53], v13 offset:49408
buffer_load_dwordx4 v18, s[40:43], s52 offen lds
s_waitcnt lgkmcnt(11)
v_mfma_f32_16x16x32_bf16 v[112:115], v[36:39], a[128:131], v[112:115]
ds_read_b64_tr_b16 v[54:55], v13 offset:49920
v_mfma_f32_16x16x32_bf16 v[116:119], v[36:39], a[132:135], v[116:119]
v_mfma_f32_16x16x32_bf16 v[120:123], v[36:39], a[136:139], v[120:123]
buffer_load_dwordx4 v19, s[40:43], s52 offen offset:1024 lds
s_add_u32 s52, s52, 32768
v_mfma_f32_16x16x32_bf16 v[124:127], v[36:39], a[140:143], v[124:127]
s_waitcnt lgkmcnt(9)
v_mfma_f32_16x16x32_bf16 v[64:67], v[40:43], a[144:147], v[64:67]
s_waitcnt vmcnt(20)
s_barrier
s_waitcnt lgkmcnt(8)
v_mfma_f32_16x16x32_bf16 v[68:71], v[40:43], a[148:151], v[68:71]
ds_read_b64_tr_b16 v[24:25], v14 offset:0
s_waitcnt lgkmcnt(8)
v_mfma_f32_16x16x32_bf16 v[72:75], v[40:43], a[152:155], v[72:75]
ds_read_b64_tr_b16 v[26:27], v14 offset:512
s_add_u32 m0, s66, 32768
s_waitcnt lgkmcnt(8)
v_mfma_f32_16x16x32_bf16 v[76:79], v[40:43], a[156:159], v[76:79]
ds_read_b128 a[128:131], v9 offset:0
s_waitcnt lgkmcnt(7)
v_mfma_f32_16x16x32_bf16 v[80:83], v[44:47], a[144:147], v[80:83]
ds_read_b128 a[132:135], v10 offset:0
v_mfma_f32_16x16x32_bf16 v[84:87], v[44:47], a[148:151], v[84:87]
ds_read_b128 a[136:139], v11 offset:0
buffer_load_dwordx4 v7, s[48:51], s13 offen sc1 lds
v_mfma_f32_16x16x32_bf16 v[88:91], v[44:47], a[152:155], v[88:91]
ds_read_b128 a[140:143], v21 offset:0
v_mfma_f32_16x16x32_bf16 v[92:95], v[44:47], a[156:159], v[92:95]
ds_read_b64_tr_b16 v[28:29], v15 offset:0
s_waitcnt lgkmcnt(9)
v_mfma_f32_16x16x32_bf16 v[96:99], v[48:51], a[144:147], v[96:99]
ds_read_b64_tr_b16 v[30:31], v15 offset:512
buffer_load_dwordx4 v20, s[48:51], s13 offen offset:1024 sc1 lds
s_add_u32 s13, s13, 1024
s_add_u32 m0, s15, 32768
v_mfma_f32_16x16x32_bf16 v[100:103], v[48:51], a[148:151], v[100:103]
ds_read_b64_tr_b16 v[32:33], v14 offset:256
v_mfma_f32_16x16x32_bf16 v[104:107], v[48:51], a[152:155], v[104:107]
ds_read_b64_tr_b16 v[34:35], v14 offset:768
v_mfma_f32_16x16x32_bf16 v[108:111], v[48:51], a[156:159], v[108:111]
ds_read_b64_tr_b16 v[36:37], v15 offset:256
buffer_load_dwordx4 v18, s[40:43], s52 offen lds
s_waitcnt lgkmcnt(11)
v_mfma_f32_16x16x32_bf16 v[112:115], v[52:55], a[144:147], v[112:115]
ds_read_b64_tr_b16 v[38:39], v15 offset:768
v_mfma_f32_16x16x32_bf16 v[116:119], v[52:55], a[148:151], v[116:119]
v_mfma_f32_16x16x32_bf16 v[120:123], v[52:55], a[152:155], v[120:123]
buffer_load_dwordx4 v19, s[40:43], s52 offen offset:1024 lds
s_add_u32 s52, s52, 32768
v_mfma_f32_16x16x32_bf16 v[124:127], v[52:55], a[156:159], v[124:127]
s_waitcnt lgkmcnt(9)
v_mfma_f32_16x16x32_bf16 v[64:67], v[24:27], a[128:131], v[64:67]
s_waitcnt vmcnt(8)
s_barrier
v_cmp_ne_u32 vcc, 1, v63
s_nop 0
s_and_b64 vcc, vcc, s[90:91]
s_cbranch_scc1 SL_fb
SR_fb:
s_waitcnt lgkmcnt(8)
v_mfma_f32_16x16x32_bf16 v[68:71], v[24:27], a[132:135], v[68:71]
ds_read_b64_tr_b16 v[40:41], v14 offset:16384
s_waitcnt lgkmcnt(8)
v_mfma_f32_16x16x32_bf16 v[72:75], v[24:27], a[136:139], v[72:75]
ds_read_b64_tr_b16 v[42:43], v14 offset:16896
s_add_u32 m0, s66, 49152
s_waitcnt lgkmcnt(8)
v_mfma_f32_16x16x32_bf16 v[76:79], v[24:27], a[140:143], v[76:79]
ds_read_b128 a[144:147], v9 offset:16384
s_waitcnt lgkmcnt(7)
v_mfma_f32_16x16x32_bf16 v[80:83], v[28:31], a[128:131], v[80:83]
ds_read_b128 a[148:151], v10 offset:16384
v_mfma_f32_16x16x32_bf16 v[84:87], v[28:31], a[132:135], v[84:87]
ds_read_b128 a[152:155], v11 offset:16384
buffer_load_dwordx4 v7, s[48:51], s12 offen sc1 lds
v_mfma_f32_16x16x32_bf16 v[88:91], v[28:31], a[136:139], v[88:91]
ds_read_b128 a[156:159], v21 offset:16384
v_mfma_f32_16x16x32_bf16 v[92:95], v[28:31], a[140:143], v[92:95]
ds_read_b64_tr_b16 v[44:45], v15 offset:16384
s_waitcnt lgkmcnt(9)
v_mfma_f32_16x16x32_bf16 v[96:99], v[32:35], a[128:131], v[96:99]
ds_read_b64_tr_b16 v[46:47], v15 offset:16896
buffer_load_dwordx4 v20, s[48:51], s12 offen offset:1024 sc1 lds
s_add_u32 s12, s12, 1024
s_add_u32 m0, s15, 49152
v_mfma_f32_16x16x32_bf16 v[100:103], v[32:35], a[132:135], v[100:103]
ds_read_b64_tr_b16 v[48:49], v14 offset:16640
v_mfma_f32_16x16x32_bf16 v[104:107], v[32:35], a[136:139], v[104:107]
ds_read_b64_tr_b16 v[50:51], v14 offset:17152
v_mfma_f32_16x16x32_bf16 v[108:111], v[32:35], a[140:143], v[108:111]
ds_read_b64_tr_b16 v[52:53], v15 offset:16640
buffer_load_dwordx4 v16, s[36:39], s67 offen lds
s_waitcnt lgkmcnt(11)
v_mfma_f32_16x16x32_bf16 v[112:115], v[36:39], a[128:131], v[112:115]
ds_read_b64_tr_b16 v[54:55], v15 offset:17152
v_mfma_f32_16x16x32_bf16 v[116:119], v[36:39], a[132:135], v[116:119]
v_mfma_f32_16x16x32_bf16 v[120:123], v[36:39], a[136:139], v[120:123]
buffer_load_dwordx4 v17, s[36:39], s67 offen offset:1024 lds
s_add_u32 s67, s67, 32768
v_mfma_f32_16x16x32_bf16 v[124:127], v[36:39], a[140:143], v[124:127]
s_waitcnt lgkmcnt(9)
v_mfma_f32_16x16x32_bf16 v[64:67], v[40:43], a[144:147], v[64:67]
s_waitcnt vmcnt(20)
s_barrier
s_waitcnt lgkmcnt(8)
v_mfma_f32_16x16x32_bf16 v[68:71], v[40:43], a[148:151], v[68:71]
ds_read_b64_tr_b16 v[24:25], v14 offset:32768
s_waitcnt lgkmcnt(8)
v_mfma_f32_16x16x32_bf16 v[72:75], v[40:43], a[152:155], v[72:75]
ds_read_b64_tr_b16 v[26:27], v14 offset:33280
s_add_u32 m0, s66, 65536
s_waitcnt lgkmcnt(8)
v_mfma_f32_16x16x32_bf16 v[76:79], v[40:43], a[156:159], v[76:79]
ds_read_b128 a[128:131], v9 offset:32768
s_waitcnt lgkmcnt(7)
v_mfma_f32_16x16x32_bf16 v[80:83], v[44:47], a[144:147], v[80:83]
ds_read_b128 a[132:135], v10 offset:32768
v_mfma_f32_16x16x32_bf16 v[84:87], v[44:47], a[148:151], v[84:87]
ds_read_b128 a[136:139], v11 offset:32768
buffer_load_dwordx4 v7, s[48:51], s12 offen sc1 lds
v_mfma_f32_16x16x32_bf16 v[88:91], v[44:47], a[152:155], v[88:91]
ds_read_b128 a[140:143], v21 offset:32768
v_mfma_f32_16x16x32_bf16 v[92:95], v[44:47], a[156:159], v[92:95]
ds_read_b64_tr_b16 v[28:29], v15 offset:32768
s_waitcnt lgkmcnt(9)
v_mfma_f32_16x16x32_bf16 v[96:99], v[48:51], a[144:147], v[96:99]
ds_read_b64_tr_b16 v[30:31], v15 offset:33280
buffer_load_dwordx4 v20, s[48:51], s12 offen offset:1024 sc1 lds
s_add_u32 s12, s12, 1024
s_add_u32 m0, s15, 65536
v_mfma_f32_16x16x32_bf16 v[100:103], v[48:51], a[148:151], v[100:103]
ds_read_b64_tr_b16 v[32:33], v14 offset:33024
v_mfma_f32_16x16x32_bf16 v[104:107], v[48:51], a[152:155], v[104:107]
ds_read_b64_tr_b16 v[34:35], v14 offset:33536
v_mfma_f32_16x16x32_bf16 v[108:111], v[48:51], a[156:159], v[108:111]
ds_read_b64_tr_b16 v[36:37], v15 offset:33024
buffer_load_dwordx4 v16, s[36:39], s67 offen lds
s_waitcnt lgkmcnt(11)
v_mfma_f32_16x16x32_bf16 v[112:115], v[52:55], a[144:147], v[112:115]
ds_read_b64_tr_b16 v[38:39], v15 offset:33536
v_mfma_f32_16x16x32_bf16 v[116:119], v[52:55], a[148:151], v[116:119]
v_mfma_f32_16x16x32_bf16 v[120:123], v[52:55], a[152:155], v[120:123]
buffer_load_dwordx4 v17, s[36:39], s67 offen offset:1024 lds
s_add_u32 s67, s67, 32768
v_mfma_f32_16x16x32_bf16 v[124:127], v[52:55], a[156:159], v[124:127]
s_waitcnt lgkmcnt(9)
v_mfma_f32_16x16x32_bf16 v[64:67], v[24:27], a[128:131], v[64:67]
s_waitcnt vmcnt(20)
s_barrier
s_waitcnt lgkmcnt(8)
v_mfma_f32_16x16x32_bf16 v[68:71], v[24:27], a[132:135], v[68:71]
ds_read_b64_tr_b16 v[40:41], v14 offset:49152
s_waitcnt lgkmcnt(8)
v_mfma_f32_16x16x32_bf16 v[72:75], v[24:27], a[136:139], v[72:75]
ds_read_b64_tr_b16 v[42:43], v14 offset:49664
s_add_u32 m0, s66, 81920
s_waitcnt lgkmcnt(8)
v_mfma_f32_16x16x32_bf16 v[76:79], v[24:27], a[140:143], v[76:79]
ds_read_b128 a[144:147], v9 offset:49152
s_waitcnt lgkmcnt(7)
v_mfma_f32_16x16x32_bf16 v[80:83], v[28:31], a[128:131], v[80:83]
ds_read_b128 a[148:151], v10 offset:49152
v_mfma_f32_16x16x32_bf16 v[84:87], v[28:31], a[132:135], v[84:87]
ds_read_b128 a[152:155], v11 offset:49152
buffer_load_dwordx4 v7, s[48:51], s12 offen sc1 lds
v_mfma_f32_16x16x32_bf16 v[88:91], v[28:31], a[136:139], v[88:91]
ds_read_b128 a[156:159], v21 offset:49152
v_mfma_f32_16x16x32_bf16 v[92:95], v[28:31], a[140:143], v[92:95]
ds_read_b64_tr_b16 v[44:45], v15 offset:49152
s_waitcnt lgkmcnt(9)
v_mfma_f32_16x16x32_bf16 v[96:99], v[32:35], a[128:131], v[96:99]
ds_read_b64_tr_b16 v[46:47], v15 offset:49664
buffer_load_dwordx4 v20, s[48:51], s12 offen offset:1024 sc1 lds
s_add_u32 s12, s12, 1024
s_add_u32 m0, s15, 81920
v_mfma_f32_16x16x32_bf16 v[100:103], v[32:35], a[132:135], v[100:103]
ds_read_b64_tr_b16 v[48:49], v14 offset:49408
v_mfma_f32_16x16x32_bf16 v[104:107], v[32:35], a[136:139], v[104:107]
ds_read_b64_tr_b16 v[50:51], v14 offset:49920
v_mfma_f32_16x16x32_bf16 v[108:111], v[32:35], a[140:143], v[108:111]
ds_read_b64_tr_b16 v[52:53], v15 offset:49408
buffer_load_dwordx4 v16, s[36:39], s67 offen lds
s_waitcnt lgkmcnt(11)
v_mfma_f32_16x16x32_bf16 v[112:115], v[36:39], a[128:131], v[112:115]
ds_read_b64_tr_b16 v[54:55], v15 offset:49920
v_mfma_f32_16x16x32_bf16 v[116:119], v[36:39], a[132:135], v[116:119]
v_mfma_f32_16x16x32_bf16 v[120:123], v[36:39], a[136:139], v[120:123]
buffer_load_dwordx4 v17, s[36:39], s67 offen offset:1024 lds
s_add_u32 s67, s67, 32768
v_mfma_f32_16x16x32_bf16 v[124:127], v[36:39], a[140:143], v[124:127]
s_waitcnt lgkmcnt(9)
v_mfma_f32_16x16x32_bf16 v[64:67], v[40:43], a[144:147], v[64:67]
s_waitcnt vmcnt(20)
s_barrier
s_waitcnt lgkmcnt(8)
v_mfma_f32_16x16x32_bf16 v[68:71], v[40:43], a[148:151], v[68:71]
ds_read_b64_tr_b16 v[24:25], v12 offset:0
s_waitcnt lgkmcnt(8)
v_mfma_f32_16x16x32_bf16 v[72:75], v[40:43], a[152:155], v[72:75]
ds_read_b64_tr_b16 v[26:27], v12 offset:512
s_add_u32 m0, s66, 98304
s_waitcnt lgkmcnt(8)
v_mfma_f32_16x16x32_bf16 v[76:79], v[40:43], a[156:159], v[76:79]
ds_read_b128 a[128:131], v4 offset:0
s_waitcnt lgkmcnt(7)
v_mfma_f32_16x16x32_bf16 v[80:83], v[44:47], a[144:147], v[80:83]
ds_read_b128 a[132:135], v5 offset:0
v_mfma_f32_16x16x32_bf16 v[84:87], v[44:47], a[148:151], v[84:87]
ds_read_b128 a[136:139], v6 offset:0
buffer_load_dwordx4 v7, s[48:51], s12 offen sc1 lds
v_mfma_f32_16x16x32_bf16 v[88:91], v[44:47], a[152:155], v[88:91]
ds_read_b128 a[140:143], v8 offset:0
v_mfma_f32_16x16x32_bf16 v[92:95], v[44:47], a[156:159], v[92:95]
ds_read_b64_tr_b16 v[28:29], v13 offset:0
s_waitcnt lgkmcnt(9)
v_mfma_f32_16x16x32_bf16 v[96:99], v[48:51], a[144:147], v[96:99]
ds_read_b64_tr_b16 v[30:31], v13 offset:512
buffer_load_dwordx4 v20, s[48:51], s12 offen offset:1024 sc1 lds
s_add_u32 s12, s12, 1024
s_add_u32 m0, s15, 98304
v_mfma_f32_16x16x32_bf16 v[100:103], v[48:51], a[148:151], v[100:103]
ds_read_b64_tr_b16 v[32:33], v12 offset:256
v_mfma_f32_16x16x32_bf16 v[104:107], v[48:51], a[152:155], v[104:107]
ds_read_b64_tr_b16 v[34:35], v12 offset:768
v_mfma_f32_16x16x32_bf16 v[108:111], v[48:51], a[156:159], v[108:111]
ds_read_b64_tr_b16 v[36:37], v13 offset:256
buffer_load_dwordx4 v16, s[36:39], s67 offen lds
s_waitcnt lgkmcnt(11)
v_mfma_f32_16x16x32_bf16 v[112:115], v[52:55], a[144:147], v[112:115]
ds_read_b64_tr_b16 v[38:39], v13 offset:768
v_mfma_f32_16x16x32_bf16 v[116:119], v[52:55], a[148:151], v[116:119]
v_mfma_f32_16x16x32_bf16 v[120:123], v[52:55], a[152:155], v[120:123]
buffer_load_dwordx4 v17, s[36:39], s67 offen offset:1024 lds
s_add_u32 s67, s67, 32768
v_mfma_f32_16x16x32_bf16 v[124:127], v[52:55], a[156:159], v[124:127]
s_mov_b32 s63, 3
P3L:
s_waitcnt lgkmcnt(9)
v_mfma_f32_16x16x32_bf16 v[64:67], v[24:27], a[128:131], v[64:67]
s_waitcnt vmcnt(20)
s_barrier
s_waitcnt lgkmcnt(8)
v_mfma_f32_16x16x32_bf16 v[68:71], v[24:27], a[132:135], v[68:71]
ds_read_b64_tr_b16 v[40:41], v12 offset:16384
s_waitcnt lgkmcnt(8)
v_mfma_f32_16x16x32_bf16 v[72:75], v[24:27], a[136:139], v[72:75]
ds_read_b64_tr_b16 v[42:43], v12 offset:16896
s_add_u32 m0, s66, 114688
s_waitcnt lgkmcnt(8)
v_mfma_f32_16x16x32_bf16 v[76:79], v[24:27], a[140:143], v[76:79]
ds_read_b128 a[144:147], v4 offset:16384
s_waitcnt lgkmcnt(7)
v_mfma_f32_16x16x32_bf16 v[80:83], v[28:31], a[128:131], v[80:83]
ds_read_b128 a[148:151], v5 offset:16384
v_mfma_f32_16x16x32_bf16 v[84:87], v[28:31], a[132:135], v[84:87]
ds_read_b128 a[152:155], v6 offset:16384
buffer_load_dwordx4 v7, s[48:51], s12 offen sc1 lds
v_mfma_f32_16x16x32_bf16 v[88:91], v[28:31], a[136:139], v[88:91]
ds_read_b128 a[156:159], v8 offset:16384
v_mfma_f32_16x16x32_bf16 v[92:95], v[28:31], a[140:143], v[92:95]
ds_read_b64_tr_b16 v[44:45], v13 offset:16384
s_waitcnt lgkmcnt(9)
v_mfma_f32_16x16x32_bf16 v[96:99], v[32:35], a[128:131], v[96:99]
ds_read_b64_tr_b16 v[46:47], v13 offset:16896
buffer_load_dwordx4 v20, s[48:51], s12 offen offset:1024 sc1 lds
s_add_u32 s12, s12, 1024
s_add_u32 m0, s15, 114688
v_mfma_f32_16x16x32_bf16 v[100:103], v[32:35], a[132:135], v[100:103]
ds_read_b64_tr_b16 v[48:49], v12 offset:16640
v_mfma_f32_16x16x32_bf16 v[104:107], v[32:35], a[136:139], v[104:107]
ds_read_b64_tr_b16 v[50:51], v12 offset:17152
v_mfma_f32_16x16x32_bf16 v[108:111], v[32:35], a[140:143], v[108:111]
ds_read_b64_tr_b16 v[52:53], v13 offset:16640
buffer_load_dwordx4 v16, s[36:39], s67 offen lds
s_waitcnt lgkmcnt(11)
v_mfma_f32_16x16x32_bf16 v[112:115], v[36:39], a[128:131], v[112:115]
ds_read_b64_tr_b16 v[54:55], v13 offset:17152
v_mfma_f32_16x16x32_bf16 v[116:119], v[36:39], a[132:135], v[116:119]
v_mfma_f32_16x16x32_bf16 v[120:123], v[36:39], a[136:139], v[120:123]
buffer_load_dwordx4 v17, s[36:39], s67 offen offset:1024 lds
s_add_u32 s67, s67, 32768
v_mfma_f32_16x16x32_bf16 v[124:127], v[36:39], a[140:143], v[124:127]
s_waitcnt lgkmcnt(9)
v_mfma_f32_16x16x32_bf16 v[64:67], v[40:43], a[144:147], v[64:67]
s_waitcnt vmcnt(20)
s_barrier
s_waitcnt lgkmcnt(8)
v_mfma_f32_16x16x32_bf16 v[68:71], v[40:43], a[148:151], v[68:71]
ds_read_b64_tr_b16 v[24:25], v12 offset:32768
s_waitcnt lgkmcnt(8)
v_mfma_f32_16x16x32_bf16 v[72:75], v[40:43], a[152:155], v[72:75]
ds_read_b64_tr_b16 v[26:27], v12 offset:33280
s_add_u32 m0, s66, 0
s_waitcnt lgkmcnt(8)
v_mfma_f32_16x16x32_bf16 v[76:79], v[40:43], a[156:159], v[76:79]
ds_read_b128 a[128:131], v4 offset:32768
s_waitcnt lgkmcnt(7)
v_mfma_f32_16x16x32_bf16 v[80:83], v[44:47], a[144:147], v[80:83]
ds_read_b128 a[132:135], v5 offset:32768
v_mfma_f32_16x16x32_bf16 v[84:87], v[44:47], a[148:151], v[84:87]
ds_read_b128 a[136:139], v6 offset:32768
buffer_load_dwordx4 v7, s[48:51], s12 offen sc1 lds
v_mfma_f32_16x16x32_bf16 v[88:91], v[44:47], a[152:155], v[88:91]
ds_read_b128 a[140:143], v8 offset:32768
v_mfma_f32_16x16x32_bf16 v[92:95], v[44:47], a[156:159], v[92:95]
ds_read_b64_tr_b16 v[28:29], v13 offset:32768
s_waitcnt lgkmcnt(9)
v_mfma_f32_16x16x32_bf16 v[96:99], v[48:51], a[144:147], v[96:99]
ds_read_b64_tr_b16 v[30:31], v13 offset:33280
buffer_load_dwordx4 v20, s[48:51], s12 offen offset:1024 sc1 lds
s_add_u32 s12, s12, 1024
s_add_u32 m0, s15, 0
v_mfma_f32_16x16x32_bf16 v[100:103], v[48:51], a[148:151], v[100:103]
ds_read_b64_tr_b16 v[32:33], v12 offset:33024
v_mfma_f32_16x16x32_bf16 v[104:107], v[48:51], a[152:155], v[104:107]
ds_read_b64_tr_b16 v[34:35], v12 offset:33536
v_mfma_f32_16x16x32_bf16 v[108:111], v[48:51], a[156:159], v[108:111]
ds_read_b64_tr_b16 v[36:37], v13 offset:33024
buffer_load_dwordx4 v16, s[36:39], s67 offen lds
s_waitcnt lgkmcnt(11)
v_mfma_f32_16x16x32_bf16 v[112:115], v[52:55], a[144:147], v[112:115]
ds_read_b64_tr_b16 v[38:39], v13 offset:33536
v_mfma_f32_16x16x32_bf16 v[116:119], v[52:55], a[148:151], v[116:119]
v_mfma_f32_16x16x32_bf16 v[120:123], v[52:55], a[152:155], v[120:123]
buffer_load_dwordx4 v17, s[36:39], s67 offen offset:1024 lds
s_add_u32 s67, s67, 32768
v_mfma_f32_16x16x32_bf16 v[124:127], v[52:55], a[156:159], v[124:127]
s_waitcnt lgkmcnt(9)
v_mfma_f32_16x16x32_bf16 v[64:67], v[24:27], a[128:131], v[64:67]
s_waitcnt vmcnt(20)
s_barrier
s_waitcnt lgkmcnt(8)
v_mfma_f32_16x16x32_bf16 v[68:71], v[24:27], a[132:135], v[68:71]
ds_read_b64_tr_b16 v[40:41], v12 offset:49152
s_waitcnt lgkmcnt(8)
v_mfma_f32_16x16x32_bf16 v[72:75], v[24:27], a[136:139], v[72:75]
ds_read_b64_tr_b16 v[42:43], v12 offset:49664
s_add_u32 m0, s66, 16384
s_waitcnt lgkmcnt(8)
v_mfma_f32_16x16x32_bf16 v[76:79], v[24:27], a[140:143], v[76:79]
ds_read_b128 a[144:147], v4 offset:49152
s_waitcnt lgkmcnt(7)
v_mfma_f32_16x16x32_bf16 v[80:83], v[28:31], a[128:131], v[80:83]
ds_read_b128 a[148:151], v5 offset:49152
v_mfma_f32_16x16x32_bf16 v[84:87], v[28:31], a[132:135], v[84:87]
ds_read_b128 a[152:155], v6 offset:49152
buffer_load_dwordx4 v7, s[48:51], s12 offen sc1 lds
v_mfma_f32_16x16x32_bf16 v[88:91], v[28:31], a[136:139], v[88:91]
ds_read_b128 a[156:159], v8 offset:49152
v_mfma_f32_16x16x32_bf16 v[92:95], v[28:31], a[140:143], v[92:95]
ds_read_b64_tr_b16 v[44:45], v13 offset:49152
s_waitcnt lgkmcnt(9)
v_mfma_f32_16x16x32_bf16 v[96:99], v[32:35], a[128:131], v[96:99]
ds_read_b64_tr_b16 v[46:47], v13 offset:49664
buffer_load_dwordx4 v20, s[48:51], s12 offen offset:1024 sc1 lds
s_add_u32 s12, s12, 1024
s_add_u32 m0, s15, 16384
v_mfma_f32_16x16x32_bf16 v[100:103], v[32:35], a[132:135], v[100:103]
ds_read_b64_tr_b16 v[48:49], v12 offset:49408
v_mfma_f32_16x16x32_bf16 v[104:107], v[32:35], a[136:139], v[104:107]
ds_read_b64_tr_b16 v[50:51], v12 offset:49920
v_mfma_f32_16x16x32_bf16 v[108:111], v[32:35], a[140:143], v[108:111]
ds_read_b64_tr_b16 v[52:53], v13 offset:49408
buffer_load_dwordx4 v16, s[36:39], s67 offen lds
s_waitcnt lgkmcnt(11)
v_mfma_f32_16x16x32_bf16 v[112:115], v[36:39], a[128:131], v[112:115]
ds_read_b64_tr_b16 v[54:55], v13 offset:49920
v_mfma_f32_16x16x32_bf16 v[116:119], v[36:39], a[132:135], v[116:119]
v_mfma_f32_16x16x32_bf16 v[120:123], v[36:39], a[136:139], v[120:123]
buffer_load_dwordx4 v17, s[36:39], s67 offen offset:1024 lds
s_add_u32 s67, s67, 32768
v_mfma_f32_16x16x32_bf16 v[124:127], v[36:39], a[140:143], v[124:127]
s_waitcnt lgkmcnt(9)
v_mfma_f32_16x16x32_bf16 v[64:67], v[40:43], a[144:147], v[64:67]
s_waitcnt vmcnt(20)
s_barrier
s_waitcnt lgkmcnt(8)
v_mfma_f32_16x16x32_bf16 v[68:71], v[40:43], a[148:151], v[68:71]
ds_read_b64_tr_b16 v[24:25], v14 offset:0
s_waitcnt lgkmcnt(8)
v_mfma_f32_16x16x32_bf16 v[72:75], v[40:43], a[152:155], v[72:75]
ds_read_b64_tr_b16 v[26:27], v14 offset:512
s_add_u32 m0, s66, 32768
s_waitcnt lgkmcnt(8)
v_mfma_f32_16x16x32_bf16 v[76:79], v[40:43], a[156:159], v[76:79]
ds_read_b128 a[128:131], v9 offset:0
s_waitcnt lgkmcnt(7)
v_mfma_f32_16x16x32_bf16 v[80:83], v[44:47], a[144:147], v[80:83]
ds_read_b128 a[132:135], v10 offset:0
v_mfma_f32_16x16x32_bf16 v[84:87], v[44:47], a[148:151], v[84:87]
ds_read_b128 a[136:139], v11 offset:0
buffer_load_dwordx4 v7, s[48:51], s12 offen sc1 lds
v_mfma_f32_16x16x32_bf16 v[88:91], v[44:47], a[152:155], v[88:91]
ds_read_b128 a[140:143], v21 offset:0
v_mfma_f32_16x16x32_bf16 v[92:95], v[44:47], a[156:159], v[92:95]
ds_read_b64_tr_b16 v[28:29], v15 offset:0
s_waitcnt lgkmcnt(9)
v_mfma_f32_16x16x32_bf16 v[96:99], v[48:51], a[144:147], v[96:99]
ds_read_b64_tr_b16 v[30:31], v15 offset:512
buffer_load_dwordx4 v20, s[48:51], s12 offen offset:1024 sc1 lds
s_add_u32 s12, s12, 1024
s_add_u32 m0, s15, 32768
v_mfma_f32_16x16x32_bf16 v[100:103], v[48:51], a[148:151], v[100:103]
ds_read_b64_tr_b16 v[32:33], v14 offset:256
v_mfma_f32_16x16x32_bf16 v[104:107], v[48:51], a[152:155], v[104:107]
ds_read_b64_tr_b16 v[34:35], v14 offset:768
v_mfma_f32_16x16x32_bf16 v[108:111], v[48:51], a[156:159], v[108:111]
ds_read_b64_tr_b16 v[36:37], v15 offset:256
buffer_load_dwordx4 v16, s[36:39], s67 offen lds
s_waitcnt lgkmcnt(11)
v_mfma_f32_16x16x32_bf16 v[112:115], v[52:55], a[144:147], v[112:115]
ds_read_b64_tr_b16 v[38:39], v15 offset:768
v_mfma_f32_16x16x32_bf16 v[116:119], v[52:55], a[148:151], v[116:119]
v_mfma_f32_16x16x32_bf16 v[120:123], v[52:55], a[152:155], v[120:123]
buffer_load_dwordx4 v17, s[36:39], s67 offen offset:1024 lds
s_add_u32 s67, s67, 32768
v_mfma_f32_16x16x32_bf16 v[124:127], v[52:55], a[156:159], v[124:127]
s_waitcnt lgkmcnt(9)
v_mfma_f32_16x16x32_bf16 v[64:67], v[24:27], a[128:131], v[64:67]
s_waitcnt vmcnt(20)
s_barrier
s_waitcnt lgkmcnt(8)
v_mfma_f32_16x16x32_bf16 v[68:71], v[24:27], a[132:135], v[68:71]
ds_read_b64_tr_b16 v[40:41], v14 offset:16384
s_waitcnt lgkmcnt(8)
v_mfma_f32_16x16x32_bf16 v[72:75], v[24:27], a[136:139], v[72:75]
ds_read_b64_tr_b16 v[42:43], v14 offset:16896
s_add_u32 m0, s66, 49152
s_waitcnt lgkmcnt(8)
v_mfma_f32_16x16x32_bf16 v[76:79], v[24:27], a[140:143], v[76:79]
ds_read_b128 a[144:147], v9 offset:16384
s_waitcnt lgkmcnt(7)
v_mfma_f32_16x16x32_bf16 v[80:83], v[28:31], a[128:131], v[80:83]
ds_read_b128 a[148:151], v10 offset:16384
v_mfma_f32_16x16x32_bf16 v[84:87], v[28:31], a[132:135], v[84:87]
ds_read_b128 a[152:155], v11 offset:16384
buffer_load_dwordx4 v7, s[48:51], s12 offen sc1 lds
v_mfma_f32_16x16x32_bf16 v[88:91], v[28:31], a[136:139], v[88:91]
ds_read_b128 a[156:159], v21 offset:16384
v_mfma_f32_16x16x32_bf16 v[92:95], v[28:31], a[140:143], v[92:95]
ds_read_b64_tr_b16 v[44:45], v15 offset:16384
s_waitcnt lgkmcnt(9)
v_mfma_f32_16x16x32_bf16 v[96:99], v[32:35], a[128:131], v[96:99]
ds_read_b64_tr_b16 v[46:47], v15 offset:16896
buffer_load_dwordx4 v20, s[48:51], s12 offen offset:1024 sc1 lds
s_add_u32 s12, s12, 1024
s_add_u32 m0, s15, 49152
v_mfma_f32_16x16x32_bf16 v[100:103], v[32:35], a[132:135], v[100:103]
ds_read_b64_tr_b16 v[48:49], v14 offset:16640
v_mfma_f32_16x16x32_bf16 v[104:107], v[32:35], a[136:139], v[104:107]
ds_read_b64_tr_b16 v[50:51], v14 offset:17152
v_mfma_f32_16x16x32_bf16 v[108:111], v[32:35], a[140:143], v[108:111]
ds_read_b64_tr_b16 v[52:53], v15 offset:16640
buffer_load_dwordx4 v16, s[36:39], s67 offen lds
s_waitcnt lgkmcnt(11)
v_mfma_f32_16x16x32_bf16 v[112:115], v[36:39], a[128:131], v[112:115]
ds_read_b64_tr_b16 v[54:55], v15 offset:17152
v_mfma_f32_16x16x32_bf16 v[116:119], v[36:39], a[132:135], v[116:119]
v_mfma_f32_16x16x32_bf16 v[120:123], v[36:39], a[136:139], v[120:123]
buffer_load_dwordx4 v17, s[36:39], s67 offen offset:1024 lds
s_add_u32 s67, s67, 32768
v_mfma_f32_16x16x32_bf16 v[124:127], v[36:39], a[140:143], v[124:127]
s_waitcnt lgkmcnt(9)
v_mfma_f32_16x16x32_bf16 v[64:67], v[40:43], a[144:147], v[64:67]
s_waitcnt vmcnt(20)
s_barrier
s_waitcnt lgkmcnt(8)
v_mfma_f32_16x16x32_bf16 v[68:71], v[40:43], a[148:151], v[68:71]
ds_read_b64_tr_b16 v[24:25], v14 offset:32768
s_waitcnt lgkmcnt(8)
v_mfma_f32_16x16x32_bf16 v[72:75], v[40:43], a[152:155], v[72:75]
ds_read_b64_tr_b16 v[26:27], v14 offset:33280
s_add_u32 m0, s66, 65536
s_waitcnt lgkmcnt(8)
v_mfma_f32_16x16x32_bf16 v[76:79], v[40:43], a[156:159], v[76:79]
ds_read_b128 a[128:131], v9 offset:32768
s_waitcnt lgkmcnt(7)
v_mfma_f32_16x16x32_bf16 v[80:83], v[44:47], a[144:147], v[80:83]
ds_read_b128 a[132:135], v10 offset:32768
v_mfma_f32_16x16x32_bf16 v[84:87], v[44:47], a[148:151], v[84:87]
ds_read_b128 a[136:139], v11 offset:32768
buffer_load_dwordx4 v7, s[48:51], s12 offen sc1 lds
v_mfma_f32_16x16x32_bf16 v[88:91], v[44:47], a[152:155], v[88:91]
ds_read_b128 a[140:143], v21 offset:32768
v_mfma_f32_16x16x32_bf16 v[92:95], v[44:47], a[156:159], v[92:95]
ds_read_b64_tr_b16 v[28:29], v15 offset:32768
s_waitcnt lgkmcnt(9)
v_mfma_f32_16x16x32_bf16 v[96:99], v[48:51], a[144:147], v[96:99]
ds_read_b64_tr_b16 v[30:31], v15 offset:33280
buffer_load_dwordx4 v20, s[48:51], s12 offen offset:1024 sc1 lds
s_add_u32 s12, s12, 1024
s_add_u32 m0, s15, 65536
v_mfma_f32_16x16x32_bf16 v[100:103], v[48:51], a[148:151], v[100:103]
ds_read_b64_tr_b16 v[32:33], v14 offset:33024
v_mfma_f32_16x16x32_bf16 v[104:107], v[48:51], a[152:155], v[104:107]
ds_read_b64_tr_b16 v[34:35], v14 offset:33536
v_mfma_f32_16x16x32_bf16 v[108:111], v[48:51], a[156:159], v[108:111]
ds_read_b64_tr_b16 v[36:37], v15 offset:33024
buffer_load_dwordx4 v16, s[36:39], s67 offen lds
s_waitcnt lgkmcnt(11)
v_mfma_f32_16x16x32_bf16 v[112:115], v[52:55], a[144:147], v[112:115]
ds_read_b64_tr_b16 v[38:39], v15 offset:33536
v_mfma_f32_16x16x32_bf16 v[116:119], v[52:55], a[148:151], v[116:119]
v_mfma_f32_16x16x32_bf16 v[120:123], v[52:55], a[152:155], v[120:123]
buffer_load_dwordx4 v17, s[36:39], s67 offen offset:1024 lds
s_add_u32 s67, s67, 32768
v_mfma_f32_16x16x32_bf16 v[124:127], v[52:55], a[156:159], v[124:127]
s_waitcnt lgkmcnt(9)
v_mfma_f32_16x16x32_bf16 v[64:67], v[24:27], a[128:131], v[64:67]
s_waitcnt vmcnt(20)
s_barrier
s_waitcnt lgkmcnt(8)
v_mfma_f32_16x16x32_bf16 v[68:71], v[24:27], a[132:135], v[68:71]
ds_read_b64_tr_b16 v[40:41], v14 offset:49152
s_waitcnt lgkmcnt(8)
v_mfma_f32_16x16x32_bf16 v[72:75], v[24:27], a[136:139], v[72:75]
ds_read_b64_tr_b16 v[42:43], v14 offset:49664
s_add_u32 m0, s66, 81920
s_waitcnt lgkmcnt(8)
v_mfma_f32_16x16x32_bf16 v[76:79], v[24:27], a[140:143], v[76:79]
ds_read_b128 a[144:147], v9 offset:49152
s_waitcnt lgkmcnt(7)
v_mfma_f32_16x16x32_bf16 v[80:83], v[28:31], a[128:131], v[80:83]
ds_read_b128 a[148:151], v10 offset:49152
v_mfma_f32_16x16x32_bf16 v[84:87], v[28:31], a[132:135], v[84:87]
ds_read_b128 a[152:155], v11 offset:49152
buffer_load_dwordx4 v7, s[48:51], s12 offen sc1 lds
v_mfma_f32_16x16x32_bf16 v[88:91], v[28:31], a[136:139], v[88:91]
ds_read_b128 a[156:159], v21 offset:49152
v_mfma_f32_16x16x32_bf16 v[92:95], v[28:31], a[140:143], v[92:95]
ds_read_b64_tr_b16 v[44:45], v15 offset:49152
s_waitcnt lgkmcnt(9)
v_mfma_f32_16x16x32_bf16 v[96:99], v[32:35], a[128:131], v[96:99]
ds_read_b64_tr_b16 v[46:47], v15 offset:49664
buffer_load_dwordx4 v20, s[48:51], s12 offen offset:1024 sc1 lds
s_add_u32 s12, s12, 1024
s_add_u32 m0, s15, 81920
v_mfma_f32_16x16x32_bf16 v[100:103], v[32:35], a[132:135], v[100:103]
ds_read_b64_tr_b16 v[48:49], v14 offset:49408
v_mfma_f32_16x16x32_bf16 v[104:107], v[32:35], a[136:139], v[104:107]
ds_read_b64_tr_b16 v[50:51], v14 offset:49920
v_mfma_f32_16x16x32_bf16 v[108:111], v[32:35], a[140:143], v[108:111]
ds_read_b64_tr_b16 v[52:53], v15 offset:49408
buffer_load_dwordx4 v16, s[36:39], s67 offen lds
s_waitcnt lgkmcnt(11)
v_mfma_f32_16x16x32_bf16 v[112:115], v[36:39], a[128:131], v[112:115]
ds_read_b64_tr_b16 v[54:55], v15 offset:49920
v_mfma_f32_16x16x32_bf16 v[116:119], v[36:39], a[132:135], v[116:119]
v_mfma_f32_16x16x32_bf16 v[120:123], v[36:39], a[136:139], v[120:123]
buffer_load_dwordx4 v17, s[36:39], s67 offen offset:1024 lds
s_add_u32 s67, s67, 32768
v_mfma_f32_16x16x32_bf16 v[124:127], v[36:39], a[140:143], v[124:127]
s_waitcnt lgkmcnt(9)
v_mfma_f32_16x16x32_bf16 v[64:67], v[40:43], a[144:147], v[64:67]
s_waitcnt vmcnt(20)
s_barrier
s_waitcnt lgkmcnt(8)
v_mfma_f32_16x16x32_bf16 v[68:71], v[40:43], a[148:151], v[68:71]
ds_read_b64_tr_b16 v[24:25], v12 offset:0
s_waitcnt lgkmcnt(8)
v_mfma_f32_16x16x32_bf16 v[72:75], v[40:43], a[152:155], v[72:75]
ds_read_b64_tr_b16 v[26:27], v12 offset:512
s_add_u32 m0, s66, 98304
s_waitcnt lgkmcnt(8)
v_mfma_f32_16x16x32_bf16 v[76:79], v[40:43], a[156:159], v[76:79]
ds_read_b128 a[128:131], v4 offset:0
s_waitcnt lgkmcnt(7)
v_mfma_f32_16x16x32_bf16 v[80:83], v[44:47], a[144:147], v[80:83]
ds_read_b128 a[132:135], v5 offset:0
v_mfma_f32_16x16x32_bf16 v[84:87], v[44:47], a[148:151], v[84:87]
ds_read_b128 a[136:139], v6 offset:0
buffer_load_dwordx4 v7, s[48:51], s12 offen sc1 lds
v_mfma_f32_16x16x32_bf16 v[88:91], v[44:47], a[152:155], v[88:91]
ds_read_b128 a[140:143], v8 offset:0
v_mfma_f32_16x16x32_bf16 v[92:95], v[44:47], a[156:159], v[92:95]
ds_read_b64_tr_b16 v[28:29], v13 offset:0
s_waitcnt lgkmcnt(9)
v_mfma_f32_16x16x32_bf16 v[96:99], v[48:51], a[144:147], v[96:99]
ds_read_b64_tr_b16 v[30:31], v13 offset:512
buffer_load_dwordx4 v20, s[48:51], s12 offen offset:1024 sc1 lds
s_add_u32 s12, s12, 1024
s_add_u32 m0, s15, 98304
v_mfma_f32_16x16x32_bf16 v[100:103], v[48:51], a[148:151], v[100:103]
ds_read_b64_tr_b16 v[32:33], v12 offset:256
v_mfma_f32_16x16x32_bf16 v[104:107], v[48:51], a[152:155], v[104:107]
ds_read_b64_tr_b16 v[34:35], v12 offset:768
v_mfma_f32_16x16x32_bf16 v[108:111], v[48:51], a[156:159], v[108:111]
ds_read_b64_tr_b16 v[36:37], v13 offset:256
buffer_load_dwordx4 v16, s[36:39], s67 offen lds
s_waitcnt lgkmcnt(11)
v_mfma_f32_16x16x32_bf16 v[112:115], v[52:55], a[144:147], v[112:115]
ds_read_b64_tr_b16 v[38:39], v13 offset:768
v_mfma_f32_16x16x32_bf16 v[116:119], v[52:55], a[148:151], v[116:119]
v_mfma_f32_16x16x32_bf16 v[120:123], v[52:55], a[152:155], v[120:123]
buffer_load_dwordx4 v17, s[36:39], s67 offen offset:1024 lds
s_add_u32 s67, s67, 32768
v_mfma_f32_16x16x32_bf16 v[124:127], v[52:55], a[156:159], v[124:127]
s_sub_u32 s63, s63, 1
s_cmp_lg_u32 s63, 0
s_cbranch_scc1 P3L
s_waitcnt lgkmcnt(9)
v_mfma_f32_16x16x32_bf16 v[64:67], v[24:27], a[128:131], v[64:67]
s_waitcnt vmcnt(20)
s_barrier
s_waitcnt lgkmcnt(8)
v_mfma_f32_16x16x32_bf16 v[68:71], v[24:27], a[132:135], v[68:71]
ds_read_b64_tr_b16 v[40:41], v12 offset:16384
s_waitcnt lgkmcnt(8)
v_mfma_f32_16x16x32_bf16 v[72:75], v[24:27], a[136:139], v[72:75]
ds_read_b64_tr_b16 v[42:43], v12 offset:16896
s_add_u32 m0, s66, 114688
s_waitcnt lgkmcnt(8)
v_mfma_f32_16x16x32_bf16 v[76:79], v[24:27], a[140:143], v[76:79]
ds_read_b128 a[144:147], v4 offset:16384
s_waitcnt lgkmcnt(7)
v_mfma_f32_16x16x32_bf16 v[80:83], v[28:31], a[128:131], v[80:83]
ds_read_b128 a[148:151], v5 offset:16384
v_mfma_f32_16x16x32_bf16 v[84:87], v[28:31], a[132:135], v[84:87]
ds_read_b128 a[152:155], v6 offset:16384
buffer_load_dwordx4 v7, s[48:51], s12 offen sc1 lds
v_mfma_f32_16x16x32_bf16 v[88:91], v[28:31], a[136:139], v[88:91]
ds_read_b128 a[156:159], v8 offset:16384
v_mfma_f32_16x16x32_bf16 v[92:95], v[28:31], a[140:143], v[92:95]
ds_read_b64_tr_b16 v[44:45], v13 offset:16384
s_waitcnt lgkmcnt(9)
v_mfma_f32_16x16x32_bf16 v[96:99], v[32:35], a[128:131], v[96:99]
ds_read_b64_tr_b16 v[46:47], v13 offset:16896
buffer_load_dwordx4 v20, s[48:51], s12 offen offset:1024 sc1 lds
s_add_u32 s12, s12, 1024
s_add_u32 m0, s15, 114688
v_mfma_f32_16x16x32_bf16 v[100:103], v[32:35], a[132:135], v[100:103]
ds_read_b64_tr_b16 v[48:49], v12 offset:16640
v_mfma_f32_16x16x32_bf16 v[104:107], v[32:35], a[136:139], v[104:107]
ds_read_b64_tr_b16 v[50:51], v12 offset:17152
v_mfma_f32_16x16x32_bf16 v[108:111], v[32:35], a[140:143], v[108:111]
ds_read_b64_tr_b16 v[52:53], v13 offset:16640
buffer_load_dwordx4 v16, s[36:39], s67 offen lds
s_waitcnt lgkmcnt(11)
v_mfma_f32_16x16x32_bf16 v[112:115], v[36:39], a[128:131], v[112:115]
ds_read_b64_tr_b16 v[54:55], v13 offset:17152
v_mfma_f32_16x16x32_bf16 v[116:119], v[36:39], a[132:135], v[116:119]
v_mfma_f32_16x16x32_bf16 v[120:123], v[36:39], a[136:139], v[120:123]
buffer_load_dwordx4 v17, s[36:39], s67 offen offset:1024 lds
s_add_u32 s67, s67, 32768
v_mfma_f32_16x16x32_bf16 v[124:127], v[36:39], a[140:143], v[124:127]
s_waitcnt lgkmcnt(9)
v_mfma_f32_16x16x32_bf16 v[64:67], v[40:43], a[144:147], v[64:67]
s_waitcnt vmcnt(20)
s_barrier
s_waitcnt lgkmcnt(8)
v_mfma_f32_16x16x32_bf16 v[68:71], v[40:43], a[148:151], v[68:71]
ds_read_b64_tr_b16 v[24:25], v12 offset:32768
s_waitcnt lgkmcnt(8)
v_mfma_f32_16x16x32_bf16 v[72:75], v[40:43], a[152:155], v[72:75]
ds_read_b64_tr_b16 v[26:27], v12 offset:33280
s_add_u32 m0, s66, 0
s_waitcnt lgkmcnt(8)
v_mfma_f32_16x16x32_bf16 v[76:79], v[40:43], a[156:159], v[76:79]
ds_read_b128 a[128:131], v4 offset:32768
s_waitcnt lgkmcnt(7)
v_mfma_f32_16x16x32_bf16 v[80:83], v[44:47], a[144:147], v[80:83]
ds_read_b128 a[132:135], v5 offset:32768
v_mfma_f32_16x16x32_bf16 v[84:87], v[44:47], a[148:151], v[84:87]
ds_read_b128 a[136:139], v6 offset:32768
buffer_load_dwordx4 v7, s[48:51], s12 offen sc1 lds
v_mfma_f32_16x16x32_bf16 v[88:91], v[44:47], a[152:155], v[88:91]
ds_read_b128 a[140:143], v8 offset:32768
v_mfma_f32_16x16x32_bf16 v[92:95], v[44:47], a[156:159], v[92:95]
ds_read_b64_tr_b16 v[28:29], v13 offset:32768
s_waitcnt lgkmcnt(9)
v_mfma_f32_16x16x32_bf16 v[96:99], v[48:51], a[144:147], v[96:99]
ds_read_b64_tr_b16 v[30:31], v13 offset:33280
buffer_load_dwordx4 v20, s[48:51], s12 offen offset:1024 sc1 lds
s_add_u32 s12, s12, 1024
s_add_u32 m0, s15, 0
v_mfma_f32_16x16x32_bf16 v[100:103], v[48:51], a[148:151], v[100:103]
ds_read_b64_tr_b16 v[32:33], v12 offset:33024
v_mfma_f32_16x16x32_bf16 v[104:107], v[48:51], a[152:155], v[104:107]
ds_read_b64_tr_b16 v[34:35], v12 offset:33536
v_mfma_f32_16x16x32_bf16 v[108:111], v[48:51], a[156:159], v[108:111]
ds_read_b64_tr_b16 v[36:37], v13 offset:33024
buffer_load_dwordx4 v16, s[36:39], s67 offen lds
s_waitcnt lgkmcnt(11)
v_mfma_f32_16x16x32_bf16 v[112:115], v[52:55], a[144:147], v[112:115]
ds_read_b64_tr_b16 v[38:39], v13 offset:33536
v_mfma_f32_16x16x32_bf16 v[116:119], v[52:55], a[148:151], v[116:119]
v_mfma_f32_16x16x32_bf16 v[120:123], v[52:55], a[152:155], v[120:123]
buffer_load_dwordx4 v17, s[36:39], s67 offen offset:1024 lds
s_add_u32 s67, s67, 32768
v_mfma_f32_16x16x32_bf16 v[124:127], v[52:55], a[156:159], v[124:127]
s_waitcnt lgkmcnt(9)
v_mfma_f32_16x16x32_bf16 v[64:67], v[24:27], a[128:131], v[64:67]
s_waitcnt vmcnt(20)
s_barrier
s_waitcnt lgkmcnt(8)
v_mfma_f32_16x16x32_bf16 v[68:71], v[24:27], a[132:135], v[68:71]
ds_read_b64_tr_b16 v[40:41], v12 offset:49152
s_waitcnt lgkmcnt(8)
v_mfma_f32_16x16x32_bf16 v[72:75], v[24:27], a[136:139], v[72:75]
ds_read_b64_tr_b16 v[42:43], v12 offset:49664
s_add_u32 m0, s66, 16384
s_waitcnt lgkmcnt(8)
v_mfma_f32_16x16x32_bf16 v[76:79], v[24:27], a[140:143], v[76:79]
ds_read_b128 a[144:147], v4 offset:49152
s_waitcnt lgkmcnt(7)
v_mfma_f32_16x16x32_bf16 v[80:83], v[28:31], a[128:131], v[80:83]
ds_read_b128 a[148:151], v5 offset:49152
v_mfma_f32_16x16x32_bf16 v[84:87], v[28:31], a[132:135], v[84:87]
ds_read_b128 a[152:155], v6 offset:49152
buffer_load_dwordx4 v7, s[48:51], s12 offen sc1 lds
v_mfma_f32_16x16x32_bf16 v[88:91], v[28:31], a[136:139], v[88:91]
ds_read_b128 a[156:159], v8 offset:49152
v_mfma_f32_16x16x32_bf16 v[92:95], v[28:31], a[140:143], v[92:95]
ds_read_b64_tr_b16 v[44:45], v13 offset:49152
s_waitcnt lgkmcnt(9)
v_mfma_f32_16x16x32_bf16 v[96:99], v[32:35], a[128:131], v[96:99]
ds_read_b64_tr_b16 v[46:47], v13 offset:49664
buffer_load_dwordx4 v20, s[48:51], s12 offen offset:1024 sc1 lds
s_add_u32 s12, s12, 1024
s_add_u32 m0, s15, 16384
v_mfma_f32_16x16x32_bf16 v[100:103], v[32:35], a[132:135], v[100:103]
ds_read_b64_tr_b16 v[48:49], v12 offset:49408
v_mfma_f32_16x16x32_bf16 v[104:107], v[32:35], a[136:139], v[104:107]
ds_read_b64_tr_b16 v[50:51], v12 offset:49920
v_mfma_f32_16x16x32_bf16 v[108:111], v[32:35], a[140:143], v[108:111]
ds_read_b64_tr_b16 v[52:53], v13 offset:49408
buffer_load_dwordx4 v16, s[36:39], s67 offen lds
s_waitcnt lgkmcnt(11)
v_mfma_f32_16x16x32_bf16 v[112:115], v[36:39], a[128:131], v[112:115]
ds_read_b64_tr_b16 v[54:55], v13 offset:49920
v_mfma_f32_16x16x32_bf16 v[116:119], v[36:39], a[132:135], v[116:119]
v_mfma_f32_16x16x32_bf16 v[120:123], v[36:39], a[136:139], v[120:123]
buffer_load_dwordx4 v17, s[36:39], s67 offen offset:1024 lds
s_add_u32 s67, s67, 32768
v_mfma_f32_16x16x32_bf16 v[124:127], v[36:39], a[140:143], v[124:127]
s_waitcnt lgkmcnt(9)
v_mfma_f32_16x16x32_bf16 v[64:67], v[40:43], a[144:147], v[64:67]
s_waitcnt vmcnt(20)
s_barrier
s_waitcnt lgkmcnt(8)
v_mfma_f32_16x16x32_bf16 v[68:71], v[40:43], a[148:151], v[68:71]
ds_read_b64_tr_b16 v[24:25], v14 offset:0
s_waitcnt lgkmcnt(8)
v_mfma_f32_16x16x32_bf16 v[72:75], v[40:43], a[152:155], v[72:75]
ds_read_b64_tr_b16 v[26:27], v14 offset:512
s_add_u32 m0, s66, 32768
s_waitcnt lgkmcnt(8)
v_mfma_f32_16x16x32_bf16 v[76:79], v[40:43], a[156:159], v[76:79]
ds_read_b128 a[128:131], v9 offset:0
s_waitcnt lgkmcnt(7)
v_mfma_f32_16x16x32_bf16 v[80:83], v[44:47], a[144:147], v[80:83]
ds_read_b128 a[132:135], v10 offset:0
v_mfma_f32_16x16x32_bf16 v[84:87], v[44:47], a[148:151], v[84:87]
ds_read_b128 a[136:139], v11 offset:0
buffer_load_dwordx4 v7, s[48:51], s12 offen sc1 lds
v_mfma_f32_16x16x32_bf16 v[88:91], v[44:47], a[152:155], v[88:91]
ds_read_b128 a[140:143], v21 offset:0
v_mfma_f32_16x16x32_bf16 v[92:95], v[44:47], a[156:159], v[92:95]
ds_read_b64_tr_b16 v[28:29], v15 offset:0
s_waitcnt lgkmcnt(9)
v_mfma_f32_16x16x32_bf16 v[96:99], v[48:51], a[144:147], v[96:99]
ds_read_b64_tr_b16 v[30:31], v15 offset:512
buffer_load_dwordx4 v20, s[48:51], s12 offen offset:1024 sc1 lds
s_add_u32 s12, s12, 1024
s_add_u32 m0, s15, 32768
v_mfma_f32_16x16x32_bf16 v[100:103], v[48:51], a[148:151], v[100:103]
ds_read_b64_tr_b16 v[32:33], v14 offset:256
v_mfma_f32_16x16x32_bf16 v[104:107], v[48:51], a[152:155], v[104:107]
ds_read_b64_tr_b16 v[34:35], v14 offset:768
v_mfma_f32_16x16x32_bf16 v[108:111], v[48:51], a[156:159], v[108:111]
ds_read_b64_tr_b16 v[36:37], v15 offset:256
buffer_load_dwordx4 v16, s[36:39], s67 offen lds
s_waitcnt lgkmcnt(11)
v_mfma_f32_16x16x32_bf16 v[112:115], v[52:55], a[144:147], v[112:115]
ds_read_b64_tr_b16 v[38:39], v15 offset:768
v_mfma_f32_16x16x32_bf16 v[116:119], v[52:55], a[148:151], v[116:119]
v_mfma_f32_16x16x32_bf16 v[120:123], v[52:55], a[152:155], v[120:123]
buffer_load_dwordx4 v17, s[36:39], s67 offen offset:1024 lds
s_add_u32 s67, s67, 32768
v_mfma_f32_16x16x32_bf16 v[124:127], v[52:55], a[156:159], v[124:127]
s_waitcnt lgkmcnt(9)
v_mfma_f32_16x16x32_bf16 v[64:67], v[24:27], a[128:131], v[64:67]
s_waitcnt vmcnt(20)
s_barrier
s_waitcnt lgkmcnt(8)
v_mfma_f32_16x16x32_bf16 v[68:71], v[24:27], a[132:135], v[68:71]
ds_read_b64_tr_b16 v[40:41], v14 offset:16384
s_waitcnt lgkmcnt(8)
v_mfma_f32_16x16x32_bf16 v[72:75], v[24:27], a[136:139], v[72:75]
ds_read_b64_tr_b16 v[42:43], v14 offset:16896
s_waitcnt lgkmcnt(8)
v_mfma_f32_16x16x32_bf16 v[76:79], v[24:27], a[140:143], v[76:79]
ds_read_b128 a[144:147], v9 offset:16384
s_waitcnt lgkmcnt(7)
v_mfma_f32_16x16x32_bf16 v[80:83], v[28:31], a[128:131], v[80:83]
ds_read_b128 a[148:151], v10 offset:16384
v_mfma_f32_16x16x32_bf16 v[84:87], v[28:31], a[132:135], v[84:87]
ds_read_b128 a[152:155], v11 offset:16384
v_mfma_f32_16x16x32_bf16 v[88:91], v[28:31], a[136:139], v[88:91]
ds_read_b128 a[156:159], v21 offset:16384
v_mfma_f32_16x16x32_bf16 v[92:95], v[28:31], a[140:143], v[92:95]
ds_read_b64_tr_b16 v[44:45], v15 offset:16384
s_waitcnt lgkmcnt(9)
v_mfma_f32_16x16x32_bf16 v[96:99], v[32:35], a[128:131], v[96:99]
ds_read_b64_tr_b16 v[46:47], v15 offset:16896
v_mfma_f32_16x16x32_bf16 v[100:103], v[32:35], a[132:135], v[100:103]
ds_read_b64_tr_b16 v[48:49], v14 offset:16640
v_mfma_f32_16x16x32_bf16 v[104:107], v[32:35], a[136:139], v[104:107]
ds_read_b64_tr_b16 v[50:51], v14 offset:17152
v_mfma_f32_16x16x32_bf16 v[108:111], v[32:35], a[140:143], v[108:111]
ds_read_b64_tr_b16 v[52:53], v15 offset:16640
s_waitcnt lgkmcnt(11)
v_mfma_f32_16x16x32_bf16 v[112:115], v[36:39], a[128:131], v[112:115]
ds_read_b64_tr_b16 v[54:55], v15 offset:17152
v_mfma_f32_16x16x32_bf16 v[116:119], v[36:39], a[132:135], v[116:119]
v_mfma_f32_16x16x32_bf16 v[120:123], v[36:39], a[136:139], v[120:123]
v_mfma_f32_16x16x32_bf16 v[124:127], v[36:39], a[140:143], v[124:127]
s_waitcnt lgkmcnt(9)
v_mfma_f32_16x16x32_bf16 v[64:67], v[40:43], a[144:147], v[64:67]
s_waitcnt vmcnt(16)
s_barrier
s_waitcnt lgkmcnt(8)
v_mfma_f32_16x16x32_bf16 v[68:71], v[40:43], a[148:151], v[68:71]
ds_read_b64_tr_b16 v[24:25], v14 offset:32768
s_waitcnt lgkmcnt(8)
v_mfma_f32_16x16x32_bf16 v[72:75], v[40:43], a[152:155], v[72:75]
ds_read_b64_tr_b16 v[26:27], v14 offset:33280
s_waitcnt lgkmcnt(8)
v_mfma_f32_16x16x32_bf16 v[76:79], v[40:43], a[156:159], v[76:79]
ds_read_b128 a[128:131], v9 offset:32768
s_waitcnt lgkmcnt(7)
v_mfma_f32_16x16x32_bf16 v[80:83], v[44:47], a[144:147], v[80:83]
ds_read_b128 a[132:135], v10 offset:32768
v_mfma_f32_16x16x32_bf16 v[84:87], v[44:47], a[148:151], v[84:87]
ds_read_b128 a[136:139], v11 offset:32768
v_mfma_f32_16x16x32_bf16 v[88:91], v[44:47], a[152:155], v[88:91]
ds_read_b128 a[140:143], v21 offset:32768
v_mfma_f32_16x16x32_bf16 v[92:95], v[44:47], a[156:159], v[92:95]
ds_read_b64_tr_b16 v[28:29], v15 offset:32768
s_waitcnt lgkmcnt(9)
v_mfma_f32_16x16x32_bf16 v[96:99], v[48:51], a[144:147], v[96:99]
ds_read_b64_tr_b16 v[30:31], v15 offset:33280
v_mfma_f32_16x16x32_bf16 v[100:103], v[48:51], a[148:151], v[100:103]
ds_read_b64_tr_b16 v[32:33], v14 offset:33024
v_mfma_f32_16x16x32_bf16 v[104:107], v[48:51], a[152:155], v[104:107]
ds_read_b64_tr_b16 v[34:35], v14 offset:33536
v_mfma_f32_16x16x32_bf16 v[108:111], v[48:51], a[156:159], v[108:111]
ds_read_b64_tr_b16 v[36:37], v15 offset:33024
s_waitcnt lgkmcnt(11)
v_mfma_f32_16x16x32_bf16 v[112:115], v[52:55], a[144:147], v[112:115]
ds_read_b64_tr_b16 v[38:39], v15 offset:33536
v_mfma_f32_16x16x32_bf16 v[116:119], v[52:55], a[148:151], v[116:119]
v_mfma_f32_16x16x32_bf16 v[120:123], v[52:55], a[152:155], v[120:123]
v_mfma_f32_16x16x32_bf16 v[124:127], v[52:55], a[156:159], v[124:127]
buffer_load_dwordx4 v[192:195], v3, s[24:27], s62 offen
buffer_load_dwordx4 v[196:199], v3, s[24:27], s62 offen offset:64
s_waitcnt lgkmcnt(9)
v_mfma_f32_16x16x32_bf16 v[64:67], v[24:27], a[128:131], v[64:67]
s_waitcnt vmcnt(14)
s_barrier
s_waitcnt lgkmcnt(8)
v_mfma_f32_16x16x32_bf16 v[68:71], v[24:27], a[132:135], v[68:71]
ds_read_b64_tr_b16 v[40:41], v14 offset:49152
s_waitcnt lgkmcnt(8)
v_mfma_f32_16x16x32_bf16 v[72:75], v[24:27], a[136:139], v[72:75]
ds_read_b64_tr_b16 v[42:43], v14 offset:49664
s_waitcnt lgkmcnt(8)
v_mfma_f32_16x16x32_bf16 v[76:79], v[24:27], a[140:143], v[76:79]
ds_read_b128 a[144:147], v9 offset:49152
s_waitcnt lgkmcnt(7)
v_mfma_f32_16x16x32_bf16 v[80:83], v[28:31], a[128:131], v[80:83]
ds_read_b128 a[148:151], v10 offset:49152
v_mfma_f32_16x16x32_bf16 v[84:87], v[28:31], a[132:135], v[84:87]
ds_read_b128 a[152:155], v11 offset:49152
v_mfma_f32_16x16x32_bf16 v[88:91], v[28:31], a[136:139], v[88:91]
ds_read_b128 a[156:159], v21 offset:49152
v_mfma_f32_16x16x32_bf16 v[92:95], v[28:31], a[140:143], v[92:95]
ds_read_b64_tr_b16 v[44:45], v15 offset:49152
s_waitcnt lgkmcnt(9)
v_mfma_f32_16x16x32_bf16 v[96:99], v[32:35], a[128:131], v[96:99]
ds_read_b64_tr_b16 v[46:47], v15 offset:49664
v_mfma_f32_16x16x32_bf16 v[100:103], v[32:35], a[132:135], v[100:103]
ds_read_b64_tr_b16 v[48:49], v14 offset:49408
v_mfma_f32_16x16x32_bf16 v[104:107], v[32:35], a[136:139], v[104:107]
ds_read_b64_tr_b16 v[50:51], v14 offset:49920
v_mfma_f32_16x16x32_bf16 v[108:111], v[32:35], a[140:143], v[108:111]
ds_read_b64_tr_b16 v[52:53], v15 offset:49408
s_waitcnt lgkmcnt(11)
v_mfma_f32_16x16x32_bf16 v[112:115], v[36:39], a[128:131], v[112:115]
ds_read_b64_tr_b16 v[54:55], v15 offset:49920
v_mfma_f32_16x16x32_bf16 v[116:119], v[36:39], a[132:135], v[116:119]
v_mfma_f32_16x16x32_bf16 v[120:123], v[36:39], a[136:139], v[120:123]
v_mfma_f32_16x16x32_bf16 v[124:127], v[36:39], a[140:143], v[124:127]
s_waitcnt lgkmcnt(9)
v_mfma_f32_16x16x32_bf16 v[64:67], v[40:43], a[144:147], v[64:67]
s_waitcnt vmcnt(10)
s_barrier
s_waitcnt lgkmcnt(8)
v_mfma_f32_16x16x32_bf16 v[68:71], v[40:43], a[148:151], v[68:71]
ds_read_b64_tr_b16 v[24:25], v12 offset:0
s_waitcnt lgkmcnt(8)
v_mfma_f32_16x16x32_bf16 v[72:75], v[40:43], a[152:155], v[72:75]
ds_read_b64_tr_b16 v[26:27], v12 offset:512
s_waitcnt lgkmcnt(8)
v_mfma_f32_16x16x32_bf16 v[76:79], v[40:43], a[156:159], v[76:79]
ds_read_b128 a[128:131], v4 offset:0
s_waitcnt lgkmcnt(7)
v_mfma_f32_16x16x32_bf16 v[80:83], v[44:47], a[144:147], v[80:83]
ds_read_b128 a[132:135], v5 offset:0
v_mfma_f32_16x16x32_bf16 v[84:87], v[44:47], a[148:151], v[84:87]
ds_read_b128 a[136:139], v6 offset:0
v_mfma_f32_16x16x32_bf16 v[88:91], v[44:47], a[152:155], v[88:91]
ds_read_b128 a[140:143], v8 offset:0
v_mfma_f32_16x16x32_bf16 v[92:95], v[44:47], a[156:159], v[92:95]
ds_read_b64_tr_b16 v[28:29], v13 offset:0
s_waitcnt lgkmcnt(9)
v_mfma_f32_16x16x32_bf16 v[96:99], v[48:51], a[144:147], v[96:99]
ds_read_b64_tr_b16 v[30:31], v13 offset:512
v_mfma_f32_16x16x32_bf16 v[100:103], v[48:51], a[148:151], v[100:103]
ds_read_b64_tr_b16 v[32:33], v12 offset:256
v_mfma_f32_16x16x32_bf16 v[104:107], v[48:51], a[152:155], v[104:107]
ds_read_b64_tr_b16 v[34:35], v12 offset:768
v_mfma_f32_16x16x32_bf16 v[108:111], v[48:51], a[156:159], v[108:111]
ds_read_b64_tr_b16 v[36:37], v13 offset:256
s_waitcnt lgkmcnt(11)
v_mfma_f32_16x16x32_bf16 v[112:115], v[52:55], a[144:147], v[112:115]
ds_read_b64_tr_b16 v[38:39], v13 offset:768
v_mfma_f32_16x16x32_bf16 v[116:119], v[52:55], a[148:151], v[116:119]
v_mfma_f32_16x16x32_bf16 v[120:123], v[52:55], a[152:155], v[120:123]
v_mfma_f32_16x16x32_bf16 v[124:127], v[52:55], a[156:159], v[124:127]
s_waitcnt lgkmcnt(9)
v_mfma_f32_16x16x32_bf16 v[64:67], v[24:27], a[128:131], v[64:67]
s_waitcnt vmcnt(6)
s_barrier
s_waitcnt lgkmcnt(8)
v_mfma_f32_16x16x32_bf16 v[68:71], v[24:27], a[132:135], v[68:71]
ds_read_b64_tr_b16 v[40:41], v12 offset:16384
s_waitcnt lgkmcnt(8)
v_mfma_f32_16x16x32_bf16 v[72:75], v[24:27], a[136:139], v[72:75]
ds_read_b64_tr_b16 v[42:43], v12 offset:16896
s_waitcnt lgkmcnt(8)
v_mfma_f32_16x16x32_bf16 v[76:79], v[24:27], a[140:143], v[76:79]
ds_read_b128 a[144:147], v4 offset:16384
s_waitcnt lgkmcnt(7)
v_mfma_f32_16x16x32_bf16 v[80:83], v[28:31], a[128:131], v[80:83]
ds_read_b128 a[148:151], v5 offset:16384
v_mfma_f32_16x16x32_bf16 v[84:87], v[28:31], a[132:135], v[84:87]
ds_read_b128 a[152:155], v6 offset:16384
v_mfma_f32_16x16x32_bf16 v[88:91], v[28:31], a[136:139], v[88:91]
ds_read_b128 a[156:159], v8 offset:16384
v_mfma_f32_16x16x32_bf16 v[92:95], v[28:31], a[140:143], v[92:95]
ds_read_b64_tr_b16 v[44:45], v13 offset:16384
s_waitcnt lgkmcnt(9)
v_mfma_f32_16x16x32_bf16 v[96:99], v[32:35], a[128:131], v[96:99]
ds_read_b64_tr_b16 v[46:47], v13 offset:16896
v_mfma_f32_16x16x32_bf16 v[100:103], v[32:35], a[132:135], v[100:103]
ds_read_b64_tr_b16 v[48:49], v12 offset:16640
v_mfma_f32_16x16x32_bf16 v[104:107], v[32:35], a[136:139], v[104:107]
ds_read_b64_tr_b16 v[50:51], v12 offset:17152
v_mfma_f32_16x16x32_bf16 v[108:111], v[32:35], a[140:143], v[108:111]
ds_read_b64_tr_b16 v[52:53], v13 offset:16640
s_waitcnt lgkmcnt(11)
v_mfma_f32_16x16x32_bf16 v[112:115], v[36:39], a[128:131], v[112:115]
ds_read_b64_tr_b16 v[54:55], v13 offset:17152
v_mfma_f32_16x16x32_bf16 v[116:119], v[36:39], a[132:135], v[116:119]
v_mfma_f32_16x16x32_bf16 v[120:123], v[36:39], a[136:139], v[120:123]
v_mfma_f32_16x16x32_bf16 v[124:127], v[36:39], a[140:143], v[124:127]
s_waitcnt lgkmcnt(9)
v_mfma_f32_16x16x32_bf16 v[64:67], v[40:43], a[144:147], v[64:67]
s_waitcnt vmcnt(2)
s_barrier
s_waitcnt lgkmcnt(8)
v_mfma_f32_16x16x32_bf16 v[68:71], v[40:43], a[148:151], v[68:71]
ds_read_b64_tr_b16 v[24:25], v12 offset:32768
s_waitcnt lgkmcnt(8)
v_mfma_f32_16x16x32_bf16 v[72:75], v[40:43], a[152:155], v[72:75]
ds_read_b64_tr_b16 v[26:27], v12 offset:33280
s_waitcnt lgkmcnt(8)
v_mfma_f32_16x16x32_bf16 v[76:79], v[40:43], a[156:159], v[76:79]
ds_read_b128 a[128:131], v4 offset:32768
s_waitcnt lgkmcnt(7)
v_mfma_f32_16x16x32_bf16 v[80:83], v[44:47], a[144:147], v[80:83]
ds_read_b128 a[132:135], v5 offset:32768
v_mfma_f32_16x16x32_bf16 v[84:87], v[44:47], a[148:151], v[84:87]
ds_read_b128 a[136:139], v6 offset:32768
v_mfma_f32_16x16x32_bf16 v[88:91], v[44:47], a[152:155], v[88:91]
ds_read_b128 a[140:143], v8 offset:32768
v_mfma_f32_16x16x32_bf16 v[92:95], v[44:47], a[156:159], v[92:95]
ds_read_b64_tr_b16 v[28:29], v13 offset:32768
s_waitcnt lgkmcnt(9)
v_mfma_f32_16x16x32_bf16 v[96:99], v[48:51], a[144:147], v[96:99]
ds_read_b64_tr_b16 v[30:31], v13 offset:33280
v_mfma_f32_16x16x32_bf16 v[100:103], v[48:51], a[148:151], v[100:103]
ds_read_b64_tr_b16 v[32:33], v12 offset:33024
v_mfma_f32_16x16x32_bf16 v[104:107], v[48:51], a[152:155], v[104:107]
ds_read_b64_tr_b16 v[34:35], v12 offset:33536
v_mfma_f32_16x16x32_bf16 v[108:111], v[48:51], a[156:159], v[108:111]
ds_read_b64_tr_b16 v[36:37], v13 offset:33024
s_waitcnt lgkmcnt(11)
v_mfma_f32_16x16x32_bf16 v[112:115], v[52:55], a[144:147], v[112:115]
ds_read_b64_tr_b16 v[38:39], v13 offset:33536
v_mfma_f32_16x16x32_bf16 v[116:119], v[52:55], a[148:151], v[116:119]
v_mfma_f32_16x16x32_bf16 v[120:123], v[52:55], a[152:155], v[120:123]
v_mfma_f32_16x16x32_bf16 v[124:127], v[52:55], a[156:159], v[124:127]
s_waitcnt lgkmcnt(9)
v_mfma_f32_16x16x32_bf16 v[64:67], v[24:27], a[128:131], v[64:67]
s_waitcnt lgkmcnt(8)
v_mfma_f32_16x16x32_bf16 v[68:71], v[24:27], a[132:135], v[68:71]
s_waitcnt lgkmcnt(7)
v_mfma_f32_16x16x32_bf16 v[72:75], v[24:27], a[136:139], v[72:75]
s_waitcnt lgkmcnt(6)
v_mfma_f32_16x16x32_bf16 v[76:79], v[24:27], a[140:143], v[76:79]
s_waitcnt lgkmcnt(4)
v_mfma_f32_16x16x32_bf16 v[80:83], v[28:31], a[128:131], v[80:83]
v_mfma_f32_16x16x32_bf16 v[84:87], v[28:31], a[132:135], v[84:87]
v_mfma_f32_16x16x32_bf16 v[88:91], v[28:31], a[136:139], v[88:91]
v_mfma_f32_16x16x32_bf16 v[92:95], v[28:31], a[140:143], v[92:95]
s_waitcnt lgkmcnt(2)
v_mfma_f32_16x16x32_bf16 v[96:99], v[32:35], a[128:131], v[96:99]
v_mfma_f32_16x16x32_bf16 v[100:103], v[32:35], a[132:135], v[100:103]
v_mfma_f32_16x16x32_bf16 v[104:107], v[32:35], a[136:139], v[104:107]
v_mfma_f32_16x16x32_bf16 v[108:111], v[32:35], a[140:143], v[108:111]
s_waitcnt lgkmcnt(0)
v_mfma_f32_16x16x32_bf16 v[112:115], v[36:39], a[128:131], v[112:115]
v_mfma_f32_16x16x32_bf16 v[116:119], v[36:39], a[132:135], v[116:119]
v_mfma_f32_16x16x32_bf16 v[120:123], v[36:39], a[136:139], v[120:123]
v_mfma_f32_16x16x32_bf16 v[124:127], v[36:39], a[140:143], v[124:127]
s_xor_b32 s3, s2, 2
s_lshl_b32 s3, s3, 16
s_lshl_b32 s23, s20, 12
s_add_u32 s3, s3, s23
s_add_u32 s3, s3, 16384
buffer_store_dwordx4 v[68:71], v7, s[32:35], s3 offen offset:0 sc1
buffer_store_dwordx4 v[84:87], v7, s[32:35], s3 offen offset:1024 sc1
buffer_store_dwordx4 v[100:103], v7, s[32:35], s3 offen offset:2048 sc1
buffer_store_dwordx4 v[116:119], v7, s[32:35], s3 offen offset:3072 sc1
s_xor_b32 s3, s2, 4
s_lshl_b32 s3, s3, 16
s_lshl_b32 s23, s20, 12
s_add_u32 s3, s3, s23
s_add_u32 s3, s3, 32768
buffer_store_dwordx4 v[72:75], v7, s[32:35], s3 offen offset:0 sc1
buffer_store_dwordx4 v[88:91], v7, s[32:35], s3 offen offset:1024 sc1
buffer_store_dwordx4 v[104:107], v7, s[32:35], s3 offen offset:2048 sc1
buffer_store_dwordx4 v[120:123], v7, s[32:35], s3 offen offset:3072 sc1
s_xor_b32 s3, s2, 6
s_lshl_b32 s3, s3, 16
s_lshl_b32 s23, s20, 12
s_add_u32 s3, s3, s23
s_add_u32 s3, s3, 49152
buffer_store_dwordx4 v[76:79], v7, s[32:35], s3 offen offset:0 sc1
buffer_store_dwordx4 v[92:95], v7, s[32:35], s3 offen offset:1024 sc1
buffer_store_dwordx4 v[108:111], v7, s[32:35], s3 offen offset:2048 sc1
buffer_store_dwordx4 v[124:127], v7, s[32:35], s3 offen offset:3072 sc1
s_lshl_b32 s3, s2, 16
s_add_u32 s52, s3, s23
s_add_u32 s53, s52, 32768
s_add_u32 s54, s52, 49152
s_add_u32 s52, s52, 16384
s_waitcnt vmcnt(0)
s_mov_b64 exec, 1
global_store_dword v22, v61, s[4:5] sc1
s_mov_b64 exec, -1
s_mov_b64 s[88:89], 14
s_mov_b32 s3, 0x100000
PCL:
global_load_dword v63, v23, s[4:5] sc1
s_waitcnt vmcnt(0)
v_cmp_ne_u32 vcc, 1, v63
s_nop 1
s_and_b64 vcc, vcc, s[88:89]
s_cbranch_scc0 PCD
s_sub_u32 s3, s3, 1
s_cbranch_scc0 PCL
PCD:
buffer_load_dwordx4 v[128:131], v7, s[32:35], s52 offen offset:0 sc1
buffer_load_dwordx4 v[132:135], v7, s[32:35], s52 offen offset:1024 sc1
buffer_load_dwordx4 v[136:139], v7, s[32:35], s52 offen offset:2048 sc1
buffer_load_dwordx4 v[140:143], v7, s[32:35], s52 offen offset:3072 sc1
buffer_load_dwordx4 v[144:147], v7, s[32:35], s53 offen offset:0 sc1
buffer_load_dwordx4 v[148:151], v7, s[32:35], s53 offen offset:1024 sc1
buffer_load_dwordx4 v[152:155], v7, s[32:35], s53 offen offset:2048 sc1
buffer_load_dwordx4 v[156:159], v7, s[32:35], s53 offen offset:3072 sc1
buffer_load_dwordx4 v[160:163], v7, s[32:35], s54 offen offset:0 sc1
buffer_load_dwordx4 v[164:167], v7, s[32:35], s54 offen offset:1024 sc1
buffer_load_dwordx4 v[168:171], v7, s[32:35], s54 offen offset:2048 sc1
buffer_load_dwordx4 v[172:175], v7, s[32:35], s54 offen offset:3072 sc1
v_lshlrev_b32 v200, 16, v192
v_and_b32 v201, 0xffff0000, v192
v_lshlrev_b32 v202, 16, v193
v_and_b32 v203, 0xffff0000, v193
v_lshlrev_b32 v204, 16, v194
v_and_b32 v205, 0xffff0000, v194
v_lshlrev_b32 v206, 16, v195
v_and_b32 v207, 0xffff0000, v195
v_lshlrev_b32 v208, 16, v196
v_and_b32 v209, 0xffff0000, v196
v_lshlrev_b32 v210, 16, v197
v_and_b32 v211, 0xffff0000, v197
v_lshlrev_b32 v212, 16, v198
v_and_b32 v213, 0xffff0000, v198
v_lshlrev_b32 v214, 16, v199
v_and_b32 v215, 0xffff0000, v199
s_waitcnt vmcnt(11)
v_pk_add_f32 v[64:65], v[64:65], v[128:129]
v_pk_add_f32 v[66:67], v[66:67], v[130:131]
s_waitcnt vmcnt(10)
v_pk_add_f32 v[80:81], v[80:81], v[132:133]
v_pk_add_f32 v[82:83], v[82:83], v[134:135]
s_waitcnt vmcnt(9)
v_pk_add_f32 v[96:97], v[96:97], v[136:137]
v_pk_add_f32 v[98:99], v[98:99], v[138:139]
s_waitcnt vmcnt(8)
v_pk_add_f32 v[112:113], v[112:113], v[140:141]
v_pk_add_f32 v[114:115], v[114:115], v[142:143]
s_waitcnt vmcnt(7)
v_pk_add_f32 v[64:65], v[64:65], v[144:145]
v_pk_add_f32 v[66:67], v[66:67], v[146:147]
s_waitcnt vmcnt(6)
v_pk_add_f32 v[80:81], v[80:81], v[148:149]
v_pk_add_f32 v[82:83], v[82:83], v[150:151]
s_waitcnt vmcnt(5)
v_pk_add_f32 v[96:97], v[96:97], v[152:153]
v_pk_add_f32 v[98:99], v[98:99], v[154:155]
s_waitcnt vmcnt(4)
v_pk_add_f32 v[112:113], v[112:113], v[156:157]
v_pk_add_f32 v[114:115], v[114:115], v[158:159]
s_waitcnt vmcnt(3)
v_pk_add_f32 v[64:65], v[64:65], v[160:161]
v_pk_add_f32 v[66:67], v[66:67], v[162:163]
s_waitcnt vmcnt(2)
v_pk_add_f32 v[80:81], v[80:81], v[164:165]
v_pk_add_f32 v[82:83], v[82:83], v[166:167]
s_waitcnt vmcnt(1)
v_pk_add_f32 v[96:97], v[96:97], v[168:169]
v_pk_add_f32 v[98:99], v[98:99], v[170:171]
s_waitcnt vmcnt(0)
v_pk_add_f32 v[112:113], v[112:113], v[172:173]
v_pk_add_f32 v[114:115], v[114:115], v[174:175]
v_permlane16_swap_b32 v64, v80
v_permlane16_swap_b32 v65, v81
v_permlane16_swap_b32 v66, v82
v_permlane16_swap_b32 v67, v83
v_permlane16_swap_b32 v96, v112
v_permlane16_swap_b32 v97, v113
v_permlane16_swap_b32 v98, v114
v_permlane16_swap_b32 v99, v115
v_pk_add_f32 v[64:65], v[64:65], v[200:201]
v_cvt_pk_bf16_f32 v48, v64, v65
v_pk_add_f32 v[66:67], v[66:67], v[202:203]
v_cvt_pk_bf16_f32 v49, v66, v67
v_pk_add_f32 v[80:81], v[80:81], v[204:205]
v_cvt_pk_bf16_f32 v50, v80, v81
v_pk_add_f32 v[82:83], v[82:83], v[206:207]
v_cvt_pk_bf16_f32 v51, v82, v83
v_pk_add_f32 v[96:97], v[96:97], v[208:209]
v_cvt_pk_bf16_f32 v52, v96, v97
v_pk_add_f32 v[98:99], v[98:99], v[210:211]
v_cvt_pk_bf16_f32 v53, v98, v99
v_pk_add_f32 v[112:113], v[112:113], v[212:213]
v_cvt_pk_bf16_f32 v54, v112, v113
v_pk_add_f32 v[114:115], v[114:115], v[214:215]
v_cvt_pk_bf16_f32 v55, v114, v115
buffer_store_dwordx4 v[48:51], v3, s[44:47], s62 offen
buffer_store_dwordx4 v[52:55], v3, s[44:47], s62 offen offset:64
END_parallel_sum__compressed_kv_cla__glu_gated_geglu__prompt_kernel:
s_endpgm
RX_hn:
s_call_b64 s[86:87], RARE0
s_branch RR_hn
RX_h:
s_call_b64 s[86:87], RARE0
s_branch RR_h
RX_l1:
s_call_b64 s[86:87], RARE1
s_branch RR_l1
RX_l0:
s_call_b64 s[86:87], RARE0
s_branch RR_l0
RX_m1:
s_call_b64 s[86:87], RARE1
s_branch RR_m1
RX_m0:
s_call_b64 s[86:87], RARE0
s_branch RR_m0
RX_t:
s_call_b64 s[86:87], RARE1
s_branch RR_t
RX_tb:
s_call_b64 s[86:87], RARE1
s_branch RR_tb
RARE0:
s_nop 15
s_nop 15
v_max3_f32 v228, v64, v65, v66
v_max3_f32 v228, v228, v67, v68
v_max3_f32 v228, v228, v69, v70
v_max3_f32 v228, v228, v71, v72
v_max3_f32 v228, v228, v73, v74
v_max3_f32 v228, v228, v75, v76
v_max3_f32 v228, v228, v77, v78
v_max_f32 v228, v228, v79
v_max3_f32 v229, v80, v81, v82
v_max3_f32 v229, v229, v83, v84
v_max3_f32 v229, v229, v85, v86
v_max3_f32 v229, v229, v87, v88
v_max3_f32 v229, v229, v89, v90
v_max3_f32 v229, v229, v91, v92
v_max3_f32 v229, v229, v93, v94
v_max_f32 v229, v229, v95
v_mov_b32 v224, v228
v_mov_b32 v225, v229
s_nop 0
v_permlane32_swap_b32 v228, v224
v_permlane32_swap_b32 v229, v225
v_max_f32 v228, v228, v224
v_max_f32 v229, v229, v225
v_max_f32 v228, 0, v228
v_sub_f32 v224, 0, v228
v_sub_f32 v225, 0, v228
v_exp_f32 v228, v224
v_add_f32 v64, v64, v224
v_add_f32 v65, v65, v224
v_add_f32 v66, v66, v224
v_add_f32 v67, v67, v224
v_add_f32 v68, v68, v224
v_add_f32 v69, v69, v224
v_add_f32 v70, v70, v224
v_add_f32 v71, v71, v224
v_add_f32 v72, v72, v224
v_add_f32 v73, v73, v224
v_add_f32 v74, v74, v224
v_add_f32 v75, v75, v224
v_add_f32 v76, v76, v224
v_add_f32 v77, v77, v224
v_add_f32 v78, v78, v224
v_add_f32 v79, v79, v224
v_add_f32 v96, v96, v224
v_add_f32 v97, v97, v224
v_add_f32 v98, v98, v224
v_add_f32 v99, v99, v224
v_add_f32 v100, v100, v224
v_add_f32 v101, v101, v224
v_add_f32 v102, v102, v224
v_add_f32 v103, v103, v224
v_add_f32 v104, v104, v224
v_add_f32 v105, v105, v224
v_add_f32 v106, v106, v224
v_add_f32 v107, v107, v224
v_add_f32 v108, v108, v224
v_add_f32 v109, v109, v224
v_add_f32 v110, v110, v224
v_add_f32 v111, v111, v224
v_add_f32 v160, v160, v224
v_add_f32 v161, v161, v224
v_add_f32 v162, v162, v224
v_add_f32 v163, v163, v224
v_add_f32 v164, v164, v224
v_add_f32 v165, v165, v224
v_add_f32 v166, v166, v224
v_add_f32 v167, v167, v224
v_add_f32 v168, v168, v224
v_add_f32 v169, v169, v224
v_add_f32 v170, v170, v224
v_add_f32 v171, v171, v224
v_add_f32 v172, v172, v224
v_add_f32 v173, v173, v224
v_add_f32 v174, v174, v224
v_add_f32 v175, v175, v224
v_mul_f32 v230, v230, v228
v_accvgpr_read_b32 v192, a0
v_accvgpr_read_b32 v193, a1
v_accvgpr_read_b32 v194, a2
v_accvgpr_read_b32 v195, a3
v_accvgpr_read_b32 v196, a4
v_accvgpr_read_b32 v197, a5
v_accvgpr_read_b32 v198, a6
v_accvgpr_read_b32 v199, a7
v_accvgpr_read_b32 v200, a8
v_accvgpr_read_b32 v201, a9
v_accvgpr_read_b32 v202, a10
v_accvgpr_read_b32 v203, a11
v_accvgpr_read_b32 v204, a12
v_accvgpr_read_b32 v205, a13
v_accvgpr_read_b32 v206, a14
v_accvgpr_read_b32 v207, a15
v_mul_f32 v192, v192, v228
v_mul_f32 v193, v193, v228
v_mul_f32 v194, v194, v228
v_mul_f32 v195, v195, v228
v_mul_f32 v196, v196, v228
v_mul_f32 v197, v197, v228
v_mul_f32 v198, v198, v228
v_mul_f32 v199, v199, v228
v_mul_f32 v200, v200, v228
v_mul_f32 v201, v201, v228
v_mul_f32 v202, v202, v228
v_mul_f32 v203, v203, v228
v_mul_f32 v204, v204, v228
v_mul_f32 v205, v205, v228
v_mul_f32 v206, v206, v228
v_mul_f32 v207, v207, v228
v_accvgpr_write_b32 a0, v192
v_accvgpr_write_b32 a1, v193
v_accvgpr_write_b32 a2, v194
v_accvgpr_write_b32 a3, v195
v_accvgpr_write_b32 a4, v196
v_accvgpr_write_b32 a5, v197
v_accvgpr_write_b32 a6, v198
v_accvgpr_write_b32 a7, v199
v_accvgpr_write_b32 a8, v200
v_accvgpr_write_b32 a9, v201
v_accvgpr_write_b32 a10, v202
v_accvgpr_write_b32 a11, v203
v_accvgpr_write_b32 a12, v204
v_accvgpr_write_b32 a13, v205
v_accvgpr_write_b32 a14, v206
v_accvgpr_write_b32 a15, v207
v_accvgpr_read_b32 v192, a32
v_accvgpr_read_b32 v193, a33
v_accvgpr_read_b32 v194, a34
v_accvgpr_read_b32 v195, a35
v_accvgpr_read_b32 v196, a36
v_accvgpr_read_b32 v197, a37
v_accvgpr_read_b32 v198, a38
v_accvgpr_read_b32 v199, a39
v_accvgpr_read_b32 v200, a40
v_accvgpr_read_b32 v201, a41
v_accvgpr_read_b32 v202, a42
v_accvgpr_read_b32 v203, a43
v_accvgpr_read_b32 v204, a44
v_accvgpr_read_b32 v205, a45
v_accvgpr_read_b32 v206, a46
v_accvgpr_read_b32 v207, a47
v_mul_f32 v192, v192, v228
v_mul_f32 v193, v193, v228
v_mul_f32 v194, v194, v228
v_mul_f32 v195, v195, v228
v_mul_f32 v196, v196, v228
v_mul_f32 v197, v197, v228
v_mul_f32 v198, v198, v228
v_mul_f32 v199, v199, v228
v_mul_f32 v200, v200, v228
v_mul_f32 v201, v201, v228
v_mul_f32 v202, v202, v228
v_mul_f32 v203, v203, v228
v_mul_f32 v204, v204, v228
v_mul_f32 v205, v205, v228
v_mul_f32 v206, v206, v228
v_mul_f32 v207, v207, v228
v_accvgpr_write_b32 a32, v192
v_accvgpr_write_b32 a33, v193
v_accvgpr_write_b32 a34, v194
v_accvgpr_write_b32 a35, v195
v_accvgpr_write_b32 a36, v196
v_accvgpr_write_b32 a37, v197
v_accvgpr_write_b32 a38, v198
v_accvgpr_write_b32 a39, v199
v_accvgpr_write_b32 a40, v200
v_accvgpr_write_b32 a41, v201
v_accvgpr_write_b32 a42, v202
v_accvgpr_write_b32 a43, v203
v_accvgpr_write_b32 a44, v204
v_accvgpr_write_b32 a45, v205
v_accvgpr_write_b32 a46, v206
v_accvgpr_write_b32 a47, v207
v_accvgpr_read_b32 v192, a64
v_accvgpr_read_b32 v193, a65
v_accvgpr_read_b32 v194, a66
v_accvgpr_read_b32 v195, a67
v_accvgpr_read_b32 v196, a68
v_accvgpr_read_b32 v197, a69
v_accvgpr_read_b32 v198, a70
v_accvgpr_read_b32 v199, a71
v_accvgpr_read_b32 v200, a72
v_accvgpr_read_b32 v201, a73
v_accvgpr_read_b32 v202, a74
v_accvgpr_read_b32 v203, a75
v_accvgpr_read_b32 v204, a76
v_accvgpr_read_b32 v205, a77
v_accvgpr_read_b32 v206, a78
v_accvgpr_read_b32 v207, a79
v_mul_f32 v192, v192, v228
v_mul_f32 v193, v193, v228
v_mul_f32 v194, v194, v228
v_mul_f32 v195, v195, v228
v_mul_f32 v196, v196, v228
v_mul_f32 v197, v197, v228
v_mul_f32 v198, v198, v228
v_mul_f32 v199, v199, v228
v_mul_f32 v200, v200, v228
v_mul_f32 v201, v201, v228
v_mul_f32 v202, v202, v228
v_mul_f32 v203, v203, v228
v_mul_f32 v204, v204, v228
v_mul_f32 v205, v205, v228
v_mul_f32 v206, v206, v228
v_mul_f32 v207, v207, v228
v_accvgpr_write_b32 a64, v192
v_accvgpr_write_b32 a65, v193
v_accvgpr_write_b32 a66, v194
v_accvgpr_write_b32 a67, v195
v_accvgpr_write_b32 a68, v196
v_accvgpr_write_b32 a69, v197
v_accvgpr_write_b32 a70, v198
v_accvgpr_write_b32 a71, v199
v_accvgpr_write_b32 a72, v200
v_accvgpr_write_b32 a73, v201
v_accvgpr_write_b32 a74, v202
v_accvgpr_write_b32 a75, v203
v_accvgpr_write_b32 a76, v204
v_accvgpr_write_b32 a77, v205
v_accvgpr_write_b32 a78, v206
v_accvgpr_write_b32 a79, v207
v_accvgpr_read_b32 v192, a96
v_accvgpr_read_b32 v193, a97
v_accvgpr_read_b32 v194, a98
v_accvgpr_read_b32 v195, a99
v_accvgpr_read_b32 v196, a100
v_accvgpr_read_b32 v197, a101
v_accvgpr_read_b32 v198, a102
v_accvgpr_read_b32 v199, a103
v_accvgpr_read_b32 v200, a104
v_accvgpr_read_b32 v201, a105
v_accvgpr_read_b32 v202, a106
v_accvgpr_read_b32 v203, a107
v_accvgpr_read_b32 v204, a108
v_accvgpr_read_b32 v205, a109
v_accvgpr_read_b32 v206, a110
v_accvgpr_read_b32 v207, a111
v_mul_f32 v192, v192, v228
v_mul_f32 v193, v193, v228
v_mul_f32 v194, v194, v228
v_mul_f32 v195, v195, v228
v_mul_f32 v196, v196, v228
v_mul_f32 v197, v197, v228
v_mul_f32 v198, v198, v228
v_mul_f32 v199, v199, v228
v_mul_f32 v200, v200, v228
v_mul_f32 v201, v201, v228
v_mul_f32 v202, v202, v228
v_mul_f32 v203, v203, v228
v_mul_f32 v204, v204, v228
v_mul_f32 v205, v205, v228
v_mul_f32 v206, v206, v228
v_mul_f32 v207, v207, v228
v_accvgpr_write_b32 a96, v192
v_accvgpr_write_b32 a97, v193
v_accvgpr_write_b32 a98, v194
v_accvgpr_write_b32 a99, v195
v_accvgpr_write_b32 a100, v196
v_accvgpr_write_b32 a101, v197
v_accvgpr_write_b32 a102, v198
v_accvgpr_write_b32 a103, v199
v_accvgpr_write_b32 a104, v200
v_accvgpr_write_b32 a105, v201
v_accvgpr_write_b32 a106, v202
v_accvgpr_write_b32 a107, v203
v_accvgpr_write_b32 a108, v204
v_accvgpr_write_b32 a109, v205
v_accvgpr_write_b32 a110, v206
v_accvgpr_write_b32 a111, v207
v_max_f32 v229, 0, v229
v_sub_f32 v226, 0, v229
v_sub_f32 v227, 0, v229
v_exp_f32 v229, v226
v_add_f32 v80, v80, v226
v_add_f32 v81, v81, v226
v_add_f32 v82, v82, v226
v_add_f32 v83, v83, v226
v_add_f32 v84, v84, v226
v_add_f32 v85, v85, v226
v_add_f32 v86, v86, v226
v_add_f32 v87, v87, v226
v_add_f32 v88, v88, v226
v_add_f32 v89, v89, v226
v_add_f32 v90, v90, v226
v_add_f32 v91, v91, v226
v_add_f32 v92, v92, v226
v_add_f32 v93, v93, v226
v_add_f32 v94, v94, v226
v_add_f32 v95, v95, v226
v_add_f32 v112, v112, v226
v_add_f32 v113, v113, v226
v_add_f32 v114, v114, v226
v_add_f32 v115, v115, v226
v_add_f32 v116, v116, v226
v_add_f32 v117, v117, v226
v_add_f32 v118, v118, v226
v_add_f32 v119, v119, v226
v_add_f32 v120, v120, v226
v_add_f32 v121, v121, v226
v_add_f32 v122, v122, v226
v_add_f32 v123, v123, v226
v_add_f32 v124, v124, v226
v_add_f32 v125, v125, v226
v_add_f32 v126, v126, v226
v_add_f32 v127, v127, v226
v_add_f32 v176, v176, v226
v_add_f32 v177, v177, v226
v_add_f32 v178, v178, v226
v_add_f32 v179, v179, v226
v_add_f32 v180, v180, v226
v_add_f32 v181, v181, v226
v_add_f32 v182, v182, v226
v_add_f32 v183, v183, v226
v_add_f32 v184, v184, v226
v_add_f32 v185, v185, v226
v_add_f32 v186, v186, v226
v_add_f32 v187, v187, v226
v_add_f32 v188, v188, v226
v_add_f32 v189, v189, v226
v_add_f32 v190, v190, v226
v_add_f32 v191, v191, v226
v_mul_f32 v231, v231, v229
v_accvgpr_read_b32 v192, a16
v_accvgpr_read_b32 v193, a17
v_accvgpr_read_b32 v194, a18
v_accvgpr_read_b32 v195, a19
v_accvgpr_read_b32 v196, a20
v_accvgpr_read_b32 v197, a21
v_accvgpr_read_b32 v198, a22
v_accvgpr_read_b32 v199, a23
v_accvgpr_read_b32 v200, a24
v_accvgpr_read_b32 v201, a25
v_accvgpr_read_b32 v202, a26
v_accvgpr_read_b32 v203, a27
v_accvgpr_read_b32 v204, a28
v_accvgpr_read_b32 v205, a29
v_accvgpr_read_b32 v206, a30
v_accvgpr_read_b32 v207, a31
v_mul_f32 v192, v192, v229
v_mul_f32 v193, v193, v229
v_mul_f32 v194, v194, v229
v_mul_f32 v195, v195, v229
v_mul_f32 v196, v196, v229
v_mul_f32 v197, v197, v229
v_mul_f32 v198, v198, v229
v_mul_f32 v199, v199, v229
v_mul_f32 v200, v200, v229
v_mul_f32 v201, v201, v229
v_mul_f32 v202, v202, v229
v_mul_f32 v203, v203, v229
v_mul_f32 v204, v204, v229
v_mul_f32 v205, v205, v229
v_mul_f32 v206, v206, v229
v_mul_f32 v207, v207, v229
v_accvgpr_write_b32 a16, v192
v_accvgpr_write_b32 a17, v193
v_accvgpr_write_b32 a18, v194
v_accvgpr_write_b32 a19, v195
v_accvgpr_write_b32 a20, v196
v_accvgpr_write_b32 a21, v197
v_accvgpr_write_b32 a22, v198
v_accvgpr_write_b32 a23, v199
v_accvgpr_write_b32 a24, v200
v_accvgpr_write_b32 a25, v201
v_accvgpr_write_b32 a26, v202
v_accvgpr_write_b32 a27, v203
v_accvgpr_write_b32 a28, v204
v_accvgpr_write_b32 a29, v205
v_accvgpr_write_b32 a30, v206
v_accvgpr_write_b32 a31, v207
v_accvgpr_read_b32 v192, a48
v_accvgpr_read_b32 v193, a49
v_accvgpr_read_b32 v194, a50
v_accvgpr_read_b32 v195, a51
v_accvgpr_read_b32 v196, a52
v_accvgpr_read_b32 v197, a53
v_accvgpr_read_b32 v198, a54
v_accvgpr_read_b32 v199, a55
v_accvgpr_read_b32 v200, a56
v_accvgpr_read_b32 v201, a57
v_accvgpr_read_b32 v202, a58
v_accvgpr_read_b32 v203, a59
v_accvgpr_read_b32 v204, a60
v_accvgpr_read_b32 v205, a61
v_accvgpr_read_b32 v206, a62
v_accvgpr_read_b32 v207, a63
v_mul_f32 v192, v192, v229
v_mul_f32 v193, v193, v229
v_mul_f32 v194, v194, v229
v_mul_f32 v195, v195, v229
v_mul_f32 v196, v196, v229
v_mul_f32 v197, v197, v229
v_mul_f32 v198, v198, v229
v_mul_f32 v199, v199, v229
v_mul_f32 v200, v200, v229
v_mul_f32 v201, v201, v229
v_mul_f32 v202, v202, v229
v_mul_f32 v203, v203, v229
v_mul_f32 v204, v204, v229
v_mul_f32 v205, v205, v229
v_mul_f32 v206, v206, v229
v_mul_f32 v207, v207, v229
v_accvgpr_write_b32 a48, v192
v_accvgpr_write_b32 a49, v193
v_accvgpr_write_b32 a50, v194
v_accvgpr_write_b32 a51, v195
v_accvgpr_write_b32 a52, v196
v_accvgpr_write_b32 a53, v197
v_accvgpr_write_b32 a54, v198
v_accvgpr_write_b32 a55, v199
v_accvgpr_write_b32 a56, v200
v_accvgpr_write_b32 a57, v201
v_accvgpr_write_b32 a58, v202
v_accvgpr_write_b32 a59, v203
v_accvgpr_write_b32 a60, v204
v_accvgpr_write_b32 a61, v205
v_accvgpr_write_b32 a62, v206
v_accvgpr_write_b32 a63, v207
v_accvgpr_read_b32 v192, a80
v_accvgpr_read_b32 v193, a81
v_accvgpr_read_b32 v194, a82
v_accvgpr_read_b32 v195, a83
v_accvgpr_read_b32 v196, a84
v_accvgpr_read_b32 v197, a85
v_accvgpr_read_b32 v198, a86
v_accvgpr_read_b32 v199, a87
v_accvgpr_read_b32 v200, a88
v_accvgpr_read_b32 v201, a89
v_accvgpr_read_b32 v202, a90
v_accvgpr_read_b32 v203, a91
v_accvgpr_read_b32 v204, a92
v_accvgpr_read_b32 v205, a93
v_accvgpr_read_b32 v206, a94
v_accvgpr_read_b32 v207, a95
v_mul_f32 v192, v192, v229
v_mul_f32 v193, v193, v229
v_mul_f32 v194, v194, v229
v_mul_f32 v195, v195, v229
v_mul_f32 v196, v196, v229
v_mul_f32 v197, v197, v229
v_mul_f32 v198, v198, v229
v_mul_f32 v199, v199, v229
v_mul_f32 v200, v200, v229
v_mul_f32 v201, v201, v229
v_mul_f32 v202, v202, v229
v_mul_f32 v203, v203, v229
v_mul_f32 v204, v204, v229
v_mul_f32 v205, v205, v229
v_mul_f32 v206, v206, v229
v_mul_f32 v207, v207, v229
v_accvgpr_write_b32 a80, v192
v_accvgpr_write_b32 a81, v193
v_accvgpr_write_b32 a82, v194
v_accvgpr_write_b32 a83, v195
v_accvgpr_write_b32 a84, v196
v_accvgpr_write_b32 a85, v197
v_accvgpr_write_b32 a86, v198
v_accvgpr_write_b32 a87, v199
v_accvgpr_write_b32 a88, v200
v_accvgpr_write_b32 a89, v201
v_accvgpr_write_b32 a90, v202
v_accvgpr_write_b32 a91, v203
v_accvgpr_write_b32 a92, v204
v_accvgpr_write_b32 a93, v205
v_accvgpr_write_b32 a94, v206
v_accvgpr_write_b32 a95, v207
v_accvgpr_read_b32 v192, a112
v_accvgpr_read_b32 v193, a113
v_accvgpr_read_b32 v194, a114
v_accvgpr_read_b32 v195, a115
v_accvgpr_read_b32 v196, a116
v_accvgpr_read_b32 v197, a117
v_accvgpr_read_b32 v198, a118
v_accvgpr_read_b32 v199, a119
v_accvgpr_read_b32 v200, a120
v_accvgpr_read_b32 v201, a121
v_accvgpr_read_b32 v202, a122
v_accvgpr_read_b32 v203, a123
v_accvgpr_read_b32 v204, a124
v_accvgpr_read_b32 v205, a125
v_accvgpr_read_b32 v206, a126
v_accvgpr_read_b32 v207, a127
v_mul_f32 v192, v192, v229
v_mul_f32 v193, v193, v229
v_mul_f32 v194, v194, v229
v_mul_f32 v195, v195, v229
v_mul_f32 v196, v196, v229
v_mul_f32 v197, v197, v229
v_mul_f32 v198, v198, v229
v_mul_f32 v199, v199, v229
v_mul_f32 v200, v200, v229
v_mul_f32 v201, v201, v229
v_mul_f32 v202, v202, v229
v_mul_f32 v203, v203, v229
v_mul_f32 v204, v204, v229
v_mul_f32 v205, v205, v229
v_mul_f32 v206, v206, v229
v_mul_f32 v207, v207, v229
v_accvgpr_write_b32 a112, v192
v_accvgpr_write_b32 a113, v193
v_accvgpr_write_b32 a114, v194
v_accvgpr_write_b32 a115, v195
v_accvgpr_write_b32 a116, v196
v_accvgpr_write_b32 a117, v197
v_accvgpr_write_b32 a118, v198
v_accvgpr_write_b32 a119, v199
v_accvgpr_write_b32 a120, v200
v_accvgpr_write_b32 a121, v201
v_accvgpr_write_b32 a122, v202
v_accvgpr_write_b32 a123, v203
v_accvgpr_write_b32 a124, v204
v_accvgpr_write_b32 a125, v205
v_accvgpr_write_b32 a126, v206
v_accvgpr_write_b32 a127, v207
v_exp_f32 v192, v64
v_exp_f32 v193, v65
v_exp_f32 v194, v66
v_add_f32 v228, v192, v193
v_exp_f32 v195, v67
v_add_f32 v228, v228, v194
v_exp_f32 v196, v68
v_add_f32 v228, v228, v195
v_exp_f32 v197, v69
v_add_f32 v228, v228, v196
v_exp_f32 v198, v70
v_add_f32 v228, v228, v197
v_exp_f32 v199, v71
v_cvt_pk_bf16_f32 v128, v192, v193
v_add_f32 v228, v228, v198
v_exp_f32 v208, v80
v_add_f32 v228, v228, v199
v_exp_f32 v209, v81
v_cvt_pk_bf16_f32 v129, v194, v195
v_exp_f32 v210, v82
v_add_f32 v229, v208, v209
v_exp_f32 v211, v83
v_cvt_pk_bf16_f32 v130, v196, v197
v_add_f32 v229, v229, v210
v_exp_f32 v212, v84
v_add_f32 v229, v229, v211
v_exp_f32 v213, v85
v_cvt_pk_bf16_f32 v131, v198, v199
v_add_f32 v229, v229, v212
v_exp_f32 v214, v86
v_add_f32 v229, v229, v213
v_exp_f32 v215, v87
v_cvt_pk_bf16_f32 v136, v208, v209
v_add_f32 v229, v229, v214
v_exp_f32 v200, v72
v_add_f32 v229, v229, v215
v_exp_f32 v201, v73
v_cvt_pk_bf16_f32 v137, v210, v211
v_add_f32 v228, v228, v200
v_exp_f32 v202, v74
v_add_f32 v228, v228, v201
v_exp_f32 v203, v75
v_cvt_pk_bf16_f32 v138, v212, v213
v_add_f32 v228, v228, v202
v_exp_f32 v204, v76
v_add_f32 v228, v228, v203
v_exp_f32 v205, v77
v_cvt_pk_bf16_f32 v139, v214, v215
v_add_f32 v228, v228, v204
v_exp_f32 v206, v78
v_add_f32 v228, v228, v205
v_exp_f32 v207, v79
v_add_f32 v228, v228, v206
v_exp_f32 v216, v88
v_add_f32 v228, v228, v207
v_exp_f32 v217, v89
v_add_f32 v229, v229, v216
v_exp_f32 v218, v90
v_add_f32 v229, v229, v217
v_exp_f32 v219, v91
v_add_f32 v229, v229, v218
v_exp_f32 v220, v92
v_add_f32 v229, v229, v219
v_exp_f32 v221, v93
v_add_f32 v229, v229, v220
v_exp_f32 v222, v94
v_add_f32 v229, v229, v221
v_exp_f32 v223, v95
v_add_f32 v229, v229, v222
v_add_f32 v229, v229, v223
s_nop 3
s_setpc_b64 s[86:87]
RARE1:
s_nop 15
s_nop 15
v_max3_f32 v228, v96, v97, v98
v_max3_f32 v228, v228, v99, v100
v_max3_f32 v228, v228, v101, v102
v_max3_f32 v228, v228, v103, v104
v_max3_f32 v228, v228, v105, v106
v_max3_f32 v228, v228, v107, v108
v_max3_f32 v228, v228, v109, v110
v_max_f32 v228, v228, v111
v_max3_f32 v229, v112, v113, v114
v_max3_f32 v229, v229, v115, v116
v_max3_f32 v229, v229, v117, v118
v_max3_f32 v229, v229, v119, v120
v_max3_f32 v229, v229, v121, v122
v_max3_f32 v229, v229, v123, v124
v_max3_f32 v229, v229, v125, v126
v_max_f32 v229, v229, v127
v_mov_b32 v224, v228
v_mov_b32 v225, v229
s_nop 0
v_permlane32_swap_b32 v228, v224
v_permlane32_swap_b32 v229, v225
v_max_f32 v228, v228, v224
v_max_f32 v229, v229, v225
v_max_f32 v228, 0, v228
v_sub_f32 v224, 0, v228
v_sub_f32 v225, 0, v228
v_exp_f32 v228, v224
v_add_f32 v64, v64, v224
v_add_f32 v65, v65, v224
v_add_f32 v66, v66, v224
v_add_f32 v67, v67, v224
v_add_f32 v68, v68, v224
v_add_f32 v69, v69, v224
v_add_f32 v70, v70, v224
v_add_f32 v71, v71, v224
v_add_f32 v72, v72, v224
v_add_f32 v73, v73, v224
v_add_f32 v74, v74, v224
v_add_f32 v75, v75, v224
v_add_f32 v76, v76, v224
v_add_f32 v77, v77, v224
v_add_f32 v78, v78, v224
v_add_f32 v79, v79, v224
v_add_f32 v96, v96, v224
v_add_f32 v97, v97, v224
v_add_f32 v98, v98, v224
v_add_f32 v99, v99, v224
v_add_f32 v100, v100, v224
v_add_f32 v101, v101, v224
v_add_f32 v102, v102, v224
v_add_f32 v103, v103, v224
v_add_f32 v104, v104, v224
v_add_f32 v105, v105, v224
v_add_f32 v106, v106, v224
v_add_f32 v107, v107, v224
v_add_f32 v108, v108, v224
v_add_f32 v109, v109, v224
v_add_f32 v110, v110, v224
v_add_f32 v111, v111, v224
v_add_f32 v160, v160, v224
v_add_f32 v161, v161, v224
v_add_f32 v162, v162, v224
v_add_f32 v163, v163, v224
v_add_f32 v164, v164, v224
v_add_f32 v165, v165, v224
v_add_f32 v166, v166, v224
v_add_f32 v167, v167, v224
v_add_f32 v168, v168, v224
v_add_f32 v169, v169, v224
v_add_f32 v170, v170, v224
v_add_f32 v171, v171, v224
v_add_f32 v172, v172, v224
v_add_f32 v173, v173, v224
v_add_f32 v174, v174, v224
v_add_f32 v175, v175, v224
v_mul_f32 v230, v230, v228
v_accvgpr_read_b32 v192, a0
v_accvgpr_read_b32 v193, a1
v_accvgpr_read_b32 v194, a2
v_accvgpr_read_b32 v195, a3
v_accvgpr_read_b32 v196, a4
v_accvgpr_read_b32 v197, a5
v_accvgpr_read_b32 v198, a6
v_accvgpr_read_b32 v199, a7
v_accvgpr_read_b32 v200, a8
v_accvgpr_read_b32 v201, a9
v_accvgpr_read_b32 v202, a10
v_accvgpr_read_b32 v203, a11
v_accvgpr_read_b32 v204, a12
v_accvgpr_read_b32 v205, a13
v_accvgpr_read_b32 v206, a14
v_accvgpr_read_b32 v207, a15
v_mul_f32 v192, v192, v228
v_mul_f32 v193, v193, v228
v_mul_f32 v194, v194, v228
v_mul_f32 v195, v195, v228
v_mul_f32 v196, v196, v228
v_mul_f32 v197, v197, v228
v_mul_f32 v198, v198, v228
v_mul_f32 v199, v199, v228
v_mul_f32 v200, v200, v228
v_mul_f32 v201, v201, v228
v_mul_f32 v202, v202, v228
v_mul_f32 v203, v203, v228
v_mul_f32 v204, v204, v228
v_mul_f32 v205, v205, v228
v_mul_f32 v206, v206, v228
v_mul_f32 v207, v207, v228
v_accvgpr_write_b32 a0, v192
v_accvgpr_write_b32 a1, v193
v_accvgpr_write_b32 a2, v194
v_accvgpr_write_b32 a3, v195
v_accvgpr_write_b32 a4, v196
v_accvgpr_write_b32 a5, v197
v_accvgpr_write_b32 a6, v198
v_accvgpr_write_b32 a7, v199
v_accvgpr_write_b32 a8, v200
v_accvgpr_write_b32 a9, v201
v_accvgpr_write_b32 a10, v202
v_accvgpr_write_b32 a11, v203
v_accvgpr_write_b32 a12, v204
v_accvgpr_write_b32 a13, v205
v_accvgpr_write_b32 a14, v206
v_accvgpr_write_b32 a15, v207
v_accvgpr_read_b32 v192, a32
v_accvgpr_read_b32 v193, a33
v_accvgpr_read_b32 v194, a34
v_accvgpr_read_b32 v195, a35
v_accvgpr_read_b32 v196, a36
v_accvgpr_read_b32 v197, a37
v_accvgpr_read_b32 v198, a38
v_accvgpr_read_b32 v199, a39
v_accvgpr_read_b32 v200, a40
v_accvgpr_read_b32 v201, a41
v_accvgpr_read_b32 v202, a42
v_accvgpr_read_b32 v203, a43
v_accvgpr_read_b32 v204, a44
v_accvgpr_read_b32 v205, a45
v_accvgpr_read_b32 v206, a46
v_accvgpr_read_b32 v207, a47
v_mul_f32 v192, v192, v228
v_mul_f32 v193, v193, v228
v_mul_f32 v194, v194, v228
v_mul_f32 v195, v195, v228
v_mul_f32 v196, v196, v228
v_mul_f32 v197, v197, v228
v_mul_f32 v198, v198, v228
v_mul_f32 v199, v199, v228
v_mul_f32 v200, v200, v228
v_mul_f32 v201, v201, v228
v_mul_f32 v202, v202, v228
v_mul_f32 v203, v203, v228
v_mul_f32 v204, v204, v228
v_mul_f32 v205, v205, v228
v_mul_f32 v206, v206, v228
v_mul_f32 v207, v207, v228
v_accvgpr_write_b32 a32, v192
v_accvgpr_write_b32 a33, v193
v_accvgpr_write_b32 a34, v194
v_accvgpr_write_b32 a35, v195
v_accvgpr_write_b32 a36, v196
v_accvgpr_write_b32 a37, v197
v_accvgpr_write_b32 a38, v198
v_accvgpr_write_b32 a39, v199
v_accvgpr_write_b32 a40, v200
v_accvgpr_write_b32 a41, v201
v_accvgpr_write_b32 a42, v202
v_accvgpr_write_b32 a43, v203
v_accvgpr_write_b32 a44, v204
v_accvgpr_write_b32 a45, v205
v_accvgpr_write_b32 a46, v206
v_accvgpr_write_b32 a47, v207
v_accvgpr_read_b32 v192, a64
v_accvgpr_read_b32 v193, a65
v_accvgpr_read_b32 v194, a66
v_accvgpr_read_b32 v195, a67
v_accvgpr_read_b32 v196, a68
v_accvgpr_read_b32 v197, a69
v_accvgpr_read_b32 v198, a70
v_accvgpr_read_b32 v199, a71
v_accvgpr_read_b32 v200, a72
v_accvgpr_read_b32 v201, a73
v_accvgpr_read_b32 v202, a74
v_accvgpr_read_b32 v203, a75
v_accvgpr_read_b32 v204, a76
v_accvgpr_read_b32 v205, a77
v_accvgpr_read_b32 v206, a78
v_accvgpr_read_b32 v207, a79
v_mul_f32 v192, v192, v228
v_mul_f32 v193, v193, v228
v_mul_f32 v194, v194, v228
v_mul_f32 v195, v195, v228
v_mul_f32 v196, v196, v228
v_mul_f32 v197, v197, v228
v_mul_f32 v198, v198, v228
v_mul_f32 v199, v199, v228
v_mul_f32 v200, v200, v228
v_mul_f32 v201, v201, v228
v_mul_f32 v202, v202, v228
v_mul_f32 v203, v203, v228
v_mul_f32 v204, v204, v228
v_mul_f32 v205, v205, v228
v_mul_f32 v206, v206, v228
v_mul_f32 v207, v207, v228
v_accvgpr_write_b32 a64, v192
v_accvgpr_write_b32 a65, v193
v_accvgpr_write_b32 a66, v194
v_accvgpr_write_b32 a67, v195
v_accvgpr_write_b32 a68, v196
v_accvgpr_write_b32 a69, v197
v_accvgpr_write_b32 a70, v198
v_accvgpr_write_b32 a71, v199
v_accvgpr_write_b32 a72, v200
v_accvgpr_write_b32 a73, v201
v_accvgpr_write_b32 a74, v202
v_accvgpr_write_b32 a75, v203
v_accvgpr_write_b32 a76, v204
v_accvgpr_write_b32 a77, v205
v_accvgpr_write_b32 a78, v206
v_accvgpr_write_b32 a79, v207
v_accvgpr_read_b32 v192, a96
v_accvgpr_read_b32 v193, a97
v_accvgpr_read_b32 v194, a98
v_accvgpr_read_b32 v195, a99
v_accvgpr_read_b32 v196, a100
v_accvgpr_read_b32 v197, a101
v_accvgpr_read_b32 v198, a102
v_accvgpr_read_b32 v199, a103
v_accvgpr_read_b32 v200, a104
v_accvgpr_read_b32 v201, a105
v_accvgpr_read_b32 v202, a106
v_accvgpr_read_b32 v203, a107
v_accvgpr_read_b32 v204, a108
v_accvgpr_read_b32 v205, a109
v_accvgpr_read_b32 v206, a110
v_accvgpr_read_b32 v207, a111
v_mul_f32 v192, v192, v228
v_mul_f32 v193, v193, v228
v_mul_f32 v194, v194, v228
v_mul_f32 v195, v195, v228
v_mul_f32 v196, v196, v228
v_mul_f32 v197, v197, v228
v_mul_f32 v198, v198, v228
v_mul_f32 v199, v199, v228
v_mul_f32 v200, v200, v228
v_mul_f32 v201, v201, v228
v_mul_f32 v202, v202, v228
v_mul_f32 v203, v203, v228
v_mul_f32 v204, v204, v228
v_mul_f32 v205, v205, v228
v_mul_f32 v206, v206, v228
v_mul_f32 v207, v207, v228
v_accvgpr_write_b32 a96, v192
v_accvgpr_write_b32 a97, v193
v_accvgpr_write_b32 a98, v194
v_accvgpr_write_b32 a99, v195
v_accvgpr_write_b32 a100, v196
v_accvgpr_write_b32 a101, v197
v_accvgpr_write_b32 a102, v198
v_accvgpr_write_b32 a103, v199
v_accvgpr_write_b32 a104, v200
v_accvgpr_write_b32 a105, v201
v_accvgpr_write_b32 a106, v202
v_accvgpr_write_b32 a107, v203
v_accvgpr_write_b32 a108, v204
v_accvgpr_write_b32 a109, v205
v_accvgpr_write_b32 a110, v206
v_accvgpr_write_b32 a111, v207
v_max_f32 v229, 0, v229
v_sub_f32 v226, 0, v229
v_sub_f32 v227, 0, v229
v_exp_f32 v229, v226
v_add_f32 v80, v80, v226
v_add_f32 v81, v81, v226
v_add_f32 v82, v82, v226
v_add_f32 v83, v83, v226
v_add_f32 v84, v84, v226
v_add_f32 v85, v85, v226
v_add_f32 v86, v86, v226
v_add_f32 v87, v87, v226
v_add_f32 v88, v88, v226
v_add_f32 v89, v89, v226
v_add_f32 v90, v90, v226
v_add_f32 v91, v91, v226
v_add_f32 v92, v92, v226
v_add_f32 v93, v93, v226
v_add_f32 v94, v94, v226
v_add_f32 v95, v95, v226
v_add_f32 v112, v112, v226
v_add_f32 v113, v113, v226
v_add_f32 v114, v114, v226
v_add_f32 v115, v115, v226
v_add_f32 v116, v116, v226
v_add_f32 v117, v117, v226
v_add_f32 v118, v118, v226
v_add_f32 v119, v119, v226
v_add_f32 v120, v120, v226
v_add_f32 v121, v121, v226
v_add_f32 v122, v122, v226
v_add_f32 v123, v123, v226
v_add_f32 v124, v124, v226
v_add_f32 v125, v125, v226
v_add_f32 v126, v126, v226
v_add_f32 v127, v127, v226
v_add_f32 v176, v176, v226
v_add_f32 v177, v177, v226
v_add_f32 v178, v178, v226
v_add_f32 v179, v179, v226
v_add_f32 v180, v180, v226
v_add_f32 v181, v181, v226
v_add_f32 v182, v182, v226
v_add_f32 v183, v183, v226
v_add_f32 v184, v184, v226
v_add_f32 v185, v185, v226
v_add_f32 v186, v186, v226
v_add_f32 v187, v187, v226
v_add_f32 v188, v188, v226
v_add_f32 v189, v189, v226
v_add_f32 v190, v190, v226
v_add_f32 v191, v191, v226
v_mul_f32 v231, v231, v229
v_accvgpr_read_b32 v192, a16
v_accvgpr_read_b32 v193, a17
v_accvgpr_read_b32 v194, a18
v_accvgpr_read_b32 v195, a19
v_accvgpr_read_b32 v196, a20
v_accvgpr_read_b32 v197, a21
v_accvgpr_read_b32 v198, a22
v_accvgpr_read_b32 v199, a23
v_accvgpr_read_b32 v200, a24
v_accvgpr_read_b32 v201, a25
v_accvgpr_read_b32 v202, a26
v_accvgpr_read_b32 v203, a27
v_accvgpr_read_b32 v204, a28
v_accvgpr_read_b32 v205, a29
v_accvgpr_read_b32 v206, a30
v_accvgpr_read_b32 v207, a31
v_mul_f32 v192, v192, v229
v_mul_f32 v193, v193, v229
v_mul_f32 v194, v194, v229
v_mul_f32 v195, v195, v229
v_mul_f32 v196, v196, v229
v_mul_f32 v197, v197, v229
v_mul_f32 v198, v198, v229
v_mul_f32 v199, v199, v229
v_mul_f32 v200, v200, v229
v_mul_f32 v201, v201, v229
v_mul_f32 v202, v202, v229
v_mul_f32 v203, v203, v229
v_mul_f32 v204, v204, v229
v_mul_f32 v205, v205, v229
v_mul_f32 v206, v206, v229
v_mul_f32 v207, v207, v229
v_accvgpr_write_b32 a16, v192
v_accvgpr_write_b32 a17, v193
v_accvgpr_write_b32 a18, v194
v_accvgpr_write_b32 a19, v195
v_accvgpr_write_b32 a20, v196
v_accvgpr_write_b32 a21, v197
v_accvgpr_write_b32 a22, v198
v_accvgpr_write_b32 a23, v199
v_accvgpr_write_b32 a24, v200
v_accvgpr_write_b32 a25, v201
v_accvgpr_write_b32 a26, v202
v_accvgpr_write_b32 a27, v203
v_accvgpr_write_b32 a28, v204
v_accvgpr_write_b32 a29, v205
v_accvgpr_write_b32 a30, v206
v_accvgpr_write_b32 a31, v207
v_accvgpr_read_b32 v192, a48
v_accvgpr_read_b32 v193, a49
v_accvgpr_read_b32 v194, a50
v_accvgpr_read_b32 v195, a51
v_accvgpr_read_b32 v196, a52
v_accvgpr_read_b32 v197, a53
v_accvgpr_read_b32 v198, a54
v_accvgpr_read_b32 v199, a55
v_accvgpr_read_b32 v200, a56
v_accvgpr_read_b32 v201, a57
v_accvgpr_read_b32 v202, a58
v_accvgpr_read_b32 v203, a59
v_accvgpr_read_b32 v204, a60
v_accvgpr_read_b32 v205, a61
v_accvgpr_read_b32 v206, a62
v_accvgpr_read_b32 v207, a63
v_mul_f32 v192, v192, v229
v_mul_f32 v193, v193, v229
v_mul_f32 v194, v194, v229
v_mul_f32 v195, v195, v229
v_mul_f32 v196, v196, v229
v_mul_f32 v197, v197, v229
v_mul_f32 v198, v198, v229
v_mul_f32 v199, v199, v229
v_mul_f32 v200, v200, v229
v_mul_f32 v201, v201, v229
v_mul_f32 v202, v202, v229
v_mul_f32 v203, v203, v229
v_mul_f32 v204, v204, v229
v_mul_f32 v205, v205, v229
v_mul_f32 v206, v206, v229
v_mul_f32 v207, v207, v229
v_accvgpr_write_b32 a48, v192
v_accvgpr_write_b32 a49, v193
v_accvgpr_write_b32 a50, v194
v_accvgpr_write_b32 a51, v195
v_accvgpr_write_b32 a52, v196
v_accvgpr_write_b32 a53, v197
v_accvgpr_write_b32 a54, v198
v_accvgpr_write_b32 a55, v199
v_accvgpr_write_b32 a56, v200
v_accvgpr_write_b32 a57, v201
v_accvgpr_write_b32 a58, v202
v_accvgpr_write_b32 a59, v203
v_accvgpr_write_b32 a60, v204
v_accvgpr_write_b32 a61, v205
v_accvgpr_write_b32 a62, v206
v_accvgpr_write_b32 a63, v207
v_accvgpr_read_b32 v192, a80
v_accvgpr_read_b32 v193, a81
v_accvgpr_read_b32 v194, a82
v_accvgpr_read_b32 v195, a83
v_accvgpr_read_b32 v196, a84
v_accvgpr_read_b32 v197, a85
v_accvgpr_read_b32 v198, a86
v_accvgpr_read_b32 v199, a87
v_accvgpr_read_b32 v200, a88
v_accvgpr_read_b32 v201, a89
v_accvgpr_read_b32 v202, a90
v_accvgpr_read_b32 v203, a91
v_accvgpr_read_b32 v204, a92
v_accvgpr_read_b32 v205, a93
v_accvgpr_read_b32 v206, a94
v_accvgpr_read_b32 v207, a95
v_mul_f32 v192, v192, v229
v_mul_f32 v193, v193, v229
v_mul_f32 v194, v194, v229
v_mul_f32 v195, v195, v229
v_mul_f32 v196, v196, v229
v_mul_f32 v197, v197, v229
v_mul_f32 v198, v198, v229
v_mul_f32 v199, v199, v229
v_mul_f32 v200, v200, v229
v_mul_f32 v201, v201, v229
v_mul_f32 v202, v202, v229
v_mul_f32 v203, v203, v229
v_mul_f32 v204, v204, v229
v_mul_f32 v205, v205, v229
v_mul_f32 v206, v206, v229
v_mul_f32 v207, v207, v229
v_accvgpr_write_b32 a80, v192
v_accvgpr_write_b32 a81, v193
v_accvgpr_write_b32 a82, v194
v_accvgpr_write_b32 a83, v195
v_accvgpr_write_b32 a84, v196
v_accvgpr_write_b32 a85, v197
v_accvgpr_write_b32 a86, v198
v_accvgpr_write_b32 a87, v199
v_accvgpr_write_b32 a88, v200
v_accvgpr_write_b32 a89, v201
v_accvgpr_write_b32 a90, v202
v_accvgpr_write_b32 a91, v203
v_accvgpr_write_b32 a92, v204
v_accvgpr_write_b32 a93, v205
v_accvgpr_write_b32 a94, v206
v_accvgpr_write_b32 a95, v207
v_accvgpr_read_b32 v192, a112
v_accvgpr_read_b32 v193, a113
v_accvgpr_read_b32 v194, a114
v_accvgpr_read_b32 v195, a115
v_accvgpr_read_b32 v196, a116
v_accvgpr_read_b32 v197, a117
v_accvgpr_read_b32 v198, a118
v_accvgpr_read_b32 v199, a119
v_accvgpr_read_b32 v200, a120
v_accvgpr_read_b32 v201, a121
v_accvgpr_read_b32 v202, a122
v_accvgpr_read_b32 v203, a123
v_accvgpr_read_b32 v204, a124
v_accvgpr_read_b32 v205, a125
v_accvgpr_read_b32 v206, a126
v_accvgpr_read_b32 v207, a127
v_mul_f32 v192, v192, v229
v_mul_f32 v193, v193, v229
v_mul_f32 v194, v194, v229
v_mul_f32 v195, v195, v229
v_mul_f32 v196, v196, v229
v_mul_f32 v197, v197, v229
v_mul_f32 v198, v198, v229
v_mul_f32 v199, v199, v229
v_mul_f32 v200, v200, v229
v_mul_f32 v201, v201, v229
v_mul_f32 v202, v202, v229
v_mul_f32 v203, v203, v229
v_mul_f32 v204, v204, v229
v_mul_f32 v205, v205, v229
v_mul_f32 v206, v206, v229
v_mul_f32 v207, v207, v229
v_accvgpr_write_b32 a112, v192
v_accvgpr_write_b32 a113, v193
v_accvgpr_write_b32 a114, v194
v_accvgpr_write_b32 a115, v195
v_accvgpr_write_b32 a116, v196
v_accvgpr_write_b32 a117, v197
v_accvgpr_write_b32 a118, v198
v_accvgpr_write_b32 a119, v199
v_accvgpr_write_b32 a120, v200
v_accvgpr_write_b32 a121, v201
v_accvgpr_write_b32 a122, v202
v_accvgpr_write_b32 a123, v203
v_accvgpr_write_b32 a124, v204
v_accvgpr_write_b32 a125, v205
v_accvgpr_write_b32 a126, v206
v_accvgpr_write_b32 a127, v207
v_exp_f32 v192, v96
v_exp_f32 v193, v97
v_exp_f32 v194, v98
v_add_f32 v228, v192, v193
v_exp_f32 v195, v99
v_add_f32 v228, v228, v194
v_exp_f32 v196, v100
v_add_f32 v228, v228, v195
v_exp_f32 v197, v101
v_add_f32 v228, v228, v196
v_exp_f32 v198, v102
v_add_f32 v228, v228, v197
v_exp_f32 v199, v103
v_cvt_pk_bf16_f32 v144, v192, v193
v_add_f32 v228, v228, v198
v_exp_f32 v208, v112
v_add_f32 v228, v228, v199
v_exp_f32 v209, v113
v_cvt_pk_bf16_f32 v145, v194, v195
v_exp_f32 v210, v114
v_add_f32 v229, v208, v209
v_exp_f32 v211, v115
v_cvt_pk_bf16_f32 v146, v196, v197
v_add_f32 v229, v229, v210
v_exp_f32 v212, v116
v_add_f32 v229, v229, v211
v_exp_f32 v213, v117
v_cvt_pk_bf16_f32 v147, v198, v199
v_add_f32 v229, v229, v212
v_exp_f32 v214, v118
v_add_f32 v229, v229, v213
v_exp_f32 v215, v119
v_cvt_pk_bf16_f32 v152, v208, v209
v_add_f32 v229, v229, v214
v_exp_f32 v200, v104
v_add_f32 v229, v229, v215
v_exp_f32 v201, v105
v_cvt_pk_bf16_f32 v153, v210, v211
v_add_f32 v228, v228, v200
v_exp_f32 v202, v106
v_add_f32 v228, v228, v201
v_exp_f32 v203, v107
v_cvt_pk_bf16_f32 v154, v212, v213
v_add_f32 v228, v228, v202
v_exp_f32 v204, v108
v_add_f32 v228, v228, v203
v_exp_f32 v205, v109
v_cvt_pk_bf16_f32 v155, v214, v215
v_add_f32 v228, v228, v204
v_exp_f32 v206, v110
v_add_f32 v228, v228, v205
v_exp_f32 v207, v111
v_add_f32 v228, v228, v206
v_exp_f32 v216, v120
v_add_f32 v228, v228, v207
v_exp_f32 v217, v121
v_add_f32 v229, v229, v216
v_exp_f32 v218, v122
v_add_f32 v229, v229, v217
v_exp_f32 v219, v123
v_add_f32 v229, v229, v218
v_exp_f32 v220, v124
v_add_f32 v229, v229, v219
v_exp_f32 v221, v125
v_add_f32 v229, v229, v220
v_exp_f32 v222, v126
v_add_f32 v229, v229, v221
v_exp_f32 v223, v127
v_add_f32 v229, v229, v222
v_add_f32 v229, v229, v223
s_nop 3
s_setpc_b64 s[86:87]
SL_x:
s_mov_b32 s3, 0x40000
SLL_x:
s_sleep 4
global_load_dword v63, v9, s[98:99] sc1
s_waitcnt vmcnt(0)
v_cmp_ne_u32 vcc, 32, v63
s_nop 1
s_and_b64 vcc, vcc, exec
s_cbranch_scc0 SR_x
s_sub_u32 s3, s3, 1
s_cbranch_scc0 SLL_x
s_branch SR_x
SL_kv:
s_mov_b32 s3, 0x40000
SLL_kv:
s_sleep 4
global_load_dword v63, v60, s[98:99] offset:32 sc1
s_waitcnt vmcnt(0)
v_cmp_ne_u32 vcc, 8, v63
s_nop 1
s_and_b64 vcc, vcc, exec
s_cbranch_scc0 SR2_kv
s_sub_u32 s3, s3, 1
s_cbranch_scc0 SLL_kv
s_branch SR2_kv
SL_fa:
s_mov_b32 s63, 0x40000
SLL_fa:
s_sleep 4
global_load_dword v63, v59, s[4:5] sc1
s_waitcnt vmcnt(0)
v_cmp_ne_u32 vcc, 1, v63
s_nop 1
s_and_b64 vcc, vcc, s[88:89]
s_cbranch_scc0 SR_fa
s_sub_u32 s63, s63, 1
s_cbranch_scc0 SLL_fa
s_branch SR_fa
SL_fb:
s_mov_b32 s3, 0x40000
SLL_fb:
s_sleep 4
global_load_dword v63, v59, s[4:5] sc1
s_waitcnt vmcnt(0)
v_cmp_ne_u32 vcc, 1, v63
s_nop 1
s_and_b64 vcc, vcc, s[90:91]
s_cbranch_scc0 SR_fb
s_sub_u32 s3, s3, 1
s_cbranch_scc0 SLL_fb
s_branch SR_fb
CODE_END:
.section .rodata,"a"
.p2align 6
.amdhsa_kernel parallel_sum__compressed_kv_cla__glu_gated_geglu__prompt_kernel
  .amdhsa_next_free_vgpr 512
  .amdhsa_next_free_sgpr 102
  .amdhsa_accum_offset 256
  .amdhsa_group_segment_fixed_size 0
  .amdhsa_kernarg_size 104
  .amdhsa_user_sgpr_count 2
  .amdhsa_user_sgpr_kernarg_segment_ptr 1
  .amdhsa_system_sgpr_workgroup_id_x 1
.end_amdhsa_kernel
```
